```python
import torch

def _softmax(x, axis=-1):
    return torch.softmax(x, dim=axis)

def _gelu(x):
    return torch.nn.functional.gelu(x, approximate='tanh')

def _silu(x):
    return torch.nn.functional.silu(x)

def _sigmoid(x):
    return torch.sigmoid(x)

def _layernorm(x, axis=-1, eps=1e-05):
    m = x.mean(dim=axis, keepdim=True)
    v = x.var(dim=axis, keepdim=True, unbiased=False)
    return (x - m) / torch.sqrt(v + eps)

def _scatter_add(tgt, idx, src, axis=0):
    return tgt.clone().index_add_(axis, idx, src)

def _segment_sum(src, seg, n):
    out = torch.zeros((n,) + src.shape[1:], dtype=src.dtype)
    return out.index_add_(0, seg, src)

def _pad(x, pw):
    flat = tuple((v for pair in reversed(pw) for v in pair))
    return torch.nn.functional.pad(x, flat)
kernel_name = 'adaLN_cond__softmax_full_mha__mixer_gmlp__prompt'

def setup_inputs():

    _w = lambda a: (lambda t: t.to(torch.bfloat16) if t.is_floating_point() else t)(torch.as_tensor(a))

    def _A_setup():
        B, S, D = (1, 2048, 576)
        return {'x': _w((lambda *s: torch.randn(*s, dtype=torch.bfloat16) * 0.05)(B, S, D)), 'wqkv': _w((lambda *s: torch.randn(*s, dtype=torch.bfloat16) * 0.05)(D, 3 * D)), 'wo': _w((lambda *s: torch.randn(*s, dtype=torch.bfloat16) * 0.05)(D, D))}
    _A_in = _A_setup()

    def _B_setup():
        B, S, D, F = (1, 2048, 576, 4608)
        Fh = F // 2
        return {'x': _w((lambda *s: torch.randn(*s, dtype=torch.bfloat16) * 0.05)(B, S, D)), 'w_in': _w((lambda *s: torch.randn(*s, dtype=torch.bfloat16) * 0.4)(D, 2 * Fh)), 'w_sp': _w(0.01 * (lambda *s: torch.randn(*s, dtype=torch.bfloat16) * 0.4)(S, S)), 'b_sp': _w(1.0 + 0.01 * (lambda *s: torch.randn(*s, dtype=torch.bfloat16) * 0.05)(S)), 'w_out': _w((lambda *s: torch.randn(*s, dtype=torch.bfloat16) * 0.05)(Fh, D))}
    _B_in = _B_setup()
    return {'A_x': _A_in['x'], 'A_wqkv': _A_in['wqkv'], 'A_wo': _A_in['wo'], 'B_x': _B_in['x'], 'B_w_in': _B_in['w_in'], 'B_w_sp': _B_in['w_sp'], 'B_b_sp': _B_in['b_sp'], 'B_w_out': _B_in['w_out'], 'c': _w((lambda *s: torch.randn(*s, dtype=torch.bfloat16) * 0.1)(1, 576) * 8.0), 'w_mod': _w((lambda *s: torch.randn(*s, dtype=torch.bfloat16) * 0.1)(576, 6 * 576) * 576 ** (-0.5) * 8.0)}

def reference(A_x, A_wqkv, A_wo, B_x, B_w_in, B_w_sp, B_b_sp, B_w_out, c, w_mod):

    def _A_ref(x, wqkv, wo):
        B, S, D = x.shape
        H = 32
        Dh = D // H
        qkv = (lambda x, *d: x.permute(*d))((x @ wqkv).reshape(B, S, 3, H, Dh), 2, 0, 3, 1, 4)
        q, k, v = (qkv[0], qkv[1], qkv[2])
        scale = Dh ** (-0.5)
        scores = torch.einsum('bhqd,bhkd->bhqk', q, k) * scale
        p = _softmax(scores, axis=-1)
        o = torch.einsum('bhqk,bhkd->bhqd', p, v)
        return (lambda x, *d: x.permute(*d))(o, 0, 2, 1, 3).reshape(B, S, D) @ wo

    def _B_ref(x, w_in, w_sp, b_sp, w_out):
        B, S, D = x.shape
        F = w_in.shape[-1]
        Fh = F // 2
        z = _gelu(torch.einsum('bsd,df->bsf', x, w_in))
        z1 = z[..., :Fh].clone()
        z2 = _layernorm(z[..., Fh:], axis=-1)
        g = torch.einsum('ts,bsf->btf', w_sp, z2) + b_sp[None, :, None]
        return torch.einsum('bsf,fd->bsd', z1 * g, w_out)
    x = A_x
    mod = (_silu(c) @ w_mod).reshape(c.shape[0], 6, 1, -1)
    sa, ca, ga, sb, cb, gb = (mod[:, 0].clone(), mod[:, 1].clone(), mod[:, 2].clone(), mod[:, 3].clone(), mod[:, 4].clone(), mod[:, 5].clone())
    h = _layernorm(x, axis=-1) * (1 + ca) + sa
    x = x + ga * _A_ref(h, A_wqkv, A_wo)
    h = _layernorm(x, axis=-1) * (1 + cb) + sb
    x = x + gb * _B_ref(h, B_w_in, B_w_sp, B_b_sp, B_w_out)
    return x
```

```asm
; @launch grid=(256,1,1) block=(512,1,1) lds=160768
.amdgcn_target "amdgcn-amd-amdhsa--gfx950"
.text
.globl adaLN_cond__softmax_full_mha__mixer_gmlp__prompt_kernel
.p2align 8
.type adaLN_cond__softmax_full_mha__mixer_gmlp__prompt_kernel,@function
adaLN_cond__softmax_full_mha__mixer_gmlp__prompt_kernel:
  s_cmp_ge_u32 s2, 256
  s_cbranch_scc1 L_k3_exit
  s_load_dwordx2 s[36:37], s[0:1], 88
  s_load_dwordx2 s[4:5], s[0:1], 0
  s_load_dwordx4 s[8:11], s[0:1], 64
  s_load_dwordx2 s[6:7], s[0:1], 96
  s_getpc_b64 s[16:17]
L_k1_pc:
  s_mov_b32 s18, L_code_end - L_k1_pc
  s_mov_b32 s19, 0x20000
  s_lshr_b32 s20, s2, 3
  s_mul_i32 s20, s20, 3072
  v_lshlrev_b32 v1, 4, v0
  v_add_u32 v2, 64, v0
  v_lshrrev_b32 v2, 8, v2
  v_lshl_or_b32 v1, v2, 24, v1
  buffer_load_dwordx4 v[244:247], v1, s[16:19], s20 offen
  s_and_b32 s13, s2, 1
  s_lshl_b32 s13, s13, 3
  s_bfe_u32 s14, s2, 0x30003
  s_add_u32 s33, s13, s14
  s_bfe_u32 s13, s2, 0x20001
  s_lshl_b32 s13, s13, 2
  s_lshr_b32 s14, s2, 6
  s_add_u32 s34, s13, s14
  s_lshl_b32 s35, s34, 4
  s_add_u32 s35, s35, s33
  s_mov_b32 s38, 0
  v_lshrrev_b32 v1, 6, v0
  v_and_b32 v0, 63, v0
  v_readfirstlane_b32 s12, v1
  v_mov_b32 v2, 0
  v_mov_b32 v3, 136192
  ds_write_b32 v3, v2 offset:3072
  v_mov_b32 v251, 160000
  v_mov_b32 v3, 0
  ds_write_b64 v251, v[2:3]
  ds_write_b64 v251, v[2:3] offset:8
  ds_write_b32 v251, v2 offset:16
  s_waitcnt lgkmcnt(0)
  s_mov_b32 s40, s36
  s_mov_b32 s41, s37
  s_mov_b32 s42, 0x100
  s_mov_b32 s43, 0x20000
  s_add_u32 s44, s6, 0x2148000
  s_addc_u32 s45, s7, 0
  s_mov_b32 s46, 0x10000
  s_mov_b32 s47, 0x20000
  s_lshl_b32 s13, s2, 3
  s_add_u32 s13, s13, s12
  s_and_b32 s13, s13, 0x7c7
  s_cmp_eq_u32 s13, 0x7c7
  s_cbranch_scc0 L_k1_noclr
  s_and_b32 s15, s2, 7
  s_add_u32 s20, s6, 0x924000
  s_addc_u32 s21, s7, 0
  s_mov_b32 s22, 0xd800
  s_mov_b32 s23, 0x20000
  v_lshlrev_b32 v1, 4, v0
  v_mov_b32 v4, 0
  v_mov_b32 v8, -1
  v_mov_b32 v5, 0
  v_mov_b32 v9, -1
  v_mov_b32 v6, 0
  v_mov_b32 v10, -1
  v_mov_b32 v7, 0
  v_mov_b32 v11, -1
  s_mul_i32 s13, s15, 5120
  buffer_store_dwordx4 v[4:7], v1, s[44:47], s13 offen offset:0 sc1
  buffer_store_dwordx4 v[4:7], v1, s[44:47], s13 offen offset:1024 sc1
  buffer_store_dwordx4 v[4:7], v1, s[44:47], s13 offen offset:2048 sc1
  buffer_store_dwordx4 v[4:7], v1, s[44:47], s13 offen offset:3072 sc1
  s_add_u32 s13, s13, 4096
  buffer_store_dwordx4 v[4:7], v1, s[44:47], s13 offen offset:0 sc1
  s_lshr_b32 s13, s15, 1
  s_mul_i32 s13, s13, 13824
  s_and_b32 s14, s15, 1
  s_mul_i32 s14, s14, 2304
  s_add_u32 s13, s13, s14
  buffer_store_dwordx4 v[8:11], v1, s[20:23], s13 offen offset:0 sc1
  buffer_store_dwordx4 v[8:11], v1, s[20:23], s13 offen offset:1024 sc1
  s_bfm_b64 exec, 16, 0
  buffer_store_dwordx4 v[8:11], v1, s[20:23], s13 offen offset:2048 sc1
  s_mov_b64 exec, -1
L_k1_noclr:
  s_barrier
  s_cmp_eq_u32 s12, 7
  s_cbranch_scc0 L_k1_work
L_k1_code:
  s_cmp_lt_u32 s2, 248
  s_cbranch_scc1 L_k1_noinit
  v_lshlrev_b32 v1, 20, v0
  v_mov_b32 v2, 1
  s_lshl_b32 s13, s15, 2
  s_waitcnt vmcnt(0)
  buffer_store_dword v2, v1, s[40:43], s13 offen sc1
L_k1_noinit:
  s_lshr_b32 s13, s2, 3
  v_lshlrev_b32 v1, 4, v0
  s_branch L_k1_join
L_k1_work:
  s_cmp_ge_u32 s12, 4
  s_cbranch_scc1 L_k1_repack
  s_cmp_eq_u32 s12, 0
  s_cbranch_scc0 L_k1_gemv
  v_lshrrev_b32 v1, 3, v0
  v_and_b32 v2, 7, v0
  s_lshl_b32 s13, s35, 3
  v_add_u32 v3, s13, v1
  v_mul_u32_u24 v3, 1152, v3
  v_lshl_add_u32 v3, v2, 4, v3
  s_waitcnt lgkmcnt(0)
  s_mov_b32 s16, s4
  s_mov_b32 s17, s5
  s_mov_b32 s18, 0x240000
  s_mov_b32 s19, 0x20000
  s_add_u32 s20, s6, 0x6e0000
  s_addc_u32 s21, s7, 0
  s_mov_b32 s22, 0x240000
  s_mov_b32 s23, 0x20000
  buffer_load_dwordx4 v[8:11], v3, s[16:19], 0 offen offset:0
  buffer_load_dwordx4 v[12:15], v3, s[16:19], 0 offen offset:128
  buffer_load_dwordx4 v[16:19], v3, s[16:19], 0 offen offset:256
  buffer_load_dwordx4 v[20:23], v3, s[16:19], 0 offen offset:384
  buffer_load_dwordx4 v[24:27], v3, s[16:19], 0 offen offset:512
  buffer_load_dwordx4 v[28:31], v3, s[16:19], 0 offen offset:640
  buffer_load_dwordx4 v[32:35], v3, s[16:19], 0 offen offset:768
  buffer_load_dwordx4 v[36:39], v3, s[16:19], 0 offen offset:896
  buffer_load_dwordx4 v[40:43], v3, s[16:19], 0 offen offset:1024
  s_add_u32 s24, s6, 0x2106000
  s_addc_u32 s25, s7, 0
  s_mov_b32 s26, 0x40000
  s_mov_b32 s27, 0x20000
  v_mov_b32 v120, -1
  v_mov_b32 v121, -1
  v_mov_b32 v122, -1
  v_mov_b32 v123, -1
  v_lshlrev_b32 v5, 4, v0
  s_lshl_b32 s14, s2, 10
  buffer_store_dwordx4 v[120:123], v5, s[24:27], s14 offen sc1
  s_lshr_b32 s13, s35, 1
  s_mul_i32 s13, s13, 18432
  s_and_b32 s14, s35, 1
  s_lshl_b32 s14, s14, 7
  s_add_u32 s13, s13, s14
  v_lshlrev_b32 v4, 8, v2
  v_lshl_add_u32 v4, v1, 4, v4
  v_add_u32 v4, s13, v4
  s_waitcnt vmcnt(9)
  v_lshlrev_b32 v48, 16, v8
  v_and_b32 v49, 0xffff0000, v8
  v_lshlrev_b32 v50, 16, v9
  v_and_b32 v51, 0xffff0000, v9
  v_lshlrev_b32 v52, 16, v10
  v_and_b32 v53, 0xffff0000, v10
  v_lshlrev_b32 v54, 16, v11
  v_and_b32 v55, 0xffff0000, v11
  s_waitcnt vmcnt(8)
  v_lshlrev_b32 v56, 16, v12
  v_and_b32 v57, 0xffff0000, v12
  v_lshlrev_b32 v58, 16, v13
  v_and_b32 v59, 0xffff0000, v13
  v_lshlrev_b32 v60, 16, v14
  v_and_b32 v61, 0xffff0000, v14
  v_lshlrev_b32 v62, 16, v15
  v_and_b32 v63, 0xffff0000, v15
  s_waitcnt vmcnt(7)
  v_lshlrev_b32 v64, 16, v16
  v_and_b32 v65, 0xffff0000, v16
  v_lshlrev_b32 v66, 16, v17
  v_and_b32 v67, 0xffff0000, v17
  v_lshlrev_b32 v68, 16, v18
  v_and_b32 v69, 0xffff0000, v18
  v_lshlrev_b32 v70, 16, v19
  v_and_b32 v71, 0xffff0000, v19
  s_waitcnt vmcnt(6)
  v_lshlrev_b32 v72, 16, v20
  v_and_b32 v73, 0xffff0000, v20
  v_lshlrev_b32 v74, 16, v21
  v_and_b32 v75, 0xffff0000, v21
  v_lshlrev_b32 v76, 16, v22
  v_and_b32 v77, 0xffff0000, v22
  v_lshlrev_b32 v78, 16, v23
  v_and_b32 v79, 0xffff0000, v23
  s_waitcnt vmcnt(5)
  v_lshlrev_b32 v80, 16, v24
  v_and_b32 v81, 0xffff0000, v24
  v_lshlrev_b32 v82, 16, v25
  v_and_b32 v83, 0xffff0000, v25
  v_lshlrev_b32 v84, 16, v26
  v_and_b32 v85, 0xffff0000, v26
  v_lshlrev_b32 v86, 16, v27
  v_and_b32 v87, 0xffff0000, v27
  s_waitcnt vmcnt(4)
  v_lshlrev_b32 v88, 16, v28
  v_and_b32 v89, 0xffff0000, v28
  v_lshlrev_b32 v90, 16, v29
  v_and_b32 v91, 0xffff0000, v29
  v_lshlrev_b32 v92, 16, v30
  v_and_b32 v93, 0xffff0000, v30
  v_lshlrev_b32 v94, 16, v31
  v_and_b32 v95, 0xffff0000, v31
  s_waitcnt vmcnt(3)
  v_lshlrev_b32 v96, 16, v32
  v_and_b32 v97, 0xffff0000, v32
  v_lshlrev_b32 v98, 16, v33
  v_and_b32 v99, 0xffff0000, v33
  v_lshlrev_b32 v100, 16, v34
  v_and_b32 v101, 0xffff0000, v34
  v_lshlrev_b32 v102, 16, v35
  v_and_b32 v103, 0xffff0000, v35
  s_waitcnt vmcnt(2)
  v_lshlrev_b32 v104, 16, v36
  v_and_b32 v105, 0xffff0000, v36
  v_lshlrev_b32 v106, 16, v37
  v_and_b32 v107, 0xffff0000, v37
  v_lshlrev_b32 v108, 16, v38
  v_and_b32 v109, 0xffff0000, v38
  v_lshlrev_b32 v110, 16, v39
  v_and_b32 v111, 0xffff0000, v39
  s_waitcnt vmcnt(1)
  v_mov_b32 v5, 1
  s_mov_b64 exec, 1
  ds_add_u32 v251, v5 offset:0
  s_mov_b64 exec, -1
  v_lshlrev_b32 v112, 16, v40
  v_and_b32 v113, 0xffff0000, v40
  v_lshlrev_b32 v114, 16, v41
  v_and_b32 v115, 0xffff0000, v41
  v_lshlrev_b32 v116, 16, v42
  v_and_b32 v117, 0xffff0000, v42
  v_lshlrev_b32 v118, 16, v43
  v_and_b32 v119, 0xffff0000, v43
  v_pk_add_f32 v[8:9], v[48:49], v[52:53]
  v_pk_add_f32 v[10:11], v[50:51], v[54:55]
  v_pk_add_f32 v[8:9], v[8:9], v[56:57]
  v_pk_add_f32 v[10:11], v[10:11], v[58:59]
  v_pk_add_f32 v[8:9], v[8:9], v[60:61]
  v_pk_add_f32 v[10:11], v[10:11], v[62:63]
  v_pk_add_f32 v[8:9], v[8:9], v[64:65]
  v_pk_add_f32 v[10:11], v[10:11], v[66:67]
  v_pk_add_f32 v[8:9], v[8:9], v[68:69]
  v_pk_add_f32 v[10:11], v[10:11], v[70:71]
  v_pk_add_f32 v[8:9], v[8:9], v[72:73]
  v_pk_add_f32 v[10:11], v[10:11], v[74:75]
  v_pk_add_f32 v[8:9], v[8:9], v[76:77]
  v_pk_add_f32 v[10:11], v[10:11], v[78:79]
  v_pk_add_f32 v[8:9], v[8:9], v[80:81]
  v_pk_add_f32 v[10:11], v[10:11], v[82:83]
  v_pk_add_f32 v[8:9], v[8:9], v[84:85]
  v_pk_add_f32 v[10:11], v[10:11], v[86:87]
  v_pk_add_f32 v[8:9], v[8:9], v[88:89]
  v_pk_add_f32 v[10:11], v[10:11], v[90:91]
  v_pk_add_f32 v[8:9], v[8:9], v[92:93]
  v_pk_add_f32 v[10:11], v[10:11], v[94:95]
  v_pk_add_f32 v[8:9], v[8:9], v[96:97]
  v_pk_add_f32 v[10:11], v[10:11], v[98:99]
  v_pk_add_f32 v[8:9], v[8:9], v[100:101]
  v_pk_add_f32 v[10:11], v[10:11], v[102:103]
  v_pk_add_f32 v[8:9], v[8:9], v[104:105]
  v_pk_add_f32 v[10:11], v[10:11], v[106:107]
  v_pk_add_f32 v[8:9], v[8:9], v[108:109]
  v_pk_add_f32 v[10:11], v[10:11], v[110:111]
  v_pk_add_f32 v[8:9], v[8:9], v[112:113]
  v_pk_add_f32 v[10:11], v[10:11], v[114:115]
  v_pk_add_f32 v[8:9], v[8:9], v[116:117]
  v_pk_add_f32 v[10:11], v[10:11], v[118:119]
  v_pk_add_f32 v[8:9], v[8:9], v[10:11]
  v_add_f32 v6, v8, v9
  s_nop 1
  v_add_f32_dpp v6, v6, v6 quad_perm:[1,0,3,2] row_mask:0xf bank_mask:0xf
  s_nop 1
  v_add_f32_dpp v6, v6, v6 quad_perm:[2,3,0,1] row_mask:0xf bank_mask:0xf
  s_nop 1
  v_add_f32_dpp v6, v6, v6 row_half_mirror row_mask:0xf bank_mask:0xf
  v_mul_f32 v6, 0xbae38e39, v6
  v_pk_add_f32 v[48:49], v[48:49], v[6:7] op_sel_hi:[1,0]
  v_pk_add_f32 v[50:51], v[50:51], v[6:7] op_sel_hi:[1,0]
  v_pk_add_f32 v[52:53], v[52:53], v[6:7] op_sel_hi:[1,0]
  v_pk_add_f32 v[54:55], v[54:55], v[6:7] op_sel_hi:[1,0]
  v_pk_add_f32 v[56:57], v[56:57], v[6:7] op_sel_hi:[1,0]
  v_pk_add_f32 v[58:59], v[58:59], v[6:7] op_sel_hi:[1,0]
  v_pk_add_f32 v[60:61], v[60:61], v[6:7] op_sel_hi:[1,0]
  v_pk_add_f32 v[62:63], v[62:63], v[6:7] op_sel_hi:[1,0]
  v_pk_add_f32 v[64:65], v[64:65], v[6:7] op_sel_hi:[1,0]
  v_pk_add_f32 v[66:67], v[66:67], v[6:7] op_sel_hi:[1,0]
  v_pk_add_f32 v[68:69], v[68:69], v[6:7] op_sel_hi:[1,0]
  v_pk_add_f32 v[70:71], v[70:71], v[6:7] op_sel_hi:[1,0]
  v_pk_add_f32 v[72:73], v[72:73], v[6:7] op_sel_hi:[1,0]
  v_pk_add_f32 v[74:75], v[74:75], v[6:7] op_sel_hi:[1,0]
  v_pk_add_f32 v[76:77], v[76:77], v[6:7] op_sel_hi:[1,0]
  v_pk_add_f32 v[78:79], v[78:79], v[6:7] op_sel_hi:[1,0]
  v_pk_add_f32 v[80:81], v[80:81], v[6:7] op_sel_hi:[1,0]
  v_pk_add_f32 v[82:83], v[82:83], v[6:7] op_sel_hi:[1,0]
  v_pk_add_f32 v[84:85], v[84:85], v[6:7] op_sel_hi:[1,0]
  v_pk_add_f32 v[86:87], v[86:87], v[6:7] op_sel_hi:[1,0]
  v_pk_add_f32 v[88:89], v[88:89], v[6:7] op_sel_hi:[1,0]
  v_pk_add_f32 v[90:91], v[90:91], v[6:7] op_sel_hi:[1,0]
  v_pk_add_f32 v[92:93], v[92:93], v[6:7] op_sel_hi:[1,0]
  v_pk_add_f32 v[94:95], v[94:95], v[6:7] op_sel_hi:[1,0]
  v_pk_add_f32 v[96:97], v[96:97], v[6:7] op_sel_hi:[1,0]
  v_pk_add_f32 v[98:99], v[98:99], v[6:7] op_sel_hi:[1,0]
  v_pk_add_f32 v[100:101], v[100:101], v[6:7] op_sel_hi:[1,0]
  v_pk_add_f32 v[102:103], v[102:103], v[6:7] op_sel_hi:[1,0]
  v_pk_add_f32 v[104:105], v[104:105], v[6:7] op_sel_hi:[1,0]
  v_pk_add_f32 v[106:107], v[106:107], v[6:7] op_sel_hi:[1,0]
  v_pk_add_f32 v[108:109], v[108:109], v[6:7] op_sel_hi:[1,0]
  v_pk_add_f32 v[110:111], v[110:111], v[6:7] op_sel_hi:[1,0]
  v_pk_add_f32 v[112:113], v[112:113], v[6:7] op_sel_hi:[1,0]
  v_pk_add_f32 v[114:115], v[114:115], v[6:7] op_sel_hi:[1,0]
  v_pk_add_f32 v[116:117], v[116:117], v[6:7] op_sel_hi:[1,0]
  v_pk_add_f32 v[118:119], v[118:119], v[6:7] op_sel_hi:[1,0]
  v_pk_mul_f32 v[8:9], v[48:49], v[48:49]
  v_pk_mul_f32 v[10:11], v[50:51], v[50:51]
  v_pk_fma_f32 v[8:9], v[52:53], v[52:53], v[8:9]
  v_pk_fma_f32 v[10:11], v[54:55], v[54:55], v[10:11]
  v_pk_fma_f32 v[8:9], v[56:57], v[56:57], v[8:9]
  v_pk_fma_f32 v[10:11], v[58:59], v[58:59], v[10:11]
  v_pk_fma_f32 v[8:9], v[60:61], v[60:61], v[8:9]
  v_pk_fma_f32 v[10:11], v[62:63], v[62:63], v[10:11]
  v_pk_fma_f32 v[8:9], v[64:65], v[64:65], v[8:9]
  v_pk_fma_f32 v[10:11], v[66:67], v[66:67], v[10:11]
  v_pk_fma_f32 v[8:9], v[68:69], v[68:69], v[8:9]
  v_pk_fma_f32 v[10:11], v[70:71], v[70:71], v[10:11]
  v_pk_fma_f32 v[8:9], v[72:73], v[72:73], v[8:9]
  v_pk_fma_f32 v[10:11], v[74:75], v[74:75], v[10:11]
  v_pk_fma_f32 v[8:9], v[76:77], v[76:77], v[8:9]
  v_pk_fma_f32 v[10:11], v[78:79], v[78:79], v[10:11]
  v_pk_fma_f32 v[8:9], v[80:81], v[80:81], v[8:9]
  v_pk_fma_f32 v[10:11], v[82:83], v[82:83], v[10:11]
  v_pk_fma_f32 v[8:9], v[84:85], v[84:85], v[8:9]
  v_pk_fma_f32 v[10:11], v[86:87], v[86:87], v[10:11]
  v_pk_fma_f32 v[8:9], v[88:89], v[88:89], v[8:9]
  v_pk_fma_f32 v[10:11], v[90:91], v[90:91], v[10:11]
  v_pk_fma_f32 v[8:9], v[92:93], v[92:93], v[8:9]
  v_pk_fma_f32 v[10:11], v[94:95], v[94:95], v[10:11]
  v_pk_fma_f32 v[8:9], v[96:97], v[96:97], v[8:9]
  v_pk_fma_f32 v[10:11], v[98:99], v[98:99], v[10:11]
  v_pk_fma_f32 v[8:9], v[100:101], v[100:101], v[8:9]
  v_pk_fma_f32 v[10:11], v[102:103], v[102:103], v[10:11]
  v_pk_fma_f32 v[8:9], v[104:105], v[104:105], v[8:9]
  v_pk_fma_f32 v[10:11], v[106:107], v[106:107], v[10:11]
  v_pk_fma_f32 v[8:9], v[108:109], v[108:109], v[8:9]
  v_pk_fma_f32 v[10:11], v[110:111], v[110:111], v[10:11]
  v_pk_fma_f32 v[8:9], v[112:113], v[112:113], v[8:9]
  v_pk_fma_f32 v[10:11], v[114:115], v[114:115], v[10:11]
  v_pk_fma_f32 v[8:9], v[116:117], v[116:117], v[8:9]
  v_pk_fma_f32 v[10:11], v[118:119], v[118:119], v[10:11]
  v_pk_add_f32 v[8:9], v[8:9], v[10:11]
  v_add_f32 v7, v8, v9
  s_nop 1
  v_add_f32_dpp v7, v7, v7 quad_perm:[1,0,3,2] row_mask:0xf bank_mask:0xf
  s_nop 1
  v_add_f32_dpp v7, v7, v7 quad_perm:[2,3,0,1] row_mask:0xf bank_mask:0xf
  s_nop 1
  v_add_f32_dpp v7, v7, v7 row_half_mirror row_mask:0xf bank_mask:0xf
  v_mov_b32 v6, 0x3727c5ac
  v_fmac_f32 v6, 0x3ae38e39, v7
  v_rsq_f32 v6, v6
  s_nop 0
  v_pk_mul_f32 v[48:49], v[48:49], v[6:7] op_sel_hi:[1,0]
  v_pk_mul_f32 v[50:51], v[50:51], v[6:7] op_sel_hi:[1,0]
  v_pk_mul_f32 v[52:53], v[52:53], v[6:7] op_sel_hi:[1,0]
  v_pk_mul_f32 v[54:55], v[54:55], v[6:7] op_sel_hi:[1,0]
  v_cvt_pk_f16_f32 v8, v48, v49
  v_cvt_pk_f16_f32 v9, v50, v51
  v_cvt_pk_f16_f32 v10, v52, v53
  v_cvt_pk_f16_f32 v11, v54, v55
  s_mov_b32 s13, 0
  buffer_store_dwordx4 v[8:11], v4, s[20:23], s13 offen sc1
  v_pk_mul_f32 v[56:57], v[56:57], v[6:7] op_sel_hi:[1,0]
  v_pk_mul_f32 v[58:59], v[58:59], v[6:7] op_sel_hi:[1,0]
  v_pk_mul_f32 v[60:61], v[60:61], v[6:7] op_sel_hi:[1,0]
  v_pk_mul_f32 v[62:63], v[62:63], v[6:7] op_sel_hi:[1,0]
  v_cvt_pk_f16_f32 v12, v56, v57
  v_cvt_pk_f16_f32 v13, v58, v59
  v_cvt_pk_f16_f32 v14, v60, v61
  v_cvt_pk_f16_f32 v15, v62, v63
  s_mov_b32 s13, 2048
  buffer_store_dwordx4 v[12:15], v4, s[20:23], s13 offen sc1
  v_pk_mul_f32 v[64:65], v[64:65], v[6:7] op_sel_hi:[1,0]
  v_pk_mul_f32 v[66:67], v[66:67], v[6:7] op_sel_hi:[1,0]
  v_pk_mul_f32 v[68:69], v[68:69], v[6:7] op_sel_hi:[1,0]
  v_pk_mul_f32 v[70:71], v[70:71], v[6:7] op_sel_hi:[1,0]
  v_cvt_pk_f16_f32 v16, v64, v65
  v_cvt_pk_f16_f32 v17, v66, v67
  v_cvt_pk_f16_f32 v18, v68, v69
  v_cvt_pk_f16_f32 v19, v70, v71
  s_mov_b32 s13, 4096
  buffer_store_dwordx4 v[16:19], v4, s[20:23], s13 offen sc1
  v_pk_mul_f32 v[72:73], v[72:73], v[6:7] op_sel_hi:[1,0]
  v_pk_mul_f32 v[74:75], v[74:75], v[6:7] op_sel_hi:[1,0]
  v_pk_mul_f32 v[76:77], v[76:77], v[6:7] op_sel_hi:[1,0]
  v_pk_mul_f32 v[78:79], v[78:79], v[6:7] op_sel_hi:[1,0]
  v_cvt_pk_f16_f32 v20, v72, v73
  v_cvt_pk_f16_f32 v21, v74, v75
  v_cvt_pk_f16_f32 v22, v76, v77
  v_cvt_pk_f16_f32 v23, v78, v79
  s_mov_b32 s13, 6144
  buffer_store_dwordx4 v[20:23], v4, s[20:23], s13 offen sc1
  v_pk_mul_f32 v[80:81], v[80:81], v[6:7] op_sel_hi:[1,0]
  v_pk_mul_f32 v[82:83], v[82:83], v[6:7] op_sel_hi:[1,0]
  v_pk_mul_f32 v[84:85], v[84:85], v[6:7] op_sel_hi:[1,0]
  v_pk_mul_f32 v[86:87], v[86:87], v[6:7] op_sel_hi:[1,0]
  v_cvt_pk_f16_f32 v24, v80, v81
  v_cvt_pk_f16_f32 v25, v82, v83
  v_cvt_pk_f16_f32 v26, v84, v85
  v_cvt_pk_f16_f32 v27, v86, v87
  s_mov_b32 s13, 8192
  buffer_store_dwordx4 v[24:27], v4, s[20:23], s13 offen sc1
  v_pk_mul_f32 v[88:89], v[88:89], v[6:7] op_sel_hi:[1,0]
  v_pk_mul_f32 v[90:91], v[90:91], v[6:7] op_sel_hi:[1,0]
  v_pk_mul_f32 v[92:93], v[92:93], v[6:7] op_sel_hi:[1,0]
  v_pk_mul_f32 v[94:95], v[94:95], v[6:7] op_sel_hi:[1,0]
  v_cvt_pk_f16_f32 v28, v88, v89
  v_cvt_pk_f16_f32 v29, v90, v91
  v_cvt_pk_f16_f32 v30, v92, v93
  v_cvt_pk_f16_f32 v31, v94, v95
  s_mov_b32 s13, 10240
  buffer_store_dwordx4 v[28:31], v4, s[20:23], s13 offen sc1
  v_pk_mul_f32 v[96:97], v[96:97], v[6:7] op_sel_hi:[1,0]
  v_pk_mul_f32 v[98:99], v[98:99], v[6:7] op_sel_hi:[1,0]
  v_pk_mul_f32 v[100:101], v[100:101], v[6:7] op_sel_hi:[1,0]
  v_pk_mul_f32 v[102:103], v[102:103], v[6:7] op_sel_hi:[1,0]
  v_cvt_pk_f16_f32 v32, v96, v97
  v_cvt_pk_f16_f32 v33, v98, v99
  v_cvt_pk_f16_f32 v34, v100, v101
  v_cvt_pk_f16_f32 v35, v102, v103
  s_mov_b32 s13, 12288
  buffer_store_dwordx4 v[32:35], v4, s[20:23], s13 offen sc1
  v_pk_mul_f32 v[104:105], v[104:105], v[6:7] op_sel_hi:[1,0]
  v_pk_mul_f32 v[106:107], v[106:107], v[6:7] op_sel_hi:[1,0]
  v_pk_mul_f32 v[108:109], v[108:109], v[6:7] op_sel_hi:[1,0]
  v_pk_mul_f32 v[110:111], v[110:111], v[6:7] op_sel_hi:[1,0]
  v_cvt_pk_f16_f32 v36, v104, v105
  v_cvt_pk_f16_f32 v37, v106, v107
  v_cvt_pk_f16_f32 v38, v108, v109
  v_cvt_pk_f16_f32 v39, v110, v111
  s_mov_b32 s13, 14336
  buffer_store_dwordx4 v[36:39], v4, s[20:23], s13 offen sc1
  v_pk_mul_f32 v[112:113], v[112:113], v[6:7] op_sel_hi:[1,0]
  v_pk_mul_f32 v[114:115], v[114:115], v[6:7] op_sel_hi:[1,0]
  v_pk_mul_f32 v[116:117], v[116:117], v[6:7] op_sel_hi:[1,0]
  v_pk_mul_f32 v[118:119], v[118:119], v[6:7] op_sel_hi:[1,0]
  v_cvt_pk_f16_f32 v40, v112, v113
  v_cvt_pk_f16_f32 v41, v114, v115
  v_cvt_pk_f16_f32 v42, v116, v117
  v_cvt_pk_f16_f32 v43, v118, v119
  s_mov_b32 s13, 16384
  buffer_store_dwordx4 v[40:43], v4, s[20:23], s13 offen sc1
  s_branch L_k1_exit
L_k1_gemv:
  s_cmp_ge_u32 s2, 216
  s_cbranch_scc1 L_k1_exit
  s_lshr_b32 s13, s2, 2
  s_and_b32 s26, s2, 3
  s_sub_u32 s14, s12, 1
  s_mul_i32 s15, s14, 48
  s_mul_i32 s27, s26, 144
  s_add_u32 s15, s15, s27
  v_lshrrev_b32 v1, 3, v0
  v_add_u32 v1, s15, v1
  v_lshlrev_b32 v2, 1, v1
  v_mul_u32_u24 v3, 6912, v1
  v_and_b32 v4, 7, v0
  v_lshl_add_u32 v3, v4, 4, v3
  s_lshl_b32 s15, s13, 7
  v_add_u32 v3, s15, v3
  s_mul_i32 s30, s26, 13824
  s_waitcnt lgkmcnt(0)
  s_mov_b32 s16, s8
  s_mov_b32 s17, s9
  s_mov_b32 s18, 0x480
  s_mov_b32 s19, 0x20000
  s_mov_b32 s20, s10
  s_mov_b32 s21, s11
  s_mov_b32 s22, 0x3cc000
  s_mov_b32 s23, 0x20000
  s_add_u32 s24, s6, 0x924000
  s_addc_u32 s25, s7, 0
  s_mov_b32 s26, 0xd800
  s_mov_b32 s27, 0x20000
  s_cmp_lt_u32 s2, 72
  s_cbranch_scc1 L_k1_go1
  s_mov_b32 s49, 0x400000
L_k1_w1:
  ds_read_b32 v5, v251 offset:0
  s_waitcnt lgkmcnt(0)
  v_readfirstlane_b32 s48, v5
  s_nop 0
  s_cmp_ge_u32 s48, 1
  s_cbranch_scc1 L_k1_w1_ok
  s_sub_u32 s49, s49, 1
  s_cbranch_scc1 L_k1_w1_ok
  s_sleep 4
  s_branch L_k1_w1
L_k1_w1_ok:
L_k1_go1:
  buffer_load_ushort v8, v2, s[16:19], 0 offen offset:0
  buffer_load_ushort v9, v2, s[16:19], 0 offen offset:16
  buffer_load_ushort v10, v2, s[16:19], 0 offen offset:32
  buffer_load_ushort v11, v2, s[16:19], 0 offen offset:48
  buffer_load_ushort v12, v2, s[16:19], 0 offen offset:64
  buffer_load_ushort v13, v2, s[16:19], 0 offen offset:80
  s_mov_b32 s15, 0
  buffer_load_dwordx4 v[16:19], v3, s[20:23], s15 offen
  s_mov_b32 s15, 55296
  buffer_load_dwordx4 v[20:23], v3, s[20:23], s15 offen
  s_mov_b32 s15, 110592
  buffer_load_dwordx4 v[24:27], v3, s[20:23], s15 offen
  s_mov_b32 s15, 165888
  buffer_load_dwordx4 v[28:31], v3, s[20:23], s15 offen
  s_mov_b32 s15, 221184
  buffer_load_dwordx4 v[32:35], v3, s[20:23], s15 offen
  s_mov_b32 s15, 276480
  buffer_load_dwordx4 v[36:39], v3, s[20:23], s15 offen
  s_waitcnt vmcnt(6)
  v_lshlrev_b32 v8, 16, v8
  v_lshlrev_b32 v9, 16, v9
  v_lshlrev_b32 v10, 16, v10
  v_lshlrev_b32 v11, 16, v11
  v_lshlrev_b32 v12, 16, v12
  v_lshlrev_b32 v13, 16, v13
  v_mul_f32 v48, 0xbfb8aa3b, v8
  v_mul_f32 v49, 0xbfb8aa3b, v9
  v_mul_f32 v50, 0xbfb8aa3b, v10
  v_mul_f32 v51, 0xbfb8aa3b, v11
  v_mul_f32 v52, 0xbfb8aa3b, v12
  v_mul_f32 v53, 0xbfb8aa3b, v13
  v_exp_f32 v48, v48
  v_exp_f32 v49, v49
  v_exp_f32 v50, v50
  v_exp_f32 v51, v51
  v_exp_f32 v52, v52
  v_exp_f32 v53, v53
  v_add_f32 v48, 1.0, v48
  v_add_f32 v49, 1.0, v49
  v_add_f32 v50, 1.0, v50
  v_add_f32 v51, 1.0, v51
  v_add_f32 v52, 1.0, v52
  v_add_f32 v53, 1.0, v53
  v_rcp_f32 v48, v48
  v_rcp_f32 v49, v49
  v_rcp_f32 v50, v50
  v_rcp_f32 v51, v51
  v_rcp_f32 v52, v52
  v_rcp_f32 v53, v53
  v_mul_f32 v8, v8, v48
  v_mul_f32 v9, v9, v49
  v_mul_f32 v10, v10, v50
  v_mul_f32 v11, v11, v51
  v_mul_f32 v12, v12, v52
  v_mul_f32 v13, v13, v53
  v_cvt_pk_bf16_f32 v8, v8, v8
  v_cvt_pk_bf16_f32 v9, v9, v9
  v_cvt_pk_bf16_f32 v10, v10, v10
  v_cvt_pk_bf16_f32 v11, v11, v11
  v_cvt_pk_bf16_f32 v12, v12, v12
  v_cvt_pk_bf16_f32 v13, v13, v13
  v_lshlrev_b32 v8, 16, v8
  v_lshlrev_b32 v9, 16, v9
  v_lshlrev_b32 v10, 16, v10
  v_lshlrev_b32 v11, 16, v11
  v_lshlrev_b32 v12, 16, v12
  v_lshlrev_b32 v13, 16, v13
  s_waitcnt vmcnt(5)
  v_lshlrev_b32 v48, 16, v16
  v_and_b32 v49, 0xffff0000, v16
  v_lshlrev_b32 v50, 16, v17
  v_and_b32 v51, 0xffff0000, v17
  v_lshlrev_b32 v52, 16, v18
  v_and_b32 v53, 0xffff0000, v18
  v_lshlrev_b32 v54, 16, v19
  v_and_b32 v55, 0xffff0000, v19
  v_mul_f32 v40, v8, v48
  v_mul_f32 v41, v8, v49
  v_mul_f32 v42, v8, v50
  v_mul_f32 v43, v8, v51
  v_mul_f32 v44, v8, v52
  v_mul_f32 v45, v8, v53
  v_mul_f32 v46, v8, v54
  v_mul_f32 v47, v8, v55
  s_waitcnt vmcnt(4)
  v_lshlrev_b32 v48, 16, v20
  v_and_b32 v49, 0xffff0000, v20
  v_lshlrev_b32 v50, 16, v21
  v_and_b32 v51, 0xffff0000, v21
  v_lshlrev_b32 v52, 16, v22
  v_and_b32 v53, 0xffff0000, v22
  v_lshlrev_b32 v54, 16, v23
  v_and_b32 v55, 0xffff0000, v23
  v_fmac_f32 v40, v9, v48
  v_fmac_f32 v41, v9, v49
  v_fmac_f32 v42, v9, v50
  v_fmac_f32 v43, v9, v51
  v_fmac_f32 v44, v9, v52
  v_fmac_f32 v45, v9, v53
  v_fmac_f32 v46, v9, v54
  v_fmac_f32 v47, v9, v55
  s_waitcnt vmcnt(3)
  v_lshlrev_b32 v48, 16, v24
  v_and_b32 v49, 0xffff0000, v24
  v_lshlrev_b32 v50, 16, v25
  v_and_b32 v51, 0xffff0000, v25
  v_lshlrev_b32 v52, 16, v26
  v_and_b32 v53, 0xffff0000, v26
  v_lshlrev_b32 v54, 16, v27
  v_and_b32 v55, 0xffff0000, v27
  v_fmac_f32 v40, v10, v48
  v_fmac_f32 v41, v10, v49
  v_fmac_f32 v42, v10, v50
  v_fmac_f32 v43, v10, v51
  v_fmac_f32 v44, v10, v52
  v_fmac_f32 v45, v10, v53
  v_fmac_f32 v46, v10, v54
  v_fmac_f32 v47, v10, v55
  s_waitcnt vmcnt(2)
  v_lshlrev_b32 v48, 16, v28
  v_and_b32 v49, 0xffff0000, v28
  v_lshlrev_b32 v50, 16, v29
  v_and_b32 v51, 0xffff0000, v29
  v_lshlrev_b32 v52, 16, v30
  v_and_b32 v53, 0xffff0000, v30
  v_lshlrev_b32 v54, 16, v31
  v_and_b32 v55, 0xffff0000, v31
  v_fmac_f32 v40, v11, v48
  v_fmac_f32 v41, v11, v49
  v_fmac_f32 v42, v11, v50
  v_fmac_f32 v43, v11, v51
  v_fmac_f32 v44, v11, v52
  v_fmac_f32 v45, v11, v53
  v_fmac_f32 v46, v11, v54
  v_fmac_f32 v47, v11, v55
  s_waitcnt vmcnt(1)
  v_lshlrev_b32 v48, 16, v32
  v_and_b32 v49, 0xffff0000, v32
  v_lshlrev_b32 v50, 16, v33
  v_and_b32 v51, 0xffff0000, v33
  v_lshlrev_b32 v52, 16, v34
  v_and_b32 v53, 0xffff0000, v34
  v_lshlrev_b32 v54, 16, v35
  v_and_b32 v55, 0xffff0000, v35
  v_fmac_f32 v40, v12, v48
  v_fmac_f32 v41, v12, v49
  v_fmac_f32 v42, v12, v50
  v_fmac_f32 v43, v12, v51
  v_fmac_f32 v44, v12, v52
  v_fmac_f32 v45, v12, v53
  v_fmac_f32 v46, v12, v54
  v_fmac_f32 v47, v12, v55
  s_waitcnt vmcnt(0)
  v_lshlrev_b32 v48, 16, v36
  v_and_b32 v49, 0xffff0000, v36
  v_lshlrev_b32 v50, 16, v37
  v_and_b32 v51, 0xffff0000, v37
  v_lshlrev_b32 v52, 16, v38
  v_and_b32 v53, 0xffff0000, v38
  v_lshlrev_b32 v54, 16, v39
  v_and_b32 v55, 0xffff0000, v39
  v_fmac_f32 v40, v13, v48
  v_fmac_f32 v41, v13, v49
  v_fmac_f32 v42, v13, v50
  v_fmac_f32 v43, v13, v51
  v_fmac_f32 v44, v13, v52
  v_fmac_f32 v45, v13, v53
  v_fmac_f32 v46, v13, v54
  v_fmac_f32 v47, v13, v55
  v_and_b32 v63, 7, v0
  v_lshlrev_b32 v63, 2, v63
  buffer_load_dword v62, v63, s[40:43], 0 offen sc1
  v_add_f32_dpp v40, v40, v40 row_ror:8 row_mask:0xf bank_mask:0xf
  v_add_f32_dpp v41, v41, v41 row_ror:8 row_mask:0xf bank_mask:0xf
  v_add_f32_dpp v42, v42, v42 row_ror:8 row_mask:0xf bank_mask:0xf
  v_add_f32_dpp v43, v43, v43 row_ror:8 row_mask:0xf bank_mask:0xf
  v_add_f32_dpp v44, v44, v44 row_ror:8 row_mask:0xf bank_mask:0xf
  v_add_f32_dpp v45, v45, v45 row_ror:8 row_mask:0xf bank_mask:0xf
  v_add_f32_dpp v46, v46, v46 row_ror:8 row_mask:0xf bank_mask:0xf
  v_add_f32_dpp v47, v47, v47 row_ror:8 row_mask:0xf bank_mask:0xf
  v_and_b32 v1, 15, v0
  v_lshrrev_b32 v2, 4, v0
  v_lshlrev_b32 v2, 8, v2
  v_lshl_add_u32 v2, v1, 5, v2
  s_lshl_b32 s15, s14, 10
  s_add_u32 s15, s15, 136192
  v_add_u32 v2, s15, v2
  v_cmp_gt_u32 vcc, 8, v1
  s_nop 0
  s_and_saveexec_b64 s[28:29], vcc
  ds_write_b128 v2, v[40:43]
  ds_write_b128 v2, v[44:47] offset:16
  s_mov_b64 exec, s[28:29]
  v_mov_b32 v1, 136192
  v_mov_b32 v2, 1
  s_mov_b64 exec, 1
  ds_add_rtn_u32 v2, v1, v2 offset:3072
  s_mov_b64 exec, -1
  s_waitcnt lgkmcnt(0)
  v_readfirstlane_b32 s28, v2
  s_nop 0
  s_cmp_eq_u32 s28, 2
  s_cbranch_scc0 L_k1_exit
  v_lshl_add_u32 v2, v0, 2, v1
  ds_read_b32 v16, v2 offset:0
  ds_read_b32 v17, v2 offset:256
  ds_read_b32 v18, v2 offset:512
  ds_read_b32 v19, v2 offset:768
  ds_read_b32 v20, v2 offset:1024
  ds_read_b32 v21, v2 offset:1280
  ds_read_b32 v22, v2 offset:1536
  ds_read_b32 v23, v2 offset:1792
  ds_read_b32 v24, v2 offset:2048
  ds_read_b32 v25, v2 offset:2304
  ds_read_b32 v26, v2 offset:2560
  ds_read_b32 v27, v2 offset:2816
  s_mul_i32 s15, s13, 7282
  s_lshr_b32 s15, s15, 16
  s_mul_i32 s28, s15, 9
  s_sub_u32 s28, s13, s28
  s_lshl_b32 s28, s28, 6
  v_add_u32 v3, s28, v0
  s_mul_i32 s28, s15, 2304
  v_lshl_add_u32 v5, v3, 2, s28
  v_lshrrev_b32 v4, 3, v3
  v_and_b32 v3, 7, v3
  v_lshlrev_b32 v3, 2, v3
  v_lshl_add_u32 v3, v4, 6, v3
  s_xor_b32 s28, s15, 1
  s_lshl_b32 s28, s28, 5
  v_add_u32 v3, s28, v3
  s_cmp_ge_u32 s15, 2
  s_cselect_b64 vcc, -1, 0
  v_cndmask_b32 v3, v3, v5, vcc
  s_waitcnt lgkmcnt(0)
  v_pk_add_f32 v[16:17], v[16:17], v[22:23]
  v_pk_add_f32 v[18:19], v[18:19], v[24:25]
  v_pk_add_f32 v[20:21], v[20:21], v[26:27]
  v_pk_add_f32 v[16:17], v[16:17], v[18:19]
  v_pk_add_f32 v[16:17], v[16:17], v[20:21]
  v_add_f32 v16, v16, v17
  s_mov_b32 s39, 0x40000
L_k1_fg:
  s_waitcnt vmcnt(0)
  v_cmp_eq_u32 vcc, 0, v62
  s_nop 1
  s_cbranch_vccz L_k1_fg_ok
  s_sub_u32 s39, s39, 1
  s_cbranch_scc1 L_k1_fg_ok
  s_sleep 2
  v_and_b32 v63, 7, v0
  v_lshlrev_b32 v63, 2, v63
  buffer_load_dword v62, v63, s[40:43], 0 offen sc1
  s_branch L_k1_fg
L_k1_fg_ok:
  buffer_store_dword v16, v3, s[24:27], s30 offen sc1
  s_cmp_lt_u32 s2, 72
  s_cbranch_scc1 L_k1_exit
  v_mov_b32 v5, 0
  v_mov_b32 v60, 1
  s_waitcnt vmcnt(0)
  s_mov_b64 exec, 1
L_k1_g2:
  s_mov_b32 s13, 39040
  buffer_atomic_add v60, v5, s[44:47], s13 offen sc1
  s_mov_b64 exec, -1
  s_branch L_k1_join
L_k1_repack:
  s_load_dwordx2 s[28:29], s[0:1], 8
  s_load_dwordx2 s[30:31], s[0:1], 16
  s_mov_b32 s24, 0x05040100
  s_mov_b32 s25, 0x07060302
  s_cmp_eq_u32 s12, 6
  s_cbranch_scc1 L_k1_wo
  s_lshl_b32 s13, s34, 1
  s_add_u32 s13, s13, s12
  s_sub_u32 s13, s13, 4
  s_lshl_b32 s13, s13, 6
  v_add_u32 v1, s13, v0
  v_mul_u32_u24 v2, 607, v1
  v_lshrrev_b32 v2, 14, v2
  v_mul_u32_u24 v6, 27, v2
  v_sub_u32 v6, v1, v6
  v_mov_b32 v7, s33
  v_mul_u32_u24 v5, 29, v6
  v_lshrrev_b32 v5, 8, v5
  v_mul_u32_u24 v8, 9, v5
  v_sub_u32 v8, v6, v8
  v_mul_u32_u24 v3, 144, v5
  v_mad_u32_u24 v3, v7, 9, v3
  v_add_u32 v3, v3, v8
  v_mul_u32_u24 v4, 27648, v2
  v_lshl_add_u32 v4, v3, 3, v4
  s_waitcnt lgkmcnt(0)
  s_mov_b32 s16, s28
  s_mov_b32 s17, s29
  s_mov_b32 s18, 0x1e6000
  s_mov_b32 s19, 0x20000
  s_add_u32 s20, s6, 0x933000
  s_addc_u32 s21, s7, 0
  s_mov_b32 s22, 0x1f8000
  s_mov_b32 s23, 0x20000
  s_mov_b32 s14, 0
  buffer_load_dwordx2 v[16:17], v4, s[16:19], s14 offen
  s_mov_b32 s14, 3456
  buffer_load_dwordx2 v[18:19], v4, s[16:19], s14 offen
  s_mov_b32 s14, 6912
  buffer_load_dwordx2 v[20:21], v4, s[16:19], s14 offen
  s_mov_b32 s14, 10368
  buffer_load_dwordx2 v[22:23], v4, s[16:19], s14 offen
  s_mov_b32 s14, 13824
  buffer_load_dwordx2 v[24:25], v4, s[16:19], s14 offen
  s_mov_b32 s14, 17280
  buffer_load_dwordx2 v[26:27], v4, s[16:19], s14 offen
  s_mov_b32 s14, 20736
  buffer_load_dwordx2 v[28:29], v4, s[16:19], s14 offen
  s_mov_b32 s14, 24192
  buffer_load_dwordx2 v[30:31], v4, s[16:19], s14 offen
  v_lshrrev_b32 v10, 1, v5
  v_lshl_add_u32 v9, v5, 1, v10
  v_lshlrev_b32 v9, 10, v9
  v_lshl_add_u32 v9, v8, 4, v9
  v_add_u32 v10, 944, v9
  v_cmp_le_u32 vcc, 5, v8
  s_nop 1
  v_cndmask_b32 v9, v9, v10, vcc
  v_lshlrev_b32 v10, 4, v5
  v_add_u32 v10, 4096, v10
  v_cmp_eq_u32 vcc, 4, v8
  s_nop 1
  v_cndmask_b32 v9, v9, v10, vcc
  v_mul_u32_u24 v7, 129024, v7
  v_lshrrev_b32 v10, 2, v2
  v_mul_u32_u24 v10, 7168, v10
  v_add3_u32 v9, v9, v7, v10
  v_and_b32 v10, 3, v2
  v_lshl_add_u32 v9, v10, 8, v9
  v_mov_b32 v10, 0x7ff00000
  v_cmp_le_u32 vcc, 72, v2
  s_nop 1
  v_cndmask_b32 v9, v9, v10, vcc
  s_waitcnt vmcnt(0)
  v_perm_b32 v32, v18, v16, s24
  v_perm_b32 v33, v22, v20, s24
  v_perm_b32 v34, v26, v24, s24
  v_perm_b32 v35, v30, v28, s24
  buffer_store_dwordx4 v[32:35], v9, s[20:23], 0 offen offset:0 sc1
  v_perm_b32 v36, v18, v16, s25
  v_perm_b32 v37, v22, v20, s25
  v_perm_b32 v38, v26, v24, s25
  v_perm_b32 v39, v30, v28, s25
  buffer_store_dwordx4 v[36:39], v9, s[20:23], 0 offen offset:64 sc1
  v_perm_b32 v40, v19, v17, s24
  v_perm_b32 v41, v23, v21, s24
  v_perm_b32 v42, v27, v25, s24
  v_perm_b32 v43, v31, v29, s24
  buffer_store_dwordx4 v[40:43], v9, s[20:23], 0 offen offset:128 sc1
  v_perm_b32 v44, v19, v17, s25
  v_perm_b32 v45, v23, v21, s25
  v_perm_b32 v46, v27, v25, s25
  v_perm_b32 v47, v31, v29, s25
  buffer_store_dwordx4 v[44:47], v9, s[20:23], 0 offen offset:192 sc1
  v_and_b32 v5, 7, v0
  v_lshlrev_b32 v5, 2, v5
  buffer_load_dword v4, v5, s[40:43], 0 offen sc1
  s_branch L_k1_exit
L_k1_wo:
  s_cmp_ge_u32 s2, 162
  s_cbranch_scc1 L_k1_exit
  s_lshl_b32 s13, s2, 6
  v_add_u32 v1, s13, v0
  v_lshrrev_b32 v2, 4, v1
  v_mul_u32_u24 v2, 911, v2
  v_lshrrev_b32 v2, 13, v2
  v_mul_u32_u24 v3, 144, v2
  v_sub_u32 v3, v1, v3
  v_lshrrev_b32 v4, 2, v2
  v_and_b32 v5, 3, v2
  v_mul_u32_u24 v6, 36, v4
  v_lshrrev_b32 v7, 1, v5
  v_mad_u32_u24 v6, v7, 20, v6
  v_and_b32 v7, 1, v5
  v_lshl_add_u32 v6, v7, 2, v6
  v_subrev_u32 v7, 64, v2
  v_mul_u32_u24 v7, 72, v7
  v_add_u32 v7, 16, v7
  v_cmp_le_u32 vcc, 64, v2
  s_nop 1
  v_cndmask_b32 v6, v6, v7, vcc
  v_mov_b32 v7, 2304
  v_mov_b32 v8, 9216
  v_mov_b32 v9, 41472
  v_cndmask_b32 v8, v8, v9, vcc
  v_mul_u32_u24 v6, 1152, v6
  v_lshl_add_u32 v48, v3, 3, v6
  v_add_u32 v49, 1152, v48
  v_add_u32 v50, v7, v48
  v_add_u32 v51, v7, v49
  v_add_u32 v52, v8, v48
  v_add_u32 v53, v8, v49
  v_add_u32 v54, v8, v50
  v_add_u32 v55, v8, v51
  s_waitcnt lgkmcnt(0)
  s_mov_b32 s16, s30
  s_mov_b32 s17, s31
  s_mov_b32 s18, 0xa2000
  s_mov_b32 s19, 0x20000
  s_add_u32 s20, s6, 0xb2b000
  s_addc_u32 s21, s7, 0
  s_mov_b32 s22, 0xa2000
  s_mov_b32 s23, 0x20000
  s_mov_b32 s49, 0x400000
L_k1_w2:
  ds_read_b32 v10, v251 offset:0
  s_waitcnt lgkmcnt(0)
  v_readfirstlane_b32 s48, v10
  s_nop 0
  s_cmp_ge_u32 s48, 1
  s_cbranch_scc1 L_k1_w2_ok
  s_sub_u32 s49, s49, 1
  s_cbranch_scc1 L_k1_w2_ok
  s_sleep 4
  s_branch L_k1_w2
L_k1_w2_ok:
  buffer_load_dwordx2 v[16:17], v48, s[16:19], 0 offen
  buffer_load_dwordx2 v[18:19], v49, s[16:19], 0 offen
  buffer_load_dwordx2 v[20:21], v50, s[16:19], 0 offen
  buffer_load_dwordx2 v[22:23], v51, s[16:19], 0 offen
  buffer_load_dwordx2 v[24:25], v52, s[16:19], 0 offen
  buffer_load_dwordx2 v[26:27], v53, s[16:19], 0 offen
  buffer_load_dwordx2 v[28:29], v54, s[16:19], 0 offen
  buffer_load_dwordx2 v[30:31], v55, s[16:19], 0 offen
  v_lshrrev_b32 v6, 3, v3
  v_mul_u32_u24 v6, 86, v6
  v_lshrrev_b32 v6, 8, v6
  v_mul_u32_u24 v7, 24, v6
  v_sub_u32 v7, v3, v7
  v_mul_u32_u24 v6, 110592, v6
  v_mul_u32_u24 v4, 6144, v4
  v_lshrrev_b32 v8, 3, v7
  v_lshlrev_b32 v8, 11, v8
  v_add3_u32 v9, v6, v4, v8
  v_lshl_add_u32 v9, v5, 8, v9
  v_and_b32 v8, 1, v7
  v_lshl_add_u32 v9, v8, 10, v9
  v_bfe_u32 v7, v7, 1, 2
  v_lshl_add_u32 v9, v7, 4, v9
  s_waitcnt vmcnt(0)
  v_perm_b32 v32, v18, v16, s24
  v_perm_b32 v33, v22, v20, s24
  v_perm_b32 v34, v26, v24, s24
  v_perm_b32 v35, v30, v28, s24
  buffer_store_dwordx4 v[32:35], v9, s[20:23], 0 offen offset:0 sc1
  v_perm_b32 v36, v18, v16, s25
  v_perm_b32 v37, v22, v20, s25
  v_perm_b32 v38, v26, v24, s25
  v_perm_b32 v39, v30, v28, s25
  buffer_store_dwordx4 v[36:39], v9, s[20:23], 0 offen offset:64 sc1
  v_perm_b32 v40, v19, v17, s24
  v_perm_b32 v41, v23, v21, s24
  v_perm_b32 v42, v27, v25, s24
  v_perm_b32 v43, v31, v29, s24
  buffer_store_dwordx4 v[40:43], v9, s[20:23], 0 offen offset:128 sc1
  v_perm_b32 v44, v19, v17, s25
  v_perm_b32 v45, v23, v21, s25
  v_perm_b32 v46, v27, v25, s25
  v_perm_b32 v47, v31, v29, s25
  buffer_store_dwordx4 v[44:47], v9, s[20:23], 0 offen offset:192 sc1
L_k1_exit:
  s_waitcnt vmcnt(0)
L_k1_join:
  s_lshl_b32 s13, s34, 7
  s_add_u32 s49, s13, 39168
  s_add_u32 s13, s13, 34816
  s_lshl_b32 s14, s33, 7
  s_add_u32 s14, s14, 36864
  v_mov_b32 v250, s13
  v_writelane_b32 v250, s14, 1
  s_waitcnt lgkmcnt(0)
  s_cmp_eq_u32 s12, 4
  s_cbranch_scc1 L_k1_sig
  s_cmp_eq_u32 s12, 0
  s_cbranch_scc1 L_k1_post
  s_cmp_eq_u32 s12, 5
  s_cbranch_scc0 L_k1_nosig
L_k1_post:
  v_mov_b32 v2, 1
  s_mov_b64 exec, 1
  ds_add_u32 v251, v2 offset:4
  s_mov_b64 exec, -1
  s_branch L_k1_nosig
L_k1_sig:
  s_mov_b32 s39, 0x40000
L_k1_fs:
  s_waitcnt vmcnt(0)
  v_cmp_eq_u32 vcc, 0, v4
  s_nop 1
  s_cbranch_vccz L_k1_fs_ok
  s_sub_u32 s39, s39, 1
  s_cbranch_scc1 L_k1_fs_ok
  s_sleep 2
  v_and_b32 v5, 7, v0
  v_lshlrev_b32 v5, 2, v5
  buffer_load_dword v4, v5, s[40:43], 0 offen sc1
  s_branch L_k1_fs
L_k1_fs_ok:
  s_mov_b32 s51, 0x400000
L_k1_w3:
  ds_read_b32 v2, v251 offset:4
  s_waitcnt lgkmcnt(0)
  v_readfirstlane_b32 s50, v2
  s_nop 0
  s_cmp_ge_u32 s50, 2
  s_cbranch_scc1 L_k1_w3_ok
  s_sub_u32 s51, s51, 1
  s_cbranch_scc1 L_k1_w3_ok
  s_sleep 1
  s_branch L_k1_w3
L_k1_w3_ok:
  v_mov_b32 v2, 1
  s_mov_b64 exec, 3
  buffer_atomic_add v2, v250, s[44:47], 0 offen sc1
  s_mov_b64 exec, -1
  v_mov_b32 v2, 1
  s_mov_b64 exec, 1
  ds_add_u32 v251, v2 offset:12
  s_mov_b64 exec, -1
L_k1_nosig:
  s_lshl_b32 s12, s12, 6
  v_add_u32 v0, s12, v0
  v_lshrrev_b32 v2, 6, v0
  v_and_b32 v1, 63, v0
  v_readfirstlane_b32 s10, v2
  s_and_b32 s13, s2, 1
  s_lshl_b32 s13, s13, 3
  s_bfe_u32 s14, s2, 0x30003
  s_add_u32 s11, s13, s14
  s_bfe_u32 s13, s2, 0x20001
  s_lshl_b32 s13, s13, 2
  s_lshr_b32 s14, s2, 6
  s_add_u32 s12, s13, s14
  s_cmp_ge_u32 s10, 4
  s_cbranch_scc1 L_k2_prod
  s_lshl_b32 s14, s10, 12
  v_lshlrev_b32 v5, 4, v1
  v_add_u32 v10, 16384, v5
  s_add_u32 s15, s14, 0
  v_add_u32 v6, s15, v5
  v_add_u32 v11, 47104, v5
  s_add_u32 s15, s14, 30720
  v_add_u32 v7, s15, v5
  v_add_u32 v12, 77824, v5
  s_add_u32 s15, s14, 61440
  v_add_u32 v8, s15, v5
  v_add_u32 v13, 108544, v5
  s_add_u32 s15, s14, 92160
  v_add_u32 v9, s15, v5
  v_lshrrev_b32 v2, 4, v1
  v_lshlrev_b32 v2, 6, v2
  v_add_u32 v14, 122880, v2
  s_lshl_b32 s15, s10, 11
  s_add_u32 s15, s15, 127488
  v_add_u32 v216, s15, v5
  s_waitcnt lgkmcnt(0)
  s_mov_b32 s16, s6
  s_mov_b32 s17, s7
  s_mov_b32 s18, 0x6e0000
  s_mov_b32 s19, 0x20000
  s_lshl_b32 s14, s12, 2
  s_add_u32 s14, s14, s10
  v_and_b32 v217, 15, v1
  v_lshrrev_b32 v218, 4, v1
  v_lshrrev_b32 v2, 3, v217
  v_and_b32 v3, 7, v217
  v_lshl_add_u32 v2, v2, 4, v3
  v_lshrrev_b32 v3, 1, v218
  v_and_b32 v4, 1, v218
  v_lshlrev_b32 v5, 9, v3
  v_lshl_add_u32 v5, v4, 3, v5
  s_lshl_b32 s15, s11, 17
  s_lshl_b32 s20, s14, 10
  s_add_u32 s15, s15, s20
  v_add_u32 v5, s15, v5
  v_lshl_add_u32 v219, v217, 4, v5
  v_lshl_add_u32 v220, v2, 4, v5
  s_mul_i32 s15, s11, 155648
  s_mul_i32 s20, s14, 1216
  s_add_u32 s15, s15, s20
  s_add_u32 s15, s15, 4718592
  v_and_b32 v3, 3, v217
  v_lshrrev_b32 v4, 2, v217
  v_lshl_add_u32 v5, v3, 2, v4
  v_lshl_add_u32 v3, v218, 4, v5
  v_lshl_add_u32 v225, v3, 4, s15
  v_add_u32 v226, 77824, v225
  v_mov_b32 v224, v5
  v_subrev_u32 v5, 8, v5
  v_and_b32 v3, 1, v5
  v_lshrrev_b32 v4, 1, v5
  v_cmp_le_u32 vcc, 4, v5
  s_nop 1
  v_cndmask_b32 v4, v4, v3, vcc
  v_cndmask_b32 v3, v3, 2, vcc
  v_mul_u32_u24 v4, 77824, v4
  v_lshl_add_u32 v4, v3, 4, v4
  v_mad_u32_u24 v4, v218, 48, v4
  s_add_u32 s15, s15, 1024
  v_add_u32 v227, s15, v4
  v_mov_b32 v4, 0x7ff00000
  v_cmp_le_u32 vcc, 6, v5
  s_nop 1
  v_cndmask_b32 v227, v227, v4, vcc
  s_lshl_b32 s15, s11, 14
  s_lshl_b32 s20, s14, 8
  s_add_u32 s15, s15, s20
  s_add_u32 s20, s15, 4194304
  s_add_u32 s21, s15, 4456448
  v_lshl_add_u32 v221, v217, 3, s20
  v_add_u32 v222, 128, v221
  v_lshl_add_u32 v2, v2, 3, s21
  v_add_u32 v3, 64, v2
  v_cmp_eq_u32 vcc, 1, v218
  s_nop 1
  v_cndmask_b32 v221, v221, v2, vcc
  v_cndmask_b32 v222, v222, v3, vcc
  v_mov_b32 v223, 0x3eae1a93
  v_cndmask_b32 v223, v223, 1.0, vcc
  v_cmp_le_u32 vcc, 2, v218
  s_nop 1
  v_cndmask_b32 v221, v221, v4, vcc
  v_cndmask_b32 v222, v222, v4, vcc
  s_mov_b32 s22, 0x3eae1a93
  s_mov_b32 s23, 65536
  s_mov_b32 s24, 2097152
  s_mov_b32 s25, 2162688
  s_mov_b32 s51, 0x400000
L_k2_cw1:
  ds_read_b32 v2, v251 offset:8
  s_waitcnt lgkmcnt(0)
  v_readfirstlane_b32 s50, v2
  s_nop 0
  s_cmp_ge_u32 s50, 1
  s_cbranch_scc1 L_k2_cw1_ok
  s_sub_u32 s51, s51, 1
  s_cbranch_scc1 L_k2_cw1_ok
  s_sleep 1
  s_branch L_k2_cw1
L_k2_cw1_ok:
L_k2_cgo:
  s_mov_b32 s50, 0x20000
L_k2_gs:
  v_lshlrev_b32 v2, 4, v0
  v_add_u32 v3, 4096, v2
  v_cmp_gt_u32 vcc, 32, v0
  v_mov_b32 v4, 0x7ff00000
  s_nop 0
  v_cndmask_b32 v3, v4, v3, vcc
  s_waitcnt lgkmcnt(0)
  s_add_u32 s28, s6, 0x924000
  s_addc_u32 s29, s7, 0
  s_mov_b32 s30, 0xd800
  s_mov_b32 s31, 0x20000
  s_mov_b32 s26, 0
  buffer_load_dwordx4 v[16:19], v2, s[28:31], s26 offen sc1
  s_mov_b32 s26, 13824
  buffer_load_dwordx4 v[20:23], v2, s[28:31], s26 offen sc1
  s_mov_b32 s26, 27648
  buffer_load_dwordx4 v[24:27], v2, s[28:31], s26 offen sc1
  s_mov_b32 s26, 41472
  buffer_load_dwordx4 v[28:31], v2, s[28:31], s26 offen sc1
  s_mov_b32 s26, 0
  buffer_load_dwordx4 v[32:35], v3, s[28:31], s26 offen sc1
  s_mov_b32 s26, 13824
  buffer_load_dwordx4 v[36:39], v3, s[28:31], s26 offen sc1
  s_mov_b32 s26, 27648
  buffer_load_dwordx4 v[40:43], v3, s[28:31], s26 offen sc1
  s_mov_b32 s26, 41472
  buffer_load_dwordx4 v[44:47], v3, s[28:31], s26 offen sc1
  s_waitcnt vmcnt(0)
  v_max3_u32 v2, v16, v17, v18
  v_max3_u32 v2, v2, v19, v20
  v_max3_u32 v2, v2, v21, v22
  v_max3_u32 v2, v2, v23, v24
  v_max3_u32 v2, v2, v25, v26
  v_max3_u32 v2, v2, v27, v28
  v_max3_u32 v2, v2, v29, v30
  v_max3_u32 v2, v2, v31, v32
  v_max3_u32 v2, v2, v33, v34
  v_max3_u32 v2, v2, v35, v36
  v_max3_u32 v2, v2, v37, v38
  v_max3_u32 v2, v2, v39, v40
  v_max3_u32 v2, v2, v41, v42
  v_max3_u32 v2, v2, v43, v44
  v_max3_u32 v2, v2, v45, v46
  v_max_u32 v2, v2, v47
  v_cmp_eq_u32 vcc, -1, v2
  s_nop 1
  s_cbranch_vccz L_k2_gsok
  s_sub_u32 s50, s50, 1
  s_cbranch_scc1 L_k2_gsok
  s_sleep 4
  s_branch L_k2_gs
L_k2_gsok:
  v_bfe_u32 v4, v0, 1, 1
  v_cvt_f32_u32 v4, v4
  v_sub_f32 v4, 1.0, v4
  v_lshlrev_b32 v2, 4, v0
  v_add_u32 v2, 122880, v2
  v_cmp_gt_u32 vcc, 32, v0
  s_waitcnt vmcnt(4)
  v_pk_add_f32 v[16:17], v[16:17], v[20:21]
  v_pk_add_f32 v[24:25], v[24:25], v[28:29]
  v_pk_add_f32 v[18:19], v[18:19], v[22:23]
  v_pk_add_f32 v[26:27], v[26:27], v[30:31]
  v_pk_add_f32 v[16:17], v[16:17], v[24:25]
  v_pk_add_f32 v[18:19], v[18:19], v[26:27]
  v_cvt_pk_bf16_f32 v20, v16, v17
  v_cvt_pk_bf16_f32 v21, v18, v19
  v_lshlrev_b32 v16, 16, v20
  v_and_b32 v17, 0xffff0000, v20
  v_lshlrev_b32 v18, 16, v21
  v_and_b32 v19, 0xffff0000, v21
  v_add_f32 v16, v16, v4
  v_add_f32 v17, v17, v4
  v_add_f32 v18, v18, v4
  v_add_f32 v19, v19, v4
  v_cvt_pk_bf16_f32 v20, v16, v17
  v_cvt_pk_bf16_f32 v21, v18, v19
  v_lshlrev_b32 v16, 16, v20
  v_and_b32 v17, 0xffff0000, v20
  v_lshlrev_b32 v18, 16, v21
  v_and_b32 v19, 0xffff0000, v21
  ds_write_b128 v2, v[16:19] offset:0
  s_waitcnt vmcnt(0)
  v_pk_add_f32 v[32:33], v[32:33], v[36:37]
  v_pk_add_f32 v[40:41], v[40:41], v[44:45]
  v_pk_add_f32 v[34:35], v[34:35], v[38:39]
  v_pk_add_f32 v[42:43], v[42:43], v[46:47]
  v_pk_add_f32 v[32:33], v[32:33], v[40:41]
  v_pk_add_f32 v[34:35], v[34:35], v[42:43]
  v_cvt_pk_bf16_f32 v36, v32, v33
  v_cvt_pk_bf16_f32 v37, v34, v35
  v_lshlrev_b32 v32, 16, v36
  v_and_b32 v33, 0xffff0000, v36
  v_lshlrev_b32 v34, 16, v37
  v_and_b32 v35, 0xffff0000, v37
  v_add_f32 v32, v32, v4
  v_add_f32 v33, v33, v4
  v_add_f32 v34, v34, v4
  v_add_f32 v35, v35, v4
  v_cvt_pk_bf16_f32 v36, v32, v33
  v_cvt_pk_bf16_f32 v37, v34, v35
  v_lshlrev_b32 v32, 16, v36
  v_and_b32 v33, 0xffff0000, v36
  v_lshlrev_b32 v34, 16, v37
  v_and_b32 v35, 0xffff0000, v37
  s_and_saveexec_b64 s[26:27], vcc
  ds_write_b128 v2, v[32:35] offset:4096
  s_mov_b64 exec, -1
  s_waitcnt lgkmcnt(0)
  s_barrier
  s_waitcnt lgkmcnt(0)
  ds_read_b128 v[152:155], v216 offset:0
  ds_read_b128 v[156:159], v216 offset:1024
  ds_read_b128 v[168:171], v14 offset:0
  ds_read_b128 v[172:175], v14 offset:16
  ds_read_b128 v[178:181], v14 offset:32
  ds_read_b128 v[182:185], v14 offset:48
  ds_read_b128 v[80:83], v10 offset:0
  ds_read_b128 v[84:87], v10 offset:1024
  ds_read_b128 v[88:91], v10 offset:2048
  ds_read_b128 v[92:95], v10 offset:3072
  ds_read_b128 v[96:99], v10 offset:4096
  ds_read_b128 v[100:103], v10 offset:5120
  ds_read_b128 v[104:107], v10 offset:6144
  ds_read_b128 v[160:163], v6 offset:0
  ds_read_b128 v[164:167], v6 offset:2048
  s_waitcnt lgkmcnt(9)
  v_fma_mix_f32 v208, v152, v168, v178 op_sel:[0,0,0] op_sel_hi:[1,0,0]
  v_fma_mix_f32 v209, v152, v169, v179 op_sel:[1,0,0] op_sel_hi:[1,0,0]
  v_fma_mix_f32 v210, v153, v170, v180 op_sel:[0,0,0] op_sel_hi:[1,0,0]
  v_fma_mix_f32 v211, v153, v171, v181 op_sel:[1,0,0] op_sel_hi:[1,0,0]
  v_fma_mix_f32 v212, v154, v172, v182 op_sel:[0,0,0] op_sel_hi:[1,0,0]
  v_fma_mix_f32 v213, v154, v173, v183 op_sel:[1,0,0] op_sel_hi:[1,0,0]
  v_fma_mix_f32 v214, v155, v174, v184 op_sel:[0,0,0] op_sel_hi:[1,0,0]
  v_fma_mix_f32 v215, v155, v175, v185 op_sel:[1,0,0] op_sel_hi:[1,0,0]
  v_cvt_pk_bf16_f32 v136, v208, v209
  v_cvt_pk_bf16_f32 v137, v210, v211
  v_cvt_pk_bf16_f32 v138, v212, v213
  v_cvt_pk_bf16_f32 v139, v214, v215
  v_fma_mix_f32 v208, v156, v168, v178 op_sel:[0,0,0] op_sel_hi:[1,0,0]
  v_fma_mix_f32 v209, v156, v169, v179 op_sel:[1,0,0] op_sel_hi:[1,0,0]
  v_fma_mix_f32 v210, v157, v170, v180 op_sel:[0,0,0] op_sel_hi:[1,0,0]
  v_fma_mix_f32 v211, v157, v171, v181 op_sel:[1,0,0] op_sel_hi:[1,0,0]
  v_fma_mix_f32 v212, v158, v172, v182 op_sel:[0,0,0] op_sel_hi:[1,0,0]
  v_fma_mix_f32 v213, v158, v173, v183 op_sel:[1,0,0] op_sel_hi:[1,0,0]
  v_fma_mix_f32 v214, v159, v174, v184 op_sel:[0,0,0] op_sel_hi:[1,0,0]
  v_fma_mix_f32 v215, v159, v175, v185 op_sel:[1,0,0] op_sel_hi:[1,0,0]
  v_cvt_pk_bf16_f32 v140, v208, v209
  v_cvt_pk_bf16_f32 v141, v210, v211
  v_cvt_pk_bf16_f32 v142, v212, v213
  v_cvt_pk_bf16_f32 v143, v214, v215
  ds_read_b128 v[188:191], v14 offset:256
  ds_read_b128 v[192:195], v14 offset:272
  ds_read_b128 v[198:201], v14 offset:288
  ds_read_b128 v[202:205], v14 offset:304
  s_waitcnt lgkmcnt(0)
  v_mfma_f32_16x16x32_bf16 v[16:19], v[80:83], v[136:139], 0
  ds_read_b128 v[108:111], v10 offset:7168
  ds_read_b128 v[112:115], v10 offset:8192
  v_mfma_f32_16x16x32_bf16 v[20:23], v[80:83], v[140:143], 0
  v_fma_mix_f32 v208, v160, v188, v198 op_sel:[0,0,0] op_sel_hi:[1,0,0]
  v_fma_mix_f32 v209, v160, v189, v199 op_sel:[1,0,0] op_sel_hi:[1,0,0]
  v_fma_mix_f32 v210, v161, v190, v200 op_sel:[0,0,0] op_sel_hi:[1,0,0]
  v_mfma_f32_16x16x32_bf16 v[24:27], v[84:87], v[136:139], 0
  ds_read_b128 v[116:119], v10 offset:9216
  ds_read_b128 v[120:123], v10 offset:10240
  v_mfma_f32_16x16x32_bf16 v[28:31], v[84:87], v[140:143], 0
  v_fma_mix_f32 v211, v161, v191, v201 op_sel:[1,0,0] op_sel_hi:[1,0,0]
  v_fma_mix_f32 v212, v162, v192, v202 op_sel:[0,0,0] op_sel_hi:[1,0,0]
  v_fma_mix_f32 v213, v162, v193, v203 op_sel:[1,0,0] op_sel_hi:[1,0,0]
  v_mfma_f32_16x16x32_bf16 v[32:35], v[88:91], v[136:139], 0
  ds_read_b128 v[124:127], v10 offset:11264
  ds_read_b128 v[128:131], v10 offset:12288
  v_mfma_f32_16x16x32_bf16 v[36:39], v[88:91], v[140:143], 0
  v_fma_mix_f32 v214, v163, v194, v204 op_sel:[0,0,0] op_sel_hi:[1,0,0]
  v_fma_mix_f32 v215, v163, v195, v205 op_sel:[1,0,0] op_sel_hi:[1,0,0]
  v_cvt_pk_bf16_f32 v144, v208, v209
  v_mfma_f32_16x16x32_bf16 v[40:43], v[92:95], v[136:139], 0
  ds_read_b128 v[132:135], v10 offset:13312
  ds_read_b128 v[152:155], v6 offset:1024
  v_mfma_f32_16x16x32_bf16 v[44:47], v[92:95], v[140:143], 0
  v_cvt_pk_bf16_f32 v145, v210, v211
  v_cvt_pk_bf16_f32 v146, v212, v213
  v_cvt_pk_bf16_f32 v147, v214, v215
  v_mfma_f32_16x16x32_bf16 v[48:51], v[96:99], v[136:139], 0
  ds_read_b128 v[156:159], v6 offset:3072
  ds_read_b128 v[168:171], v14 offset:512
  v_mfma_f32_16x16x32_bf16 v[52:55], v[96:99], v[140:143], 0
  v_fma_mix_f32 v208, v164, v188, v198 op_sel:[0,0,0] op_sel_hi:[1,0,0]
  v_fma_mix_f32 v209, v164, v189, v199 op_sel:[1,0,0] op_sel_hi:[1,0,0]
  v_fma_mix_f32 v210, v165, v190, v200 op_sel:[0,0,0] op_sel_hi:[1,0,0]
  v_mfma_f32_16x16x32_bf16 v[56:59], v[136:139], v[100:103], 0
  ds_read_b128 v[172:175], v14 offset:528
  ds_read_b128 v[178:181], v14 offset:544
  v_mfma_f32_16x16x32_bf16 v[60:63], v[140:143], v[100:103], 0
  v_fma_mix_f32 v211, v165, v191, v201 op_sel:[1,0,0] op_sel_hi:[1,0,0]
  v_fma_mix_f32 v212, v166, v192, v202 op_sel:[0,0,0] op_sel_hi:[1,0,0]
  v_fma_mix_f32 v213, v166, v193, v203 op_sel:[1,0,0] op_sel_hi:[1,0,0]
  v_mfma_f32_16x16x32_bf16 v[64:67], v[136:139], v[104:107], 0
  ds_read_b128 v[182:185], v14 offset:560
  v_mfma_f32_16x16x32_bf16 v[68:71], v[140:143], v[104:107], 0
  v_fma_mix_f32 v214, v167, v194, v204 op_sel:[0,0,0] op_sel_hi:[1,0,0]
  v_fma_mix_f32 v215, v167, v195, v205 op_sel:[1,0,0] op_sel_hi:[1,0,0]
  v_cvt_pk_bf16_f32 v148, v208, v209
  v_mfma_f32_16x16x32_bf16 v[72:75], v[136:139], v[96:99], 0
  v_mfma_f32_16x16x32_bf16 v[76:79], v[140:143], v[96:99], 0
  v_cvt_pk_bf16_f32 v149, v210, v211
  v_cvt_pk_bf16_f32 v150, v212, v213
  v_cvt_pk_bf16_f32 v151, v214, v215
  s_waitcnt lgkmcnt(0)
  s_barrier
  v_mfma_f32_16x16x32_bf16 v[16:19], v[108:111], v[144:147], v[16:19]
  ds_read_b128 v[80:83], v11 offset:0
  ds_read_b128 v[84:87], v11 offset:1024
  v_mfma_f32_16x16x32_bf16 v[20:23], v[108:111], v[148:151], v[20:23]
  v_fma_mix_f32 v208, v152, v168, v178 op_sel:[0,0,0] op_sel_hi:[1,0,0]
  v_fma_mix_f32 v209, v152, v169, v179 op_sel:[1,0,0] op_sel_hi:[1,0,0]
  v_fma_mix_f32 v210, v153, v170, v180 op_sel:[0,0,0] op_sel_hi:[1,0,0]
  v_mfma_f32_16x16x32_bf16 v[24:27], v[112:115], v[144:147], v[24:27]
  ds_read_b128 v[88:91], v11 offset:2048
  ds_read_b128 v[92:95], v11 offset:3072
  v_mfma_f32_16x16x32_bf16 v[28:31], v[112:115], v[148:151], v[28:31]
  v_fma_mix_f32 v211, v153, v171, v181 op_sel:[1,0,0] op_sel_hi:[1,0,0]
  v_fma_mix_f32 v212, v154, v172, v182 op_sel:[0,0,0] op_sel_hi:[1,0,0]
  v_fma_mix_f32 v213, v154, v173, v183 op_sel:[1,0,0] op_sel_hi:[1,0,0]
  v_mfma_f32_16x16x32_bf16 v[32:35], v[116:119], v[144:147], v[32:35]
  ds_read_b128 v[96:99], v11 offset:4096
  ds_read_b128 v[100:103], v11 offset:5120
  v_mfma_f32_16x16x32_bf16 v[36:39], v[116:119], v[148:151], v[36:39]
  v_fma_mix_f32 v214, v155, v174, v184 op_sel:[0,0,0] op_sel_hi:[1,0,0]
  v_fma_mix_f32 v215, v155, v175, v185 op_sel:[1,0,0] op_sel_hi:[1,0,0]
  v_cvt_pk_bf16_f32 v136, v208, v209
  v_mfma_f32_16x16x32_bf16 v[40:43], v[120:123], v[144:147], v[40:43]
  ds_read_b128 v[104:107], v11 offset:6144
  ds_read_b128 v[160:163], v7 offset:0
  v_mfma_f32_16x16x32_bf16 v[44:47], v[120:123], v[148:151], v[44:47]
  v_cvt_pk_bf16_f32 v137, v210, v211
  v_cvt_pk_bf16_f32 v138, v212, v213
  v_cvt_pk_bf16_f32 v139, v214, v215
  v_mfma_f32_16x16x32_bf16 v[48:51], v[124:127], v[144:147], v[48:51]
  ds_read_b128 v[164:167], v7 offset:2048
  ds_read_b128 v[188:191], v14 offset:768
  v_mfma_f32_16x16x32_bf16 v[52:55], v[124:127], v[148:151], v[52:55]
  v_fma_mix_f32 v208, v156, v168, v178 op_sel:[0,0,0] op_sel_hi:[1,0,0]
  v_fma_mix_f32 v209, v156, v169, v179 op_sel:[1,0,0] op_sel_hi:[1,0,0]
  v_fma_mix_f32 v210, v157, v170, v180 op_sel:[0,0,0] op_sel_hi:[1,0,0]
  v_mfma_f32_16x16x32_bf16 v[56:59], v[144:147], v[128:131], v[56:59]
  ds_read_b128 v[192:195], v14 offset:784
  ds_read_b128 v[198:201], v14 offset:800
  v_mfma_f32_16x16x32_bf16 v[60:63], v[148:151], v[128:131], v[60:63]
  v_fma_mix_f32 v211, v157, v171, v181 op_sel:[1,0,0] op_sel_hi:[1,0,0]
  v_fma_mix_f32 v212, v158, v172, v182 op_sel:[0,0,0] op_sel_hi:[1,0,0]
  v_fma_mix_f32 v213, v158, v173, v183 op_sel:[1,0,0] op_sel_hi:[1,0,0]
  v_mfma_f32_16x16x32_bf16 v[64:67], v[144:147], v[132:135], v[64:67]
  ds_read_b128 v[202:205], v14 offset:816
  v_mfma_f32_16x16x32_bf16 v[68:71], v[148:151], v[132:135], v[68:71]
  v_fma_mix_f32 v214, v159, v174, v184 op_sel:[0,0,0] op_sel_hi:[1,0,0]
  v_fma_mix_f32 v215, v159, v175, v185 op_sel:[1,0,0] op_sel_hi:[1,0,0]
  v_cvt_pk_bf16_f32 v140, v208, v209
  v_mfma_f32_16x16x32_bf16 v[72:75], v[144:147], v[124:127], v[72:75]
  v_mfma_f32_16x16x32_bf16 v[76:79], v[148:151], v[124:127], v[76:79]
  v_cvt_pk_bf16_f32 v141, v210, v211
  v_cvt_pk_bf16_f32 v142, v212, v213
  v_cvt_pk_bf16_f32 v143, v214, v215
  s_waitcnt lgkmcnt(0)
  v_mfma_f32_16x16x32_bf16 v[16:19], v[80:83], v[136:139], v[16:19]
  ds_read_b128 v[108:111], v11 offset:7168
  ds_read_b128 v[112:115], v11 offset:8192
  v_mfma_f32_16x16x32_bf16 v[20:23], v[80:83], v[140:143], v[20:23]
  v_fma_mix_f32 v208, v160, v188, v198 op_sel:[0,0,0] op_sel_hi:[1,0,0]
  v_fma_mix_f32 v209, v160, v189, v199 op_sel:[1,0,0] op_sel_hi:[1,0,0]
  v_fma_mix_f32 v210, v161, v190, v200 op_sel:[0,0,0] op_sel_hi:[1,0,0]
  v_mfma_f32_16x16x32_bf16 v[24:27], v[84:87], v[136:139], v[24:27]
  ds_read_b128 v[116:119], v11 offset:9216
  ds_read_b128 v[120:123], v11 offset:10240
  v_mfma_f32_16x16x32_bf16 v[28:31], v[84:87], v[140:143], v[28:31]
  v_fma_mix_f32 v211, v161, v191, v201 op_sel:[1,0,0] op_sel_hi:[1,0,0]
  v_fma_mix_f32 v212, v162, v192, v202 op_sel:[0,0,0] op_sel_hi:[1,0,0]
  v_fma_mix_f32 v213, v162, v193, v203 op_sel:[1,0,0] op_sel_hi:[1,0,0]
  v_mfma_f32_16x16x32_bf16 v[32:35], v[88:91], v[136:139], v[32:35]
  ds_read_b128 v[124:127], v11 offset:11264
  ds_read_b128 v[128:131], v11 offset:12288
  v_mfma_f32_16x16x32_bf16 v[36:39], v[88:91], v[140:143], v[36:39]
  v_fma_mix_f32 v214, v163, v194, v204 op_sel:[0,0,0] op_sel_hi:[1,0,0]
  v_fma_mix_f32 v215, v163, v195, v205 op_sel:[1,0,0] op_sel_hi:[1,0,0]
  v_cvt_pk_bf16_f32 v144, v208, v209
  v_mfma_f32_16x16x32_bf16 v[40:43], v[92:95], v[136:139], v[40:43]
  ds_read_b128 v[132:135], v11 offset:13312
  ds_read_b128 v[152:155], v7 offset:1024
  v_mfma_f32_16x16x32_bf16 v[44:47], v[92:95], v[140:143], v[44:47]
  v_cvt_pk_bf16_f32 v145, v210, v211
  v_cvt_pk_bf16_f32 v146, v212, v213
  v_cvt_pk_bf16_f32 v147, v214, v215
  v_mfma_f32_16x16x32_bf16 v[48:51], v[96:99], v[136:139], v[48:51]
  ds_read_b128 v[156:159], v7 offset:3072
  ds_read_b128 v[168:171], v14 offset:1024
  v_mfma_f32_16x16x32_bf16 v[52:55], v[96:99], v[140:143], v[52:55]
  v_fma_mix_f32 v208, v164, v188, v198 op_sel:[0,0,0] op_sel_hi:[1,0,0]
  v_fma_mix_f32 v209, v164, v189, v199 op_sel:[1,0,0] op_sel_hi:[1,0,0]
  v_fma_mix_f32 v210, v165, v190, v200 op_sel:[0,0,0] op_sel_hi:[1,0,0]
  v_mfma_f32_16x16x32_bf16 v[56:59], v[136:139], v[100:103], v[56:59]
  ds_read_b128 v[172:175], v14 offset:1040
  ds_read_b128 v[178:181], v14 offset:1056
  v_mfma_f32_16x16x32_bf16 v[60:63], v[140:143], v[100:103], v[60:63]
  v_fma_mix_f32 v211, v165, v191, v201 op_sel:[1,0,0] op_sel_hi:[1,0,0]
  v_fma_mix_f32 v212, v166, v192, v202 op_sel:[0,0,0] op_sel_hi:[1,0,0]
  v_fma_mix_f32 v213, v166, v193, v203 op_sel:[1,0,0] op_sel_hi:[1,0,0]
  v_mfma_f32_16x16x32_bf16 v[64:67], v[136:139], v[104:107], v[64:67]
  ds_read_b128 v[182:185], v14 offset:1072
  v_mfma_f32_16x16x32_bf16 v[68:71], v[140:143], v[104:107], v[68:71]
  v_fma_mix_f32 v214, v167, v194, v204 op_sel:[0,0,0] op_sel_hi:[1,0,0]
  v_fma_mix_f32 v215, v167, v195, v205 op_sel:[1,0,0] op_sel_hi:[1,0,0]
  v_cvt_pk_bf16_f32 v148, v208, v209
  v_mfma_f32_16x16x32_bf16 v[72:75], v[136:139], v[96:99], v[72:75]
  v_mfma_f32_16x16x32_bf16 v[76:79], v[140:143], v[96:99], v[76:79]
  v_cvt_pk_bf16_f32 v149, v210, v211
  v_cvt_pk_bf16_f32 v150, v212, v213
  v_cvt_pk_bf16_f32 v151, v214, v215
  s_waitcnt lgkmcnt(0)
  s_barrier
  v_mfma_f32_16x16x32_bf16 v[16:19], v[108:111], v[144:147], v[16:19]
  ds_read_b128 v[80:83], v12 offset:0
  ds_read_b128 v[84:87], v12 offset:1024
  v_mfma_f32_16x16x32_bf16 v[20:23], v[108:111], v[148:151], v[20:23]
  v_fma_mix_f32 v208, v152, v168, v178 op_sel:[0,0,0] op_sel_hi:[1,0,0]
  v_fma_mix_f32 v209, v152, v169, v179 op_sel:[1,0,0] op_sel_hi:[1,0,0]
  v_fma_mix_f32 v210, v153, v170, v180 op_sel:[0,0,0] op_sel_hi:[1,0,0]
  v_mfma_f32_16x16x32_bf16 v[24:27], v[112:115], v[144:147], v[24:27]
  ds_read_b128 v[88:91], v12 offset:2048
  ds_read_b128 v[92:95], v12 offset:3072
  v_mfma_f32_16x16x32_bf16 v[28:31], v[112:115], v[148:151], v[28:31]
  v_fma_mix_f32 v211, v153, v171, v181 op_sel:[1,0,0] op_sel_hi:[1,0,0]
  v_fma_mix_f32 v212, v154, v172, v182 op_sel:[0,0,0] op_sel_hi:[1,0,0]
  v_fma_mix_f32 v213, v154, v173, v183 op_sel:[1,0,0] op_sel_hi:[1,0,0]
  v_mfma_f32_16x16x32_bf16 v[32:35], v[116:119], v[144:147], v[32:35]
  ds_read_b128 v[96:99], v12 offset:4096
  ds_read_b128 v[100:103], v12 offset:5120
  v_mfma_f32_16x16x32_bf16 v[36:39], v[116:119], v[148:151], v[36:39]
  v_fma_mix_f32 v214, v155, v174, v184 op_sel:[0,0,0] op_sel_hi:[1,0,0]
  v_fma_mix_f32 v215, v155, v175, v185 op_sel:[1,0,0] op_sel_hi:[1,0,0]
  v_cvt_pk_bf16_f32 v136, v208, v209
  v_mfma_f32_16x16x32_bf16 v[40:43], v[120:123], v[144:147], v[40:43]
  ds_read_b128 v[104:107], v12 offset:6144
  ds_read_b128 v[160:163], v8 offset:0
  v_mfma_f32_16x16x32_bf16 v[44:47], v[120:123], v[148:151], v[44:47]
  v_cvt_pk_bf16_f32 v137, v210, v211
  v_cvt_pk_bf16_f32 v138, v212, v213
  v_cvt_pk_bf16_f32 v139, v214, v215
  v_mfma_f32_16x16x32_bf16 v[48:51], v[124:127], v[144:147], v[48:51]
  ds_read_b128 v[164:167], v8 offset:2048
  ds_read_b128 v[188:191], v14 offset:1280
  v_mfma_f32_16x16x32_bf16 v[52:55], v[124:127], v[148:151], v[52:55]
  v_fma_mix_f32 v208, v156, v168, v178 op_sel:[0,0,0] op_sel_hi:[1,0,0]
  v_fma_mix_f32 v209, v156, v169, v179 op_sel:[1,0,0] op_sel_hi:[1,0,0]
  v_fma_mix_f32 v210, v157, v170, v180 op_sel:[0,0,0] op_sel_hi:[1,0,0]
  v_mfma_f32_16x16x32_bf16 v[56:59], v[144:147], v[128:131], v[56:59]
  ds_read_b128 v[192:195], v14 offset:1296
  ds_read_b128 v[198:201], v14 offset:1312
  v_mfma_f32_16x16x32_bf16 v[60:63], v[148:151], v[128:131], v[60:63]
  v_fma_mix_f32 v211, v157, v171, v181 op_sel:[1,0,0] op_sel_hi:[1,0,0]
  v_fma_mix_f32 v212, v158, v172, v182 op_sel:[0,0,0] op_sel_hi:[1,0,0]
  v_fma_mix_f32 v213, v158, v173, v183 op_sel:[1,0,0] op_sel_hi:[1,0,0]
  v_mfma_f32_16x16x32_bf16 v[64:67], v[144:147], v[132:135], v[64:67]
  ds_read_b128 v[202:205], v14 offset:1328
  v_mfma_f32_16x16x32_bf16 v[68:71], v[148:151], v[132:135], v[68:71]
  v_fma_mix_f32 v214, v159, v174, v184 op_sel:[0,0,0] op_sel_hi:[1,0,0]
  v_fma_mix_f32 v215, v159, v175, v185 op_sel:[1,0,0] op_sel_hi:[1,0,0]
  v_cvt_pk_bf16_f32 v140, v208, v209
  v_mfma_f32_16x16x32_bf16 v[72:75], v[144:147], v[124:127], v[72:75]
  v_mfma_f32_16x16x32_bf16 v[76:79], v[148:151], v[124:127], v[76:79]
  v_cvt_pk_bf16_f32 v141, v210, v211
  v_cvt_pk_bf16_f32 v142, v212, v213
  v_cvt_pk_bf16_f32 v143, v214, v215
  s_waitcnt lgkmcnt(0)
  v_mfma_f32_16x16x32_bf16 v[16:19], v[80:83], v[136:139], v[16:19]
  ds_read_b128 v[108:111], v12 offset:7168
  ds_read_b128 v[112:115], v12 offset:8192
  v_mfma_f32_16x16x32_bf16 v[20:23], v[80:83], v[140:143], v[20:23]
  v_fma_mix_f32 v208, v160, v188, v198 op_sel:[0,0,0] op_sel_hi:[1,0,0]
  v_fma_mix_f32 v209, v160, v189, v199 op_sel:[1,0,0] op_sel_hi:[1,0,0]
  v_fma_mix_f32 v210, v161, v190, v200 op_sel:[0,0,0] op_sel_hi:[1,0,0]
  v_mfma_f32_16x16x32_bf16 v[24:27], v[84:87], v[136:139], v[24:27]
  ds_read_b128 v[116:119], v12 offset:9216
  ds_read_b128 v[120:123], v12 offset:10240
  v_mfma_f32_16x16x32_bf16 v[28:31], v[84:87], v[140:143], v[28:31]
  v_fma_mix_f32 v211, v161, v191, v201 op_sel:[1,0,0] op_sel_hi:[1,0,0]
  v_fma_mix_f32 v212, v162, v192, v202 op_sel:[0,0,0] op_sel_hi:[1,0,0]
  v_fma_mix_f32 v213, v162, v193, v203 op_sel:[1,0,0] op_sel_hi:[1,0,0]
  v_mfma_f32_16x16x32_bf16 v[32:35], v[88:91], v[136:139], v[32:35]
  ds_read_b128 v[124:127], v12 offset:11264
  ds_read_b128 v[128:131], v12 offset:12288
  v_mfma_f32_16x16x32_bf16 v[36:39], v[88:91], v[140:143], v[36:39]
  v_fma_mix_f32 v214, v163, v194, v204 op_sel:[0,0,0] op_sel_hi:[1,0,0]
  v_fma_mix_f32 v215, v163, v195, v205 op_sel:[1,0,0] op_sel_hi:[1,0,0]
  v_cvt_pk_bf16_f32 v144, v208, v209
  v_mfma_f32_16x16x32_bf16 v[40:43], v[92:95], v[136:139], v[40:43]
  ds_read_b128 v[132:135], v12 offset:13312
  ds_read_b128 v[152:155], v8 offset:1024
  v_mfma_f32_16x16x32_bf16 v[44:47], v[92:95], v[140:143], v[44:47]
  v_cvt_pk_bf16_f32 v145, v210, v211
  v_cvt_pk_bf16_f32 v146, v212, v213
  v_cvt_pk_bf16_f32 v147, v214, v215
  v_mfma_f32_16x16x32_bf16 v[48:51], v[96:99], v[136:139], v[48:51]
  ds_read_b128 v[156:159], v8 offset:3072
  ds_read_b128 v[168:171], v14 offset:1536
  v_mfma_f32_16x16x32_bf16 v[52:55], v[96:99], v[140:143], v[52:55]
  v_fma_mix_f32 v208, v164, v188, v198 op_sel:[0,0,0] op_sel_hi:[1,0,0]
  v_fma_mix_f32 v209, v164, v189, v199 op_sel:[1,0,0] op_sel_hi:[1,0,0]
  v_fma_mix_f32 v210, v165, v190, v200 op_sel:[0,0,0] op_sel_hi:[1,0,0]
  v_mfma_f32_16x16x32_bf16 v[56:59], v[136:139], v[100:103], v[56:59]
  ds_read_b128 v[172:175], v14 offset:1552
  ds_read_b128 v[178:181], v14 offset:1568
  v_mfma_f32_16x16x32_bf16 v[60:63], v[140:143], v[100:103], v[60:63]
  v_fma_mix_f32 v211, v165, v191, v201 op_sel:[1,0,0] op_sel_hi:[1,0,0]
  v_fma_mix_f32 v212, v166, v192, v202 op_sel:[0,0,0] op_sel_hi:[1,0,0]
  v_fma_mix_f32 v213, v166, v193, v203 op_sel:[1,0,0] op_sel_hi:[1,0,0]
  v_mfma_f32_16x16x32_bf16 v[64:67], v[136:139], v[104:107], v[64:67]
  ds_read_b128 v[182:185], v14 offset:1584
  v_mfma_f32_16x16x32_bf16 v[68:71], v[140:143], v[104:107], v[68:71]
  v_fma_mix_f32 v214, v167, v194, v204 op_sel:[0,0,0] op_sel_hi:[1,0,0]
  v_fma_mix_f32 v215, v167, v195, v205 op_sel:[1,0,0] op_sel_hi:[1,0,0]
  v_cvt_pk_bf16_f32 v148, v208, v209
  v_mfma_f32_16x16x32_bf16 v[72:75], v[136:139], v[96:99], v[72:75]
  v_mfma_f32_16x16x32_bf16 v[76:79], v[140:143], v[96:99], v[76:79]
  v_cvt_pk_bf16_f32 v149, v210, v211
  v_cvt_pk_bf16_f32 v150, v212, v213
  v_cvt_pk_bf16_f32 v151, v214, v215
  s_waitcnt lgkmcnt(0)
  s_barrier
  v_mfma_f32_16x16x32_bf16 v[16:19], v[108:111], v[144:147], v[16:19]
  ds_read_b128 v[80:83], v13 offset:0
  ds_read_b128 v[84:87], v13 offset:1024
  v_mfma_f32_16x16x32_bf16 v[20:23], v[108:111], v[148:151], v[20:23]
  v_fma_mix_f32 v208, v152, v168, v178 op_sel:[0,0,0] op_sel_hi:[1,0,0]
  v_fma_mix_f32 v209, v152, v169, v179 op_sel:[1,0,0] op_sel_hi:[1,0,0]
  v_fma_mix_f32 v210, v153, v170, v180 op_sel:[0,0,0] op_sel_hi:[1,0,0]
  v_mfma_f32_16x16x32_bf16 v[24:27], v[112:115], v[144:147], v[24:27]
  ds_read_b128 v[88:91], v13 offset:2048
  ds_read_b128 v[92:95], v13 offset:3072
  v_mfma_f32_16x16x32_bf16 v[28:31], v[112:115], v[148:151], v[28:31]
  v_fma_mix_f32 v211, v153, v171, v181 op_sel:[1,0,0] op_sel_hi:[1,0,0]
  v_fma_mix_f32 v212, v154, v172, v182 op_sel:[0,0,0] op_sel_hi:[1,0,0]
  v_fma_mix_f32 v213, v154, v173, v183 op_sel:[1,0,0] op_sel_hi:[1,0,0]
  v_mfma_f32_16x16x32_bf16 v[32:35], v[116:119], v[144:147], v[32:35]
  ds_read_b128 v[96:99], v13 offset:4096
  ds_read_b128 v[100:103], v13 offset:5120
  v_mfma_f32_16x16x32_bf16 v[36:39], v[116:119], v[148:151], v[36:39]
  v_fma_mix_f32 v214, v155, v174, v184 op_sel:[0,0,0] op_sel_hi:[1,0,0]
  v_fma_mix_f32 v215, v155, v175, v185 op_sel:[1,0,0] op_sel_hi:[1,0,0]
  v_cvt_pk_bf16_f32 v136, v208, v209
  v_mfma_f32_16x16x32_bf16 v[40:43], v[120:123], v[144:147], v[40:43]
  ds_read_b128 v[104:107], v13 offset:6144
  ds_read_b128 v[160:163], v9 offset:0
  v_mfma_f32_16x16x32_bf16 v[44:47], v[120:123], v[148:151], v[44:47]
  v_cvt_pk_bf16_f32 v137, v210, v211
  v_cvt_pk_bf16_f32 v138, v212, v213
  v_cvt_pk_bf16_f32 v139, v214, v215
  v_mfma_f32_16x16x32_bf16 v[48:51], v[124:127], v[144:147], v[48:51]
  ds_read_b128 v[164:167], v9 offset:2048
  ds_read_b128 v[188:191], v14 offset:1792
  v_mfma_f32_16x16x32_bf16 v[52:55], v[124:127], v[148:151], v[52:55]
  v_fma_mix_f32 v208, v156, v168, v178 op_sel:[0,0,0] op_sel_hi:[1,0,0]
  v_fma_mix_f32 v209, v156, v169, v179 op_sel:[1,0,0] op_sel_hi:[1,0,0]
  v_fma_mix_f32 v210, v157, v170, v180 op_sel:[0,0,0] op_sel_hi:[1,0,0]
  v_mfma_f32_16x16x32_bf16 v[56:59], v[144:147], v[128:131], v[56:59]
  ds_read_b128 v[192:195], v14 offset:1808
  ds_read_b128 v[198:201], v14 offset:1824
  v_mfma_f32_16x16x32_bf16 v[60:63], v[148:151], v[128:131], v[60:63]
  v_fma_mix_f32 v211, v157, v171, v181 op_sel:[1,0,0] op_sel_hi:[1,0,0]
  v_fma_mix_f32 v212, v158, v172, v182 op_sel:[0,0,0] op_sel_hi:[1,0,0]
  v_fma_mix_f32 v213, v158, v173, v183 op_sel:[1,0,0] op_sel_hi:[1,0,0]
  v_mfma_f32_16x16x32_bf16 v[64:67], v[144:147], v[132:135], v[64:67]
  ds_read_b128 v[202:205], v14 offset:1840
  v_mfma_f32_16x16x32_bf16 v[68:71], v[148:151], v[132:135], v[68:71]
  v_fma_mix_f32 v214, v159, v174, v184 op_sel:[0,0,0] op_sel_hi:[1,0,0]
  v_fma_mix_f32 v215, v159, v175, v185 op_sel:[1,0,0] op_sel_hi:[1,0,0]
  v_cvt_pk_bf16_f32 v140, v208, v209
  v_mfma_f32_16x16x32_bf16 v[72:75], v[144:147], v[124:127], v[72:75]
  v_mfma_f32_16x16x32_bf16 v[76:79], v[148:151], v[124:127], v[76:79]
  v_cvt_pk_bf16_f32 v141, v210, v211
  v_cvt_pk_bf16_f32 v142, v212, v213
  v_cvt_pk_bf16_f32 v143, v214, v215
  s_waitcnt lgkmcnt(0)
  v_mfma_f32_16x16x32_bf16 v[16:19], v[80:83], v[136:139], v[16:19]
  ds_read_b128 v[108:111], v13 offset:7168
  ds_read_b128 v[112:115], v13 offset:8192
  v_mfma_f32_16x16x32_bf16 v[20:23], v[80:83], v[140:143], v[20:23]
  v_fma_mix_f32 v208, v160, v188, v198 op_sel:[0,0,0] op_sel_hi:[1,0,0]
  v_fma_mix_f32 v209, v160, v189, v199 op_sel:[1,0,0] op_sel_hi:[1,0,0]
  v_fma_mix_f32 v210, v161, v190, v200 op_sel:[0,0,0] op_sel_hi:[1,0,0]
  v_mfma_f32_16x16x32_bf16 v[24:27], v[84:87], v[136:139], v[24:27]
  ds_read_b128 v[116:119], v13 offset:9216
  ds_read_b128 v[120:123], v13 offset:10240
  v_mfma_f32_16x16x32_bf16 v[28:31], v[84:87], v[140:143], v[28:31]
  v_fma_mix_f32 v211, v161, v191, v201 op_sel:[1,0,0] op_sel_hi:[1,0,0]
  v_fma_mix_f32 v212, v162, v192, v202 op_sel:[0,0,0] op_sel_hi:[1,0,0]
  v_fma_mix_f32 v213, v162, v193, v203 op_sel:[1,0,0] op_sel_hi:[1,0,0]
  v_mfma_f32_16x16x32_bf16 v[32:35], v[88:91], v[136:139], v[32:35]
  ds_read_b128 v[124:127], v13 offset:11264
  ds_read_b128 v[128:131], v13 offset:12288
  v_mfma_f32_16x16x32_bf16 v[36:39], v[88:91], v[140:143], v[36:39]
  v_fma_mix_f32 v214, v163, v194, v204 op_sel:[0,0,0] op_sel_hi:[1,0,0]
  v_fma_mix_f32 v215, v163, v195, v205 op_sel:[1,0,0] op_sel_hi:[1,0,0]
  v_cvt_pk_bf16_f32 v144, v208, v209
  v_mfma_f32_16x16x32_bf16 v[40:43], v[92:95], v[136:139], v[40:43]
  ds_read_b128 v[132:135], v13 offset:13312
  ds_read_b128 v[152:155], v9 offset:1024
  v_mfma_f32_16x16x32_bf16 v[44:47], v[92:95], v[140:143], v[44:47]
  v_cvt_pk_bf16_f32 v145, v210, v211
  v_cvt_pk_bf16_f32 v146, v212, v213
  v_cvt_pk_bf16_f32 v147, v214, v215
  v_mfma_f32_16x16x32_bf16 v[48:51], v[96:99], v[136:139], v[48:51]
  ds_read_b128 v[156:159], v9 offset:3072
  ds_read_b128 v[168:171], v14 offset:2048
  v_mfma_f32_16x16x32_bf16 v[52:55], v[96:99], v[140:143], v[52:55]
  v_fma_mix_f32 v208, v164, v188, v198 op_sel:[0,0,0] op_sel_hi:[1,0,0]
  v_fma_mix_f32 v209, v164, v189, v199 op_sel:[1,0,0] op_sel_hi:[1,0,0]
  v_fma_mix_f32 v210, v165, v190, v200 op_sel:[0,0,0] op_sel_hi:[1,0,0]
  v_mfma_f32_16x16x32_bf16 v[56:59], v[136:139], v[100:103], v[56:59]
  ds_read_b128 v[172:175], v14 offset:2064
  ds_read_b128 v[178:181], v14 offset:2080
  v_mfma_f32_16x16x32_bf16 v[60:63], v[140:143], v[100:103], v[60:63]
  v_fma_mix_f32 v211, v165, v191, v201 op_sel:[1,0,0] op_sel_hi:[1,0,0]
  v_fma_mix_f32 v212, v166, v192, v202 op_sel:[0,0,0] op_sel_hi:[1,0,0]
  v_fma_mix_f32 v213, v166, v193, v203 op_sel:[1,0,0] op_sel_hi:[1,0,0]
  v_mfma_f32_16x16x32_bf16 v[64:67], v[136:139], v[104:107], v[64:67]
  ds_read_b128 v[182:185], v14 offset:2096
  v_mfma_f32_16x16x32_bf16 v[68:71], v[140:143], v[104:107], v[68:71]
  v_fma_mix_f32 v214, v167, v194, v204 op_sel:[0,0,0] op_sel_hi:[1,0,0]
  v_fma_mix_f32 v215, v167, v195, v205 op_sel:[1,0,0] op_sel_hi:[1,0,0]
  v_cvt_pk_bf16_f32 v148, v208, v209
  v_mfma_f32_16x16x32_bf16 v[72:75], v[136:139], v[96:99], v[72:75]
  v_mfma_f32_16x16x32_bf16 v[76:79], v[140:143], v[96:99], v[76:79]
  v_cvt_pk_bf16_f32 v149, v210, v211
  v_cvt_pk_bf16_f32 v150, v212, v213
  v_cvt_pk_bf16_f32 v151, v214, v215
  s_waitcnt lgkmcnt(0)
  s_barrier
  v_mfma_f32_16x16x32_bf16 v[16:19], v[108:111], v[144:147], v[16:19]
  ds_read_b128 v[80:83], v10 offset:0
  ds_read_b128 v[84:87], v10 offset:1024
  v_mfma_f32_16x16x32_bf16 v[20:23], v[108:111], v[148:151], v[20:23]
  v_fma_mix_f32 v208, v152, v168, v178 op_sel:[0,0,0] op_sel_hi:[1,0,0]
  v_fma_mix_f32 v209, v152, v169, v179 op_sel:[1,0,0] op_sel_hi:[1,0,0]
  v_fma_mix_f32 v210, v153, v170, v180 op_sel:[0,0,0] op_sel_hi:[1,0,0]
  v_mfma_f32_16x16x32_bf16 v[24:27], v[112:115], v[144:147], v[24:27]
  ds_read_b128 v[88:91], v10 offset:2048
  ds_read_b128 v[92:95], v10 offset:3072
  v_mfma_f32_16x16x32_bf16 v[28:31], v[112:115], v[148:151], v[28:31]
  v_fma_mix_f32 v211, v153, v171, v181 op_sel:[1,0,0] op_sel_hi:[1,0,0]
  v_fma_mix_f32 v212, v154, v172, v182 op_sel:[0,0,0] op_sel_hi:[1,0,0]
  v_fma_mix_f32 v213, v154, v173, v183 op_sel:[1,0,0] op_sel_hi:[1,0,0]
  v_mfma_f32_16x16x32_bf16 v[32:35], v[116:119], v[144:147], v[32:35]
  ds_read_b128 v[96:99], v10 offset:4096
  ds_read_b128 v[100:103], v10 offset:5120
  v_mfma_f32_16x16x32_bf16 v[36:39], v[116:119], v[148:151], v[36:39]
  v_fma_mix_f32 v214, v155, v174, v184 op_sel:[0,0,0] op_sel_hi:[1,0,0]
  v_fma_mix_f32 v215, v155, v175, v185 op_sel:[1,0,0] op_sel_hi:[1,0,0]
  v_cvt_pk_bf16_f32 v136, v208, v209
  v_mfma_f32_16x16x32_bf16 v[40:43], v[120:123], v[144:147], v[40:43]
  ds_read_b128 v[104:107], v10 offset:6144
  ds_read_b128 v[160:163], v6 offset:0
  v_mfma_f32_16x16x32_bf16 v[44:47], v[120:123], v[148:151], v[44:47]
  v_cvt_pk_bf16_f32 v137, v210, v211
  v_cvt_pk_bf16_f32 v138, v212, v213
  v_cvt_pk_bf16_f32 v139, v214, v215
  v_mfma_f32_16x16x32_bf16 v[48:51], v[124:127], v[144:147], v[48:51]
  ds_read_b128 v[164:167], v6 offset:2048
  ds_read_b128 v[188:191], v14 offset:2304
  v_mfma_f32_16x16x32_bf16 v[52:55], v[124:127], v[148:151], v[52:55]
  v_fma_mix_f32 v208, v156, v168, v178 op_sel:[0,0,0] op_sel_hi:[1,0,0]
  v_fma_mix_f32 v209, v156, v169, v179 op_sel:[1,0,0] op_sel_hi:[1,0,0]
  v_fma_mix_f32 v210, v157, v170, v180 op_sel:[0,0,0] op_sel_hi:[1,0,0]
  v_mfma_f32_16x16x32_bf16 v[56:59], v[144:147], v[128:131], v[56:59]
  ds_read_b128 v[192:195], v14 offset:2320
  ds_read_b128 v[198:201], v14 offset:2336
  v_mfma_f32_16x16x32_bf16 v[60:63], v[148:151], v[128:131], v[60:63]
  v_fma_mix_f32 v211, v157, v171, v181 op_sel:[1,0,0] op_sel_hi:[1,0,0]
  v_fma_mix_f32 v212, v158, v172, v182 op_sel:[0,0,0] op_sel_hi:[1,0,0]
  v_fma_mix_f32 v213, v158, v173, v183 op_sel:[1,0,0] op_sel_hi:[1,0,0]
  v_mfma_f32_16x16x32_bf16 v[64:67], v[144:147], v[132:135], v[64:67]
  ds_read_b128 v[202:205], v14 offset:2352
  v_mfma_f32_16x16x32_bf16 v[68:71], v[148:151], v[132:135], v[68:71]
  v_fma_mix_f32 v214, v159, v174, v184 op_sel:[0,0,0] op_sel_hi:[1,0,0]
  v_fma_mix_f32 v215, v159, v175, v185 op_sel:[1,0,0] op_sel_hi:[1,0,0]
  v_cvt_pk_bf16_f32 v140, v208, v209
  v_mfma_f32_16x16x32_bf16 v[72:75], v[144:147], v[124:127], v[72:75]
  v_mfma_f32_16x16x32_bf16 v[76:79], v[148:151], v[124:127], v[76:79]
  v_cvt_pk_bf16_f32 v141, v210, v211
  v_cvt_pk_bf16_f32 v142, v212, v213
  v_cvt_pk_bf16_f32 v143, v214, v215
  s_waitcnt lgkmcnt(0)
  v_mfma_f32_16x16x32_bf16 v[16:19], v[80:83], v[136:139], v[16:19]
  ds_read_b128 v[108:111], v10 offset:7168
  ds_read_b128 v[112:115], v10 offset:8192
  v_mfma_f32_16x16x32_bf16 v[20:23], v[80:83], v[140:143], v[20:23]
  v_fma_mix_f32 v208, v160, v188, v198 op_sel:[0,0,0] op_sel_hi:[1,0,0]
  v_fma_mix_f32 v209, v160, v189, v199 op_sel:[1,0,0] op_sel_hi:[1,0,0]
  v_fma_mix_f32 v210, v161, v190, v200 op_sel:[0,0,0] op_sel_hi:[1,0,0]
  v_mfma_f32_16x16x32_bf16 v[24:27], v[84:87], v[136:139], v[24:27]
  ds_read_b128 v[116:119], v10 offset:9216
  ds_read_b128 v[120:123], v10 offset:10240
  v_mfma_f32_16x16x32_bf16 v[28:31], v[84:87], v[140:143], v[28:31]
  v_fma_mix_f32 v211, v161, v191, v201 op_sel:[1,0,0] op_sel_hi:[1,0,0]
  v_fma_mix_f32 v212, v162, v192, v202 op_sel:[0,0,0] op_sel_hi:[1,0,0]
  v_fma_mix_f32 v213, v162, v193, v203 op_sel:[1,0,0] op_sel_hi:[1,0,0]
  v_mfma_f32_16x16x32_bf16 v[32:35], v[88:91], v[136:139], v[32:35]
  ds_read_b128 v[124:127], v10 offset:11264
  ds_read_b128 v[128:131], v10 offset:12288
  v_mfma_f32_16x16x32_bf16 v[36:39], v[88:91], v[140:143], v[36:39]
  v_fma_mix_f32 v214, v163, v194, v204 op_sel:[0,0,0] op_sel_hi:[1,0,0]
  v_fma_mix_f32 v215, v163, v195, v205 op_sel:[1,0,0] op_sel_hi:[1,0,0]
  v_cvt_pk_bf16_f32 v144, v208, v209
  v_mfma_f32_16x16x32_bf16 v[40:43], v[92:95], v[136:139], v[40:43]
  ds_read_b128 v[132:135], v10 offset:13312
  ds_read_b128 v[152:155], v6 offset:1024
  v_mfma_f32_16x16x32_bf16 v[44:47], v[92:95], v[140:143], v[44:47]
  v_cvt_pk_bf16_f32 v145, v210, v211
  v_cvt_pk_bf16_f32 v146, v212, v213
  v_cvt_pk_bf16_f32 v147, v214, v215
  v_mfma_f32_16x16x32_bf16 v[48:51], v[96:99], v[136:139], v[48:51]
  ds_read_b128 v[156:159], v6 offset:3072
  ds_read_b128 v[168:171], v14 offset:2560
  v_mfma_f32_16x16x32_bf16 v[52:55], v[96:99], v[140:143], v[52:55]
  v_fma_mix_f32 v208, v164, v188, v198 op_sel:[0,0,0] op_sel_hi:[1,0,0]
  v_fma_mix_f32 v209, v164, v189, v199 op_sel:[1,0,0] op_sel_hi:[1,0,0]
  v_fma_mix_f32 v210, v165, v190, v200 op_sel:[0,0,0] op_sel_hi:[1,0,0]
  v_mfma_f32_16x16x32_bf16 v[56:59], v[136:139], v[100:103], v[56:59]
  ds_read_b128 v[172:175], v14 offset:2576
  ds_read_b128 v[178:181], v14 offset:2592
  v_mfma_f32_16x16x32_bf16 v[60:63], v[140:143], v[100:103], v[60:63]
  v_fma_mix_f32 v211, v165, v191, v201 op_sel:[1,0,0] op_sel_hi:[1,0,0]
  v_fma_mix_f32 v212, v166, v192, v202 op_sel:[0,0,0] op_sel_hi:[1,0,0]
  v_fma_mix_f32 v213, v166, v193, v203 op_sel:[1,0,0] op_sel_hi:[1,0,0]
  v_mfma_f32_16x16x32_bf16 v[64:67], v[136:139], v[104:107], v[64:67]
  ds_read_b128 v[182:185], v14 offset:2608
  v_mfma_f32_16x16x32_bf16 v[68:71], v[140:143], v[104:107], v[68:71]
  v_fma_mix_f32 v214, v167, v194, v204 op_sel:[0,0,0] op_sel_hi:[1,0,0]
  v_fma_mix_f32 v215, v167, v195, v205 op_sel:[1,0,0] op_sel_hi:[1,0,0]
  v_cvt_pk_bf16_f32 v148, v208, v209
  v_mfma_f32_16x16x32_bf16 v[72:75], v[136:139], v[96:99], v[72:75]
  v_mfma_f32_16x16x32_bf16 v[76:79], v[140:143], v[96:99], v[76:79]
  v_cvt_pk_bf16_f32 v149, v210, v211
  v_cvt_pk_bf16_f32 v150, v212, v213
  v_cvt_pk_bf16_f32 v151, v214, v215
  s_waitcnt lgkmcnt(0)
  s_barrier
  v_mfma_f32_16x16x32_bf16 v[16:19], v[108:111], v[144:147], v[16:19]
  ds_read_b128 v[80:83], v11 offset:0
  ds_read_b128 v[84:87], v11 offset:1024
  v_mfma_f32_16x16x32_bf16 v[20:23], v[108:111], v[148:151], v[20:23]
  v_fma_mix_f32 v208, v152, v168, v178 op_sel:[0,0,0] op_sel_hi:[1,0,0]
  v_fma_mix_f32 v209, v152, v169, v179 op_sel:[1,0,0] op_sel_hi:[1,0,0]
  v_fma_mix_f32 v210, v153, v170, v180 op_sel:[0,0,0] op_sel_hi:[1,0,0]
  v_mfma_f32_16x16x32_bf16 v[24:27], v[112:115], v[144:147], v[24:27]
  ds_read_b128 v[88:91], v11 offset:2048
  ds_read_b128 v[92:95], v11 offset:3072
  v_mfma_f32_16x16x32_bf16 v[28:31], v[112:115], v[148:151], v[28:31]
  v_fma_mix_f32 v211, v153, v171, v181 op_sel:[1,0,0] op_sel_hi:[1,0,0]
  v_fma_mix_f32 v212, v154, v172, v182 op_sel:[0,0,0] op_sel_hi:[1,0,0]
  v_fma_mix_f32 v213, v154, v173, v183 op_sel:[1,0,0] op_sel_hi:[1,0,0]
  v_mfma_f32_16x16x32_bf16 v[32:35], v[116:119], v[144:147], v[32:35]
  ds_read_b128 v[96:99], v11 offset:4096
  ds_read_b128 v[100:103], v11 offset:5120
  v_mfma_f32_16x16x32_bf16 v[36:39], v[116:119], v[148:151], v[36:39]
  v_fma_mix_f32 v214, v155, v174, v184 op_sel:[0,0,0] op_sel_hi:[1,0,0]
  v_fma_mix_f32 v215, v155, v175, v185 op_sel:[1,0,0] op_sel_hi:[1,0,0]
  v_cvt_pk_bf16_f32 v136, v208, v209
  v_mfma_f32_16x16x32_bf16 v[40:43], v[120:123], v[144:147], v[40:43]
  ds_read_b128 v[104:107], v11 offset:6144
  ds_read_b128 v[160:163], v7 offset:0
  v_mfma_f32_16x16x32_bf16 v[44:47], v[120:123], v[148:151], v[44:47]
  v_cvt_pk_bf16_f32 v137, v210, v211
  v_cvt_pk_bf16_f32 v138, v212, v213
  v_cvt_pk_bf16_f32 v139, v214, v215
  v_mfma_f32_16x16x32_bf16 v[48:51], v[124:127], v[144:147], v[48:51]
  ds_read_b128 v[164:167], v7 offset:2048
  ds_read_b128 v[188:191], v14 offset:2816
  v_mfma_f32_16x16x32_bf16 v[52:55], v[124:127], v[148:151], v[52:55]
  v_fma_mix_f32 v208, v156, v168, v178 op_sel:[0,0,0] op_sel_hi:[1,0,0]
  v_fma_mix_f32 v209, v156, v169, v179 op_sel:[1,0,0] op_sel_hi:[1,0,0]
  v_fma_mix_f32 v210, v157, v170, v180 op_sel:[0,0,0] op_sel_hi:[1,0,0]
  v_mfma_f32_16x16x32_bf16 v[56:59], v[144:147], v[128:131], v[56:59]
  ds_read_b128 v[192:195], v14 offset:2832
  ds_read_b128 v[198:201], v14 offset:2848
  v_mfma_f32_16x16x32_bf16 v[60:63], v[148:151], v[128:131], v[60:63]
  v_fma_mix_f32 v211, v157, v171, v181 op_sel:[1,0,0] op_sel_hi:[1,0,0]
  v_fma_mix_f32 v212, v158, v172, v182 op_sel:[0,0,0] op_sel_hi:[1,0,0]
  v_fma_mix_f32 v213, v158, v173, v183 op_sel:[1,0,0] op_sel_hi:[1,0,0]
  v_mfma_f32_16x16x32_bf16 v[64:67], v[144:147], v[132:135], v[64:67]
  ds_read_b128 v[202:205], v14 offset:2864
  v_mfma_f32_16x16x32_bf16 v[68:71], v[148:151], v[132:135], v[68:71]
  v_fma_mix_f32 v214, v159, v174, v184 op_sel:[0,0,0] op_sel_hi:[1,0,0]
  v_fma_mix_f32 v215, v159, v175, v185 op_sel:[1,0,0] op_sel_hi:[1,0,0]
  v_cvt_pk_bf16_f32 v140, v208, v209
  v_mfma_f32_16x16x32_bf16 v[72:75], v[144:147], v[124:127], v[72:75]
  v_mfma_f32_16x16x32_bf16 v[76:79], v[148:151], v[124:127], v[76:79]
  v_cvt_pk_bf16_f32 v141, v210, v211
  v_cvt_pk_bf16_f32 v142, v212, v213
  v_cvt_pk_bf16_f32 v143, v214, v215
  s_waitcnt lgkmcnt(0)
  v_mfma_f32_16x16x32_bf16 v[16:19], v[80:83], v[136:139], v[16:19]
  ds_read_b128 v[108:111], v11 offset:7168
  ds_read_b128 v[112:115], v11 offset:8192
  v_mfma_f32_16x16x32_bf16 v[20:23], v[80:83], v[140:143], v[20:23]
  v_fma_mix_f32 v208, v160, v188, v198 op_sel:[0,0,0] op_sel_hi:[1,0,0]
  v_fma_mix_f32 v209, v160, v189, v199 op_sel:[1,0,0] op_sel_hi:[1,0,0]
  v_fma_mix_f32 v210, v161, v190, v200 op_sel:[0,0,0] op_sel_hi:[1,0,0]
  v_mfma_f32_16x16x32_bf16 v[24:27], v[84:87], v[136:139], v[24:27]
  ds_read_b128 v[116:119], v11 offset:9216
  ds_read_b128 v[120:123], v11 offset:10240
  v_mfma_f32_16x16x32_bf16 v[28:31], v[84:87], v[140:143], v[28:31]
  v_fma_mix_f32 v211, v161, v191, v201 op_sel:[1,0,0] op_sel_hi:[1,0,0]
  v_fma_mix_f32 v212, v162, v192, v202 op_sel:[0,0,0] op_sel_hi:[1,0,0]
  v_fma_mix_f32 v213, v162, v193, v203 op_sel:[1,0,0] op_sel_hi:[1,0,0]
  v_mfma_f32_16x16x32_bf16 v[32:35], v[88:91], v[136:139], v[32:35]
  ds_read_b128 v[124:127], v11 offset:11264
  ds_read_b128 v[128:131], v11 offset:12288
  v_mfma_f32_16x16x32_bf16 v[36:39], v[88:91], v[140:143], v[36:39]
  v_fma_mix_f32 v214, v163, v194, v204 op_sel:[0,0,0] op_sel_hi:[1,0,0]
  v_fma_mix_f32 v215, v163, v195, v205 op_sel:[1,0,0] op_sel_hi:[1,0,0]
  v_cvt_pk_bf16_f32 v144, v208, v209
  v_mfma_f32_16x16x32_bf16 v[40:43], v[92:95], v[136:139], v[40:43]
  ds_read_b128 v[132:135], v11 offset:13312
  ds_read_b128 v[152:155], v7 offset:1024
  v_mfma_f32_16x16x32_bf16 v[44:47], v[92:95], v[140:143], v[44:47]
  v_cvt_pk_bf16_f32 v145, v210, v211
  v_cvt_pk_bf16_f32 v146, v212, v213
  v_cvt_pk_bf16_f32 v147, v214, v215
  v_mfma_f32_16x16x32_bf16 v[48:51], v[96:99], v[136:139], v[48:51]
  ds_read_b128 v[156:159], v7 offset:3072
  ds_read_b128 v[168:171], v14 offset:3072
  v_mfma_f32_16x16x32_bf16 v[52:55], v[96:99], v[140:143], v[52:55]
  v_fma_mix_f32 v208, v164, v188, v198 op_sel:[0,0,0] op_sel_hi:[1,0,0]
  v_fma_mix_f32 v209, v164, v189, v199 op_sel:[1,0,0] op_sel_hi:[1,0,0]
  v_fma_mix_f32 v210, v165, v190, v200 op_sel:[0,0,0] op_sel_hi:[1,0,0]
  v_mfma_f32_16x16x32_bf16 v[56:59], v[136:139], v[100:103], v[56:59]
  ds_read_b128 v[172:175], v14 offset:3088
  ds_read_b128 v[178:181], v14 offset:3104
  v_mfma_f32_16x16x32_bf16 v[60:63], v[140:143], v[100:103], v[60:63]
  v_fma_mix_f32 v211, v165, v191, v201 op_sel:[1,0,0] op_sel_hi:[1,0,0]
  v_fma_mix_f32 v212, v166, v192, v202 op_sel:[0,0,0] op_sel_hi:[1,0,0]
  v_fma_mix_f32 v213, v166, v193, v203 op_sel:[1,0,0] op_sel_hi:[1,0,0]
  v_mfma_f32_16x16x32_bf16 v[64:67], v[136:139], v[104:107], v[64:67]
  ds_read_b128 v[182:185], v14 offset:3120
  v_mfma_f32_16x16x32_bf16 v[68:71], v[140:143], v[104:107], v[68:71]
  v_fma_mix_f32 v214, v167, v194, v204 op_sel:[0,0,0] op_sel_hi:[1,0,0]
  v_fma_mix_f32 v215, v167, v195, v205 op_sel:[1,0,0] op_sel_hi:[1,0,0]
  v_cvt_pk_bf16_f32 v148, v208, v209
  v_mfma_f32_16x16x32_bf16 v[72:75], v[136:139], v[96:99], v[72:75]
  v_mfma_f32_16x16x32_bf16 v[76:79], v[140:143], v[96:99], v[76:79]
  v_cvt_pk_bf16_f32 v149, v210, v211
  v_cvt_pk_bf16_f32 v150, v212, v213
  v_cvt_pk_bf16_f32 v151, v214, v215
  s_waitcnt lgkmcnt(0)
  s_barrier
  v_mfma_f32_16x16x32_bf16 v[16:19], v[108:111], v[144:147], v[16:19]
  ds_read_b128 v[80:83], v12 offset:0
  ds_read_b128 v[84:87], v12 offset:1024
  v_mfma_f32_16x16x32_bf16 v[20:23], v[108:111], v[148:151], v[20:23]
  v_fma_mix_f32 v208, v152, v168, v178 op_sel:[0,0,0] op_sel_hi:[1,0,0]
  v_fma_mix_f32 v209, v152, v169, v179 op_sel:[1,0,0] op_sel_hi:[1,0,0]
  v_fma_mix_f32 v210, v153, v170, v180 op_sel:[0,0,0] op_sel_hi:[1,0,0]
  v_mfma_f32_16x16x32_bf16 v[24:27], v[112:115], v[144:147], v[24:27]
  ds_read_b128 v[88:91], v12 offset:2048
  ds_read_b128 v[92:95], v12 offset:3072
  v_mfma_f32_16x16x32_bf16 v[28:31], v[112:115], v[148:151], v[28:31]
  v_fma_mix_f32 v211, v153, v171, v181 op_sel:[1,0,0] op_sel_hi:[1,0,0]
  v_fma_mix_f32 v212, v154, v172, v182 op_sel:[0,0,0] op_sel_hi:[1,0,0]
  v_fma_mix_f32 v213, v154, v173, v183 op_sel:[1,0,0] op_sel_hi:[1,0,0]
  v_mfma_f32_16x16x32_bf16 v[32:35], v[116:119], v[144:147], v[32:35]
  ds_read_b128 v[96:99], v12 offset:4096
  ds_read_b128 v[100:103], v12 offset:5120
  v_mfma_f32_16x16x32_bf16 v[36:39], v[116:119], v[148:151], v[36:39]
  v_fma_mix_f32 v214, v155, v174, v184 op_sel:[0,0,0] op_sel_hi:[1,0,0]
  v_fma_mix_f32 v215, v155, v175, v185 op_sel:[1,0,0] op_sel_hi:[1,0,0]
  v_cvt_pk_bf16_f32 v136, v208, v209
  v_mfma_f32_16x16x32_bf16 v[40:43], v[120:123], v[144:147], v[40:43]
  ds_read_b128 v[104:107], v12 offset:6144
  ds_read_b128 v[160:163], v8 offset:0
  v_mfma_f32_16x16x32_bf16 v[44:47], v[120:123], v[148:151], v[44:47]
  v_cvt_pk_bf16_f32 v137, v210, v211
  v_cvt_pk_bf16_f32 v138, v212, v213
  v_cvt_pk_bf16_f32 v139, v214, v215
  v_mfma_f32_16x16x32_bf16 v[48:51], v[124:127], v[144:147], v[48:51]
  ds_read_b128 v[164:167], v8 offset:2048
  ds_read_b128 v[188:191], v14 offset:3328
  v_mfma_f32_16x16x32_bf16 v[52:55], v[124:127], v[148:151], v[52:55]
  v_fma_mix_f32 v208, v156, v168, v178 op_sel:[0,0,0] op_sel_hi:[1,0,0]
  v_fma_mix_f32 v209, v156, v169, v179 op_sel:[1,0,0] op_sel_hi:[1,0,0]
  v_fma_mix_f32 v210, v157, v170, v180 op_sel:[0,0,0] op_sel_hi:[1,0,0]
  v_mfma_f32_16x16x32_bf16 v[56:59], v[144:147], v[128:131], v[56:59]
  ds_read_b128 v[192:195], v14 offset:3344
  ds_read_b128 v[198:201], v14 offset:3360
  v_mfma_f32_16x16x32_bf16 v[60:63], v[148:151], v[128:131], v[60:63]
  v_fma_mix_f32 v211, v157, v171, v181 op_sel:[1,0,0] op_sel_hi:[1,0,0]
  v_fma_mix_f32 v212, v158, v172, v182 op_sel:[0,0,0] op_sel_hi:[1,0,0]
  v_fma_mix_f32 v213, v158, v173, v183 op_sel:[1,0,0] op_sel_hi:[1,0,0]
  v_mfma_f32_16x16x32_bf16 v[64:67], v[144:147], v[132:135], v[64:67]
  ds_read_b128 v[202:205], v14 offset:3376
  v_mfma_f32_16x16x32_bf16 v[68:71], v[148:151], v[132:135], v[68:71]
  v_fma_mix_f32 v214, v159, v174, v184 op_sel:[0,0,0] op_sel_hi:[1,0,0]
  v_fma_mix_f32 v215, v159, v175, v185 op_sel:[1,0,0] op_sel_hi:[1,0,0]
  v_cvt_pk_bf16_f32 v140, v208, v209
  v_mfma_f32_16x16x32_bf16 v[72:75], v[144:147], v[124:127], v[72:75]
  v_mfma_f32_16x16x32_bf16 v[76:79], v[148:151], v[124:127], v[76:79]
  v_cvt_pk_bf16_f32 v141, v210, v211
  v_cvt_pk_bf16_f32 v142, v212, v213
  v_cvt_pk_bf16_f32 v143, v214, v215
  s_waitcnt lgkmcnt(0)
  v_mfma_f32_16x16x32_bf16 v[16:19], v[80:83], v[136:139], v[16:19]
  ds_read_b128 v[108:111], v12 offset:7168
  ds_read_b128 v[112:115], v12 offset:8192
  v_mfma_f32_16x16x32_bf16 v[20:23], v[80:83], v[140:143], v[20:23]
  v_fma_mix_f32 v208, v160, v188, v198 op_sel:[0,0,0] op_sel_hi:[1,0,0]
  v_fma_mix_f32 v209, v160, v189, v199 op_sel:[1,0,0] op_sel_hi:[1,0,0]
  v_fma_mix_f32 v210, v161, v190, v200 op_sel:[0,0,0] op_sel_hi:[1,0,0]
  v_mfma_f32_16x16x32_bf16 v[24:27], v[84:87], v[136:139], v[24:27]
  ds_read_b128 v[116:119], v12 offset:9216
  ds_read_b128 v[120:123], v12 offset:10240
  v_mfma_f32_16x16x32_bf16 v[28:31], v[84:87], v[140:143], v[28:31]
  v_fma_mix_f32 v211, v161, v191, v201 op_sel:[1,0,0] op_sel_hi:[1,0,0]
  v_fma_mix_f32 v212, v162, v192, v202 op_sel:[0,0,0] op_sel_hi:[1,0,0]
  v_fma_mix_f32 v213, v162, v193, v203 op_sel:[1,0,0] op_sel_hi:[1,0,0]
  v_mfma_f32_16x16x32_bf16 v[32:35], v[88:91], v[136:139], v[32:35]
  ds_read_b128 v[124:127], v12 offset:11264
  ds_read_b128 v[128:131], v12 offset:12288
  v_mfma_f32_16x16x32_bf16 v[36:39], v[88:91], v[140:143], v[36:39]
  v_fma_mix_f32 v214, v163, v194, v204 op_sel:[0,0,0] op_sel_hi:[1,0,0]
  v_fma_mix_f32 v215, v163, v195, v205 op_sel:[1,0,0] op_sel_hi:[1,0,0]
  v_cvt_pk_bf16_f32 v144, v208, v209
  v_mfma_f32_16x16x32_bf16 v[40:43], v[92:95], v[136:139], v[40:43]
  ds_read_b128 v[132:135], v12 offset:13312
  ds_read_b128 v[152:155], v8 offset:1024
  v_mfma_f32_16x16x32_bf16 v[44:47], v[92:95], v[140:143], v[44:47]
  v_cvt_pk_bf16_f32 v145, v210, v211
  v_cvt_pk_bf16_f32 v146, v212, v213
  v_cvt_pk_bf16_f32 v147, v214, v215
  v_mfma_f32_16x16x32_bf16 v[48:51], v[96:99], v[136:139], v[48:51]
  ds_read_b128 v[156:159], v8 offset:3072
  ds_read_b128 v[168:171], v14 offset:3584
  v_mfma_f32_16x16x32_bf16 v[52:55], v[96:99], v[140:143], v[52:55]
  v_fma_mix_f32 v208, v164, v188, v198 op_sel:[0,0,0] op_sel_hi:[1,0,0]
  v_fma_mix_f32 v209, v164, v189, v199 op_sel:[1,0,0] op_sel_hi:[1,0,0]
  v_fma_mix_f32 v210, v165, v190, v200 op_sel:[0,0,0] op_sel_hi:[1,0,0]
  v_mfma_f32_16x16x32_bf16 v[56:59], v[136:139], v[100:103], v[56:59]
  ds_read_b128 v[172:175], v14 offset:3600
  ds_read_b128 v[178:181], v14 offset:3616
  v_mfma_f32_16x16x32_bf16 v[60:63], v[140:143], v[100:103], v[60:63]
  v_fma_mix_f32 v211, v165, v191, v201 op_sel:[1,0,0] op_sel_hi:[1,0,0]
  v_fma_mix_f32 v212, v166, v192, v202 op_sel:[0,0,0] op_sel_hi:[1,0,0]
  v_fma_mix_f32 v213, v166, v193, v203 op_sel:[1,0,0] op_sel_hi:[1,0,0]
  v_mfma_f32_16x16x32_bf16 v[64:67], v[136:139], v[104:107], v[64:67]
  ds_read_b128 v[182:185], v14 offset:3632
  v_mfma_f32_16x16x32_bf16 v[68:71], v[140:143], v[104:107], v[68:71]
  v_fma_mix_f32 v214, v167, v194, v204 op_sel:[0,0,0] op_sel_hi:[1,0,0]
  v_fma_mix_f32 v215, v167, v195, v205 op_sel:[1,0,0] op_sel_hi:[1,0,0]
  v_cvt_pk_bf16_f32 v148, v208, v209
  v_mfma_f32_16x16x32_bf16 v[72:75], v[136:139], v[96:99], v[72:75]
  v_mfma_f32_16x16x32_bf16 v[76:79], v[140:143], v[96:99], v[76:79]
  v_cvt_pk_bf16_f32 v149, v210, v211
  v_cvt_pk_bf16_f32 v150, v212, v213
  v_cvt_pk_bf16_f32 v151, v214, v215
  s_waitcnt lgkmcnt(0)
  s_barrier
  v_mfma_f32_16x16x32_bf16 v[16:19], v[108:111], v[144:147], v[16:19]
  ds_read_b128 v[80:83], v13 offset:0
  ds_read_b128 v[84:87], v13 offset:1024
  v_mfma_f32_16x16x32_bf16 v[20:23], v[108:111], v[148:151], v[20:23]
  v_fma_mix_f32 v208, v152, v168, v178 op_sel:[0,0,0] op_sel_hi:[1,0,0]
  v_fma_mix_f32 v209, v152, v169, v179 op_sel:[1,0,0] op_sel_hi:[1,0,0]
  v_fma_mix_f32 v210, v153, v170, v180 op_sel:[0,0,0] op_sel_hi:[1,0,0]
  v_mfma_f32_16x16x32_bf16 v[24:27], v[112:115], v[144:147], v[24:27]
  ds_read_b128 v[88:91], v13 offset:2048
  ds_read_b128 v[92:95], v13 offset:3072
  v_mfma_f32_16x16x32_bf16 v[28:31], v[112:115], v[148:151], v[28:31]
  v_fma_mix_f32 v211, v153, v171, v181 op_sel:[1,0,0] op_sel_hi:[1,0,0]
  v_fma_mix_f32 v212, v154, v172, v182 op_sel:[0,0,0] op_sel_hi:[1,0,0]
  v_fma_mix_f32 v213, v154, v173, v183 op_sel:[1,0,0] op_sel_hi:[1,0,0]
  v_mfma_f32_16x16x32_bf16 v[32:35], v[116:119], v[144:147], v[32:35]
  ds_read_b128 v[96:99], v13 offset:4096
  ds_read_b128 v[100:103], v13 offset:5120
  v_mfma_f32_16x16x32_bf16 v[36:39], v[116:119], v[148:151], v[36:39]
  v_fma_mix_f32 v214, v155, v174, v184 op_sel:[0,0,0] op_sel_hi:[1,0,0]
  v_fma_mix_f32 v215, v155, v175, v185 op_sel:[1,0,0] op_sel_hi:[1,0,0]
  v_cvt_pk_bf16_f32 v136, v208, v209
  v_mfma_f32_16x16x32_bf16 v[40:43], v[120:123], v[144:147], v[40:43]
  ds_read_b128 v[104:107], v13 offset:6144
  ds_read_b128 v[160:163], v9 offset:0
  v_mfma_f32_16x16x32_bf16 v[44:47], v[120:123], v[148:151], v[44:47]
  v_cvt_pk_bf16_f32 v137, v210, v211
  v_cvt_pk_bf16_f32 v138, v212, v213
  v_cvt_pk_bf16_f32 v139, v214, v215
  v_mfma_f32_16x16x32_bf16 v[48:51], v[124:127], v[144:147], v[48:51]
  ds_read_b128 v[164:167], v9 offset:2048
  ds_read_b128 v[188:191], v14 offset:3840
  v_mfma_f32_16x16x32_bf16 v[52:55], v[124:127], v[148:151], v[52:55]
  v_fma_mix_f32 v208, v156, v168, v178 op_sel:[0,0,0] op_sel_hi:[1,0,0]
  v_fma_mix_f32 v209, v156, v169, v179 op_sel:[1,0,0] op_sel_hi:[1,0,0]
  v_fma_mix_f32 v210, v157, v170, v180 op_sel:[0,0,0] op_sel_hi:[1,0,0]
  v_mfma_f32_16x16x32_bf16 v[56:59], v[144:147], v[128:131], v[56:59]
  ds_read_b128 v[192:195], v14 offset:3856
  ds_read_b128 v[198:201], v14 offset:3872
  v_mfma_f32_16x16x32_bf16 v[60:63], v[148:151], v[128:131], v[60:63]
  v_fma_mix_f32 v211, v157, v171, v181 op_sel:[1,0,0] op_sel_hi:[1,0,0]
  v_fma_mix_f32 v212, v158, v172, v182 op_sel:[0,0,0] op_sel_hi:[1,0,0]
  v_fma_mix_f32 v213, v158, v173, v183 op_sel:[1,0,0] op_sel_hi:[1,0,0]
  v_mfma_f32_16x16x32_bf16 v[64:67], v[144:147], v[132:135], v[64:67]
  ds_read_b128 v[202:205], v14 offset:3888
  v_mfma_f32_16x16x32_bf16 v[68:71], v[148:151], v[132:135], v[68:71]
  v_fma_mix_f32 v214, v159, v174, v184 op_sel:[0,0,0] op_sel_hi:[1,0,0]
  v_fma_mix_f32 v215, v159, v175, v185 op_sel:[1,0,0] op_sel_hi:[1,0,0]
  v_cvt_pk_bf16_f32 v140, v208, v209
  v_mfma_f32_16x16x32_bf16 v[72:75], v[144:147], v[124:127], v[72:75]
  v_mfma_f32_16x16x32_bf16 v[76:79], v[148:151], v[124:127], v[76:79]
  v_cvt_pk_bf16_f32 v141, v210, v211
  v_cvt_pk_bf16_f32 v142, v212, v213
  v_cvt_pk_bf16_f32 v143, v214, v215
  s_waitcnt lgkmcnt(0)
  v_mfma_f32_16x16x32_bf16 v[16:19], v[80:83], v[136:139], v[16:19]
  ds_read_b128 v[108:111], v13 offset:7168
  ds_read_b128 v[112:115], v13 offset:8192
  v_mfma_f32_16x16x32_bf16 v[20:23], v[80:83], v[140:143], v[20:23]
  v_fma_mix_f32 v208, v160, v188, v198 op_sel:[0,0,0] op_sel_hi:[1,0,0]
  v_fma_mix_f32 v209, v160, v189, v199 op_sel:[1,0,0] op_sel_hi:[1,0,0]
  v_fma_mix_f32 v210, v161, v190, v200 op_sel:[0,0,0] op_sel_hi:[1,0,0]
  v_mfma_f32_16x16x32_bf16 v[24:27], v[84:87], v[136:139], v[24:27]
  ds_read_b128 v[116:119], v13 offset:9216
  ds_read_b128 v[120:123], v13 offset:10240
  v_mfma_f32_16x16x32_bf16 v[28:31], v[84:87], v[140:143], v[28:31]
  v_fma_mix_f32 v211, v161, v191, v201 op_sel:[1,0,0] op_sel_hi:[1,0,0]
  v_fma_mix_f32 v212, v162, v192, v202 op_sel:[0,0,0] op_sel_hi:[1,0,0]
  v_fma_mix_f32 v213, v162, v193, v203 op_sel:[1,0,0] op_sel_hi:[1,0,0]
  v_mfma_f32_16x16x32_bf16 v[32:35], v[88:91], v[136:139], v[32:35]
  ds_read_b128 v[124:127], v13 offset:11264
  ds_read_b128 v[128:131], v13 offset:12288
  v_mfma_f32_16x16x32_bf16 v[36:39], v[88:91], v[140:143], v[36:39]
  v_fma_mix_f32 v214, v163, v194, v204 op_sel:[0,0,0] op_sel_hi:[1,0,0]
  v_fma_mix_f32 v215, v163, v195, v205 op_sel:[1,0,0] op_sel_hi:[1,0,0]
  v_cvt_pk_bf16_f32 v144, v208, v209
  v_mfma_f32_16x16x32_bf16 v[40:43], v[92:95], v[136:139], v[40:43]
  ds_read_b128 v[132:135], v13 offset:13312
  ds_read_b128 v[152:155], v9 offset:1024
  v_mfma_f32_16x16x32_bf16 v[44:47], v[92:95], v[140:143], v[44:47]
  v_cvt_pk_bf16_f32 v145, v210, v211
  v_cvt_pk_bf16_f32 v146, v212, v213
  v_cvt_pk_bf16_f32 v147, v214, v215
  v_mfma_f32_16x16x32_bf16 v[48:51], v[96:99], v[136:139], v[48:51]
  ds_read_b128 v[156:159], v9 offset:3072
  ds_read_b128 v[168:171], v14 offset:4096
  v_mfma_f32_16x16x32_bf16 v[52:55], v[96:99], v[140:143], v[52:55]
  v_fma_mix_f32 v208, v164, v188, v198 op_sel:[0,0,0] op_sel_hi:[1,0,0]
  v_fma_mix_f32 v209, v164, v189, v199 op_sel:[1,0,0] op_sel_hi:[1,0,0]
  v_fma_mix_f32 v210, v165, v190, v200 op_sel:[0,0,0] op_sel_hi:[1,0,0]
  v_mfma_f32_16x16x32_bf16 v[56:59], v[136:139], v[100:103], v[56:59]
  ds_read_b128 v[172:175], v14 offset:4112
  ds_read_b128 v[178:181], v14 offset:4128
  v_mfma_f32_16x16x32_bf16 v[60:63], v[140:143], v[100:103], v[60:63]
  v_fma_mix_f32 v211, v165, v191, v201 op_sel:[1,0,0] op_sel_hi:[1,0,0]
  v_fma_mix_f32 v212, v166, v192, v202 op_sel:[0,0,0] op_sel_hi:[1,0,0]
  v_fma_mix_f32 v213, v166, v193, v203 op_sel:[1,0,0] op_sel_hi:[1,0,0]
  v_mfma_f32_16x16x32_bf16 v[64:67], v[136:139], v[104:107], v[64:67]
  ds_read_b128 v[182:185], v14 offset:4144
  v_mfma_f32_16x16x32_bf16 v[68:71], v[140:143], v[104:107], v[68:71]
  v_fma_mix_f32 v214, v167, v194, v204 op_sel:[0,0,0] op_sel_hi:[1,0,0]
  v_fma_mix_f32 v215, v167, v195, v205 op_sel:[1,0,0] op_sel_hi:[1,0,0]
  v_cvt_pk_bf16_f32 v148, v208, v209
  v_mfma_f32_16x16x32_bf16 v[72:75], v[136:139], v[96:99], v[72:75]
  v_mfma_f32_16x16x32_bf16 v[76:79], v[140:143], v[96:99], v[76:79]
  v_cvt_pk_bf16_f32 v149, v210, v211
  v_cvt_pk_bf16_f32 v150, v212, v213
  v_cvt_pk_bf16_f32 v151, v214, v215
  s_waitcnt lgkmcnt(0)
  s_barrier
  v_mfma_f32_16x16x32_bf16 v[16:19], v[108:111], v[144:147], v[16:19]
  ds_read_b128 v[80:83], v10 offset:0
  ds_read_b128 v[84:87], v10 offset:1024
  v_mfma_f32_16x16x32_bf16 v[20:23], v[108:111], v[148:151], v[20:23]
  v_fma_mix_f32 v208, v152, v168, v178 op_sel:[0,0,0] op_sel_hi:[1,0,0]
  v_fma_mix_f32 v209, v152, v169, v179 op_sel:[1,0,0] op_sel_hi:[1,0,0]
  v_fma_mix_f32 v210, v153, v170, v180 op_sel:[0,0,0] op_sel_hi:[1,0,0]
  v_mfma_f32_16x16x32_bf16 v[24:27], v[112:115], v[144:147], v[24:27]
  ds_read_b128 v[88:91], v10 offset:2048
  ds_read_b128 v[92:95], v10 offset:3072
  v_mfma_f32_16x16x32_bf16 v[28:31], v[112:115], v[148:151], v[28:31]
  v_fma_mix_f32 v211, v153, v171, v181 op_sel:[1,0,0] op_sel_hi:[1,0,0]
  v_fma_mix_f32 v212, v154, v172, v182 op_sel:[0,0,0] op_sel_hi:[1,0,0]
  v_fma_mix_f32 v213, v154, v173, v183 op_sel:[1,0,0] op_sel_hi:[1,0,0]
  v_mfma_f32_16x16x32_bf16 v[32:35], v[116:119], v[144:147], v[32:35]
  ds_read_b128 v[96:99], v10 offset:4096
  ds_read_b128 v[100:103], v10 offset:5120
  v_mfma_f32_16x16x32_bf16 v[36:39], v[116:119], v[148:151], v[36:39]
  v_fma_mix_f32 v214, v155, v174, v184 op_sel:[0,0,0] op_sel_hi:[1,0,0]
  v_fma_mix_f32 v215, v155, v175, v185 op_sel:[1,0,0] op_sel_hi:[1,0,0]
  v_cvt_pk_bf16_f32 v136, v208, v209
  v_mfma_f32_16x16x32_bf16 v[40:43], v[120:123], v[144:147], v[40:43]
  ds_read_b128 v[104:107], v10 offset:6144
  ds_read_b128 v[160:163], v6 offset:0
  v_mfma_f32_16x16x32_bf16 v[44:47], v[120:123], v[148:151], v[44:47]
  v_cvt_pk_bf16_f32 v137, v210, v211
  v_cvt_pk_bf16_f32 v138, v212, v213
  v_cvt_pk_bf16_f32 v139, v214, v215
  v_mfma_f32_16x16x32_bf16 v[48:51], v[124:127], v[144:147], v[48:51]
  ds_read_b128 v[164:167], v6 offset:2048
  ds_read_b128 v[188:191], v14 offset:4352
  v_mfma_f32_16x16x32_bf16 v[52:55], v[124:127], v[148:151], v[52:55]
  v_fma_mix_f32 v208, v156, v168, v178 op_sel:[0,0,0] op_sel_hi:[1,0,0]
  v_fma_mix_f32 v209, v156, v169, v179 op_sel:[1,0,0] op_sel_hi:[1,0,0]
  v_fma_mix_f32 v210, v157, v170, v180 op_sel:[0,0,0] op_sel_hi:[1,0,0]
  v_mfma_f32_16x16x32_bf16 v[56:59], v[144:147], v[128:131], v[56:59]
  ds_read_b128 v[192:195], v14 offset:4368
  ds_read_b128 v[198:201], v14 offset:4384
  v_mfma_f32_16x16x32_bf16 v[60:63], v[148:151], v[128:131], v[60:63]
  v_fma_mix_f32 v211, v157, v171, v181 op_sel:[1,0,0] op_sel_hi:[1,0,0]
  v_fma_mix_f32 v212, v158, v172, v182 op_sel:[0,0,0] op_sel_hi:[1,0,0]
  v_fma_mix_f32 v213, v158, v173, v183 op_sel:[1,0,0] op_sel_hi:[1,0,0]
  v_mfma_f32_16x16x32_bf16 v[64:67], v[144:147], v[132:135], v[64:67]
  ds_read_b128 v[202:205], v14 offset:4400
  v_mfma_f32_16x16x32_bf16 v[68:71], v[148:151], v[132:135], v[68:71]
  v_fma_mix_f32 v214, v159, v174, v184 op_sel:[0,0,0] op_sel_hi:[1,0,0]
  v_fma_mix_f32 v215, v159, v175, v185 op_sel:[1,0,0] op_sel_hi:[1,0,0]
  v_cvt_pk_bf16_f32 v140, v208, v209
  v_mfma_f32_16x16x32_bf16 v[72:75], v[144:147], v[124:127], v[72:75]
  v_mfma_f32_16x16x32_bf16 v[76:79], v[148:151], v[124:127], v[76:79]
  v_cvt_pk_bf16_f32 v141, v210, v211
  v_cvt_pk_bf16_f32 v142, v212, v213
  v_cvt_pk_bf16_f32 v143, v214, v215
  s_waitcnt lgkmcnt(0)
  v_mfma_f32_16x16x32_bf16 v[16:19], v[80:83], v[136:139], v[16:19]
  ds_read_b128 v[108:111], v10 offset:7168
  ds_read_b128 v[112:115], v10 offset:8192
  v_mfma_f32_16x16x32_bf16 v[20:23], v[80:83], v[140:143], v[20:23]
  v_fma_mix_f32 v208, v160, v188, v198 op_sel:[0,0,0] op_sel_hi:[1,0,0]
  v_fma_mix_f32 v209, v160, v189, v199 op_sel:[1,0,0] op_sel_hi:[1,0,0]
  v_fma_mix_f32 v210, v161, v190, v200 op_sel:[0,0,0] op_sel_hi:[1,0,0]
  v_mfma_f32_16x16x32_bf16 v[24:27], v[84:87], v[136:139], v[24:27]
  ds_read_b128 v[116:119], v10 offset:9216
  ds_read_b128 v[120:123], v10 offset:10240
  v_mfma_f32_16x16x32_bf16 v[28:31], v[84:87], v[140:143], v[28:31]
  v_fma_mix_f32 v211, v161, v191, v201 op_sel:[1,0,0] op_sel_hi:[1,0,0]
  v_fma_mix_f32 v212, v162, v192, v202 op_sel:[0,0,0] op_sel_hi:[1,0,0]
  v_fma_mix_f32 v213, v162, v193, v203 op_sel:[1,0,0] op_sel_hi:[1,0,0]
  v_mfma_f32_16x16x32_bf16 v[32:35], v[88:91], v[136:139], v[32:35]
  ds_read_b128 v[124:127], v10 offset:11264
  ds_read_b128 v[128:131], v10 offset:12288
  v_mfma_f32_16x16x32_bf16 v[36:39], v[88:91], v[140:143], v[36:39]
  v_fma_mix_f32 v214, v163, v194, v204 op_sel:[0,0,0] op_sel_hi:[1,0,0]
  v_fma_mix_f32 v215, v163, v195, v205 op_sel:[1,0,0] op_sel_hi:[1,0,0]
  v_cvt_pk_bf16_f32 v144, v208, v209
  v_mfma_f32_16x16x32_bf16 v[40:43], v[92:95], v[136:139], v[40:43]
  ds_read_b128 v[132:135], v10 offset:13312
  v_mfma_f32_16x16x32_bf16 v[44:47], v[92:95], v[140:143], v[44:47]
  v_cvt_pk_bf16_f32 v145, v210, v211
  v_cvt_pk_bf16_f32 v146, v212, v213
  v_cvt_pk_bf16_f32 v147, v214, v215
  v_mfma_f32_16x16x32_bf16 v[48:51], v[96:99], v[136:139], v[48:51]
  v_mfma_f32_16x16x32_bf16 v[52:55], v[96:99], v[140:143], v[52:55]
  v_fma_mix_f32 v208, v164, v188, v198 op_sel:[0,0,0] op_sel_hi:[1,0,0]
  v_fma_mix_f32 v209, v164, v189, v199 op_sel:[1,0,0] op_sel_hi:[1,0,0]
  v_fma_mix_f32 v210, v165, v190, v200 op_sel:[0,0,0] op_sel_hi:[1,0,0]
  v_mfma_f32_16x16x32_bf16 v[56:59], v[136:139], v[100:103], v[56:59]
  v_mfma_f32_16x16x32_bf16 v[60:63], v[140:143], v[100:103], v[60:63]
  v_fma_mix_f32 v211, v165, v191, v201 op_sel:[1,0,0] op_sel_hi:[1,0,0]
  v_fma_mix_f32 v212, v166, v192, v202 op_sel:[0,0,0] op_sel_hi:[1,0,0]
  v_fma_mix_f32 v213, v166, v193, v203 op_sel:[1,0,0] op_sel_hi:[1,0,0]
  v_mfma_f32_16x16x32_bf16 v[64:67], v[136:139], v[104:107], v[64:67]
  v_mfma_f32_16x16x32_bf16 v[68:71], v[140:143], v[104:107], v[68:71]
  v_fma_mix_f32 v214, v167, v194, v204 op_sel:[0,0,0] op_sel_hi:[1,0,0]
  v_fma_mix_f32 v215, v167, v195, v205 op_sel:[1,0,0] op_sel_hi:[1,0,0]
  v_cvt_pk_bf16_f32 v148, v208, v209
  v_mfma_f32_16x16x32_bf16 v[72:75], v[136:139], v[96:99], v[72:75]
  v_mfma_f32_16x16x32_bf16 v[76:79], v[140:143], v[96:99], v[76:79]
  v_cvt_pk_bf16_f32 v149, v210, v211
  v_cvt_pk_bf16_f32 v150, v212, v213
  v_cvt_pk_bf16_f32 v151, v214, v215
  s_waitcnt lgkmcnt(0)
  v_mfma_f32_16x16x32_bf16 v[16:19], v[108:111], v[144:147], v[16:19]
  v_mfma_f32_16x16x32_bf16 v[20:23], v[108:111], v[148:151], v[20:23]
  v_mfma_f32_16x16x32_bf16 v[24:27], v[112:115], v[144:147], v[24:27]
  v_mfma_f32_16x16x32_bf16 v[28:31], v[112:115], v[148:151], v[28:31]
  v_mfma_f32_16x16x32_bf16 v[32:35], v[116:119], v[144:147], v[32:35]
  v_mfma_f32_16x16x32_bf16 v[36:39], v[116:119], v[148:151], v[36:39]
  v_mfma_f32_16x16x32_bf16 v[40:43], v[120:123], v[144:147], v[40:43]
  v_mfma_f32_16x16x32_bf16 v[44:47], v[120:123], v[148:151], v[44:47]
  v_mfma_f32_16x16x32_bf16 v[48:51], v[124:127], v[144:147], v[48:51]
  v_mfma_f32_16x16x32_bf16 v[52:55], v[124:127], v[148:151], v[52:55]
  v_mfma_f32_16x16x32_bf16 v[56:59], v[144:147], v[128:131], v[56:59]
  v_mfma_f32_16x16x32_bf16 v[60:63], v[148:151], v[128:131], v[60:63]
  v_mfma_f32_16x16x32_bf16 v[64:67], v[144:147], v[132:135], v[64:67]
  v_mfma_f32_16x16x32_bf16 v[68:71], v[148:151], v[132:135], v[68:71]
  v_mfma_f32_16x16x32_bf16 v[72:75], v[144:147], v[124:127], v[72:75]
  v_mfma_f32_16x16x32_bf16 v[76:79], v[148:151], v[124:127], v[76:79]
  v_mul_f32 v16, s22, v16
  v_mul_f32 v17, s22, v17
  v_mul_f32 v18, s22, v18
  v_mul_f32 v19, s22, v19
  v_cvt_pk_bf16_f32 v80, v16, v17
  v_cvt_pk_bf16_f32 v81, v18, v19
  buffer_store_dwordx2 v[80:81], v219, s[16:19], 0 offen offset:0 sc1
  v_mul_f32 v20, s22, v20
  v_mul_f32 v21, s22, v21
  v_mul_f32 v22, s22, v22
  v_mul_f32 v23, s22, v23
  v_cvt_pk_bf16_f32 v82, v20, v21
  v_cvt_pk_bf16_f32 v83, v22, v23
  buffer_store_dwordx2 v[82:83], v219, s[16:19], 0 offen offset:256 sc1
  v_mul_f32 v24, s22, v24
  v_mul_f32 v25, s22, v25
  v_mul_f32 v26, s22, v26
  v_mul_f32 v27, s22, v27
  v_cvt_pk_bf16_f32 v84, v24, v25
  v_cvt_pk_bf16_f32 v85, v26, v27
  buffer_store_dwordx2 v[84:85], v219, s[16:19], s23 offen offset:0 sc1
  v_mul_f32 v28, s22, v28
  v_mul_f32 v29, s22, v29
  v_mul_f32 v30, s22, v30
  v_mul_f32 v31, s22, v31
  v_cvt_pk_bf16_f32 v86, v28, v29
  v_cvt_pk_bf16_f32 v87, v30, v31
  buffer_store_dwordx2 v[86:87], v219, s[16:19], s23 offen offset:256 sc1
  v_cvt_pk_bf16_f32 v88, v32, v33
  v_cvt_pk_bf16_f32 v89, v34, v35
  buffer_store_dwordx2 v[88:89], v220, s[16:19], s24 offen offset:0 sc1
  v_cvt_pk_bf16_f32 v90, v36, v37
  v_cvt_pk_bf16_f32 v91, v38, v39
  buffer_store_dwordx2 v[90:91], v220, s[16:19], s24 offen offset:128 sc1
  v_cvt_pk_bf16_f32 v92, v40, v41
  v_cvt_pk_bf16_f32 v93, v42, v43
  buffer_store_dwordx2 v[92:93], v220, s[16:19], s25 offen offset:0 sc1
  v_cvt_pk_bf16_f32 v94, v44, v45
  v_cvt_pk_bf16_f32 v95, v46, v47
  buffer_store_dwordx2 v[94:95], v220, s[16:19], s25 offen offset:128 sc1
  v_permlane32_swap_b32 v48, v50
  v_permlane32_swap_b32 v49, v51
  s_nop 1
  v_permlane16_swap_b32 v48, v49
  v_permlane16_swap_b32 v50, v51
  v_mul_f32 v48, v223, v48
  v_mul_f32 v49, v223, v49
  v_mul_f32 v50, v223, v50
  v_mul_f32 v51, v223, v51
  v_cvt_pk_bf16_f32 v96, v48, v49
  v_cvt_pk_bf16_f32 v97, v50, v51
  buffer_store_dwordx2 v[96:97], v221, s[16:19], 0 offen sc1
  v_permlane32_swap_b32 v52, v54
  v_permlane32_swap_b32 v53, v55
  s_nop 1
  v_permlane16_swap_b32 v52, v53
  v_permlane16_swap_b32 v54, v55
  v_mul_f32 v52, v223, v52
  v_mul_f32 v53, v223, v53
  v_mul_f32 v54, v223, v54
  v_mul_f32 v55, v223, v55
  v_cvt_pk_bf16_f32 v98, v52, v53
  v_cvt_pk_bf16_f32 v99, v54, v55
  buffer_store_dwordx2 v[98:99], v222, s[16:19], 0 offen sc1
  v_cmp_le_u32 vcc, 12, v224
  v_mov_b32 v2, 0x3f803f80
  v_cvt_pk_bf16_f32 v108, v56, v57
  v_cvt_pk_bf16_f32 v109, v58, v59
  v_cvt_pk_bf16_f32 v110, v60, v61
  v_cvt_pk_bf16_f32 v111, v62, v63
  buffer_store_dwordx4 v[108:111], v225, s[16:19], 0 offen sc1
  v_cvt_pk_bf16_f32 v112, v64, v65
  v_cvt_pk_bf16_f32 v113, v66, v67
  v_cvt_pk_bf16_f32 v114, v68, v69
  v_cvt_pk_bf16_f32 v115, v70, v71
  buffer_store_dwordx4 v[112:115], v226, s[16:19], 0 offen sc1
  v_cvt_pk_bf16_f32 v116, v72, v73
  v_cvt_pk_bf16_f32 v117, v74, v75
  v_cvt_pk_bf16_f32 v118, v76, v77
  v_cvt_pk_bf16_f32 v119, v78, v79
  v_cndmask_b32 v116, v116, v2, vcc
  v_cndmask_b32 v117, v117, v2, vcc
  v_cndmask_b32 v118, v118, v2, vcc
  v_cndmask_b32 v119, v119, v2, vcc
  buffer_store_dwordx4 v[116:119], v227, s[16:19], 0 offen sc1
  s_branch L_k23_join
L_k2_prod:
  s_sub_u32 s14, s10, 4
  s_mul_i32 s15, s11, 129024
  s_mul_i32 s24, s14, 3584
  s_add_u32 s15, s15, s24
  v_lshl_add_u32 v6, v1, 4, s15
  v_and_b32 v2, 3, v1
  v_add_u32 v2, 1, v2
  v_lshrrev_b32 v2, 2, v2
  v_and_b32 v2, s14, v2
  v_lshl_or_b32 v7, v2, 30, v6
  s_lshl_b32 s20, s12, 3
  s_lshl_b32 s21, s14, 1
  s_add_u32 s20, s20, s21
  s_mul_i32 s20, s20, 18432
  v_lshl_add_u32 v8, v1, 4, s20
  v_add_u32 v9, 18432, v8
  s_lshl_b32 s23, s14, 12
  s_lshl_b32 s21, s14, 11
  s_add_u32 s21, s21, 127488
  s_add_u32 s24, s24, 16384
  s_waitcnt lgkmcnt(0)
  s_add_u32 s28, s6, 0x933000
  s_addc_u32 s29, s7, 0
  s_mov_b32 s30, 0x1f8000
  s_mov_b32 s31, 0x20000
  s_add_u32 s32, s6, 0x6e0000
  s_addc_u32 s33, s7, 0
  s_mov_b32 s34, 0x240000
  s_mov_b32 s35, 0x20000
  s_add_u32 s36, s6, 0x920000
  s_addc_u32 s37, s7, 0
  s_mov_b32 s38, 0x3600
  s_mov_b32 s39, 0x20000
  s_cmp_eq_u32 s10, 4
  s_cbranch_scc0 L_k2_nopoll
  v_mov_b32 v3, 0
  v_writelane_b32 v3, 16, 0
  v_writelane_b32 v3, 16, 1
  s_mov_b32 s26, 0x40000
L_k2_poll_chk:
  v_mov_b32 v4, 0x7fffffff
  s_bfm_b64 exec, 2, 0
  v_mov_b32 v4, 0
  buffer_atomic_add v4, v250, s[44:47], 0 offen sc0 sc1
  s_mov_b64 exec, -1
  s_waitcnt vmcnt(0)
  v_cmp_lt_u32 vcc, v4, v3
  s_nop 1
  s_cbranch_vccz L_k2_poll_ok
  s_sub_u32 s26, s26, 1
  s_cbranch_scc1 L_k2_poll_ok
  s_sleep 2
  s_branch L_k2_poll_chk
L_k2_poll_ok:
  v_mov_b32 v2, 1
  s_mov_b64 exec, 1
  ds_add_u32 v251, v2 offset:8
  s_mov_b64 exec, -1
  s_branch L_k2_pgo
L_k2_nopoll:
  s_mov_b32 s51, 0x400000
L_k2_pw1:
  ds_read_b32 v2, v251 offset:8
  s_waitcnt lgkmcnt(0)
  v_readfirstlane_b32 s50, v2
  s_nop 0
  s_cmp_ge_u32 s50, 1
  s_cbranch_scc1 L_k2_pw1_ok
  s_sub_u32 s51, s51, 1
  s_cbranch_scc1 L_k2_pw1_ok
  s_sleep 1
  s_branch L_k2_pw1
L_k2_pw1_ok:
L_k2_pgo:
  s_mov_b32 s25, 1024
  s_mov_b32 s26, 0
  s_add_u32 m0, s21, 0
  s_nop 0
  buffer_load_dwordx4 v8, s[32:35], 0 offen sc1 lds
  s_add_u32 m0, s23, 0
  s_nop 0
  buffer_load_dwordx4 v8, s[32:35], s25 offen sc1 lds
  buffer_load_dwordx4 v8, s[32:35], s25 offen offset:1024 sc1 lds
  s_add_u32 m0, s21, 1024
  s_nop 0
  buffer_load_dwordx4 v9, s[32:35], 0 offen sc1 lds
  s_add_u32 m0, s23, 2048
  s_nop 0
  buffer_load_dwordx4 v9, s[32:35], s25 offen sc1 lds
  buffer_load_dwordx4 v9, s[32:35], s25 offen offset:1024 sc1 lds
  s_add_u32 m0, s24, 0
  s_bfm_b64 exec, 32, 0
  buffer_load_dwordx4 v6, s[28:31], s26 offen sc1 lds
  s_mov_b64 exec, -1
  buffer_load_dwordx4 v7, s[28:31], s26 offen offset:512 sc1 lds
  buffer_load_dwordx4 v6, s[28:31], s26 offen offset:1536 sc1 lds
  buffer_load_dwordx4 v6, s[28:31], s26 offen offset:2560 sc1 lds
  s_mov_b32 s25, 3072
  s_mov_b32 s26, 14336
  s_add_u32 m0, s23, 30720
  s_nop 0
  buffer_load_dwordx4 v8, s[32:35], s25 offen sc1 lds
  buffer_load_dwordx4 v8, s[32:35], s25 offen offset:1024 sc1 lds
  s_add_u32 m0, s23, 32768
  s_nop 0
  buffer_load_dwordx4 v9, s[32:35], s25 offen sc1 lds
  buffer_load_dwordx4 v9, s[32:35], s25 offen offset:1024 sc1 lds
  s_add_u32 m0, s24, 30720
  s_bfm_b64 exec, 32, 0
  buffer_load_dwordx4 v6, s[28:31], s26 offen sc1 lds
  s_mov_b64 exec, -1
  buffer_load_dwordx4 v7, s[28:31], s26 offen offset:512 sc1 lds
  buffer_load_dwordx4 v6, s[28:31], s26 offen offset:1536 sc1 lds
  buffer_load_dwordx4 v6, s[28:31], s26 offen offset:2560 sc1 lds
  s_waitcnt vmcnt(8)
  s_barrier
  s_mov_b32 s25, 5120
  s_mov_b32 s26, 28672
  s_add_u32 m0, s23, 61440
  s_nop 0
  buffer_load_dwordx4 v8, s[32:35], s25 offen sc1 lds
  buffer_load_dwordx4 v8, s[32:35], s25 offen offset:1024 sc1 lds
  s_add_u32 m0, s23, 63488
  s_nop 0
  buffer_load_dwordx4 v9, s[32:35], s25 offen sc1 lds
  buffer_load_dwordx4 v9, s[32:35], s25 offen offset:1024 sc1 lds
  s_add_u32 m0, s24, 61440
  s_bfm_b64 exec, 32, 0
  buffer_load_dwordx4 v6, s[28:31], s26 offen sc1 lds
  s_mov_b64 exec, -1
  buffer_load_dwordx4 v7, s[28:31], s26 offen offset:512 sc1 lds
  buffer_load_dwordx4 v6, s[28:31], s26 offen offset:1536 sc1 lds
  buffer_load_dwordx4 v6, s[28:31], s26 offen offset:2560 sc1 lds
  s_mov_b32 s25, 7168
  s_mov_b32 s26, 43008
  s_add_u32 m0, s23, 92160
  s_nop 0
  buffer_load_dwordx4 v8, s[32:35], s25 offen sc1 lds
  buffer_load_dwordx4 v8, s[32:35], s25 offen offset:1024 sc1 lds
  s_add_u32 m0, s23, 94208
  s_nop 0
  buffer_load_dwordx4 v9, s[32:35], s25 offen sc1 lds
  buffer_load_dwordx4 v9, s[32:35], s25 offen offset:1024 sc1 lds
  s_add_u32 m0, s24, 92160
  s_bfm_b64 exec, 32, 0
  buffer_load_dwordx4 v6, s[28:31], s26 offen sc1 lds
  s_mov_b64 exec, -1
  buffer_load_dwordx4 v7, s[28:31], s26 offen offset:512 sc1 lds
  buffer_load_dwordx4 v6, s[28:31], s26 offen offset:1536 sc1 lds
  buffer_load_dwordx4 v6, s[28:31], s26 offen offset:2560 sc1 lds
  s_waitcnt vmcnt(16)
  s_barrier
  s_mov_b32 s25, 9216
  s_mov_b32 s26, 57344
  s_add_u32 m0, s23, 0
  s_nop 0
  buffer_load_dwordx4 v8, s[32:35], s25 offen sc1 lds
  buffer_load_dwordx4 v8, s[32:35], s25 offen offset:1024 sc1 lds
  s_add_u32 m0, s23, 2048
  s_nop 0
  buffer_load_dwordx4 v9, s[32:35], s25 offen sc1 lds
  buffer_load_dwordx4 v9, s[32:35], s25 offen offset:1024 sc1 lds
  s_add_u32 m0, s24, 0
  s_bfm_b64 exec, 32, 0
  buffer_load_dwordx4 v6, s[28:31], s26 offen sc1 lds
  s_mov_b64 exec, -1
  buffer_load_dwordx4 v7, s[28:31], s26 offen offset:512 sc1 lds
  buffer_load_dwordx4 v6, s[28:31], s26 offen offset:1536 sc1 lds
  buffer_load_dwordx4 v6, s[28:31], s26 offen offset:2560 sc1 lds
  s_waitcnt vmcnt(16)
  s_barrier
  s_mov_b32 s25, 11264
  s_mov_b32 s26, 71680
  s_add_u32 m0, s23, 30720
  s_nop 0
  buffer_load_dwordx4 v8, s[32:35], s25 offen sc1 lds
  buffer_load_dwordx4 v8, s[32:35], s25 offen offset:1024 sc1 lds
  s_add_u32 m0, s23, 32768
  s_nop 0
  buffer_load_dwordx4 v9, s[32:35], s25 offen sc1 lds
  buffer_load_dwordx4 v9, s[32:35], s25 offen offset:1024 sc1 lds
  s_add_u32 m0, s24, 30720
  s_bfm_b64 exec, 32, 0
  buffer_load_dwordx4 v6, s[28:31], s26 offen sc1 lds
  s_mov_b64 exec, -1
  buffer_load_dwordx4 v7, s[28:31], s26 offen offset:512 sc1 lds
  buffer_load_dwordx4 v6, s[28:31], s26 offen offset:1536 sc1 lds
  buffer_load_dwordx4 v6, s[28:31], s26 offen offset:2560 sc1 lds
  s_waitcnt vmcnt(16)
  s_barrier
  s_mov_b32 s25, 13312
  s_mov_b32 s26, 86016
  s_add_u32 m0, s23, 61440
  s_nop 0
  buffer_load_dwordx4 v8, s[32:35], s25 offen sc1 lds
  buffer_load_dwordx4 v8, s[32:35], s25 offen offset:1024 sc1 lds
  s_add_u32 m0, s23, 63488
  s_nop 0
  buffer_load_dwordx4 v9, s[32:35], s25 offen sc1 lds
  buffer_load_dwordx4 v9, s[32:35], s25 offen offset:1024 sc1 lds
  s_add_u32 m0, s24, 61440
  s_bfm_b64 exec, 32, 0
  buffer_load_dwordx4 v6, s[28:31], s26 offen sc1 lds
  s_mov_b64 exec, -1
  buffer_load_dwordx4 v7, s[28:31], s26 offen offset:512 sc1 lds
  buffer_load_dwordx4 v6, s[28:31], s26 offen offset:1536 sc1 lds
  buffer_load_dwordx4 v6, s[28:31], s26 offen offset:2560 sc1 lds
  s_waitcnt vmcnt(16)
  s_barrier
  s_mov_b32 s25, 15360
  s_mov_b32 s26, 100352
  s_add_u32 m0, s23, 92160
  s_nop 0
  buffer_load_dwordx4 v8, s[32:35], s25 offen sc1 lds
  buffer_load_dwordx4 v8, s[32:35], s25 offen offset:1024 sc1 lds
  s_add_u32 m0, s23, 94208
  s_nop 0
  buffer_load_dwordx4 v9, s[32:35], s25 offen sc1 lds
  buffer_load_dwordx4 v9, s[32:35], s25 offen offset:1024 sc1 lds
  s_add_u32 m0, s24, 92160
  s_bfm_b64 exec, 32, 0
  buffer_load_dwordx4 v6, s[28:31], s26 offen sc1 lds
  s_mov_b64 exec, -1
  buffer_load_dwordx4 v7, s[28:31], s26 offen offset:512 sc1 lds
  buffer_load_dwordx4 v6, s[28:31], s26 offen offset:1536 sc1 lds
  buffer_load_dwordx4 v6, s[28:31], s26 offen offset:2560 sc1 lds
  s_waitcnt vmcnt(16)
  s_barrier
  s_mov_b32 s25, 17408
  s_mov_b32 s26, 114688
  s_add_u32 m0, s23, 0
  s_nop 0
  buffer_load_dwordx4 v8, s[32:35], s25 offen sc1 lds
  s_add_u32 m0, s23, 2048
  s_nop 0
  buffer_load_dwordx4 v9, s[32:35], s25 offen sc1 lds
  s_add_u32 m0, s24, 0
  s_bfm_b64 exec, 32, 0
  buffer_load_dwordx4 v6, s[28:31], s26 offen sc1 lds
  s_mov_b64 exec, -1
  buffer_load_dwordx4 v7, s[28:31], s26 offen offset:512 sc1 lds
  buffer_load_dwordx4 v6, s[28:31], s26 offen offset:1536 sc1 lds
  buffer_load_dwordx4 v6, s[28:31], s26 offen offset:2560 sc1 lds
  s_waitcnt vmcnt(14)
  s_barrier
  s_waitcnt vmcnt(6)
  s_barrier
  s_waitcnt vmcnt(0)
  s_barrier
  s_lshl_b32 s15, s2, 2
  s_add_u32 s15, s15, s14
  s_cmp_ge_u32 s15, 9
  s_cbranch_scc1 L_k23_join
  s_mov_b32 s27, 39040
  v_mov_b32 v2, 0
  v_mov_b32 v3, 0x7fffffff
  s_bfm_b64 exec, 1, 0
  v_mov_b32 v3, 0
  buffer_atomic_add v3, v2, s[44:47], s27 offen sc0 sc1
  s_mov_b64 exec, -1
  s_waitcnt vmcnt(0)
  s_mov_b32 s26, 0x40000
L_k2_pollg_chk:
  v_readfirstlane_b32 s25, v3
  s_nop 0
  s_cmp_ge_u32 s25, 144
  s_cbranch_scc1 L_k2_pollg_ok
  s_sub_u32 s26, s26, 1
  s_cbranch_scc1 L_k2_pollg_ok
  s_sleep 8
  v_mov_b32 v3, 0x7fffffff
  s_bfm_b64 exec, 1, 0
  v_mov_b32 v3, 0
  buffer_atomic_add v3, v2, s[44:47], s27 offen sc0 sc1
  s_mov_b64 exec, -1
  s_waitcnt vmcnt(0)
  s_branch L_k2_pollg_chk
L_k2_pollg_ok:
  s_add_u32 s28, s6, 0x924000
  s_addc_u32 s29, s7, 0
  s_mov_b32 s30, 0xd800
  s_mov_b32 s31, 0x20000
  s_add_u32 s32, s6, 0x932000
  s_addc_u32 s33, s7, 0
  s_mov_b32 s34, 0x900
  s_mov_b32 s35, 0x20000
  s_lshl_b32 s15, s15, 6
  v_add_u32 v2, s15, v1
  v_lshlrev_b32 v3, 4, v2
  s_mov_b32 s26, 4608
  buffer_load_dwordx4 v[12:15], v3, s[28:31], s26 offen sc1
  s_mov_b32 s26, 18432
  buffer_load_dwordx4 v[16:19], v3, s[28:31], s26 offen sc1
  s_mov_b32 s26, 32256
  buffer_load_dwordx4 v[20:23], v3, s[28:31], s26 offen sc1
  s_mov_b32 s26, 46080
  buffer_load_dwordx4 v[24:27], v3, s[28:31], s26 offen sc1
  v_lshrrev_b32 v4, 4, v2
  v_mul_u32_u24 v4, 29, v4
  v_lshrrev_b32 v4, 8, v4
  v_mul_u32_u24 v5, 144, v4
  v_sub_u32 v5, v2, v5
  v_cmp_eq_u32 vcc, 2, v4
  s_nop 1
  v_cndmask_b32 v2, 0, 1.0, vcc
  v_lshrrev_b32 v6, 3, v5
  v_and_b32 v5, 7, v5
  v_lshlrev_b32 v5, 3, v5
  v_lshl_add_u32 v5, v6, 7, v5
  v_sub_u32 v4, 2, v4
  v_lshl_add_u32 v5, v4, 6, v5
  v_lshrrev_b32 v4, 1, v4
  v_lshl_or_b32 v5, v4, 20, v5
  s_mov_b32 s26, 4608
  s_waitcnt vmcnt(0)
  v_pk_add_f32 v[12:13], v[12:13], v[16:17]
  v_pk_add_f32 v[20:21], v[20:21], v[24:25]
  v_pk_add_f32 v[14:15], v[14:15], v[18:19]
  v_pk_add_f32 v[22:23], v[22:23], v[26:27]
  v_pk_add_f32 v[12:13], v[12:13], v[20:21]
  v_pk_add_f32 v[14:15], v[14:15], v[22:23]
  v_cvt_pk_bf16_f32 v16, v12, v13
  v_cvt_pk_bf16_f32 v17, v14, v15
  v_lshlrev_b32 v12, 16, v16
  v_and_b32 v13, 0xffff0000, v16
  v_lshlrev_b32 v14, 16, v17
  v_and_b32 v15, 0xffff0000, v17
  v_add_f32 v12, v12, v2
  v_add_f32 v13, v13, v2
  v_add_f32 v14, v14, v2
  v_add_f32 v15, v15, v2
  v_cvt_pk_bf16_f32 v16, v12, v13
  v_cvt_pk_bf16_f32 v17, v14, v15
  v_lshlrev_b32 v12, 16, v16
  v_and_b32 v13, 0xffff0000, v16
  v_lshlrev_b32 v14, 16, v17
  v_and_b32 v15, 0xffff0000, v17
  buffer_store_dwordx4 v[12:15], v3, s[36:39], s26 offen sc1
  buffer_store_dwordx2 v[16:17], v5, s[32:35], 0 offen sc1
L_k23_join:
  s_waitcnt lgkmcnt(0)
  s_and_b32 s54, s11, 15
  s_load_dwordx2 s[6:7], s[0:1], 96
  s_load_dwordx2 s[4:5], s[0:1], 32
  s_load_dwordx2 s[8:9], s[0:1], 56
  s_load_dwordx2 s[44:45], s[0:1], 40
  v_lshrrev_b32 v2, 6, v0
  v_and_b32 v1, 63, v0
  v_readfirstlane_b32 s10, v2
  s_and_b32 s11, s2, 7
  s_lshl_b32 s11, s11, 2
  s_lshr_b32 s12, s2, 6
  s_add_u32 s11, s11, s12
  s_bfe_u32 s12, s2, 0x30003
  s_lshl_b32 s12, s12, 3
  s_and_b32 s13, s10, 3
  s_lshl_b32 s13, s13, 1
  s_add_u32 s12, s12, s13
  s_lshr_b32 s31, s10, 2
  s_add_u32 s12, s12, s31
  v_lshlrev_b32 v6, 4, v1
  s_lshl_b32 s13, s11, 16
  s_lshl_b32 s14, s12, 10
  s_add_u32 s14, s14, s13
  s_lshr_b32 s15, s11, 1
  s_lshl_b32 s15, s15, 14
  s_lshl_b32 s20, s12, 8
  s_add_u32 s20, s20, s15
  s_add_u32 s20, s20, 4194304
  v_and_b32 v2, 31, v1
  v_lshlrev_b32 v8, 3, v2
  v_mov_b32 v15, v8
  s_waitcnt lgkmcnt(0)
  s_mov_b32 s16, s6
  s_mov_b32 s17, s7
  s_mov_b32 s18, 0x6e0000
  s_mov_b32 s19, 0x20000
  s_add_u32 s21, s13, 2097152
  s_add_u32 s22, s15, 4456448
  s_mul_i32 s23, s11, 77824
  s_add_u32 s23, s23, 4718592
  s_mov_b32 s34, 0x05040100
  s_mov_b32 s35, 0x07060302
  s_lshl_b32 s24, s2, 9
  v_add_u32 v2, s24, v0
  s_cmp_ge_u32 s2, 162
  s_cbranch_scc1 L_k3_wout
  s_mov_b32 s36, s4
  s_mov_b32 s37, s5
  s_mov_b32 s38, 0x510000
  s_mov_b32 s39, 0x20000
  s_add_u32 s40, s6, 0xbcd000
  s_addc_u32 s41, s7, 0
  s_mov_b32 s42, 0x510000
  s_mov_b32 s43, 0x20000
  s_mov_b32 s33, 9216
  v_lshrrev_b32 v3, 7, v2
  v_mul_u32_u24 v3, 911, v3
  v_lshrrev_b32 v3, 13, v3
  v_mul_u32_u24 v4, 1152, v3
  v_sub_u32 v4, v2, v4
  v_lshlrev_b32 v11, 3, v4
  v_lshrrev_b32 v2, 2, v4
  v_mul_u32_u24 v2, 57, v2
  v_lshrrev_b32 v2, 9, v2
  v_mul_u32_u24 v5, 36, v2
  v_sub_u32 v5, v4, v5
  v_lshrrev_b32 v4, 2, v5
  v_mul_u32_u24 v12, 165888, v2
  v_and_b32 v2, 1, v2
  v_sub_u32 v4, v4, v2
  v_min_u32 v4, 8, v4
  v_lshl_add_u32 v12, v4, 10, v12
  v_and_b32 v5, 3, v5
  v_lshl_add_u32 v12, v5, 4, v12
  v_and_b32 v5, 3, v3
  v_lshl_add_u32 v12, v5, 8, v12
  v_lshrrev_b32 v3, 2, v3
  v_mad_u32_u24 v12, v3, s33, v12
  v_lshlrev_b32 v5, 3, v5
  s_mov_b32 s47, 36864
  s_mov_b32 s67, 9216
  s_branch L_k3_sidecommon
L_k3_wout:
  s_mov_b32 s36, s8
  s_mov_b32 s37, s9
  s_mov_b32 s38, 0x288000
  s_mov_b32 s39, 0x20000
  s_add_u32 s40, s6, 0x10dd000
  s_addc_u32 s41, s7, 0
  s_mov_b32 s42, 0x288000
  s_mov_b32 s43, 0x20000
  s_cmp_ge_u32 s2, 243
  s_cselect_b32 s38, 0, s38
  s_cselect_b32 s42, 0, s42
  s_mov_b32 s33, 1152
  v_subrev_u32 v2, 82944, v2
  v_lshrrev_b32 v3, 4, v2
  v_mul_u32_u24 v3, 1821, v3
  v_lshrrev_b32 v3, 14, v3
  v_mul_u32_u24 v4, 144, v3
  v_sub_u32 v4, v2, v4
  v_lshlrev_b32 v11, 3, v4
  v_lshrrev_b32 v2, 1, v4
  v_mul_u32_u24 v2, 57, v2
  v_lshrrev_b32 v2, 9, v2
  v_mul_u32_u24 v5, 18, v2
  v_sub_u32 v5, v4, v5
  v_mul_u32_u24 v12, 331776, v2
  v_lshrrev_b32 v4, 3, v5
  v_lshl_add_u32 v12, v4, 11, v12
  v_bfe_u32 v2, v5, 1, 2
  v_lshl_add_u32 v12, v2, 4, v12
  v_cmp_le_u32 vcc, 16, v5
  v_and_b32 v2, 1, v5
  v_and_b32 v5, 3, v3
  v_lshlrev_b32 v4, 8, v5
  v_lshl_add_u32 v4, v2, 10, v4
  v_lshlrev_b32 v2, 4, v2
  v_and_b32 v140, 1, v5
  v_lshl_add_u32 v2, v140, 5, v2
  v_lshrrev_b32 v140, 1, v5
  v_lshl_add_u32 v2, v140, 8, v2
  v_cndmask_b32 v4, v4, v2, vcc
  v_add_u32 v12, v12, v4
  v_lshrrev_b32 v3, 2, v3
  v_mul_u32_u24 v2, 4608, v3
  v_add_u32 v12, v12, v2
  s_mov_b32 s47, 18432
  s_mov_b32 s67, 4608
L_k3_sidecommon:
  v_lshl_add_u32 v3, v3, 5, v5
  v_mad_u32_u24 v11, v3, s33, v11
  s_mov_b32 s48, s44
  s_mov_b32 s49, s45
  s_mov_b32 s50, 0x800000
  s_mov_b32 s51, 0x20000
  s_lshl_b32 s46, s2, 15
  s_lshl_b32 s25, s10, 12
  s_add_u32 s46, s46, s25
  s_lshl_b32 s24, s31, 15
  v_add_u32 v7, s24, v6
  s_lshl_b32 s24, s31, 13
  s_add_u32 s24, s24, 65536
  v_add_u32 v8, s24, v8
  v_and_b32 v2, 31, v1
  v_lshrrev_b32 v4, 5, v1
  v_lshlrev_b32 v5, 4, v2
  v_lshl_add_u32 v9, v4, 8, v5
  v_add_u32 v10, 512, v9
  v_min_u32 v3, 18, v2
  v_lshlrev_b32 v3, 4, v3
  v_mad_u32_u24 v3, v4, 48, v3
  v_add_u32 v3, 768, v3
  v_add_u32 v5, 96, v3
  v_cmp_le_u32 vcc, 16, v2
  s_mul_i32 s24, s31, 38912
  s_add_u32 s24, s24, 81920
  v_cndmask_b32 v9, v9, v3, vcc
  v_cndmask_b32 v10, v10, v5, vcc
  s_mov_b32 s52, 0x0047ffff
  s_mov_b32 s53, 0x0047ffff
  v_mov_b32 v5, 0x40000
  v_add_u32 v9, s24, v9
  v_cndmask_b32 v9, v5, v9, s[52:53]
  v_add_u32 v10, s24, v10
  v_cndmask_b32 v10, v5, v10, s[52:53]
  s_mul_i32 s24, s12, 36864
  v_lshrrev_b32 v3, 4, v2
  v_mul_u32_u24 v3, 18432, v3
  v_and_b32 v2, 15, v2
  v_lshl_add_u32 v3, v2, 4, v3
  v_add_u32 v3, s24, v3
  s_lshl_b32 s24, s11, 9
  v_lshl_add_u32 v13, v4, 8, v3
  v_add_u32 v13, s24, v13
  s_lshr_b32 s24, s11, 2
  s_lshl_b32 s24, s24, 8
  s_and_b32 s25, s11, 3
  s_lshl_b32 s25, s25, 2
  s_add_u32 s24, s24, s25
  s_add_u32 s24, s24, 16384
  v_add_u32 v14, s24, v3
  v_lshlrev_b32 v4, 30, v4
  v_or_b32 v14, v14, v4
  v_mov_b32 v2, 159744
  v_mov_b32 v3, 0
  ds_write_b32 v2, v3
  s_add_u32 s56, s6, 0x2148000
  s_addc_u32 s57, s7, 0
  s_mov_b32 s58, 0x10000
  s_mov_b32 s59, 0x20000
  s_lshl_b32 s54, s54, 7
  s_add_u32 s54, s54, 32768
  s_lshr_b32 s55, s11, 1
  s_lshl_b32 s55, s55, 7
  s_add_u32 s55, s55, 32768
  s_waitcnt vmcnt(0) lgkmcnt(0)
  s_barrier
  s_cmp_eq_u32 s10, 4
  s_cbranch_scc0 L_k3_nopoll
  s_mov_b64 exec, 1
  v_mov_b32 v156, 0
  v_mov_b32 v157, 1
  buffer_atomic_add v157, v156, s[56:59], s54 offen sc1
  s_mov_b64 exec, -1
  v_mov_b32 v156, 0
  v_mov_b32 v157, 0x7fffffff
  s_bfm_b64 exec, 1, 0
  v_mov_b32 v157, 0
  buffer_atomic_add v157, v156, s[56:59], s55 offen sc0 sc1
  s_mov_b64 exec, -1
  s_waitcnt vmcnt(0)
  s_mov_b32 s25, 0x40000
L_k3_poll_chk:
  v_readfirstlane_b32 s24, v157
  s_nop 0
  s_cmp_ge_u32 s24, 16
  s_cbranch_scc1 L_k3_poll_ok
  s_sub_u32 s25, s25, 1
  s_cbranch_scc1 L_k3_poll_ok
  s_sleep 1
  v_mov_b32 v157, 0x7fffffff
  s_bfm_b64 exec, 1, 0
  v_mov_b32 v157, 0
  buffer_atomic_add v157, v156, s[56:59], s55 offen sc0 sc1
  s_mov_b64 exec, -1
  s_waitcnt vmcnt(0)
  s_branch L_k3_poll_chk
L_k3_poll_ok:
L_k3_nopoll:
  s_barrier
  buffer_load_dwordx4 v[16:19], v6, s[16:19], s14 offen sc1
  buffer_load_dwordx2 v[24:25], v15, s[16:19], s20 offen sc1
  s_xor_b32 s14, s14, 1024
  s_xor_b32 s20, s20, 256
  buffer_load_dwordx4 v[20:23], v6, s[16:19], s14 offen sc1
  buffer_load_dwordx2 v[26:27], v15, s[16:19], s20 offen sc1
  s_and_b32 s24, s10, 3
  s_mul_i32 s24, s24, 1024
  s_mul_i32 s25, s31, 32768
  s_add_u32 s24, s24, s25
  s_add_u32 s25, s24, s21
  s_add_u32 s25, s25, 0
  s_add_u32 m0, s24, 0
  s_nop 0
  buffer_load_dwordx4 v6, s[16:19], s25 offen sc1 lds
  s_and_b32 s24, s10, 3
  s_mul_i32 s24, s24, 256
  s_mul_i32 s25, s31, 8192
  s_add_u32 s24, s24, s25
  s_add_u32 s25, s24, s22
  s_add_u32 s25, s25, 0
  s_add_u32 m0, s24, 65536
  s_bfm_b64 exec, 16, 0
  buffer_load_dwordx4 v6, s[16:19], s25 offen sc1 lds
  s_mov_b64 exec, -1
  s_and_b32 s24, s10, 3
  s_mul_i32 s24, s24, 1216
  s_mul_i32 s25, s31, 38912
  s_add_u32 s24, s24, s25
  s_add_u32 s25, s24, s23
  s_add_u32 s25, s25, 0
  s_add_u32 m0, s24, 81920
  s_bfm_b64 exec, 12, 0
  buffer_load_dwordx4 v6, s[16:19], s25 offen sc1 lds
  s_mov_b64 exec, -1
  buffer_load_dwordx4 v6, s[16:19], s25 offen offset:192 sc1 lds
  s_waitcnt vmcnt(4)
  s_bitcmp1_b32 s11, 0
  s_cselect_b64 s[26:27], 0, -1
  s_cselect_b64 s[28:29], -1, 0
  s_mov_b32 s27, 0
  s_mov_b32 s29, 0
  v_cndmask_b32 v24, 0, v24, s[26:27]
  v_cndmask_b32 v25, 0, v25, s[28:29]
  v_cndmask_b32 v26, 0, v26, s[26:27]
  v_cndmask_b32 v27, 0, v27, s[28:29]
  s_waitcnt vmcnt(0) lgkmcnt(0)
  s_barrier
  ds_read_b128 v[32:35], v7 offset:0
  ds_read_b64 v[28:29], v8 offset:0
  ds_read_b128 v[108:111], v9 offset:0
  ds_read_b128 v[112:115], v10 offset:0
  s_waitcnt lgkmcnt(0)
  v_mfma_f32_32x32x16_bf16 v[36:51], v[32:35], v[16:19], 0
  s_nop 9
  v_mfma_f32_32x32x8_bf16 v[36:51], v[28:29], v[24:25], v[36:51]
  s_nop 7
  s_nop 1
  s_setprio 3
  v_mfma_f32_32x32x16_bf16 v[52:67], v[32:35], v[20:23], 0
  ds_read_b128 v[32:35], v7 offset:1024
  v_exp_f32 v36, v36
  v_exp_f32 v37, v37
  v_exp_f32 v38, v38
  v_exp_f32 v39, v39
  v_cvt_pk_bf16_f32 v68, v36, v37
  ds_read_b64 v[30:31], v8 offset:256
  v_cvt_pk_bf16_f32 v69, v38, v39
  v_exp_f32 v40, v40
  v_exp_f32 v41, v41
  v_exp_f32 v42, v42
  v_exp_f32 v43, v43
  v_mfma_f32_32x32x8_bf16 v[52:67], v[28:29], v[26:27], v[52:67]
  ds_read_b128 v[116:119], v9 offset:1216
  v_cvt_pk_bf16_f32 v70, v40, v41
  v_cvt_pk_bf16_f32 v71, v42, v43
  v_exp_f32 v44, v44
  v_exp_f32 v45, v45
  v_exp_f32 v46, v46
  v_exp_f32 v47, v47
  v_mfma_f32_32x32x16_bf16 v[76:91], v[108:111], v[68:71], 0
  ds_read_b128 v[120:123], v10 offset:1216
  v_cvt_pk_bf16_f32 v72, v44, v45
  v_cvt_pk_bf16_f32 v73, v46, v47
  v_exp_f32 v48, v48
  v_exp_f32 v49, v49
  v_exp_f32 v50, v50
  v_exp_f32 v51, v51
  v_cvt_pk_bf16_f32 v74, v48, v49
  v_cvt_pk_bf16_f32 v75, v50, v51
  s_and_b32 s24, s10, 3
  s_mul_i32 s24, s24, 2048
  s_mul_i32 s25, s31, 32768
  s_add_u32 s24, s24, s25
  s_add_u32 s25, s24, s21
  s_add_u32 s25, s25, 4096
  s_add_u32 m0, s24, 4096
  s_nop 0
  buffer_load_dwordx4 v6, s[16:19], s25 offen sc1 lds
  buffer_load_dwordx4 v6, s[16:19], s25 offen offset:1024 sc1 lds
  s_waitcnt lgkmcnt(0)
  v_mfma_f32_32x32x16_bf16 v[36:51], v[32:35], v[16:19], 0
  v_exp_f32 v52, v52
  v_exp_f32 v53, v53
  v_exp_f32 v54, v54
  v_exp_f32 v55, v55
  v_cvt_pk_bf16_f32 v68, v52, v53
  v_mfma_f32_32x32x16_bf16 v[76:91], v[112:115], v[72:75], v[76:91]
  v_cvt_pk_bf16_f32 v69, v54, v55
  v_exp_f32 v56, v56
  v_exp_f32 v57, v57
  v_exp_f32 v58, v58
  v_exp_f32 v59, v59
  v_mfma_f32_32x32x8_bf16 v[36:51], v[30:31], v[24:25], v[36:51]
  v_cvt_pk_bf16_f32 v70, v56, v57
  v_cvt_pk_bf16_f32 v71, v58, v59
  v_exp_f32 v60, v60
  v_exp_f32 v61, v61
  v_exp_f32 v62, v62
  v_exp_f32 v63, v63
  v_mfma_f32_32x32x16_bf16 v[92:107], v[108:111], v[68:71], 0
  v_cvt_pk_bf16_f32 v72, v60, v61
  v_cvt_pk_bf16_f32 v73, v62, v63
  v_exp_f32 v64, v64
  v_exp_f32 v65, v65
  v_exp_f32 v66, v66
  v_exp_f32 v67, v67
  v_cvt_pk_bf16_f32 v74, v64, v65
  v_cvt_pk_bf16_f32 v75, v66, v67
  s_and_b32 s24, s10, 3
  s_mul_i32 s24, s24, 512
  s_mul_i32 s25, s31, 8192
  s_add_u32 s24, s24, s25
  s_add_u32 s25, s24, s22
  s_add_u32 s25, s25, 1024
  s_add_u32 m0, s24, 66560
  s_bfm_b64 exec, 32, 0
  buffer_load_dwordx4 v6, s[16:19], s25 offen sc1 lds
  s_mov_b64 exec, -1
  v_mfma_f32_32x32x16_bf16 v[52:67], v[32:35], v[20:23], 0
  ds_read_b128 v[32:35], v7 offset:2048
  v_exp_f32 v36, v36
  v_exp_f32 v37, v37
  v_exp_f32 v38, v38
  v_exp_f32 v39, v39
  v_cvt_pk_bf16_f32 v68, v36, v37
  v_mfma_f32_32x32x16_bf16 v[92:107], v[112:115], v[72:75], v[92:107]
  ds_read_b64 v[28:29], v8 offset:512
  v_cvt_pk_bf16_f32 v69, v38, v39
  v_exp_f32 v40, v40
  v_exp_f32 v41, v41
  v_exp_f32 v42, v42
  v_exp_f32 v43, v43
  v_mfma_f32_32x32x8_bf16 v[52:67], v[30:31], v[26:27], v[52:67]
  ds_read_b128 v[108:111], v9 offset:2432
  v_cvt_pk_bf16_f32 v70, v40, v41
  v_cvt_pk_bf16_f32 v71, v42, v43
  v_exp_f32 v44, v44
  v_exp_f32 v45, v45
  v_exp_f32 v46, v46
  v_exp_f32 v47, v47
  v_mfma_f32_32x32x16_bf16 v[76:91], v[116:119], v[68:71], v[76:91]
  ds_read_b128 v[112:115], v10 offset:2432
  v_cvt_pk_bf16_f32 v72, v44, v45
  v_cvt_pk_bf16_f32 v73, v46, v47
  v_exp_f32 v48, v48
  v_exp_f32 v49, v49
  v_exp_f32 v50, v50
  v_exp_f32 v51, v51
  v_cvt_pk_bf16_f32 v74, v48, v49
  v_cvt_pk_bf16_f32 v75, v50, v51
  s_and_b32 s24, s10, 3
  s_mul_i32 s24, s24, 2432
  s_mul_i32 s25, s31, 38912
  s_add_u32 s24, s24, s25
  s_add_u32 s25, s24, s23
  s_add_u32 s25, s25, 4864
  s_add_u32 m0, s24, 86784
  s_nop 0
  buffer_load_dwordx4 v6, s[16:19], s25 offen sc1 lds
  buffer_load_dwordx4 v6, s[16:19], s25 offen offset:1024 sc1 lds
  s_waitcnt lgkmcnt(0)
  v_mfma_f32_32x32x16_bf16 v[36:51], v[32:35], v[16:19], 0
  v_exp_f32 v52, v52
  v_exp_f32 v53, v53
  v_exp_f32 v54, v54
  v_exp_f32 v55, v55
  v_cvt_pk_bf16_f32 v68, v52, v53
  v_mfma_f32_32x32x16_bf16 v[76:91], v[120:123], v[72:75], v[76:91]
  v_cvt_pk_bf16_f32 v69, v54, v55
  v_exp_f32 v56, v56
  v_exp_f32 v57, v57
  v_exp_f32 v58, v58
  v_exp_f32 v59, v59
  v_mfma_f32_32x32x8_bf16 v[36:51], v[28:29], v[24:25], v[36:51]
  v_cvt_pk_bf16_f32 v70, v56, v57
  v_cvt_pk_bf16_f32 v71, v58, v59
  v_exp_f32 v60, v60
  v_exp_f32 v61, v61
  v_exp_f32 v62, v62
  v_exp_f32 v63, v63
  v_mfma_f32_32x32x16_bf16 v[92:107], v[116:119], v[68:71], v[92:107]
  v_cvt_pk_bf16_f32 v72, v60, v61
  v_cvt_pk_bf16_f32 v73, v62, v63
  v_exp_f32 v64, v64
  v_exp_f32 v65, v65
  v_exp_f32 v66, v66
  v_exp_f32 v67, v67
  v_cvt_pk_bf16_f32 v74, v64, v65
  v_cvt_pk_bf16_f32 v75, v66, v67
  s_and_b32 s24, s10, 3
  s_mul_i32 s24, s24, 2432
  s_mul_i32 s25, s31, 38912
  s_add_u32 s24, s24, s25
  s_add_u32 s25, s24, s23
  s_add_u32 s25, s25, 6912
  s_add_u32 m0, s24, 88832
  s_bfm_b64 exec, 24, 0
  buffer_load_dwordx4 v6, s[16:19], s25 offen sc1 lds
  s_mov_b64 exec, -1
  s_setprio 2
  v_mfma_f32_32x32x16_bf16 v[52:67], v[32:35], v[20:23], 0
  ds_read_b128 v[32:35], v7 offset:3072
  v_exp_f32 v36, v36
  v_exp_f32 v37, v37
  v_exp_f32 v38, v38
  v_exp_f32 v39, v39
  v_cvt_pk_bf16_f32 v68, v36, v37
  v_mfma_f32_32x32x16_bf16 v[92:107], v[120:123], v[72:75], v[92:107]
  ds_read_b64 v[30:31], v8 offset:768
  v_cvt_pk_bf16_f32 v69, v38, v39
  v_exp_f32 v40, v40
  v_exp_f32 v41, v41
  v_exp_f32 v42, v42
  v_exp_f32 v43, v43
  v_mfma_f32_32x32x8_bf16 v[52:67], v[28:29], v[26:27], v[52:67]
  ds_read_b128 v[116:119], v9 offset:3648
  v_cvt_pk_bf16_f32 v70, v40, v41
  v_cvt_pk_bf16_f32 v71, v42, v43
  v_exp_f32 v44, v44
  v_exp_f32 v45, v45
  v_exp_f32 v46, v46
  v_exp_f32 v47, v47
  v_mfma_f32_32x32x16_bf16 v[76:91], v[108:111], v[68:71], v[76:91]
  ds_read_b128 v[120:123], v10 offset:3648
  v_cvt_pk_bf16_f32 v72, v44, v45
  v_cvt_pk_bf16_f32 v73, v46, v47
  v_exp_f32 v48, v48
  v_exp_f32 v49, v49
  v_exp_f32 v50, v50
  v_exp_f32 v51, v51
  v_cvt_pk_bf16_f32 v74, v48, v49
  v_cvt_pk_bf16_f32 v75, v50, v51
  s_and_b32 s24, s10, 3
  s_mul_i32 s24, s24, 5120
  s_mul_i32 s25, s31, 32768
  s_add_u32 s24, s24, s25
  s_add_u32 s25, s24, s21
  s_add_u32 s25, s25, 12288
  s_add_u32 m0, s24, 12288
  s_nop 0
  buffer_load_dwordx4 v6, s[16:19], s25 offen sc1 lds
  buffer_load_dwordx4 v6, s[16:19], s25 offen offset:1024 sc1 lds
  s_waitcnt lgkmcnt(0)
  v_mfma_f32_32x32x16_bf16 v[36:51], v[32:35], v[16:19], 0
  v_exp_f32 v52, v52
  v_exp_f32 v53, v53
  v_exp_f32 v54, v54
  v_exp_f32 v55, v55
  v_cvt_pk_bf16_f32 v68, v52, v53
  v_mfma_f32_32x32x16_bf16 v[76:91], v[112:115], v[72:75], v[76:91]
  v_cvt_pk_bf16_f32 v69, v54, v55
  v_exp_f32 v56, v56
  v_exp_f32 v57, v57
  v_exp_f32 v58, v58
  v_exp_f32 v59, v59
  v_mfma_f32_32x32x8_bf16 v[36:51], v[30:31], v[24:25], v[36:51]
  v_cvt_pk_bf16_f32 v70, v56, v57
  v_cvt_pk_bf16_f32 v71, v58, v59
  v_exp_f32 v60, v60
  v_exp_f32 v61, v61
  v_exp_f32 v62, v62
  v_exp_f32 v63, v63
  v_mfma_f32_32x32x16_bf16 v[92:107], v[108:111], v[68:71], v[92:107]
  v_cvt_pk_bf16_f32 v72, v60, v61
  v_cvt_pk_bf16_f32 v73, v62, v63
  v_exp_f32 v64, v64
  v_exp_f32 v65, v65
  v_exp_f32 v66, v66
  v_exp_f32 v67, v67
  v_cvt_pk_bf16_f32 v74, v64, v65
  v_cvt_pk_bf16_f32 v75, v66, v67
  s_and_b32 s24, s10, 3
  s_mul_i32 s24, s24, 5120
  s_mul_i32 s25, s31, 32768
  s_add_u32 s24, s24, s25
  s_add_u32 s25, s24, s21
  s_add_u32 s25, s25, 14336
  s_add_u32 m0, s24, 14336
  s_nop 0
  buffer_load_dwordx4 v6, s[16:19], s25 offen sc1 lds
  buffer_load_dwordx4 v6, s[16:19], s25 offen offset:1024 sc1 lds
  s_waitcnt vmcnt(4) lgkmcnt(0)
  s_barrier
  v_mfma_f32_32x32x16_bf16 v[52:67], v[32:35], v[20:23], 0
  ds_read_b128 v[32:35], v7 offset:4096
  v_exp_f32 v36, v36
  v_exp_f32 v37, v37
  v_exp_f32 v38, v38
  v_exp_f32 v39, v39
  v_cvt_pk_bf16_f32 v68, v36, v37
  v_mfma_f32_32x32x16_bf16 v[92:107], v[112:115], v[72:75], v[92:107]
  ds_read_b64 v[28:29], v8 offset:1024
  v_cvt_pk_bf16_f32 v69, v38, v39
  v_exp_f32 v40, v40
  v_exp_f32 v41, v41
  v_exp_f32 v42, v42
  v_exp_f32 v43, v43
  v_mfma_f32_32x32x8_bf16 v[52:67], v[30:31], v[26:27], v[52:67]
  ds_read_b128 v[108:111], v9 offset:4864
  v_cvt_pk_bf16_f32 v70, v40, v41
  v_cvt_pk_bf16_f32 v71, v42, v43
  v_exp_f32 v44, v44
  v_exp_f32 v45, v45
  v_exp_f32 v46, v46
  v_exp_f32 v47, v47
  v_mfma_f32_32x32x16_bf16 v[76:91], v[116:119], v[68:71], v[76:91]
  ds_read_b128 v[112:115], v10 offset:4864
  v_cvt_pk_bf16_f32 v72, v44, v45
  v_cvt_pk_bf16_f32 v73, v46, v47
  v_exp_f32 v48, v48
  v_exp_f32 v49, v49
  v_exp_f32 v50, v50
  v_exp_f32 v51, v51
  v_cvt_pk_bf16_f32 v74, v48, v49
  v_cvt_pk_bf16_f32 v75, v50, v51
  s_and_b32 s24, s10, 3
  s_mul_i32 s24, s24, 5120
  s_mul_i32 s25, s31, 32768
  s_add_u32 s24, s24, s25
  s_add_u32 s25, s24, s21
  s_add_u32 s25, s25, 16384
  s_add_u32 m0, s24, 16384
  s_nop 0
  buffer_load_dwordx4 v6, s[16:19], s25 offen sc1 lds
  s_waitcnt lgkmcnt(0)
  v_mfma_f32_32x32x16_bf16 v[36:51], v[32:35], v[16:19], 0
  v_exp_f32 v52, v52
  v_exp_f32 v53, v53
  v_exp_f32 v54, v54
  v_exp_f32 v55, v55
  v_cvt_pk_bf16_f32 v68, v52, v53
  v_mfma_f32_32x32x16_bf16 v[76:91], v[120:123], v[72:75], v[76:91]
  v_cvt_pk_bf16_f32 v69, v54, v55
  v_exp_f32 v56, v56
  v_exp_f32 v57, v57
  v_exp_f32 v58, v58
  v_exp_f32 v59, v59
  v_mfma_f32_32x32x8_bf16 v[36:51], v[28:29], v[24:25], v[36:51]
  v_cvt_pk_bf16_f32 v70, v56, v57
  v_cvt_pk_bf16_f32 v71, v58, v59
  v_exp_f32 v60, v60
  v_exp_f32 v61, v61
  v_exp_f32 v62, v62
  v_exp_f32 v63, v63
  v_mfma_f32_32x32x16_bf16 v[92:107], v[116:119], v[68:71], v[92:107]
  v_cvt_pk_bf16_f32 v72, v60, v61
  v_cvt_pk_bf16_f32 v73, v62, v63
  v_exp_f32 v64, v64
  v_exp_f32 v65, v65
  v_exp_f32 v66, v66
  v_exp_f32 v67, v67
  v_cvt_pk_bf16_f32 v74, v64, v65
  v_cvt_pk_bf16_f32 v75, v66, v67
  s_and_b32 s24, s10, 3
  s_mul_i32 s24, s24, 1280
  s_mul_i32 s25, s31, 8192
  s_add_u32 s24, s24, s25
  s_add_u32 s25, s24, s22
  s_add_u32 s25, s25, 3072
  s_add_u32 m0, s24, 68608
  s_bfm_b64 exec, 16, 0
  buffer_load_dwordx4 v6, s[16:19], s25 offen sc1 lds
  s_mov_b64 exec, -1
  buffer_load_dwordx4 v6, s[16:19], s25 offen offset:256 sc1 lds
  s_setprio 1
  v_mfma_f32_32x32x16_bf16 v[52:67], v[32:35], v[20:23], 0
  ds_read_b128 v[32:35], v7 offset:5120
  v_exp_f32 v36, v36
  v_exp_f32 v37, v37
  v_exp_f32 v38, v38
  v_exp_f32 v39, v39
  v_cvt_pk_bf16_f32 v68, v36, v37
  v_mfma_f32_32x32x16_bf16 v[92:107], v[120:123], v[72:75], v[92:107]
  ds_read_b64 v[30:31], v8 offset:1280
  v_cvt_pk_bf16_f32 v69, v38, v39
  v_exp_f32 v40, v40
  v_exp_f32 v41, v41
  v_exp_f32 v42, v42
  v_exp_f32 v43, v43
  v_mfma_f32_32x32x8_bf16 v[52:67], v[28:29], v[26:27], v[52:67]
  ds_read_b128 v[116:119], v9 offset:6080
  v_cvt_pk_bf16_f32 v70, v40, v41
  v_cvt_pk_bf16_f32 v71, v42, v43
  v_exp_f32 v44, v44
  v_exp_f32 v45, v45
  v_exp_f32 v46, v46
  v_exp_f32 v47, v47
  v_mfma_f32_32x32x16_bf16 v[76:91], v[108:111], v[68:71], v[76:91]
  ds_read_b128 v[120:123], v10 offset:6080
  v_cvt_pk_bf16_f32 v72, v44, v45
  v_cvt_pk_bf16_f32 v73, v46, v47
  v_exp_f32 v48, v48
  v_exp_f32 v49, v49
  v_exp_f32 v50, v50
  v_exp_f32 v51, v51
  v_cvt_pk_bf16_f32 v74, v48, v49
  v_cvt_pk_bf16_f32 v75, v50, v51
  s_and_b32 s24, s10, 3
  s_mul_i32 s24, s24, 6080
  s_mul_i32 s25, s31, 38912
  s_add_u32 s24, s24, s25
  s_add_u32 s25, s24, s23
  s_add_u32 s25, s25, 14592
  s_add_u32 m0, s24, 96512
  s_nop 0
  buffer_load_dwordx4 v6, s[16:19], s25 offen sc1 lds
  buffer_load_dwordx4 v6, s[16:19], s25 offen offset:1024 sc1 lds
  s_waitcnt lgkmcnt(0)
  v_mfma_f32_32x32x16_bf16 v[36:51], v[32:35], v[16:19], 0
  v_exp_f32 v52, v52
  v_exp_f32 v53, v53
  v_exp_f32 v54, v54
  v_exp_f32 v55, v55
  v_cvt_pk_bf16_f32 v68, v52, v53
  v_mfma_f32_32x32x16_bf16 v[76:91], v[112:115], v[72:75], v[76:91]
  v_cvt_pk_bf16_f32 v69, v54, v55
  v_exp_f32 v56, v56
  v_exp_f32 v57, v57
  v_exp_f32 v58, v58
  v_exp_f32 v59, v59
  v_mfma_f32_32x32x8_bf16 v[36:51], v[30:31], v[24:25], v[36:51]
  v_cvt_pk_bf16_f32 v70, v56, v57
  v_cvt_pk_bf16_f32 v71, v58, v59
  v_exp_f32 v60, v60
  v_exp_f32 v61, v61
  v_exp_f32 v62, v62
  v_exp_f32 v63, v63
  v_mfma_f32_32x32x16_bf16 v[92:107], v[108:111], v[68:71], v[92:107]
  v_cvt_pk_bf16_f32 v72, v60, v61
  v_cvt_pk_bf16_f32 v73, v62, v63
  v_exp_f32 v64, v64
  v_exp_f32 v65, v65
  v_exp_f32 v66, v66
  v_exp_f32 v67, v67
  v_cvt_pk_bf16_f32 v74, v64, v65
  v_cvt_pk_bf16_f32 v75, v66, v67
  s_and_b32 s24, s10, 3
  s_mul_i32 s24, s24, 6080
  s_mul_i32 s25, s31, 38912
  s_add_u32 s24, s24, s25
  s_add_u32 s25, s24, s23
  s_add_u32 s25, s25, 16640
  s_add_u32 m0, s24, 98560
  s_nop 0
  buffer_load_dwordx4 v6, s[16:19], s25 offen sc1 lds
  buffer_load_dwordx4 v6, s[16:19], s25 offen offset:1024 sc1 lds
  v_mfma_f32_32x32x16_bf16 v[52:67], v[32:35], v[20:23], 0
  ds_read_b128 v[32:35], v7 offset:6144
  v_exp_f32 v36, v36
  v_exp_f32 v37, v37
  v_exp_f32 v38, v38
  v_exp_f32 v39, v39
  v_cvt_pk_bf16_f32 v68, v36, v37
  v_mfma_f32_32x32x16_bf16 v[92:107], v[112:115], v[72:75], v[92:107]
  ds_read_b64 v[28:29], v8 offset:1536
  v_cvt_pk_bf16_f32 v69, v38, v39
  v_exp_f32 v40, v40
  v_exp_f32 v41, v41
  v_exp_f32 v42, v42
  v_exp_f32 v43, v43
  v_mfma_f32_32x32x8_bf16 v[52:67], v[30:31], v[26:27], v[52:67]
  ds_read_b128 v[108:111], v9 offset:7296
  v_cvt_pk_bf16_f32 v70, v40, v41
  v_cvt_pk_bf16_f32 v71, v42, v43
  v_exp_f32 v44, v44
  v_exp_f32 v45, v45
  v_exp_f32 v46, v46
  v_exp_f32 v47, v47
  v_mfma_f32_32x32x16_bf16 v[76:91], v[116:119], v[68:71], v[76:91]
  ds_read_b128 v[112:115], v10 offset:7296
  v_cvt_pk_bf16_f32 v72, v44, v45
  v_cvt_pk_bf16_f32 v73, v46, v47
  v_exp_f32 v48, v48
  v_exp_f32 v49, v49
  v_exp_f32 v50, v50
  v_exp_f32 v51, v51
  v_cvt_pk_bf16_f32 v74, v48, v49
  v_cvt_pk_bf16_f32 v75, v50, v51
  s_and_b32 s24, s10, 3
  s_mul_i32 s24, s24, 6080
  s_mul_i32 s25, s31, 38912
  s_add_u32 s24, s24, s25
  s_add_u32 s25, s24, s23
  s_add_u32 s25, s25, 18688
  s_add_u32 m0, s24, 100608
  s_bfm_b64 exec, 60, 0
  buffer_load_dwordx4 v6, s[16:19], s25 offen sc1 lds
  s_mov_b64 exec, -1
  buffer_load_dwordx4 v6, s[16:19], s25 offen offset:960 sc1 lds
  s_waitcnt lgkmcnt(0)
  v_mfma_f32_32x32x16_bf16 v[36:51], v[32:35], v[16:19], 0
  v_exp_f32 v52, v52
  v_exp_f32 v53, v53
  v_exp_f32 v54, v54
  v_exp_f32 v55, v55
  v_cvt_pk_bf16_f32 v68, v52, v53
  v_mfma_f32_32x32x16_bf16 v[76:91], v[120:123], v[72:75], v[76:91]
  v_cvt_pk_bf16_f32 v69, v54, v55
  v_exp_f32 v56, v56
  v_exp_f32 v57, v57
  v_exp_f32 v58, v58
  v_exp_f32 v59, v59
  v_mfma_f32_32x32x8_bf16 v[36:51], v[28:29], v[24:25], v[36:51]
  v_cvt_pk_bf16_f32 v70, v56, v57
  v_cvt_pk_bf16_f32 v71, v58, v59
  v_exp_f32 v60, v60
  v_exp_f32 v61, v61
  v_exp_f32 v62, v62
  v_exp_f32 v63, v63
  v_mfma_f32_32x32x16_bf16 v[92:107], v[116:119], v[68:71], v[92:107]
  v_cvt_pk_bf16_f32 v72, v60, v61
  v_cvt_pk_bf16_f32 v73, v62, v63
  v_exp_f32 v64, v64
  v_exp_f32 v65, v65
  v_exp_f32 v66, v66
  v_exp_f32 v67, v67
  v_cvt_pk_bf16_f32 v74, v64, v65
  v_cvt_pk_bf16_f32 v75, v66, v67
  s_setprio 0
  v_mfma_f32_32x32x16_bf16 v[52:67], v[32:35], v[20:23], 0
  ds_read_b128 v[32:35], v7 offset:7168
  v_exp_f32 v36, v36
  v_exp_f32 v37, v37
  v_exp_f32 v38, v38
  v_exp_f32 v39, v39
  v_cvt_pk_bf16_f32 v68, v36, v37
  v_mfma_f32_32x32x16_bf16 v[92:107], v[120:123], v[72:75], v[92:107]
  ds_read_b64 v[30:31], v8 offset:1792
  v_cvt_pk_bf16_f32 v69, v38, v39
  v_exp_f32 v40, v40
  v_exp_f32 v41, v41
  v_exp_f32 v42, v42
  v_exp_f32 v43, v43
  v_mfma_f32_32x32x8_bf16 v[52:67], v[28:29], v[26:27], v[52:67]
  ds_read_b128 v[116:119], v9 offset:8512
  v_cvt_pk_bf16_f32 v70, v40, v41
  v_cvt_pk_bf16_f32 v71, v42, v43
  v_exp_f32 v44, v44
  v_exp_f32 v45, v45
  v_exp_f32 v46, v46
  v_exp_f32 v47, v47
  v_mfma_f32_32x32x16_bf16 v[76:91], v[108:111], v[68:71], v[76:91]
  ds_read_b128 v[120:123], v10 offset:8512
  v_cvt_pk_bf16_f32 v72, v44, v45
  v_cvt_pk_bf16_f32 v73, v46, v47
  v_exp_f32 v48, v48
  v_exp_f32 v49, v49
  v_exp_f32 v50, v50
  v_exp_f32 v51, v51
  v_cvt_pk_bf16_f32 v74, v48, v49
  v_cvt_pk_bf16_f32 v75, v50, v51
  s_mul_i32 s32, s67, 0
  buffer_load_dwordx2 v[124:125], v11, s[36:39], s32 offen
  s_waitcnt lgkmcnt(0)
  v_mfma_f32_32x32x16_bf16 v[36:51], v[32:35], v[16:19], 0
  v_exp_f32 v52, v52
  v_exp_f32 v53, v53
  v_exp_f32 v54, v54
  v_exp_f32 v55, v55
  v_cvt_pk_bf16_f32 v68, v52, v53
  v_mfma_f32_32x32x16_bf16 v[76:91], v[112:115], v[72:75], v[76:91]
  v_cvt_pk_bf16_f32 v69, v54, v55
  v_exp_f32 v56, v56
  v_exp_f32 v57, v57
  v_exp_f32 v58, v58
  v_exp_f32 v59, v59
  v_mfma_f32_32x32x8_bf16 v[36:51], v[30:31], v[24:25], v[36:51]
  v_cvt_pk_bf16_f32 v70, v56, v57
  v_cvt_pk_bf16_f32 v71, v58, v59
  v_exp_f32 v60, v60
  v_exp_f32 v61, v61
  v_exp_f32 v62, v62
  v_exp_f32 v63, v63
  v_mfma_f32_32x32x16_bf16 v[92:107], v[108:111], v[68:71], v[92:107]
  v_cvt_pk_bf16_f32 v72, v60, v61
  v_cvt_pk_bf16_f32 v73, v62, v63
  v_exp_f32 v64, v64
  v_exp_f32 v65, v65
  v_exp_f32 v66, v66
  v_exp_f32 v67, v67
  v_cvt_pk_bf16_f32 v74, v64, v65
  v_cvt_pk_bf16_f32 v75, v66, v67
  v_mfma_f32_32x32x16_bf16 v[52:67], v[32:35], v[20:23], 0
  ds_read_b128 v[32:35], v7 offset:8192
  v_exp_f32 v36, v36
  v_exp_f32 v37, v37
  v_exp_f32 v38, v38
  v_exp_f32 v39, v39
  v_cvt_pk_bf16_f32 v68, v36, v37
  v_mfma_f32_32x32x16_bf16 v[92:107], v[112:115], v[72:75], v[92:107]
  ds_read_b64 v[28:29], v8 offset:2048
  v_cvt_pk_bf16_f32 v69, v38, v39
  v_exp_f32 v40, v40
  v_exp_f32 v41, v41
  v_exp_f32 v42, v42
  v_exp_f32 v43, v43
  v_mfma_f32_32x32x8_bf16 v[52:67], v[30:31], v[26:27], v[52:67]
  ds_read_b128 v[108:111], v9 offset:9728
  v_cvt_pk_bf16_f32 v70, v40, v41
  v_cvt_pk_bf16_f32 v71, v42, v43
  v_exp_f32 v44, v44
  v_exp_f32 v45, v45
  v_exp_f32 v46, v46
  v_exp_f32 v47, v47
  v_mfma_f32_32x32x16_bf16 v[76:91], v[116:119], v[68:71], v[76:91]
  ds_read_b128 v[112:115], v10 offset:9728
  v_cvt_pk_bf16_f32 v72, v44, v45
  v_cvt_pk_bf16_f32 v73, v46, v47
  v_exp_f32 v48, v48
  v_exp_f32 v49, v49
  v_exp_f32 v50, v50
  v_exp_f32 v51, v51
  v_cvt_pk_bf16_f32 v74, v48, v49
  v_cvt_pk_bf16_f32 v75, v50, v51
  s_mul_i32 s32, s67, 1
  buffer_load_dwordx2 v[126:127], v11, s[36:39], s32 offen
  s_waitcnt lgkmcnt(0)
  v_mfma_f32_32x32x16_bf16 v[36:51], v[32:35], v[16:19], 0
  v_exp_f32 v52, v52
  v_exp_f32 v53, v53
  v_exp_f32 v54, v54
  v_exp_f32 v55, v55
  v_cvt_pk_bf16_f32 v68, v52, v53
  v_mfma_f32_32x32x16_bf16 v[76:91], v[120:123], v[72:75], v[76:91]
  v_cvt_pk_bf16_f32 v69, v54, v55
  v_exp_f32 v56, v56
  v_exp_f32 v57, v57
  v_exp_f32 v58, v58
  v_exp_f32 v59, v59
  v_mfma_f32_32x32x8_bf16 v[36:51], v[28:29], v[24:25], v[36:51]
  v_cvt_pk_bf16_f32 v70, v56, v57
  v_cvt_pk_bf16_f32 v71, v58, v59
  v_exp_f32 v60, v60
  v_exp_f32 v61, v61
  v_exp_f32 v62, v62
  v_exp_f32 v63, v63
  v_mfma_f32_32x32x16_bf16 v[92:107], v[116:119], v[68:71], v[92:107]
  v_cvt_pk_bf16_f32 v72, v60, v61
  v_cvt_pk_bf16_f32 v73, v62, v63
  v_exp_f32 v64, v64
  v_exp_f32 v65, v65
  v_exp_f32 v66, v66
  v_exp_f32 v67, v67
  v_cvt_pk_bf16_f32 v74, v64, v65
  v_cvt_pk_bf16_f32 v75, v66, v67
  s_setprio 3
  v_mfma_f32_32x32x16_bf16 v[52:67], v[32:35], v[20:23], 0
  ds_read_b128 v[32:35], v7 offset:9216
  v_exp_f32 v36, v36
  v_exp_f32 v37, v37
  v_exp_f32 v38, v38
  v_exp_f32 v39, v39
  v_cvt_pk_bf16_f32 v68, v36, v37
  v_mfma_f32_32x32x16_bf16 v[92:107], v[120:123], v[72:75], v[92:107]
  ds_read_b64 v[30:31], v8 offset:2304
  v_cvt_pk_bf16_f32 v69, v38, v39
  v_exp_f32 v40, v40
  v_exp_f32 v41, v41
  v_exp_f32 v42, v42
  v_exp_f32 v43, v43
  v_mfma_f32_32x32x8_bf16 v[52:67], v[28:29], v[26:27], v[52:67]
  ds_read_b128 v[116:119], v9 offset:10944
  v_cvt_pk_bf16_f32 v70, v40, v41
  v_cvt_pk_bf16_f32 v71, v42, v43
  v_exp_f32 v44, v44
  v_exp_f32 v45, v45
  v_exp_f32 v46, v46
  v_exp_f32 v47, v47
  v_mfma_f32_32x32x16_bf16 v[76:91], v[108:111], v[68:71], v[76:91]
  ds_read_b128 v[120:123], v10 offset:10944
  v_cvt_pk_bf16_f32 v72, v44, v45
  v_cvt_pk_bf16_f32 v73, v46, v47
  v_exp_f32 v48, v48
  v_exp_f32 v49, v49
  v_exp_f32 v50, v50
  v_exp_f32 v51, v51
  v_cvt_pk_bf16_f32 v74, v48, v49
  v_cvt_pk_bf16_f32 v75, v50, v51
  s_mul_i32 s32, s67, 2
  buffer_load_dwordx2 v[128:129], v11, s[36:39], s32 offen
  s_waitcnt lgkmcnt(0)
  v_mfma_f32_32x32x16_bf16 v[36:51], v[32:35], v[16:19], 0
  v_exp_f32 v52, v52
  v_exp_f32 v53, v53
  v_exp_f32 v54, v54
  v_exp_f32 v55, v55
  v_cvt_pk_bf16_f32 v68, v52, v53
  v_mfma_f32_32x32x16_bf16 v[76:91], v[112:115], v[72:75], v[76:91]
  v_cvt_pk_bf16_f32 v69, v54, v55
  v_exp_f32 v56, v56
  v_exp_f32 v57, v57
  v_exp_f32 v58, v58
  v_exp_f32 v59, v59
  v_mfma_f32_32x32x8_bf16 v[36:51], v[30:31], v[24:25], v[36:51]
  v_cvt_pk_bf16_f32 v70, v56, v57
  v_cvt_pk_bf16_f32 v71, v58, v59
  v_exp_f32 v60, v60
  v_exp_f32 v61, v61
  v_exp_f32 v62, v62
  v_exp_f32 v63, v63
  v_mfma_f32_32x32x16_bf16 v[92:107], v[108:111], v[68:71], v[92:107]
  v_cvt_pk_bf16_f32 v72, v60, v61
  v_cvt_pk_bf16_f32 v73, v62, v63
  v_exp_f32 v64, v64
  v_exp_f32 v65, v65
  v_exp_f32 v66, v66
  v_exp_f32 v67, v67
  v_cvt_pk_bf16_f32 v74, v64, v65
  v_cvt_pk_bf16_f32 v75, v66, v67
  v_mfma_f32_32x32x16_bf16 v[52:67], v[32:35], v[20:23], 0
  ds_read_b128 v[32:35], v7 offset:10240
  v_exp_f32 v36, v36
  v_exp_f32 v37, v37
  v_exp_f32 v38, v38
  v_exp_f32 v39, v39
  v_cvt_pk_bf16_f32 v68, v36, v37
  v_mfma_f32_32x32x16_bf16 v[92:107], v[112:115], v[72:75], v[92:107]
  ds_read_b64 v[28:29], v8 offset:2560
  v_cvt_pk_bf16_f32 v69, v38, v39
  v_exp_f32 v40, v40
  v_exp_f32 v41, v41
  v_exp_f32 v42, v42
  v_exp_f32 v43, v43
  v_mfma_f32_32x32x8_bf16 v[52:67], v[30:31], v[26:27], v[52:67]
  ds_read_b128 v[108:111], v9 offset:12160
  v_cvt_pk_bf16_f32 v70, v40, v41
  v_cvt_pk_bf16_f32 v71, v42, v43
  v_exp_f32 v44, v44
  v_exp_f32 v45, v45
  v_exp_f32 v46, v46
  v_exp_f32 v47, v47
  v_mfma_f32_32x32x16_bf16 v[76:91], v[116:119], v[68:71], v[76:91]
  ds_read_b128 v[112:115], v10 offset:12160
  v_cvt_pk_bf16_f32 v72, v44, v45
  v_cvt_pk_bf16_f32 v73, v46, v47
  v_exp_f32 v48, v48
  v_exp_f32 v49, v49
  v_exp_f32 v50, v50
  v_exp_f32 v51, v51
  v_cvt_pk_bf16_f32 v74, v48, v49
  v_cvt_pk_bf16_f32 v75, v50, v51
  s_mul_i32 s32, s67, 3
  buffer_load_dwordx2 v[130:131], v11, s[36:39], s32 offen
  s_waitcnt lgkmcnt(0)
  v_mfma_f32_32x32x16_bf16 v[36:51], v[32:35], v[16:19], 0
  v_exp_f32 v52, v52
  v_exp_f32 v53, v53
  v_exp_f32 v54, v54
  v_exp_f32 v55, v55
  v_cvt_pk_bf16_f32 v68, v52, v53
  v_mfma_f32_32x32x16_bf16 v[76:91], v[120:123], v[72:75], v[76:91]
  v_cvt_pk_bf16_f32 v69, v54, v55
  v_exp_f32 v56, v56
  v_exp_f32 v57, v57
  v_exp_f32 v58, v58
  v_exp_f32 v59, v59
  v_mfma_f32_32x32x8_bf16 v[36:51], v[28:29], v[24:25], v[36:51]
  v_cvt_pk_bf16_f32 v70, v56, v57
  v_cvt_pk_bf16_f32 v71, v58, v59
  v_exp_f32 v60, v60
  v_exp_f32 v61, v61
  v_exp_f32 v62, v62
  v_exp_f32 v63, v63
  v_mfma_f32_32x32x16_bf16 v[92:107], v[116:119], v[68:71], v[92:107]
  v_cvt_pk_bf16_f32 v72, v60, v61
  v_cvt_pk_bf16_f32 v73, v62, v63
  v_exp_f32 v64, v64
  v_exp_f32 v65, v65
  v_exp_f32 v66, v66
  v_exp_f32 v67, v67
  v_cvt_pk_bf16_f32 v74, v64, v65
  v_cvt_pk_bf16_f32 v75, v66, v67
  s_setprio 2
  v_mfma_f32_32x32x16_bf16 v[52:67], v[32:35], v[20:23], 0
  ds_read_b128 v[32:35], v7 offset:11264
  v_exp_f32 v36, v36
  v_exp_f32 v37, v37
  v_exp_f32 v38, v38
  v_exp_f32 v39, v39
  v_cvt_pk_bf16_f32 v68, v36, v37
  v_mfma_f32_32x32x16_bf16 v[92:107], v[120:123], v[72:75], v[92:107]
  ds_read_b64 v[30:31], v8 offset:2816
  v_cvt_pk_bf16_f32 v69, v38, v39
  v_exp_f32 v40, v40
  v_exp_f32 v41, v41
  v_exp_f32 v42, v42
  v_exp_f32 v43, v43
  v_mfma_f32_32x32x8_bf16 v[52:67], v[28:29], v[26:27], v[52:67]
  ds_read_b128 v[116:119], v9 offset:13376
  v_cvt_pk_bf16_f32 v70, v40, v41
  v_cvt_pk_bf16_f32 v71, v42, v43
  v_exp_f32 v44, v44
  v_exp_f32 v45, v45
  v_exp_f32 v46, v46
  v_exp_f32 v47, v47
  v_mfma_f32_32x32x16_bf16 v[76:91], v[108:111], v[68:71], v[76:91]
  ds_read_b128 v[120:123], v10 offset:13376
  v_cvt_pk_bf16_f32 v72, v44, v45
  v_cvt_pk_bf16_f32 v73, v46, v47
  v_exp_f32 v48, v48
  v_exp_f32 v49, v49
  v_exp_f32 v50, v50
  v_exp_f32 v51, v51
  v_cvt_pk_bf16_f32 v74, v48, v49
  v_cvt_pk_bf16_f32 v75, v50, v51
  s_mul_i32 s32, s67, 0
  s_add_u32 s32, s32, s47
  buffer_load_dwordx2 v[132:133], v11, s[36:39], s32 offen
  s_waitcnt lgkmcnt(0)
  v_mfma_f32_32x32x16_bf16 v[36:51], v[32:35], v[16:19], 0
  v_exp_f32 v52, v52
  v_exp_f32 v53, v53
  v_exp_f32 v54, v54
  v_exp_f32 v55, v55
  v_cvt_pk_bf16_f32 v68, v52, v53
  v_mfma_f32_32x32x16_bf16 v[76:91], v[112:115], v[72:75], v[76:91]
  v_cvt_pk_bf16_f32 v69, v54, v55
  v_exp_f32 v56, v56
  v_exp_f32 v57, v57
  v_exp_f32 v58, v58
  v_exp_f32 v59, v59
  v_mfma_f32_32x32x8_bf16 v[36:51], v[30:31], v[24:25], v[36:51]
  v_cvt_pk_bf16_f32 v70, v56, v57
  v_cvt_pk_bf16_f32 v71, v58, v59
  v_exp_f32 v60, v60
  v_exp_f32 v61, v61
  v_exp_f32 v62, v62
  v_exp_f32 v63, v63
  v_mfma_f32_32x32x16_bf16 v[92:107], v[108:111], v[68:71], v[92:107]
  v_cvt_pk_bf16_f32 v72, v60, v61
  v_cvt_pk_bf16_f32 v73, v62, v63
  v_exp_f32 v64, v64
  v_exp_f32 v65, v65
  v_exp_f32 v66, v66
  v_exp_f32 v67, v67
  v_cvt_pk_bf16_f32 v74, v64, v65
  v_cvt_pk_bf16_f32 v75, v66, v67
  s_waitcnt vmcnt(5) lgkmcnt(0)
  s_barrier
  v_mfma_f32_32x32x16_bf16 v[52:67], v[32:35], v[20:23], 0
  ds_read_b128 v[32:35], v7 offset:12288
  v_exp_f32 v36, v36
  v_exp_f32 v37, v37
  v_exp_f32 v38, v38
  v_exp_f32 v39, v39
  v_cvt_pk_bf16_f32 v68, v36, v37
  v_mfma_f32_32x32x16_bf16 v[92:107], v[112:115], v[72:75], v[92:107]
  ds_read_b64 v[28:29], v8 offset:3072
  v_cvt_pk_bf16_f32 v69, v38, v39
  v_exp_f32 v40, v40
  v_exp_f32 v41, v41
  v_exp_f32 v42, v42
  v_exp_f32 v43, v43
  v_mfma_f32_32x32x8_bf16 v[52:67], v[30:31], v[26:27], v[52:67]
  ds_read_b128 v[108:111], v9 offset:14592
  v_cvt_pk_bf16_f32 v70, v40, v41
  v_cvt_pk_bf16_f32 v71, v42, v43
  v_exp_f32 v44, v44
  v_exp_f32 v45, v45
  v_exp_f32 v46, v46
  v_exp_f32 v47, v47
  v_mfma_f32_32x32x16_bf16 v[76:91], v[116:119], v[68:71], v[76:91]
  ds_read_b128 v[112:115], v10 offset:14592
  v_cvt_pk_bf16_f32 v72, v44, v45
  v_cvt_pk_bf16_f32 v73, v46, v47
  v_exp_f32 v48, v48
  v_exp_f32 v49, v49
  v_exp_f32 v50, v50
  v_exp_f32 v51, v51
  v_cvt_pk_bf16_f32 v74, v48, v49
  v_cvt_pk_bf16_f32 v75, v50, v51
  s_mul_i32 s32, s67, 1
  s_add_u32 s32, s32, s47
  buffer_load_dwordx2 v[134:135], v11, s[36:39], s32 offen
  s_waitcnt lgkmcnt(0)
  v_mfma_f32_32x32x16_bf16 v[36:51], v[32:35], v[16:19], 0
  v_exp_f32 v52, v52
  v_exp_f32 v53, v53
  v_exp_f32 v54, v54
  v_exp_f32 v55, v55
  v_cvt_pk_bf16_f32 v68, v52, v53
  v_mfma_f32_32x32x16_bf16 v[76:91], v[120:123], v[72:75], v[76:91]
  v_cvt_pk_bf16_f32 v69, v54, v55
  v_exp_f32 v56, v56
  v_exp_f32 v57, v57
  v_exp_f32 v58, v58
  v_exp_f32 v59, v59
  v_mfma_f32_32x32x8_bf16 v[36:51], v[28:29], v[24:25], v[36:51]
  v_cvt_pk_bf16_f32 v70, v56, v57
  v_cvt_pk_bf16_f32 v71, v58, v59
  v_exp_f32 v60, v60
  v_exp_f32 v61, v61
  v_exp_f32 v62, v62
  v_exp_f32 v63, v63
  v_mfma_f32_32x32x16_bf16 v[92:107], v[116:119], v[68:71], v[92:107]
  v_cvt_pk_bf16_f32 v72, v60, v61
  v_cvt_pk_bf16_f32 v73, v62, v63
  v_exp_f32 v64, v64
  v_exp_f32 v65, v65
  v_exp_f32 v66, v66
  v_exp_f32 v67, v67
  v_cvt_pk_bf16_f32 v74, v64, v65
  v_cvt_pk_bf16_f32 v75, v66, v67
  s_setprio 1
  v_mfma_f32_32x32x16_bf16 v[52:67], v[32:35], v[20:23], 0
  ds_read_b128 v[32:35], v7 offset:13312
  v_exp_f32 v36, v36
  v_exp_f32 v37, v37
  v_exp_f32 v38, v38
  v_exp_f32 v39, v39
  v_cvt_pk_bf16_f32 v68, v36, v37
  v_mfma_f32_32x32x16_bf16 v[92:107], v[120:123], v[72:75], v[92:107]
  ds_read_b64 v[30:31], v8 offset:3328
  v_cvt_pk_bf16_f32 v69, v38, v39
  v_exp_f32 v40, v40
  v_exp_f32 v41, v41
  v_exp_f32 v42, v42
  v_exp_f32 v43, v43
  v_mfma_f32_32x32x8_bf16 v[52:67], v[28:29], v[26:27], v[52:67]
  ds_read_b128 v[116:119], v9 offset:15808
  v_cvt_pk_bf16_f32 v70, v40, v41
  v_cvt_pk_bf16_f32 v71, v42, v43
  v_exp_f32 v44, v44
  v_exp_f32 v45, v45
  v_exp_f32 v46, v46
  v_exp_f32 v47, v47
  v_mfma_f32_32x32x16_bf16 v[76:91], v[108:111], v[68:71], v[76:91]
  ds_read_b128 v[120:123], v10 offset:15808
  v_cvt_pk_bf16_f32 v72, v44, v45
  v_cvt_pk_bf16_f32 v73, v46, v47
  v_exp_f32 v48, v48
  v_exp_f32 v49, v49
  v_exp_f32 v50, v50
  v_exp_f32 v51, v51
  v_cvt_pk_bf16_f32 v74, v48, v49
  v_cvt_pk_bf16_f32 v75, v50, v51
  s_mul_i32 s32, s67, 2
  s_add_u32 s32, s32, s47
  buffer_load_dwordx2 v[136:137], v11, s[36:39], s32 offen
  s_waitcnt lgkmcnt(0)
  v_mfma_f32_32x32x16_bf16 v[36:51], v[32:35], v[16:19], 0
  v_exp_f32 v52, v52
  v_exp_f32 v53, v53
  v_exp_f32 v54, v54
  v_exp_f32 v55, v55
  v_cvt_pk_bf16_f32 v68, v52, v53
  v_mfma_f32_32x32x16_bf16 v[76:91], v[112:115], v[72:75], v[76:91]
  v_cvt_pk_bf16_f32 v69, v54, v55
  v_exp_f32 v56, v56
  v_exp_f32 v57, v57
  v_exp_f32 v58, v58
  v_exp_f32 v59, v59
  v_mfma_f32_32x32x8_bf16 v[36:51], v[30:31], v[24:25], v[36:51]
  v_cvt_pk_bf16_f32 v70, v56, v57
  v_cvt_pk_bf16_f32 v71, v58, v59
  v_exp_f32 v60, v60
  v_exp_f32 v61, v61
  v_exp_f32 v62, v62
  v_exp_f32 v63, v63
  v_mfma_f32_32x32x16_bf16 v[92:107], v[108:111], v[68:71], v[92:107]
  v_cvt_pk_bf16_f32 v72, v60, v61
  v_cvt_pk_bf16_f32 v73, v62, v63
  v_exp_f32 v64, v64
  v_exp_f32 v65, v65
  v_exp_f32 v66, v66
  v_exp_f32 v67, v67
  v_cvt_pk_bf16_f32 v74, v64, v65
  v_cvt_pk_bf16_f32 v75, v66, v67
  v_mfma_f32_32x32x16_bf16 v[52:67], v[32:35], v[20:23], 0
  ds_read_b128 v[32:35], v7 offset:14336
  v_exp_f32 v36, v36
  v_exp_f32 v37, v37
  v_exp_f32 v38, v38
  v_exp_f32 v39, v39
  v_cvt_pk_bf16_f32 v68, v36, v37
  v_mfma_f32_32x32x16_bf16 v[92:107], v[112:115], v[72:75], v[92:107]
  ds_read_b64 v[28:29], v8 offset:3584
  v_cvt_pk_bf16_f32 v69, v38, v39
  v_exp_f32 v40, v40
  v_exp_f32 v41, v41
  v_exp_f32 v42, v42
  v_exp_f32 v43, v43
  v_mfma_f32_32x32x8_bf16 v[52:67], v[30:31], v[26:27], v[52:67]
  ds_read_b128 v[108:111], v9 offset:17024
  v_cvt_pk_bf16_f32 v70, v40, v41
  v_cvt_pk_bf16_f32 v71, v42, v43
  v_exp_f32 v44, v44
  v_exp_f32 v45, v45
  v_exp_f32 v46, v46
  v_exp_f32 v47, v47
  v_mfma_f32_32x32x16_bf16 v[76:91], v[116:119], v[68:71], v[76:91]
  ds_read_b128 v[112:115], v10 offset:17024
  v_cvt_pk_bf16_f32 v72, v44, v45
  v_cvt_pk_bf16_f32 v73, v46, v47
  v_exp_f32 v48, v48
  v_exp_f32 v49, v49
  v_exp_f32 v50, v50
  v_exp_f32 v51, v51
  v_cvt_pk_bf16_f32 v74, v48, v49
  v_cvt_pk_bf16_f32 v75, v50, v51
  s_mul_i32 s32, s67, 3
  s_add_u32 s32, s32, s47
  buffer_load_dwordx2 v[138:139], v11, s[36:39], s32 offen
  s_waitcnt lgkmcnt(0)
  v_mfma_f32_32x32x16_bf16 v[36:51], v[32:35], v[16:19], 0
  v_exp_f32 v52, v52
  v_exp_f32 v53, v53
  v_exp_f32 v54, v54
  v_exp_f32 v55, v55
  v_cvt_pk_bf16_f32 v68, v52, v53
  v_mfma_f32_32x32x16_bf16 v[76:91], v[120:123], v[72:75], v[76:91]
  v_cvt_pk_bf16_f32 v69, v54, v55
  v_exp_f32 v56, v56
  v_exp_f32 v57, v57
  v_exp_f32 v58, v58
  v_exp_f32 v59, v59
  v_mfma_f32_32x32x8_bf16 v[36:51], v[28:29], v[24:25], v[36:51]
  v_cvt_pk_bf16_f32 v70, v56, v57
  v_cvt_pk_bf16_f32 v71, v58, v59
  v_exp_f32 v60, v60
  v_exp_f32 v61, v61
  v_exp_f32 v62, v62
  v_exp_f32 v63, v63
  v_mfma_f32_32x32x16_bf16 v[92:107], v[116:119], v[68:71], v[92:107]
  v_cvt_pk_bf16_f32 v72, v60, v61
  v_cvt_pk_bf16_f32 v73, v62, v63
  v_exp_f32 v64, v64
  v_exp_f32 v65, v65
  v_exp_f32 v66, v66
  v_exp_f32 v67, v67
  v_cvt_pk_bf16_f32 v74, v64, v65
  v_cvt_pk_bf16_f32 v75, v66, v67
  s_setprio 0
  v_mfma_f32_32x32x16_bf16 v[52:67], v[32:35], v[20:23], 0
  ds_read_b128 v[32:35], v7 offset:15360
  v_exp_f32 v36, v36
  v_exp_f32 v37, v37
  v_exp_f32 v38, v38
  v_exp_f32 v39, v39
  v_cvt_pk_bf16_f32 v68, v36, v37
  v_mfma_f32_32x32x16_bf16 v[92:107], v[120:123], v[72:75], v[92:107]
  ds_read_b64 v[30:31], v8 offset:3840
  v_cvt_pk_bf16_f32 v69, v38, v39
  v_exp_f32 v40, v40
  v_exp_f32 v41, v41
  v_exp_f32 v42, v42
  v_exp_f32 v43, v43
  v_mfma_f32_32x32x8_bf16 v[52:67], v[28:29], v[26:27], v[52:67]
  ds_read_b128 v[116:119], v9 offset:18240
  v_cvt_pk_bf16_f32 v70, v40, v41
  v_cvt_pk_bf16_f32 v71, v42, v43
  v_exp_f32 v44, v44
  v_exp_f32 v45, v45
  v_exp_f32 v46, v46
  v_exp_f32 v47, v47
  v_mfma_f32_32x32x16_bf16 v[76:91], v[108:111], v[68:71], v[76:91]
  ds_read_b128 v[120:123], v10 offset:18240
  v_cvt_pk_bf16_f32 v72, v44, v45
  v_cvt_pk_bf16_f32 v73, v46, v47
  v_exp_f32 v48, v48
  v_exp_f32 v49, v49
  v_exp_f32 v50, v50
  v_exp_f32 v51, v51
  v_cvt_pk_bf16_f32 v74, v48, v49
  v_cvt_pk_bf16_f32 v75, v50, v51
  s_waitcnt lgkmcnt(0)
  v_mfma_f32_32x32x16_bf16 v[36:51], v[32:35], v[16:19], 0
  v_exp_f32 v52, v52
  v_exp_f32 v53, v53
  v_exp_f32 v54, v54
  v_exp_f32 v55, v55
  v_cvt_pk_bf16_f32 v68, v52, v53
  v_mfma_f32_32x32x16_bf16 v[76:91], v[112:115], v[72:75], v[76:91]
  v_cvt_pk_bf16_f32 v69, v54, v55
  v_exp_f32 v56, v56
  v_exp_f32 v57, v57
  v_exp_f32 v58, v58
  v_exp_f32 v59, v59
  v_mfma_f32_32x32x8_bf16 v[36:51], v[30:31], v[24:25], v[36:51]
  v_cvt_pk_bf16_f32 v70, v56, v57
  v_cvt_pk_bf16_f32 v71, v58, v59
  v_exp_f32 v60, v60
  v_exp_f32 v61, v61
  v_exp_f32 v62, v62
  v_exp_f32 v63, v63
  v_mfma_f32_32x32x16_bf16 v[92:107], v[108:111], v[68:71], v[92:107]
  v_cvt_pk_bf16_f32 v72, v60, v61
  v_cvt_pk_bf16_f32 v73, v62, v63
  v_exp_f32 v64, v64
  v_exp_f32 v65, v65
  v_exp_f32 v66, v66
  v_exp_f32 v67, v67
  v_cvt_pk_bf16_f32 v74, v64, v65
  v_cvt_pk_bf16_f32 v75, v66, v67
  v_mfma_f32_32x32x16_bf16 v[52:67], v[32:35], v[20:23], 0
  ds_read_b128 v[32:35], v7 offset:16384
  v_exp_f32 v36, v36
  v_exp_f32 v37, v37
  v_exp_f32 v38, v38
  v_exp_f32 v39, v39
  v_cvt_pk_bf16_f32 v68, v36, v37
  v_mfma_f32_32x32x16_bf16 v[92:107], v[112:115], v[72:75], v[92:107]
  ds_read_b64 v[28:29], v8 offset:4096
  v_cvt_pk_bf16_f32 v69, v38, v39
  v_exp_f32 v40, v40
  v_exp_f32 v41, v41
  v_exp_f32 v42, v42
  v_exp_f32 v43, v43
  v_mfma_f32_32x32x8_bf16 v[52:67], v[30:31], v[26:27], v[52:67]
  ds_read_b128 v[108:111], v9 offset:19456
  v_cvt_pk_bf16_f32 v70, v40, v41
  v_cvt_pk_bf16_f32 v71, v42, v43
  v_exp_f32 v44, v44
  v_exp_f32 v45, v45
  v_exp_f32 v46, v46
  v_exp_f32 v47, v47
  v_mfma_f32_32x32x16_bf16 v[76:91], v[116:119], v[68:71], v[76:91]
  ds_read_b128 v[112:115], v10 offset:19456
  v_cvt_pk_bf16_f32 v72, v44, v45
  v_cvt_pk_bf16_f32 v73, v46, v47
  v_exp_f32 v48, v48
  v_exp_f32 v49, v49
  v_exp_f32 v50, v50
  v_exp_f32 v51, v51
  v_cvt_pk_bf16_f32 v74, v48, v49
  v_cvt_pk_bf16_f32 v75, v50, v51
  s_waitcnt lgkmcnt(0)
  v_mfma_f32_32x32x16_bf16 v[36:51], v[32:35], v[16:19], 0
  v_exp_f32 v52, v52
  v_exp_f32 v53, v53
  v_exp_f32 v54, v54
  v_exp_f32 v55, v55
  v_cvt_pk_bf16_f32 v68, v52, v53
  v_mfma_f32_32x32x16_bf16 v[76:91], v[120:123], v[72:75], v[76:91]
  v_cvt_pk_bf16_f32 v69, v54, v55
  v_exp_f32 v56, v56
  v_exp_f32 v57, v57
  v_exp_f32 v58, v58
  v_exp_f32 v59, v59
  v_mfma_f32_32x32x8_bf16 v[36:51], v[28:29], v[24:25], v[36:51]
  v_cvt_pk_bf16_f32 v70, v56, v57
  v_cvt_pk_bf16_f32 v71, v58, v59
  v_exp_f32 v60, v60
  v_exp_f32 v61, v61
  v_exp_f32 v62, v62
  v_exp_f32 v63, v63
  v_mfma_f32_32x32x16_bf16 v[92:107], v[116:119], v[68:71], v[92:107]
  v_cvt_pk_bf16_f32 v72, v60, v61
  v_cvt_pk_bf16_f32 v73, v62, v63
  v_exp_f32 v64, v64
  v_exp_f32 v65, v65
  v_exp_f32 v66, v66
  v_exp_f32 v67, v67
  v_cvt_pk_bf16_f32 v74, v64, v65
  v_cvt_pk_bf16_f32 v75, v66, v67
  s_setprio 3
  v_mfma_f32_32x32x16_bf16 v[52:67], v[32:35], v[20:23], 0
  ds_read_b128 v[32:35], v7 offset:17408
  v_exp_f32 v36, v36
  v_exp_f32 v37, v37
  v_exp_f32 v38, v38
  v_exp_f32 v39, v39
  v_cvt_pk_bf16_f32 v68, v36, v37
  v_mfma_f32_32x32x16_bf16 v[92:107], v[120:123], v[72:75], v[92:107]
  ds_read_b64 v[30:31], v8 offset:4352
  v_cvt_pk_bf16_f32 v69, v38, v39
  v_exp_f32 v40, v40
  v_exp_f32 v41, v41
  v_exp_f32 v42, v42
  v_exp_f32 v43, v43
  v_mfma_f32_32x32x8_bf16 v[52:67], v[28:29], v[26:27], v[52:67]
  ds_read_b128 v[116:119], v9 offset:20672
  v_cvt_pk_bf16_f32 v70, v40, v41
  v_cvt_pk_bf16_f32 v71, v42, v43
  v_exp_f32 v44, v44
  v_exp_f32 v45, v45
  v_exp_f32 v46, v46
  v_exp_f32 v47, v47
  v_mfma_f32_32x32x16_bf16 v[76:91], v[108:111], v[68:71], v[76:91]
  ds_read_b128 v[120:123], v10 offset:20672
  v_cvt_pk_bf16_f32 v72, v44, v45
  v_cvt_pk_bf16_f32 v73, v46, v47
  v_exp_f32 v48, v48
  v_exp_f32 v49, v49
  v_exp_f32 v50, v50
  v_exp_f32 v51, v51
  v_cvt_pk_bf16_f32 v74, v48, v49
  v_cvt_pk_bf16_f32 v75, v50, v51
  s_waitcnt lgkmcnt(0)
  v_mfma_f32_32x32x16_bf16 v[36:51], v[32:35], v[16:19], 0
  v_exp_f32 v52, v52
  v_exp_f32 v53, v53
  v_exp_f32 v54, v54
  v_exp_f32 v55, v55
  v_cvt_pk_bf16_f32 v68, v52, v53
  v_mfma_f32_32x32x16_bf16 v[76:91], v[112:115], v[72:75], v[76:91]
  v_cvt_pk_bf16_f32 v69, v54, v55
  v_exp_f32 v56, v56
  v_exp_f32 v57, v57
  v_exp_f32 v58, v58
  v_exp_f32 v59, v59
  v_mfma_f32_32x32x8_bf16 v[36:51], v[30:31], v[24:25], v[36:51]
  v_cvt_pk_bf16_f32 v70, v56, v57
  v_cvt_pk_bf16_f32 v71, v58, v59
  v_exp_f32 v60, v60
  v_exp_f32 v61, v61
  v_exp_f32 v62, v62
  v_exp_f32 v63, v63
  v_mfma_f32_32x32x16_bf16 v[92:107], v[108:111], v[68:71], v[92:107]
  v_cvt_pk_bf16_f32 v72, v60, v61
  v_cvt_pk_bf16_f32 v73, v62, v63
  v_exp_f32 v64, v64
  v_exp_f32 v65, v65
  v_exp_f32 v66, v66
  v_exp_f32 v67, v67
  v_cvt_pk_bf16_f32 v74, v64, v65
  v_cvt_pk_bf16_f32 v75, v66, v67
  v_mfma_f32_32x32x16_bf16 v[52:67], v[32:35], v[20:23], 0
  ds_read_b128 v[32:35], v7 offset:18432
  v_exp_f32 v36, v36
  v_exp_f32 v37, v37
  v_exp_f32 v38, v38
  v_exp_f32 v39, v39
  v_cvt_pk_bf16_f32 v68, v36, v37
  v_mfma_f32_32x32x16_bf16 v[92:107], v[112:115], v[72:75], v[92:107]
  ds_read_b64 v[28:29], v8 offset:4608
  v_cvt_pk_bf16_f32 v69, v38, v39
  v_exp_f32 v40, v40
  v_exp_f32 v41, v41
  v_exp_f32 v42, v42
  v_exp_f32 v43, v43
  v_mfma_f32_32x32x8_bf16 v[52:67], v[30:31], v[26:27], v[52:67]
  ds_read_b128 v[108:111], v9 offset:21888
  v_cvt_pk_bf16_f32 v70, v40, v41
  v_cvt_pk_bf16_f32 v71, v42, v43
  v_exp_f32 v44, v44
  v_exp_f32 v45, v45
  v_exp_f32 v46, v46
  v_exp_f32 v47, v47
  v_mfma_f32_32x32x16_bf16 v[76:91], v[116:119], v[68:71], v[76:91]
  ds_read_b128 v[112:115], v10 offset:21888
  v_cvt_pk_bf16_f32 v72, v44, v45
  v_cvt_pk_bf16_f32 v73, v46, v47
  v_exp_f32 v48, v48
  v_exp_f32 v49, v49
  v_exp_f32 v50, v50
  v_exp_f32 v51, v51
  v_cvt_pk_bf16_f32 v74, v48, v49
  v_cvt_pk_bf16_f32 v75, v50, v51
  s_waitcnt lgkmcnt(0)
  v_mfma_f32_32x32x16_bf16 v[36:51], v[32:35], v[16:19], 0
  v_exp_f32 v52, v52
  v_exp_f32 v53, v53
  v_exp_f32 v54, v54
  v_exp_f32 v55, v55
  v_cvt_pk_bf16_f32 v68, v52, v53
  v_mfma_f32_32x32x16_bf16 v[76:91], v[120:123], v[72:75], v[76:91]
  v_cvt_pk_bf16_f32 v69, v54, v55
  v_exp_f32 v56, v56
  v_exp_f32 v57, v57
  v_exp_f32 v58, v58
  v_exp_f32 v59, v59
  v_mfma_f32_32x32x8_bf16 v[36:51], v[28:29], v[24:25], v[36:51]
  v_cvt_pk_bf16_f32 v70, v56, v57
  v_cvt_pk_bf16_f32 v71, v58, v59
  v_exp_f32 v60, v60
  v_exp_f32 v61, v61
  v_exp_f32 v62, v62
  v_exp_f32 v63, v63
  v_mfma_f32_32x32x16_bf16 v[92:107], v[116:119], v[68:71], v[92:107]
  v_cvt_pk_bf16_f32 v72, v60, v61
  v_cvt_pk_bf16_f32 v73, v62, v63
  v_exp_f32 v64, v64
  v_exp_f32 v65, v65
  v_exp_f32 v66, v66
  v_exp_f32 v67, v67
  v_cvt_pk_bf16_f32 v74, v64, v65
  v_cvt_pk_bf16_f32 v75, v66, v67
  s_setprio 2
  v_mfma_f32_32x32x16_bf16 v[52:67], v[32:35], v[20:23], 0
  ds_read_b128 v[32:35], v7 offset:19456
  v_exp_f32 v36, v36
  v_exp_f32 v37, v37
  v_exp_f32 v38, v38
  v_exp_f32 v39, v39
  v_cvt_pk_bf16_f32 v68, v36, v37
  v_mfma_f32_32x32x16_bf16 v[92:107], v[120:123], v[72:75], v[92:107]
  ds_read_b64 v[30:31], v8 offset:4864
  v_cvt_pk_bf16_f32 v69, v38, v39
  v_exp_f32 v40, v40
  v_exp_f32 v41, v41
  v_exp_f32 v42, v42
  v_exp_f32 v43, v43
  v_mfma_f32_32x32x8_bf16 v[52:67], v[28:29], v[26:27], v[52:67]
  ds_read_b128 v[116:119], v9 offset:23104
  v_cvt_pk_bf16_f32 v70, v40, v41
  v_cvt_pk_bf16_f32 v71, v42, v43
  v_exp_f32 v44, v44
  v_exp_f32 v45, v45
  v_exp_f32 v46, v46
  v_exp_f32 v47, v47
  v_mfma_f32_32x32x16_bf16 v[76:91], v[108:111], v[68:71], v[76:91]
  ds_read_b128 v[120:123], v10 offset:23104
  v_cvt_pk_bf16_f32 v72, v44, v45
  v_cvt_pk_bf16_f32 v73, v46, v47
  v_exp_f32 v48, v48
  v_exp_f32 v49, v49
  v_exp_f32 v50, v50
  v_exp_f32 v51, v51
  v_cvt_pk_bf16_f32 v74, v48, v49
  v_cvt_pk_bf16_f32 v75, v50, v51
  s_waitcnt vmcnt(0)
  v_perm_b32 v140, v126, v124, s34
  v_perm_b32 v141, v130, v128, s34
  v_perm_b32 v142, v134, v132, s34
  v_perm_b32 v143, v138, v136, s34
  buffer_store_dwordx4 v[140:143], v12, s[40:43], 0 offen offset:0 sc1
  s_waitcnt lgkmcnt(0)
  v_mfma_f32_32x32x16_bf16 v[36:51], v[32:35], v[16:19], 0
  v_exp_f32 v52, v52
  v_exp_f32 v53, v53
  v_exp_f32 v54, v54
  v_exp_f32 v55, v55
  v_cvt_pk_bf16_f32 v68, v52, v53
  v_mfma_f32_32x32x16_bf16 v[76:91], v[112:115], v[72:75], v[76:91]
  v_cvt_pk_bf16_f32 v69, v54, v55
  v_exp_f32 v56, v56
  v_exp_f32 v57, v57
  v_exp_f32 v58, v58
  v_exp_f32 v59, v59
  v_mfma_f32_32x32x8_bf16 v[36:51], v[30:31], v[24:25], v[36:51]
  v_cvt_pk_bf16_f32 v70, v56, v57
  v_cvt_pk_bf16_f32 v71, v58, v59
  v_exp_f32 v60, v60
  v_exp_f32 v61, v61
  v_exp_f32 v62, v62
  v_exp_f32 v63, v63
  v_mfma_f32_32x32x16_bf16 v[92:107], v[108:111], v[68:71], v[92:107]
  v_cvt_pk_bf16_f32 v72, v60, v61
  v_cvt_pk_bf16_f32 v73, v62, v63
  v_exp_f32 v64, v64
  v_exp_f32 v65, v65
  v_exp_f32 v66, v66
  v_exp_f32 v67, v67
  v_cvt_pk_bf16_f32 v74, v64, v65
  v_cvt_pk_bf16_f32 v75, v66, v67
  v_mfma_f32_32x32x16_bf16 v[52:67], v[32:35], v[20:23], 0
  ds_read_b128 v[32:35], v7 offset:20480
  v_exp_f32 v36, v36
  v_exp_f32 v37, v37
  v_exp_f32 v38, v38
  v_exp_f32 v39, v39
  v_cvt_pk_bf16_f32 v68, v36, v37
  v_mfma_f32_32x32x16_bf16 v[92:107], v[112:115], v[72:75], v[92:107]
  ds_read_b64 v[28:29], v8 offset:5120
  v_cvt_pk_bf16_f32 v69, v38, v39
  v_exp_f32 v40, v40
  v_exp_f32 v41, v41
  v_exp_f32 v42, v42
  v_exp_f32 v43, v43
  v_mfma_f32_32x32x8_bf16 v[52:67], v[30:31], v[26:27], v[52:67]
  ds_read_b128 v[108:111], v9 offset:24320
  v_cvt_pk_bf16_f32 v70, v40, v41
  v_cvt_pk_bf16_f32 v71, v42, v43
  v_exp_f32 v44, v44
  v_exp_f32 v45, v45
  v_exp_f32 v46, v46
  v_exp_f32 v47, v47
  v_mfma_f32_32x32x16_bf16 v[76:91], v[116:119], v[68:71], v[76:91]
  ds_read_b128 v[112:115], v10 offset:24320
  v_cvt_pk_bf16_f32 v72, v44, v45
  v_cvt_pk_bf16_f32 v73, v46, v47
  v_exp_f32 v48, v48
  v_exp_f32 v49, v49
  v_exp_f32 v50, v50
  v_exp_f32 v51, v51
  v_cvt_pk_bf16_f32 v74, v48, v49
  v_cvt_pk_bf16_f32 v75, v50, v51
  buffer_load_dwordx4 v[156:159], v6, s[48:51], s46 offen offset:0
  s_waitcnt lgkmcnt(0)
  v_mfma_f32_32x32x16_bf16 v[36:51], v[32:35], v[16:19], 0
  v_exp_f32 v52, v52
  v_exp_f32 v53, v53
  v_exp_f32 v54, v54
  v_exp_f32 v55, v55
  v_cvt_pk_bf16_f32 v68, v52, v53
  v_mfma_f32_32x32x16_bf16 v[76:91], v[120:123], v[72:75], v[76:91]
  v_cvt_pk_bf16_f32 v69, v54, v55
  v_exp_f32 v56, v56
  v_exp_f32 v57, v57
  v_exp_f32 v58, v58
  v_exp_f32 v59, v59
  v_mfma_f32_32x32x8_bf16 v[36:51], v[28:29], v[24:25], v[36:51]
  v_cvt_pk_bf16_f32 v70, v56, v57
  v_cvt_pk_bf16_f32 v71, v58, v59
  v_exp_f32 v60, v60
  v_exp_f32 v61, v61
  v_exp_f32 v62, v62
  v_exp_f32 v63, v63
  v_mfma_f32_32x32x16_bf16 v[92:107], v[116:119], v[68:71], v[92:107]
  v_cvt_pk_bf16_f32 v72, v60, v61
  v_cvt_pk_bf16_f32 v73, v62, v63
  v_exp_f32 v64, v64
  v_exp_f32 v65, v65
  v_exp_f32 v66, v66
  v_exp_f32 v67, v67
  v_cvt_pk_bf16_f32 v74, v64, v65
  v_cvt_pk_bf16_f32 v75, v66, v67
  v_perm_b32 v144, v126, v124, s35
  v_perm_b32 v145, v130, v128, s35
  v_perm_b32 v146, v134, v132, s35
  v_perm_b32 v147, v138, v136, s35
  buffer_store_dwordx4 v[144:147], v12, s[40:43], 0 offen offset:64 sc1
  s_setprio 1
  v_mfma_f32_32x32x16_bf16 v[52:67], v[32:35], v[20:23], 0
  ds_read_b128 v[32:35], v7 offset:21504
  v_exp_f32 v36, v36
  v_exp_f32 v37, v37
  v_exp_f32 v38, v38
  v_exp_f32 v39, v39
  v_cvt_pk_bf16_f32 v68, v36, v37
  v_mfma_f32_32x32x16_bf16 v[92:107], v[120:123], v[72:75], v[92:107]
  ds_read_b64 v[30:31], v8 offset:5376
  v_cvt_pk_bf16_f32 v69, v38, v39
  v_exp_f32 v40, v40
  v_exp_f32 v41, v41
  v_exp_f32 v42, v42
  v_exp_f32 v43, v43
  v_mfma_f32_32x32x8_bf16 v[52:67], v[28:29], v[26:27], v[52:67]
  ds_read_b128 v[116:119], v9 offset:25536
  v_cvt_pk_bf16_f32 v70, v40, v41
  v_cvt_pk_bf16_f32 v71, v42, v43
  v_exp_f32 v44, v44
  v_exp_f32 v45, v45
  v_exp_f32 v46, v46
  v_exp_f32 v47, v47
  v_mfma_f32_32x32x16_bf16 v[76:91], v[108:111], v[68:71], v[76:91]
  ds_read_b128 v[120:123], v10 offset:25536
  v_cvt_pk_bf16_f32 v72, v44, v45
  v_cvt_pk_bf16_f32 v73, v46, v47
  v_exp_f32 v48, v48
  v_exp_f32 v49, v49
  v_exp_f32 v50, v50
  v_exp_f32 v51, v51
  v_cvt_pk_bf16_f32 v74, v48, v49
  v_cvt_pk_bf16_f32 v75, v50, v51
  s_waitcnt lgkmcnt(0)
  v_mfma_f32_32x32x16_bf16 v[36:51], v[32:35], v[16:19], 0
  v_exp_f32 v52, v52
  v_exp_f32 v53, v53
  v_exp_f32 v54, v54
  v_exp_f32 v55, v55
  v_cvt_pk_bf16_f32 v68, v52, v53
  v_mfma_f32_32x32x16_bf16 v[76:91], v[112:115], v[72:75], v[76:91]
  v_cvt_pk_bf16_f32 v69, v54, v55
  v_exp_f32 v56, v56
  v_exp_f32 v57, v57
  v_exp_f32 v58, v58
  v_exp_f32 v59, v59
  v_mfma_f32_32x32x8_bf16 v[36:51], v[30:31], v[24:25], v[36:51]
  v_cvt_pk_bf16_f32 v70, v56, v57
  v_cvt_pk_bf16_f32 v71, v58, v59
  v_exp_f32 v60, v60
  v_exp_f32 v61, v61
  v_exp_f32 v62, v62
  v_exp_f32 v63, v63
  v_mfma_f32_32x32x16_bf16 v[92:107], v[108:111], v[68:71], v[92:107]
  v_cvt_pk_bf16_f32 v72, v60, v61
  v_cvt_pk_bf16_f32 v73, v62, v63
  v_exp_f32 v64, v64
  v_exp_f32 v65, v65
  v_exp_f32 v66, v66
  v_exp_f32 v67, v67
  v_cvt_pk_bf16_f32 v74, v64, v65
  v_cvt_pk_bf16_f32 v75, v66, v67
  v_mfma_f32_32x32x16_bf16 v[52:67], v[32:35], v[20:23], 0
  ds_read_b128 v[32:35], v7 offset:22528
  v_exp_f32 v36, v36
  v_exp_f32 v37, v37
  v_exp_f32 v38, v38
  v_exp_f32 v39, v39
  v_cvt_pk_bf16_f32 v68, v36, v37
  v_mfma_f32_32x32x16_bf16 v[92:107], v[112:115], v[72:75], v[92:107]
  ds_read_b64 v[28:29], v8 offset:5632
  v_cvt_pk_bf16_f32 v69, v38, v39
  v_exp_f32 v40, v40
  v_exp_f32 v41, v41
  v_exp_f32 v42, v42
  v_exp_f32 v43, v43
  v_mfma_f32_32x32x8_bf16 v[52:67], v[30:31], v[26:27], v[52:67]
  ds_read_b128 v[108:111], v9 offset:26752
  v_cvt_pk_bf16_f32 v70, v40, v41
  v_cvt_pk_bf16_f32 v71, v42, v43
  v_exp_f32 v44, v44
  v_exp_f32 v45, v45
  v_exp_f32 v46, v46
  v_exp_f32 v47, v47
  v_mfma_f32_32x32x16_bf16 v[76:91], v[116:119], v[68:71], v[76:91]
  ds_read_b128 v[112:115], v10 offset:26752
  v_cvt_pk_bf16_f32 v72, v44, v45
  v_cvt_pk_bf16_f32 v73, v46, v47
  v_exp_f32 v48, v48
  v_exp_f32 v49, v49
  v_exp_f32 v50, v50
  v_exp_f32 v51, v51
  v_cvt_pk_bf16_f32 v74, v48, v49
  v_cvt_pk_bf16_f32 v75, v50, v51
  buffer_load_dwordx4 v[156:159], v6, s[48:51], s46 offen offset:1024
  v_perm_b32 v148, v127, v125, s34
  v_perm_b32 v149, v131, v129, s34
  v_perm_b32 v150, v135, v133, s34
  v_perm_b32 v151, v139, v137, s34
  buffer_store_dwordx4 v[148:151], v12, s[40:43], 0 offen offset:128 sc1
  s_waitcnt lgkmcnt(0)
  v_mfma_f32_32x32x16_bf16 v[36:51], v[32:35], v[16:19], 0
  v_exp_f32 v52, v52
  v_exp_f32 v53, v53
  v_exp_f32 v54, v54
  v_exp_f32 v55, v55
  v_cvt_pk_bf16_f32 v68, v52, v53
  v_mfma_f32_32x32x16_bf16 v[76:91], v[120:123], v[72:75], v[76:91]
  v_cvt_pk_bf16_f32 v69, v54, v55
  v_exp_f32 v56, v56
  v_exp_f32 v57, v57
  v_exp_f32 v58, v58
  v_exp_f32 v59, v59
  v_mfma_f32_32x32x8_bf16 v[36:51], v[28:29], v[24:25], v[36:51]
  v_cvt_pk_bf16_f32 v70, v56, v57
  v_cvt_pk_bf16_f32 v71, v58, v59
  v_exp_f32 v60, v60
  v_exp_f32 v61, v61
  v_exp_f32 v62, v62
  v_exp_f32 v63, v63
  v_mfma_f32_32x32x16_bf16 v[92:107], v[116:119], v[68:71], v[92:107]
  v_cvt_pk_bf16_f32 v72, v60, v61
  v_cvt_pk_bf16_f32 v73, v62, v63
  v_exp_f32 v64, v64
  v_exp_f32 v65, v65
  v_exp_f32 v66, v66
  v_exp_f32 v67, v67
  v_cvt_pk_bf16_f32 v74, v64, v65
  v_cvt_pk_bf16_f32 v75, v66, v67
  s_setprio 0
  v_mfma_f32_32x32x16_bf16 v[52:67], v[32:35], v[20:23], 0
  ds_read_b128 v[32:35], v7 offset:23552
  v_exp_f32 v36, v36
  v_exp_f32 v37, v37
  v_exp_f32 v38, v38
  v_exp_f32 v39, v39
  v_cvt_pk_bf16_f32 v68, v36, v37
  v_mfma_f32_32x32x16_bf16 v[92:107], v[120:123], v[72:75], v[92:107]
  ds_read_b64 v[30:31], v8 offset:5888
  v_cvt_pk_bf16_f32 v69, v38, v39
  v_exp_f32 v40, v40
  v_exp_f32 v41, v41
  v_exp_f32 v42, v42
  v_exp_f32 v43, v43
  v_mfma_f32_32x32x8_bf16 v[52:67], v[28:29], v[26:27], v[52:67]
  ds_read_b128 v[116:119], v9 offset:27968
  v_cvt_pk_bf16_f32 v70, v40, v41
  v_cvt_pk_bf16_f32 v71, v42, v43
  v_exp_f32 v44, v44
  v_exp_f32 v45, v45
  v_exp_f32 v46, v46
  v_exp_f32 v47, v47
  v_mfma_f32_32x32x16_bf16 v[76:91], v[108:111], v[68:71], v[76:91]
  ds_read_b128 v[120:123], v10 offset:27968
  v_cvt_pk_bf16_f32 v72, v44, v45
  v_cvt_pk_bf16_f32 v73, v46, v47
  v_exp_f32 v48, v48
  v_exp_f32 v49, v49
  v_exp_f32 v50, v50
  v_exp_f32 v51, v51
  v_cvt_pk_bf16_f32 v74, v48, v49
  v_cvt_pk_bf16_f32 v75, v50, v51
  s_waitcnt lgkmcnt(0)
  v_mfma_f32_32x32x16_bf16 v[36:51], v[32:35], v[16:19], 0
  v_exp_f32 v52, v52
  v_exp_f32 v53, v53
  v_exp_f32 v54, v54
  v_exp_f32 v55, v55
  v_cvt_pk_bf16_f32 v68, v52, v53
  v_mfma_f32_32x32x16_bf16 v[76:91], v[112:115], v[72:75], v[76:91]
  v_cvt_pk_bf16_f32 v69, v54, v55
  v_exp_f32 v56, v56
  v_exp_f32 v57, v57
  v_exp_f32 v58, v58
  v_exp_f32 v59, v59
  v_mfma_f32_32x32x8_bf16 v[36:51], v[30:31], v[24:25], v[36:51]
  v_cvt_pk_bf16_f32 v70, v56, v57
  v_cvt_pk_bf16_f32 v71, v58, v59
  v_exp_f32 v60, v60
  v_exp_f32 v61, v61
  v_exp_f32 v62, v62
  v_exp_f32 v63, v63
  v_mfma_f32_32x32x16_bf16 v[92:107], v[108:111], v[68:71], v[92:107]
  v_cvt_pk_bf16_f32 v72, v60, v61
  v_cvt_pk_bf16_f32 v73, v62, v63
  v_exp_f32 v64, v64
  v_exp_f32 v65, v65
  v_exp_f32 v66, v66
  v_exp_f32 v67, v67
  v_cvt_pk_bf16_f32 v74, v64, v65
  v_cvt_pk_bf16_f32 v75, v66, v67
  v_perm_b32 v152, v127, v125, s35
  v_perm_b32 v153, v131, v129, s35
  v_perm_b32 v154, v135, v133, s35
  v_perm_b32 v155, v139, v137, s35
  buffer_store_dwordx4 v[152:155], v12, s[40:43], 0 offen offset:192 sc1
  v_mfma_f32_32x32x16_bf16 v[52:67], v[32:35], v[20:23], 0
  ds_read_b128 v[32:35], v7 offset:24576
  v_exp_f32 v36, v36
  v_exp_f32 v37, v37
  v_exp_f32 v38, v38
  v_exp_f32 v39, v39
  v_cvt_pk_bf16_f32 v68, v36, v37
  v_mfma_f32_32x32x16_bf16 v[92:107], v[112:115], v[72:75], v[92:107]
  ds_read_b64 v[28:29], v8 offset:6144
  v_cvt_pk_bf16_f32 v69, v38, v39
  v_exp_f32 v40, v40
  v_exp_f32 v41, v41
  v_exp_f32 v42, v42
  v_exp_f32 v43, v43
  v_mfma_f32_32x32x8_bf16 v[52:67], v[30:31], v[26:27], v[52:67]
  ds_read_b128 v[108:111], v9 offset:29184
  v_cvt_pk_bf16_f32 v70, v40, v41
  v_cvt_pk_bf16_f32 v71, v42, v43
  v_exp_f32 v44, v44
  v_exp_f32 v45, v45
  v_exp_f32 v46, v46
  v_exp_f32 v47, v47
  v_mfma_f32_32x32x16_bf16 v[76:91], v[116:119], v[68:71], v[76:91]
  ds_read_b128 v[112:115], v10 offset:29184
  v_cvt_pk_bf16_f32 v72, v44, v45
  v_cvt_pk_bf16_f32 v73, v46, v47
  v_exp_f32 v48, v48
  v_exp_f32 v49, v49
  v_exp_f32 v50, v50
  v_exp_f32 v51, v51
  v_cvt_pk_bf16_f32 v74, v48, v49
  v_cvt_pk_bf16_f32 v75, v50, v51
  buffer_load_dwordx4 v[156:159], v6, s[48:51], s46 offen offset:2048
  s_waitcnt lgkmcnt(0)
  v_mfma_f32_32x32x16_bf16 v[36:51], v[32:35], v[16:19], 0
  v_exp_f32 v52, v52
  v_exp_f32 v53, v53
  v_exp_f32 v54, v54
  v_exp_f32 v55, v55
  v_cvt_pk_bf16_f32 v68, v52, v53
  v_mfma_f32_32x32x16_bf16 v[76:91], v[120:123], v[72:75], v[76:91]
  v_cvt_pk_bf16_f32 v69, v54, v55
  v_exp_f32 v56, v56
  v_exp_f32 v57, v57
  v_exp_f32 v58, v58
  v_exp_f32 v59, v59
  v_mfma_f32_32x32x8_bf16 v[36:51], v[28:29], v[24:25], v[36:51]
  v_cvt_pk_bf16_f32 v70, v56, v57
  v_cvt_pk_bf16_f32 v71, v58, v59
  v_exp_f32 v60, v60
  v_exp_f32 v61, v61
  v_exp_f32 v62, v62
  v_exp_f32 v63, v63
  v_mfma_f32_32x32x16_bf16 v[92:107], v[116:119], v[68:71], v[92:107]
  v_cvt_pk_bf16_f32 v72, v60, v61
  v_cvt_pk_bf16_f32 v73, v62, v63
  v_exp_f32 v64, v64
  v_exp_f32 v65, v65
  v_exp_f32 v66, v66
  v_exp_f32 v67, v67
  v_cvt_pk_bf16_f32 v74, v64, v65
  v_cvt_pk_bf16_f32 v75, v66, v67
  s_setprio 3
  v_mfma_f32_32x32x16_bf16 v[52:67], v[32:35], v[20:23], 0
  ds_read_b128 v[32:35], v7 offset:25600
  v_exp_f32 v36, v36
  v_exp_f32 v37, v37
  v_exp_f32 v38, v38
  v_exp_f32 v39, v39
  v_cvt_pk_bf16_f32 v68, v36, v37
  v_mfma_f32_32x32x16_bf16 v[92:107], v[120:123], v[72:75], v[92:107]
  ds_read_b64 v[30:31], v8 offset:6400
  v_cvt_pk_bf16_f32 v69, v38, v39
  v_exp_f32 v40, v40
  v_exp_f32 v41, v41
  v_exp_f32 v42, v42
  v_exp_f32 v43, v43
  v_mfma_f32_32x32x8_bf16 v[52:67], v[28:29], v[26:27], v[52:67]
  ds_read_b128 v[116:119], v9 offset:30400
  v_cvt_pk_bf16_f32 v70, v40, v41
  v_cvt_pk_bf16_f32 v71, v42, v43
  v_exp_f32 v44, v44
  v_exp_f32 v45, v45
  v_exp_f32 v46, v46
  v_exp_f32 v47, v47
  v_mfma_f32_32x32x16_bf16 v[76:91], v[108:111], v[68:71], v[76:91]
  ds_read_b128 v[120:123], v10 offset:30400
  v_cvt_pk_bf16_f32 v72, v44, v45
  v_cvt_pk_bf16_f32 v73, v46, v47
  v_exp_f32 v48, v48
  v_exp_f32 v49, v49
  v_exp_f32 v50, v50
  v_exp_f32 v51, v51
  v_cvt_pk_bf16_f32 v74, v48, v49
  v_cvt_pk_bf16_f32 v75, v50, v51
  s_waitcnt lgkmcnt(0)
  v_mfma_f32_32x32x16_bf16 v[36:51], v[32:35], v[16:19], 0
  v_exp_f32 v52, v52
  v_exp_f32 v53, v53
  v_exp_f32 v54, v54
  v_exp_f32 v55, v55
  v_cvt_pk_bf16_f32 v68, v52, v53
  v_mfma_f32_32x32x16_bf16 v[76:91], v[112:115], v[72:75], v[76:91]
  v_cvt_pk_bf16_f32 v69, v54, v55
  v_exp_f32 v56, v56
  v_exp_f32 v57, v57
  v_exp_f32 v58, v58
  v_exp_f32 v59, v59
  v_mfma_f32_32x32x8_bf16 v[36:51], v[30:31], v[24:25], v[36:51]
  v_cvt_pk_bf16_f32 v70, v56, v57
  v_cvt_pk_bf16_f32 v71, v58, v59
  v_exp_f32 v60, v60
  v_exp_f32 v61, v61
  v_exp_f32 v62, v62
  v_exp_f32 v63, v63
  v_mfma_f32_32x32x16_bf16 v[92:107], v[108:111], v[68:71], v[92:107]
  v_cvt_pk_bf16_f32 v72, v60, v61
  v_cvt_pk_bf16_f32 v73, v62, v63
  v_exp_f32 v64, v64
  v_exp_f32 v65, v65
  v_exp_f32 v66, v66
  v_exp_f32 v67, v67
  v_cvt_pk_bf16_f32 v74, v64, v65
  v_cvt_pk_bf16_f32 v75, v66, v67
  v_mfma_f32_32x32x16_bf16 v[52:67], v[32:35], v[20:23], 0
  ds_read_b128 v[32:35], v7 offset:26624
  v_exp_f32 v36, v36
  v_exp_f32 v37, v37
  v_exp_f32 v38, v38
  v_exp_f32 v39, v39
  v_cvt_pk_bf16_f32 v68, v36, v37
  v_mfma_f32_32x32x16_bf16 v[92:107], v[112:115], v[72:75], v[92:107]
  ds_read_b64 v[28:29], v8 offset:6656
  v_cvt_pk_bf16_f32 v69, v38, v39
  v_exp_f32 v40, v40
  v_exp_f32 v41, v41
  v_exp_f32 v42, v42
  v_exp_f32 v43, v43
  v_mfma_f32_32x32x8_bf16 v[52:67], v[30:31], v[26:27], v[52:67]
  ds_read_b128 v[108:111], v9 offset:31616
  v_cvt_pk_bf16_f32 v70, v40, v41
  v_cvt_pk_bf16_f32 v71, v42, v43
  v_exp_f32 v44, v44
  v_exp_f32 v45, v45
  v_exp_f32 v46, v46
  v_exp_f32 v47, v47
  v_mfma_f32_32x32x16_bf16 v[76:91], v[116:119], v[68:71], v[76:91]
  ds_read_b128 v[112:115], v10 offset:31616
  v_cvt_pk_bf16_f32 v72, v44, v45
  v_cvt_pk_bf16_f32 v73, v46, v47
  v_exp_f32 v48, v48
  v_exp_f32 v49, v49
  v_exp_f32 v50, v50
  v_exp_f32 v51, v51
  v_cvt_pk_bf16_f32 v74, v48, v49
  v_cvt_pk_bf16_f32 v75, v50, v51
  buffer_load_dwordx4 v[156:159], v6, s[48:51], s46 offen offset:3072
  s_waitcnt lgkmcnt(0)
  v_mfma_f32_32x32x16_bf16 v[36:51], v[32:35], v[16:19], 0
  v_exp_f32 v52, v52
  v_exp_f32 v53, v53
  v_exp_f32 v54, v54
  v_exp_f32 v55, v55
  v_cvt_pk_bf16_f32 v68, v52, v53
  v_mfma_f32_32x32x16_bf16 v[76:91], v[120:123], v[72:75], v[76:91]
  v_cvt_pk_bf16_f32 v69, v54, v55
  v_exp_f32 v56, v56
  v_exp_f32 v57, v57
  v_exp_f32 v58, v58
  v_exp_f32 v59, v59
  v_mfma_f32_32x32x8_bf16 v[36:51], v[28:29], v[24:25], v[36:51]
  v_cvt_pk_bf16_f32 v70, v56, v57
  v_cvt_pk_bf16_f32 v71, v58, v59
  v_exp_f32 v60, v60
  v_exp_f32 v61, v61
  v_exp_f32 v62, v62
  v_exp_f32 v63, v63
  v_mfma_f32_32x32x16_bf16 v[92:107], v[116:119], v[68:71], v[92:107]
  v_cvt_pk_bf16_f32 v72, v60, v61
  v_cvt_pk_bf16_f32 v73, v62, v63
  v_exp_f32 v64, v64
  v_exp_f32 v65, v65
  v_exp_f32 v66, v66
  v_exp_f32 v67, v67
  v_cvt_pk_bf16_f32 v74, v64, v65
  v_cvt_pk_bf16_f32 v75, v66, v67
  s_setprio 2
  v_mfma_f32_32x32x16_bf16 v[52:67], v[32:35], v[20:23], 0
  ds_read_b128 v[32:35], v7 offset:27648
  v_exp_f32 v36, v36
  v_exp_f32 v37, v37
  v_exp_f32 v38, v38
  v_exp_f32 v39, v39
  v_cvt_pk_bf16_f32 v68, v36, v37
  v_mfma_f32_32x32x16_bf16 v[92:107], v[120:123], v[72:75], v[92:107]
  ds_read_b64 v[30:31], v8 offset:6912
  v_cvt_pk_bf16_f32 v69, v38, v39
  v_exp_f32 v40, v40
  v_exp_f32 v41, v41
  v_exp_f32 v42, v42
  v_exp_f32 v43, v43
  v_mfma_f32_32x32x8_bf16 v[52:67], v[28:29], v[26:27], v[52:67]
  ds_read_b128 v[116:119], v9 offset:32832
  v_cvt_pk_bf16_f32 v70, v40, v41
  v_cvt_pk_bf16_f32 v71, v42, v43
  v_exp_f32 v44, v44
  v_exp_f32 v45, v45
  v_exp_f32 v46, v46
  v_exp_f32 v47, v47
  v_mfma_f32_32x32x16_bf16 v[76:91], v[108:111], v[68:71], v[76:91]
  ds_read_b128 v[120:123], v10 offset:32832
  v_cvt_pk_bf16_f32 v72, v44, v45
  v_cvt_pk_bf16_f32 v73, v46, v47
  v_exp_f32 v48, v48
  v_exp_f32 v49, v49
  v_exp_f32 v50, v50
  v_exp_f32 v51, v51
  v_cvt_pk_bf16_f32 v74, v48, v49
  v_cvt_pk_bf16_f32 v75, v50, v51
  s_waitcnt lgkmcnt(0)
  v_mfma_f32_32x32x16_bf16 v[36:51], v[32:35], v[16:19], 0
  v_exp_f32 v52, v52
  v_exp_f32 v53, v53
  v_exp_f32 v54, v54
  v_exp_f32 v55, v55
  v_cvt_pk_bf16_f32 v68, v52, v53
  v_mfma_f32_32x32x16_bf16 v[76:91], v[112:115], v[72:75], v[76:91]
  v_cvt_pk_bf16_f32 v69, v54, v55
  v_exp_f32 v56, v56
  v_exp_f32 v57, v57
  v_exp_f32 v58, v58
  v_exp_f32 v59, v59
  v_mfma_f32_32x32x8_bf16 v[36:51], v[30:31], v[24:25], v[36:51]
  v_cvt_pk_bf16_f32 v70, v56, v57
  v_cvt_pk_bf16_f32 v71, v58, v59
  v_exp_f32 v60, v60
  v_exp_f32 v61, v61
  v_exp_f32 v62, v62
  v_exp_f32 v63, v63
  v_mfma_f32_32x32x16_bf16 v[92:107], v[108:111], v[68:71], v[92:107]
  v_cvt_pk_bf16_f32 v72, v60, v61
  v_cvt_pk_bf16_f32 v73, v62, v63
  v_exp_f32 v64, v64
  v_exp_f32 v65, v65
  v_exp_f32 v66, v66
  v_exp_f32 v67, v67
  v_cvt_pk_bf16_f32 v74, v64, v65
  v_cvt_pk_bf16_f32 v75, v66, v67
  v_mfma_f32_32x32x16_bf16 v[52:67], v[32:35], v[20:23], 0
  ds_read_b128 v[32:35], v7 offset:28672
  v_exp_f32 v36, v36
  v_exp_f32 v37, v37
  v_exp_f32 v38, v38
  v_exp_f32 v39, v39
  v_cvt_pk_bf16_f32 v68, v36, v37
  v_mfma_f32_32x32x16_bf16 v[92:107], v[112:115], v[72:75], v[92:107]
  ds_read_b64 v[28:29], v8 offset:7168
  v_cvt_pk_bf16_f32 v69, v38, v39
  v_exp_f32 v40, v40
  v_exp_f32 v41, v41
  v_exp_f32 v42, v42
  v_exp_f32 v43, v43
  v_mfma_f32_32x32x8_bf16 v[52:67], v[30:31], v[26:27], v[52:67]
  ds_read_b128 v[108:111], v9 offset:34048
  v_cvt_pk_bf16_f32 v70, v40, v41
  v_cvt_pk_bf16_f32 v71, v42, v43
  v_exp_f32 v44, v44
  v_exp_f32 v45, v45
  v_exp_f32 v46, v46
  v_exp_f32 v47, v47
  v_mfma_f32_32x32x16_bf16 v[76:91], v[116:119], v[68:71], v[76:91]
  ds_read_b128 v[112:115], v10 offset:34048
  v_cvt_pk_bf16_f32 v72, v44, v45
  v_cvt_pk_bf16_f32 v73, v46, v47
  v_exp_f32 v48, v48
  v_exp_f32 v49, v49
  v_exp_f32 v50, v50
  v_exp_f32 v51, v51
  v_cvt_pk_bf16_f32 v74, v48, v49
  v_cvt_pk_bf16_f32 v75, v50, v51
  s_waitcnt lgkmcnt(0)
  v_mfma_f32_32x32x16_bf16 v[36:51], v[32:35], v[16:19], 0
  v_exp_f32 v52, v52
  v_exp_f32 v53, v53
  v_exp_f32 v54, v54
  v_exp_f32 v55, v55
  v_cvt_pk_bf16_f32 v68, v52, v53
  v_mfma_f32_32x32x16_bf16 v[76:91], v[120:123], v[72:75], v[76:91]
  v_cvt_pk_bf16_f32 v69, v54, v55
  v_exp_f32 v56, v56
  v_exp_f32 v57, v57
  v_exp_f32 v58, v58
  v_exp_f32 v59, v59
  v_mfma_f32_32x32x8_bf16 v[36:51], v[28:29], v[24:25], v[36:51]
  v_cvt_pk_bf16_f32 v70, v56, v57
  v_cvt_pk_bf16_f32 v71, v58, v59
  v_exp_f32 v60, v60
  v_exp_f32 v61, v61
  v_exp_f32 v62, v62
  v_exp_f32 v63, v63
  v_mfma_f32_32x32x16_bf16 v[92:107], v[116:119], v[68:71], v[92:107]
  v_cvt_pk_bf16_f32 v72, v60, v61
  v_cvt_pk_bf16_f32 v73, v62, v63
  v_exp_f32 v64, v64
  v_exp_f32 v65, v65
  v_exp_f32 v66, v66
  v_exp_f32 v67, v67
  v_cvt_pk_bf16_f32 v74, v64, v65
  v_cvt_pk_bf16_f32 v75, v66, v67
  s_setprio 1
  v_mfma_f32_32x32x16_bf16 v[52:67], v[32:35], v[20:23], 0
  ds_read_b128 v[32:35], v7 offset:29696
  v_exp_f32 v36, v36
  v_exp_f32 v37, v37
  v_exp_f32 v38, v38
  v_exp_f32 v39, v39
  v_cvt_pk_bf16_f32 v68, v36, v37
  v_mfma_f32_32x32x16_bf16 v[92:107], v[120:123], v[72:75], v[92:107]
  ds_read_b64 v[30:31], v8 offset:7424
  v_cvt_pk_bf16_f32 v69, v38, v39
  v_exp_f32 v40, v40
  v_exp_f32 v41, v41
  v_exp_f32 v42, v42
  v_exp_f32 v43, v43
  v_mfma_f32_32x32x8_bf16 v[52:67], v[28:29], v[26:27], v[52:67]
  ds_read_b128 v[116:119], v9 offset:35264
  v_cvt_pk_bf16_f32 v70, v40, v41
  v_cvt_pk_bf16_f32 v71, v42, v43
  v_exp_f32 v44, v44
  v_exp_f32 v45, v45
  v_exp_f32 v46, v46
  v_exp_f32 v47, v47
  v_mfma_f32_32x32x16_bf16 v[76:91], v[108:111], v[68:71], v[76:91]
  ds_read_b128 v[120:123], v10 offset:35264
  v_cvt_pk_bf16_f32 v72, v44, v45
  v_cvt_pk_bf16_f32 v73, v46, v47
  v_exp_f32 v48, v48
  v_exp_f32 v49, v49
  v_exp_f32 v50, v50
  v_exp_f32 v51, v51
  v_cvt_pk_bf16_f32 v74, v48, v49
  v_cvt_pk_bf16_f32 v75, v50, v51
  s_waitcnt lgkmcnt(0)
  v_mfma_f32_32x32x16_bf16 v[36:51], v[32:35], v[16:19], 0
  v_exp_f32 v52, v52
  v_exp_f32 v53, v53
  v_exp_f32 v54, v54
  v_exp_f32 v55, v55
  v_cvt_pk_bf16_f32 v68, v52, v53
  v_mfma_f32_32x32x16_bf16 v[76:91], v[112:115], v[72:75], v[76:91]
  v_cvt_pk_bf16_f32 v69, v54, v55
  v_exp_f32 v56, v56
  v_exp_f32 v57, v57
  v_exp_f32 v58, v58
  v_exp_f32 v59, v59
  v_mfma_f32_32x32x8_bf16 v[36:51], v[30:31], v[24:25], v[36:51]
  v_cvt_pk_bf16_f32 v70, v56, v57
  v_cvt_pk_bf16_f32 v71, v58, v59
  v_exp_f32 v60, v60
  v_exp_f32 v61, v61
  v_exp_f32 v62, v62
  v_exp_f32 v63, v63
  v_mfma_f32_32x32x16_bf16 v[92:107], v[108:111], v[68:71], v[92:107]
  v_cvt_pk_bf16_f32 v72, v60, v61
  v_cvt_pk_bf16_f32 v73, v62, v63
  v_exp_f32 v64, v64
  v_exp_f32 v65, v65
  v_exp_f32 v66, v66
  v_exp_f32 v67, v67
  v_cvt_pk_bf16_f32 v74, v64, v65
  v_cvt_pk_bf16_f32 v75, v66, v67
  v_mfma_f32_32x32x16_bf16 v[52:67], v[32:35], v[20:23], 0
  ds_read_b128 v[32:35], v7 offset:30720
  v_exp_f32 v36, v36
  v_exp_f32 v37, v37
  v_exp_f32 v38, v38
  v_exp_f32 v39, v39
  v_cvt_pk_bf16_f32 v68, v36, v37
  v_mfma_f32_32x32x16_bf16 v[92:107], v[112:115], v[72:75], v[92:107]
  ds_read_b64 v[28:29], v8 offset:7680
  v_cvt_pk_bf16_f32 v69, v38, v39
  v_exp_f32 v40, v40
  v_exp_f32 v41, v41
  v_exp_f32 v42, v42
  v_exp_f32 v43, v43
  v_mfma_f32_32x32x8_bf16 v[52:67], v[30:31], v[26:27], v[52:67]
  ds_read_b128 v[108:111], v9 offset:36480
  v_cvt_pk_bf16_f32 v70, v40, v41
  v_cvt_pk_bf16_f32 v71, v42, v43
  v_exp_f32 v44, v44
  v_exp_f32 v45, v45
  v_exp_f32 v46, v46
  v_exp_f32 v47, v47
  v_mfma_f32_32x32x16_bf16 v[76:91], v[116:119], v[68:71], v[76:91]
  ds_read_b128 v[112:115], v10 offset:36480
  v_cvt_pk_bf16_f32 v72, v44, v45
  v_cvt_pk_bf16_f32 v73, v46, v47
  v_exp_f32 v48, v48
  v_exp_f32 v49, v49
  v_exp_f32 v50, v50
  v_exp_f32 v51, v51
  v_cvt_pk_bf16_f32 v74, v48, v49
  v_cvt_pk_bf16_f32 v75, v50, v51
  s_waitcnt lgkmcnt(0)
  v_mfma_f32_32x32x16_bf16 v[36:51], v[32:35], v[16:19], 0
  v_exp_f32 v52, v52
  v_exp_f32 v53, v53
  v_exp_f32 v54, v54
  v_exp_f32 v55, v55
  v_cvt_pk_bf16_f32 v68, v52, v53
  v_mfma_f32_32x32x16_bf16 v[76:91], v[120:123], v[72:75], v[76:91]
  v_cvt_pk_bf16_f32 v69, v54, v55
  v_exp_f32 v56, v56
  v_exp_f32 v57, v57
  v_exp_f32 v58, v58
  v_exp_f32 v59, v59
  v_mfma_f32_32x32x8_bf16 v[36:51], v[28:29], v[24:25], v[36:51]
  v_cvt_pk_bf16_f32 v70, v56, v57
  v_cvt_pk_bf16_f32 v71, v58, v59
  v_exp_f32 v60, v60
  v_exp_f32 v61, v61
  v_exp_f32 v62, v62
  v_exp_f32 v63, v63
  v_mfma_f32_32x32x16_bf16 v[92:107], v[116:119], v[68:71], v[92:107]
  v_cvt_pk_bf16_f32 v72, v60, v61
  v_cvt_pk_bf16_f32 v73, v62, v63
  v_exp_f32 v64, v64
  v_exp_f32 v65, v65
  v_exp_f32 v66, v66
  v_exp_f32 v67, v67
  v_cvt_pk_bf16_f32 v74, v64, v65
  v_cvt_pk_bf16_f32 v75, v66, v67
  s_setprio 0
  v_mfma_f32_32x32x16_bf16 v[52:67], v[32:35], v[20:23], 0
  ds_read_b128 v[32:35], v7 offset:31744
  v_exp_f32 v36, v36
  v_exp_f32 v37, v37
  v_exp_f32 v38, v38
  v_exp_f32 v39, v39
  v_cvt_pk_bf16_f32 v68, v36, v37
  v_mfma_f32_32x32x16_bf16 v[92:107], v[120:123], v[72:75], v[92:107]
  ds_read_b64 v[30:31], v8 offset:7936
  v_cvt_pk_bf16_f32 v69, v38, v39
  v_exp_f32 v40, v40
  v_exp_f32 v41, v41
  v_exp_f32 v42, v42
  v_exp_f32 v43, v43
  v_mfma_f32_32x32x8_bf16 v[52:67], v[28:29], v[26:27], v[52:67]
  ds_read_b128 v[116:119], v9 offset:37696
  v_cvt_pk_bf16_f32 v70, v40, v41
  v_cvt_pk_bf16_f32 v71, v42, v43
  v_exp_f32 v44, v44
  v_exp_f32 v45, v45
  v_exp_f32 v46, v46
  v_exp_f32 v47, v47
  v_mfma_f32_32x32x16_bf16 v[76:91], v[108:111], v[68:71], v[76:91]
  ds_read_b128 v[120:123], v10 offset:37696
  v_cvt_pk_bf16_f32 v72, v44, v45
  v_cvt_pk_bf16_f32 v73, v46, v47
  v_exp_f32 v48, v48
  v_exp_f32 v49, v49
  v_exp_f32 v50, v50
  v_exp_f32 v51, v51
  v_cvt_pk_bf16_f32 v74, v48, v49
  v_cvt_pk_bf16_f32 v75, v50, v51
  s_waitcnt lgkmcnt(0)
  v_mfma_f32_32x32x16_bf16 v[36:51], v[32:35], v[16:19], 0
  v_exp_f32 v52, v52
  v_exp_f32 v53, v53
  v_exp_f32 v54, v54
  v_exp_f32 v55, v55
  v_cvt_pk_bf16_f32 v68, v52, v53
  v_mfma_f32_32x32x16_bf16 v[76:91], v[112:115], v[72:75], v[76:91]
  v_cvt_pk_bf16_f32 v69, v54, v55
  v_exp_f32 v56, v56
  v_exp_f32 v57, v57
  v_exp_f32 v58, v58
  v_exp_f32 v59, v59
  v_mfma_f32_32x32x8_bf16 v[36:51], v[30:31], v[24:25], v[36:51]
  v_cvt_pk_bf16_f32 v70, v56, v57
  v_cvt_pk_bf16_f32 v71, v58, v59
  v_exp_f32 v60, v60
  v_exp_f32 v61, v61
  v_exp_f32 v62, v62
  v_exp_f32 v63, v63
  v_mfma_f32_32x32x16_bf16 v[92:107], v[108:111], v[68:71], v[92:107]
  v_cvt_pk_bf16_f32 v72, v60, v61
  v_cvt_pk_bf16_f32 v73, v62, v63
  v_exp_f32 v64, v64
  v_exp_f32 v65, v65
  v_exp_f32 v66, v66
  v_exp_f32 v67, v67
  v_cvt_pk_bf16_f32 v74, v64, v65
  v_cvt_pk_bf16_f32 v75, v66, v67
  v_mfma_f32_32x32x16_bf16 v[52:67], v[32:35], v[20:23], 0
  v_exp_f32 v36, v36
  v_exp_f32 v37, v37
  v_exp_f32 v38, v38
  v_exp_f32 v39, v39
  v_cvt_pk_bf16_f32 v68, v36, v37
  v_mfma_f32_32x32x16_bf16 v[92:107], v[112:115], v[72:75], v[92:107]
  v_cvt_pk_bf16_f32 v69, v38, v39
  v_exp_f32 v40, v40
  v_exp_f32 v41, v41
  v_exp_f32 v42, v42
  v_exp_f32 v43, v43
  v_mfma_f32_32x32x8_bf16 v[52:67], v[30:31], v[26:27], v[52:67]
  v_cvt_pk_bf16_f32 v70, v40, v41
  v_cvt_pk_bf16_f32 v71, v42, v43
  v_exp_f32 v44, v44
  v_exp_f32 v45, v45
  v_exp_f32 v46, v46
  v_exp_f32 v47, v47
  v_mfma_f32_32x32x16_bf16 v[76:91], v[116:119], v[68:71], v[76:91]
  v_cvt_pk_bf16_f32 v72, v44, v45
  v_cvt_pk_bf16_f32 v73, v46, v47
  v_exp_f32 v48, v48
  v_exp_f32 v49, v49
  v_exp_f32 v50, v50
  v_exp_f32 v51, v51
  v_cvt_pk_bf16_f32 v74, v48, v49
  v_cvt_pk_bf16_f32 v75, v50, v51
  s_waitcnt lgkmcnt(0)
  v_exp_f32 v52, v52
  v_exp_f32 v53, v53
  v_exp_f32 v54, v54
  v_exp_f32 v55, v55
  v_cvt_pk_bf16_f32 v68, v52, v53
  v_mfma_f32_32x32x16_bf16 v[76:91], v[120:123], v[72:75], v[76:91]
  v_cvt_pk_bf16_f32 v69, v54, v55
  v_exp_f32 v56, v56
  v_exp_f32 v57, v57
  v_exp_f32 v58, v58
  v_exp_f32 v59, v59
  v_cvt_pk_bf16_f32 v70, v56, v57
  v_cvt_pk_bf16_f32 v71, v58, v59
  v_exp_f32 v60, v60
  v_exp_f32 v61, v61
  v_exp_f32 v62, v62
  v_exp_f32 v63, v63
  v_mfma_f32_32x32x16_bf16 v[92:107], v[116:119], v[68:71], v[92:107]
  v_cvt_pk_bf16_f32 v72, v60, v61
  v_cvt_pk_bf16_f32 v73, v62, v63
  v_exp_f32 v64, v64
  v_exp_f32 v65, v65
  v_exp_f32 v66, v66
  v_exp_f32 v67, v67
  v_cvt_pk_bf16_f32 v74, v64, v65
  v_cvt_pk_bf16_f32 v75, v66, v67
L_k3_tail:
  s_setprio 0
  s_nop 1
  v_mfma_f32_32x32x16_bf16 v[92:107], v[120:123], v[72:75], v[92:107]
  v_mov_b32 v2, 0x2b800000
  v_mov_b32 v3, 0x53800000
  v_mov_b32 v4, 159744
  v_mov_b32 v5, 1
  v_cmp_le_f32 s[26:27], v2, v86
  v_cmp_ge_f32 s[28:29], v3, v86
  s_nop 4
  s_nop 0
  v_cmp_le_f32 s[54:55], v2, v102
  v_cmp_ge_f32 vcc, v3, v102
  s_and_b64 s[26:27], s[26:27], s[28:29]
  s_and_b64 s[26:27], s[26:27], s[54:55]
  s_and_b64 s[26:27], s[26:27], vcc
  s_cmp_eq_u64 s[26:27], -1
  s_cbranch_scc1 L_k3_safe
  ds_write_b32 v4, v5
L_k3_safe:
  s_and_b32 s24, s10, 3
  s_mul_i32 s24, s24, 3072
  s_lshl_b32 s25, s31, 15
  s_add_u32 s30, s24, s25
  s_xor_b32 s25, s25, 32768
  s_add_u32 s25, s24, s25
  v_add_u32 v2, s30, v6
  v_add_u32 v3, s25, v6
  ds_write_b128 v2, v[92:95] offset:0
  ds_write_b128 v2, v[96:99] offset:1024
  ds_write_b128 v2, v[100:103] offset:2048
  s_cmp_eq_u32 s10, 0
  s_cbranch_scc0 L_k3_noq
  s_waitcnt vmcnt(0)
  v_and_b32 v156, 15, v1
  v_lshlrev_b32 v156, 7, v156
  v_add_u32 v156, 32768, v156
  v_mov_b32 v157, 16
  s_mov_b32 s24, 0x40000
L_k3_pollq_chk:
  buffer_load_dword v158, v156, s[56:59], 0 offen sc1
  s_waitcnt vmcnt(0)
  v_cmp_lt_u32 vcc, v158, v157
  s_nop 1
  s_cbranch_vccz L_k3_pollq_ok
  s_sub_u32 s24, s24, 1
  s_cbranch_scc1 L_k3_pollq_ok
  s_sleep 4
  s_branch L_k3_pollq_chk
L_k3_pollq_ok:
L_k3_noq:
  s_waitcnt lgkmcnt(0) vmcnt(0)
  s_barrier
  s_add_u32 s56, s6, 0x2148000
  s_addc_u32 s57, s7, 0
  s_mov_b32 s58, 0x10000
  s_mov_b32 s59, 0x20000
  s_cmp_eq_u32 s10, 0
  s_cbranch_scc0 L_k3_nosigr
  s_and_b32 s24, s2, 7
  s_lshl_b32 s24, s24, 7
  s_add_u32 s24, s24, 6144
  s_mov_b64 exec, 1
  v_mov_b32 v156, 0
  v_mov_b32 v157, 1
  buffer_atomic_add v157, v156, s[56:59], s24 offen sc1
  s_mov_b64 exec, -1
L_k3_nosigr:
  ds_read_b32 v5, v4
  ds_read_b128 v[92:95], v3 offset:0
  ds_read_b128 v[96:99], v3 offset:1024
  ds_read_b128 v[100:103], v3 offset:2048
  s_waitcnt lgkmcnt(0)
  v_readfirstlane_b32 s24, v5
  s_nop 0
  s_cmp_eq_u32 s24, 0
  s_cbranch_scc0 L_k3_slow
  v_add_f32 v76, v76, v92
  v_add_f32 v77, v77, v93
  v_add_f32 v78, v78, v94
  v_add_f32 v79, v79, v95
  v_add_f32 v80, v80, v96
  v_add_f32 v81, v81, v97
  v_add_f32 v82, v82, v98
  v_add_f32 v83, v83, v99
  v_add_f32 v84, v84, v100
  v_add_f32 v85, v85, v101
  v_add_f32 v86, v86, v102
L_k3_out:
  s_add_u32 s16, s6, 0x6e0000
  s_addc_u32 s17, s7, 0
  s_mov_b32 s18, 0x240000
  s_mov_b32 s19, 0x20000
  v_rcp_f32 v2, v86
  s_nop 0
  v_mul_f32 v76, v76, v2
  v_mul_f32 v77, v77, v2
  v_mul_f32 v78, v78, v2
  v_mul_f32 v79, v79, v2
  v_mul_f32 v80, v80, v2
  v_mul_f32 v81, v81, v2
  v_mul_f32 v82, v82, v2
  v_mul_f32 v83, v83, v2
  v_mul_f32 v84, v84, v2
  v_mul_f32 v85, v85, v2
  v_cvt_pk_bf16_f32 v68, v76, v77
  v_cvt_pk_bf16_f32 v69, v78, v79
  v_cvt_pk_bf16_f32 v70, v80, v81
  v_cvt_pk_bf16_f32 v71, v82, v83
  v_cvt_pk_bf16_f32 v72, v84, v85
  buffer_store_dwordx4 v[68:71], v13, s[16:19], 0 offen sc1
  buffer_store_dword v72, v14, s[16:19], 0 offen sc1
  s_lshl_b32 s24, s12, 7
  s_add_u32 s24, s24, 16384
  s_barrier
  s_waitcnt vmcnt(0)
  s_mov_b64 exec, 1
  v_mov_b32 v156, 0
  v_mov_b32 v157, 1
  buffer_atomic_add v157, v156, s[56:59], s24 offen sc1
  s_mov_b64 exec, -1
  s_branch L_k4_entry
L_k3_exit:
  s_endpgm
L_k3_slow:
  s_barrier
  s_add_u32 s25, s30, s21
  s_add_u32 m0, s30, 0
  s_nop 0
  buffer_load_dwordx4 v6, s[16:19], s25 offen sc1 lds
  buffer_load_dwordx4 v6, s[16:19], s25 offen offset:1024 sc1 lds
  buffer_load_dwordx4 v6, s[16:19], s25 offen offset:2048 sc1 lds
  s_waitcnt vmcnt(0)
  s_barrier
  v_and_b32 v5, 31, v1
  v_lshlrev_b32 v5, 3, v5
  v_add_u32 v8, 65536, v5
  s_mul_i32 s24, s31, 38912
  v_subrev_u32 v9, s24, v9
  v_subrev_u32 v10, s24, v10
  v_mov_b32 v2, 0xff800000
  v_mov_b32 v3, v6
  v_mov_b32 v4, v8
  s_mov_b32 s30, 64
L_k3_max:
  ds_read_b128 v[32:35], v3
  ds_read_b64 v[28:29], v4
  v_add_u32 v3, 1024, v3
  v_add_u32 v4, 256, v4
  s_waitcnt lgkmcnt(0)
  v_mfma_f32_32x32x16_bf16 v[36:51], v[32:35], v[16:19], 0
  s_nop 9
  v_mfma_f32_32x32x8_bf16 v[36:51], v[28:29], v[24:25], v[36:51]
  s_nop 11
  v_max3_f32 v2, v2, v36, v37
  v_max3_f32 v2, v2, v38, v39
  v_max3_f32 v2, v2, v40, v41
  v_max3_f32 v2, v2, v42, v43
  v_max3_f32 v2, v2, v44, v45
  v_max3_f32 v2, v2, v46, v47
  v_max3_f32 v2, v2, v48, v49
  v_max3_f32 v2, v2, v50, v51
  s_sub_u32 s30, s30, 1
  s_cmp_lg_u32 s30, 0
  s_cbranch_scc1 L_k3_max
  v_mov_b32 v3, v2
  s_nop 1
  v_permlane32_swap_b32 v2, v3
  v_max_f32 v2, v2, v3
  v_sub_f32 v92, 0, v2
  v_mov_b32 v76, 0
  v_sub_f32 v93, 0, v2
  v_mov_b32 v77, 0
  v_sub_f32 v94, 0, v2
  v_mov_b32 v78, 0
  v_sub_f32 v95, 0, v2
  v_mov_b32 v79, 0
  v_sub_f32 v96, 0, v2
  v_mov_b32 v80, 0
  v_sub_f32 v97, 0, v2
  v_mov_b32 v81, 0
  v_sub_f32 v98, 0, v2
  v_mov_b32 v82, 0
  v_sub_f32 v99, 0, v2
  v_mov_b32 v83, 0
  v_sub_f32 v100, 0, v2
  v_mov_b32 v84, 0
  v_sub_f32 v101, 0, v2
  v_mov_b32 v85, 0
  v_sub_f32 v102, 0, v2
  v_mov_b32 v86, 0
  v_sub_f32 v103, 0, v2
  v_mov_b32 v87, 0
  v_sub_f32 v104, 0, v2
  v_mov_b32 v88, 0
  v_sub_f32 v105, 0, v2
  v_mov_b32 v89, 0
  v_sub_f32 v106, 0, v2
  v_mov_b32 v90, 0
  v_sub_f32 v107, 0, v2
  v_mov_b32 v91, 0
  v_mov_b32 v3, v6
  s_mov_b32 s30, 64
L_k3_pv:
  ds_read_b128 v[32:35], v3
  ds_read_b64 v[28:29], v8
  ds_read_b128 v[108:111], v9
  ds_read_b128 v[112:115], v10
  v_add_u32 v3, 1024, v3
  v_add_u32 v8, 256, v8
  v_add_u32 v9, 1216, v9
  v_add_u32 v10, 1216, v10
  s_waitcnt lgkmcnt(0)
  v_mfma_f32_32x32x16_bf16 v[36:51], v[32:35], v[16:19], v[92:107]
  s_nop 9
  v_mfma_f32_32x32x8_bf16 v[36:51], v[28:29], v[24:25], v[36:51]
  s_nop 11
  v_exp_f32 v36, v36
  v_exp_f32 v37, v37
  v_exp_f32 v38, v38
  v_exp_f32 v39, v39
  v_exp_f32 v40, v40
  v_exp_f32 v41, v41
  v_exp_f32 v42, v42
  v_exp_f32 v43, v43
  v_exp_f32 v44, v44
  v_exp_f32 v45, v45
  v_exp_f32 v46, v46
  v_exp_f32 v47, v47
  v_exp_f32 v48, v48
  v_exp_f32 v49, v49
  v_exp_f32 v50, v50
  v_exp_f32 v51, v51
  v_cvt_pk_bf16_f32 v68, v36, v37
  v_cvt_pk_bf16_f32 v69, v38, v39
  v_cvt_pk_bf16_f32 v70, v40, v41
  v_cvt_pk_bf16_f32 v71, v42, v43
  v_cvt_pk_bf16_f32 v72, v44, v45
  v_cvt_pk_bf16_f32 v73, v46, v47
  v_cvt_pk_bf16_f32 v74, v48, v49
  v_cvt_pk_bf16_f32 v75, v50, v51
  v_mfma_f32_32x32x16_bf16 v[76:91], v[108:111], v[68:71], v[76:91]
  s_nop 0
  v_mfma_f32_32x32x16_bf16 v[76:91], v[112:115], v[72:75], v[76:91]
  s_sub_u32 s30, s30, 1
  s_cmp_lg_u32 s30, 0
  s_cbranch_scc1 L_k3_pv
  s_nop 11
  s_branch L_k3_out
L_k4_entry:
  s_waitcnt lgkmcnt(0)
  s_mov_b32 s69, 0
  s_load_dwordx2 s[4:5], s[0:1], 0
  s_load_dwordx2 s[6:7], s[0:1], 96
  v_lshrrev_b32 v2, 6, v0
  v_and_b32 v1, 63, v0
  v_readfirstlane_b32 s10, v2
  s_and_b32 s11, s2, 7
  s_lshr_b32 s12, s2, 3
  s_cmp_ge_u32 s12, 24
  s_cbranch_scc1 L_k4_side
  s_mov_b32 s69, 1
  s_lshr_b32 s13, s12, 2
  s_and_b32 s12, s12, 3
  s_lshl_b32 s11, s11, 2
  s_add_u32 s12, s12, s11
  s_cmp_ge_u32 s10, 4
  s_cbranch_scc1 L_k4_prod
  v_and_b32 v208, 15, v1
  v_lshrrev_b32 v209, 4, v1
  s_lshl_b32 s14, s12, 2
  s_add_u32 s14, s14, s10
  s_lshl_b32 s15, s14, 4
  v_add_u32 v2, s15, v208
  v_mul_u32_u24 v210, 1152, v2
  s_mul_i32 s15, s13, 192
  v_lshl_add_u32 v210, v209, 4, v210
  v_add_u32 v210, s15, v210
  v_mul_u32_u24 v214, 192, v208
  v_lshl_add_u32 v214, v209, 4, v214
  s_mul_i32 s15, s10, 3072
  s_add_u32 s15, s15, 144384
  v_add_u32 v214, s15, v214
  v_lshlrev_b32 v213, 5, v209
  v_add_u32 v213, 156672, v213
  s_lshl_b32 s15, s13, 14
  v_lshl_add_u32 v212, v2, 3, s15
  v_lshlrev_b32 v4, 26, v209
  v_or_b32 v212, v212, v4
  v_lshrrev_b32 v3, 5, v2
  v_bfe_u32 v4, v2, 2, 1
  v_lshl_add_u32 v3, v3, 1, v4
  v_mul_u32_u24 v3, 18432, v3
  v_bfe_u32 v4, v2, 3, 2
  v_lshl_add_u32 v3, v4, 6, v3
  v_and_b32 v4, 3, v2
  v_lshl_add_u32 v3, v4, 4, v3
  v_lshl_add_u32 v3, v209, 8, v3
  s_mul_i32 s15, s13, 3072
  v_add_u32 v211, s15, v3
  s_lshl_b32 s14, s10, 11
  v_lshlrev_b32 v5, 4, v1
  v_add_u32 v9, 0, v5
  v_add_u32 v6, s14, v9
  v_add_u32 v10, 49152, v5
  v_add_u32 v7, s14, v10
  v_add_u32 v11, 98304, v5
  v_add_u32 v8, s14, v11
  s_waitcnt lgkmcnt(0)
  s_barrier
  ds_read_b128 v[132:135], v7 offset:36864
  ds_read_b128 v[36:39], v9 offset:0
  ds_read_b128 v[40:43], v9 offset:1024
  ds_read_b128 v[44:47], v9 offset:2048
  ds_read_b128 v[48:51], v9 offset:3072
  ds_read_b128 v[52:55], v9 offset:4096
  ds_read_b128 v[56:59], v9 offset:5120
  ds_read_b128 v[136:139], v7 offset:37888
  ds_read_b128 v[60:63], v9 offset:6144
  ds_read_b128 v[64:67], v9 offset:7168
  ds_read_b128 v[68:71], v9 offset:8192
  ds_read_b128 v[72:75], v9 offset:9216
  ds_read_b128 v[76:79], v9 offset:10240
  ds_read_b128 v[80:83], v9 offset:11264
  s_waitcnt lgkmcnt(0)
  s_barrier
  v_mfma_f32_16x16x32_bf16 v[12:15], v[36:39], v[132:135], 0
  ds_read_b128 v[140:143], v7 offset:45056
  ds_read_b128 v[84:87], v9 offset:12288
  v_mfma_f32_16x16x32_bf16 v[16:19], v[40:43], v[132:135], 0
  ds_read_b128 v[88:91], v9 offset:13312
  ds_read_b128 v[92:95], v9 offset:14336
  v_mfma_f32_16x16x32_bf16 v[20:23], v[44:47], v[132:135], 0
  ds_read_b128 v[96:99], v9 offset:15360
  ds_read_b128 v[100:103], v9 offset:16384
  v_mfma_f32_16x16x32_bf16 v[24:27], v[48:51], v[132:135], 0
  ds_read_b128 v[104:107], v9 offset:17408
  ds_read_b128 v[144:147], v7 offset:46080
  v_mfma_f32_16x16x32_bf16 v[28:31], v[52:55], v[132:135], 0
  ds_read_b128 v[108:111], v9 offset:18432
  ds_read_b128 v[112:115], v9 offset:19456
  v_mfma_f32_16x16x32_bf16 v[32:35], v[56:59], v[132:135], 0
  ds_read_b128 v[116:119], v9 offset:20480
  ds_read_b128 v[120:123], v9 offset:21504
  v_mfma_f32_16x16x32_bf16 v[12:15], v[60:63], v[136:139], v[12:15]
  ds_read_b128 v[124:127], v9 offset:22528
  ds_read_b128 v[128:131], v9 offset:23552
  v_mfma_f32_16x16x32_bf16 v[16:19], v[64:67], v[136:139], v[16:19]
  v_mfma_f32_16x16x32_bf16 v[20:23], v[68:71], v[136:139], v[20:23]
  v_mfma_f32_16x16x32_bf16 v[24:27], v[72:75], v[136:139], v[24:27]
  v_mfma_f32_16x16x32_bf16 v[28:31], v[76:79], v[136:139], v[28:31]
  v_mfma_f32_16x16x32_bf16 v[32:35], v[80:83], v[136:139], v[32:35]
  s_waitcnt lgkmcnt(0)
  s_barrier
  v_mfma_f32_16x16x32_bf16 v[12:15], v[84:87], v[140:143], v[12:15]
  ds_read_b128 v[132:135], v8 offset:4096
  ds_read_b128 v[36:39], v9 offset:24576
  v_mfma_f32_16x16x32_bf16 v[16:19], v[88:91], v[140:143], v[16:19]
  ds_read_b128 v[40:43], v9 offset:25600
  ds_read_b128 v[44:47], v9 offset:26624
  v_mfma_f32_16x16x32_bf16 v[20:23], v[92:95], v[140:143], v[20:23]
  ds_read_b128 v[48:51], v9 offset:27648
  ds_read_b128 v[52:55], v9 offset:28672
  v_mfma_f32_16x16x32_bf16 v[24:27], v[96:99], v[140:143], v[24:27]
  ds_read_b128 v[56:59], v9 offset:29696
  ds_read_b128 v[136:139], v8 offset:5120
  v_mfma_f32_16x16x32_bf16 v[28:31], v[100:103], v[140:143], v[28:31]
  ds_read_b128 v[60:63], v9 offset:30720
  ds_read_b128 v[64:67], v9 offset:31744
  v_mfma_f32_16x16x32_bf16 v[32:35], v[104:107], v[140:143], v[32:35]
  ds_read_b128 v[68:71], v9 offset:32768
  ds_read_b128 v[72:75], v9 offset:33792
  v_mfma_f32_16x16x32_bf16 v[12:15], v[108:111], v[144:147], v[12:15]
  ds_read_b128 v[76:79], v9 offset:34816
  ds_read_b128 v[80:83], v9 offset:35840
  v_mfma_f32_16x16x32_bf16 v[16:19], v[112:115], v[144:147], v[16:19]
  v_mfma_f32_16x16x32_bf16 v[20:23], v[116:119], v[144:147], v[20:23]
  v_mfma_f32_16x16x32_bf16 v[24:27], v[120:123], v[144:147], v[24:27]
  v_mfma_f32_16x16x32_bf16 v[28:31], v[124:127], v[144:147], v[28:31]
  v_mfma_f32_16x16x32_bf16 v[32:35], v[128:131], v[144:147], v[32:35]
  s_waitcnt lgkmcnt(0)
  s_barrier
  v_mfma_f32_16x16x32_bf16 v[12:15], v[36:39], v[132:135], v[12:15]
  ds_read_b128 v[140:143], v8 offset:12288
  ds_read_b128 v[84:87], v9 offset:36864
  v_mfma_f32_16x16x32_bf16 v[16:19], v[40:43], v[132:135], v[16:19]
  ds_read_b128 v[88:91], v9 offset:37888
  ds_read_b128 v[92:95], v9 offset:38912
  v_mfma_f32_16x16x32_bf16 v[20:23], v[44:47], v[132:135], v[20:23]
  ds_read_b128 v[96:99], v9 offset:39936
  ds_read_b128 v[100:103], v9 offset:40960
  v_mfma_f32_16x16x32_bf16 v[24:27], v[48:51], v[132:135], v[24:27]
  ds_read_b128 v[104:107], v9 offset:41984
  ds_read_b128 v[144:147], v8 offset:13312
  v_mfma_f32_16x16x32_bf16 v[28:31], v[52:55], v[132:135], v[28:31]
  ds_read_b128 v[108:111], v9 offset:43008
  ds_read_b128 v[112:115], v9 offset:44032
  v_mfma_f32_16x16x32_bf16 v[32:35], v[56:59], v[132:135], v[32:35]
  ds_read_b128 v[116:119], v9 offset:45056
  ds_read_b128 v[120:123], v9 offset:46080
  v_mfma_f32_16x16x32_bf16 v[12:15], v[60:63], v[136:139], v[12:15]
  ds_read_b128 v[124:127], v9 offset:47104
  ds_read_b128 v[128:131], v9 offset:48128
  v_mfma_f32_16x16x32_bf16 v[16:19], v[64:67], v[136:139], v[16:19]
  v_mfma_f32_16x16x32_bf16 v[20:23], v[68:71], v[136:139], v[20:23]
  v_mfma_f32_16x16x32_bf16 v[24:27], v[72:75], v[136:139], v[24:27]
  v_mfma_f32_16x16x32_bf16 v[28:31], v[76:79], v[136:139], v[28:31]
  v_mfma_f32_16x16x32_bf16 v[32:35], v[80:83], v[136:139], v[32:35]
  s_waitcnt lgkmcnt(0)
  s_barrier
  v_mfma_f32_16x16x32_bf16 v[12:15], v[84:87], v[140:143], v[12:15]
  ds_read_b128 v[132:135], v8 offset:20480
  ds_read_b128 v[36:39], v10 offset:0
  v_mfma_f32_16x16x32_bf16 v[16:19], v[88:91], v[140:143], v[16:19]
  ds_read_b128 v[40:43], v10 offset:1024
  ds_read_b128 v[44:47], v10 offset:2048
  v_mfma_f32_16x16x32_bf16 v[20:23], v[92:95], v[140:143], v[20:23]
  ds_read_b128 v[48:51], v10 offset:3072
  ds_read_b128 v[52:55], v10 offset:4096
  v_mfma_f32_16x16x32_bf16 v[24:27], v[96:99], v[140:143], v[24:27]
  ds_read_b128 v[56:59], v10 offset:5120
  ds_read_b128 v[136:139], v8 offset:21504
  v_mfma_f32_16x16x32_bf16 v[28:31], v[100:103], v[140:143], v[28:31]
  ds_read_b128 v[60:63], v10 offset:6144
  ds_read_b128 v[64:67], v10 offset:7168
  v_mfma_f32_16x16x32_bf16 v[32:35], v[104:107], v[140:143], v[32:35]
  ds_read_b128 v[68:71], v10 offset:8192
  ds_read_b128 v[72:75], v10 offset:9216
  v_mfma_f32_16x16x32_bf16 v[12:15], v[108:111], v[144:147], v[12:15]
  ds_read_b128 v[76:79], v10 offset:10240
  ds_read_b128 v[80:83], v10 offset:11264
  v_mfma_f32_16x16x32_bf16 v[16:19], v[112:115], v[144:147], v[16:19]
  v_mfma_f32_16x16x32_bf16 v[20:23], v[116:119], v[144:147], v[20:23]
  v_mfma_f32_16x16x32_bf16 v[24:27], v[120:123], v[144:147], v[24:27]
  v_mfma_f32_16x16x32_bf16 v[28:31], v[124:127], v[144:147], v[28:31]
  v_mfma_f32_16x16x32_bf16 v[32:35], v[128:131], v[144:147], v[32:35]
  s_waitcnt lgkmcnt(0)
  s_barrier
  v_mfma_f32_16x16x32_bf16 v[12:15], v[36:39], v[132:135], v[12:15]
  ds_read_b128 v[140:143], v8 offset:28672
  ds_read_b128 v[84:87], v10 offset:12288
  v_mfma_f32_16x16x32_bf16 v[16:19], v[40:43], v[132:135], v[16:19]
  ds_read_b128 v[88:91], v10 offset:13312
  ds_read_b128 v[92:95], v10 offset:14336
  v_mfma_f32_16x16x32_bf16 v[20:23], v[44:47], v[132:135], v[20:23]
  ds_read_b128 v[96:99], v10 offset:15360
  ds_read_b128 v[100:103], v10 offset:16384
  v_mfma_f32_16x16x32_bf16 v[24:27], v[48:51], v[132:135], v[24:27]
  ds_read_b128 v[104:107], v10 offset:17408
  ds_read_b128 v[144:147], v8 offset:29696
  v_mfma_f32_16x16x32_bf16 v[28:31], v[52:55], v[132:135], v[28:31]
  ds_read_b128 v[108:111], v10 offset:18432
  ds_read_b128 v[112:115], v10 offset:19456
  v_mfma_f32_16x16x32_bf16 v[32:35], v[56:59], v[132:135], v[32:35]
  ds_read_b128 v[116:119], v10 offset:20480
  ds_read_b128 v[120:123], v10 offset:21504
  v_mfma_f32_16x16x32_bf16 v[12:15], v[60:63], v[136:139], v[12:15]
  ds_read_b128 v[124:127], v10 offset:22528
  ds_read_b128 v[128:131], v10 offset:23552
  v_mfma_f32_16x16x32_bf16 v[16:19], v[64:67], v[136:139], v[16:19]
  v_mfma_f32_16x16x32_bf16 v[20:23], v[68:71], v[136:139], v[20:23]
  v_mfma_f32_16x16x32_bf16 v[24:27], v[72:75], v[136:139], v[24:27]
  v_mfma_f32_16x16x32_bf16 v[28:31], v[76:79], v[136:139], v[28:31]
  v_mfma_f32_16x16x32_bf16 v[32:35], v[80:83], v[136:139], v[32:35]
  s_waitcnt lgkmcnt(0)
  s_barrier
  v_mfma_f32_16x16x32_bf16 v[12:15], v[84:87], v[140:143], v[12:15]
  ds_read_b128 v[132:135], v7 offset:36864
  ds_read_b128 v[36:39], v10 offset:24576
  v_mfma_f32_16x16x32_bf16 v[16:19], v[88:91], v[140:143], v[16:19]
  ds_read_b128 v[40:43], v10 offset:25600
  ds_read_b128 v[44:47], v10 offset:26624
  v_mfma_f32_16x16x32_bf16 v[20:23], v[92:95], v[140:143], v[20:23]
  ds_read_b128 v[48:51], v10 offset:27648
  ds_read_b128 v[52:55], v10 offset:28672
  v_mfma_f32_16x16x32_bf16 v[24:27], v[96:99], v[140:143], v[24:27]
  ds_read_b128 v[56:59], v10 offset:29696
  ds_read_b128 v[136:139], v7 offset:37888
  v_mfma_f32_16x16x32_bf16 v[28:31], v[100:103], v[140:143], v[28:31]
  ds_read_b128 v[60:63], v10 offset:30720
  ds_read_b128 v[64:67], v10 offset:31744
  v_mfma_f32_16x16x32_bf16 v[32:35], v[104:107], v[140:143], v[32:35]
  ds_read_b128 v[68:71], v10 offset:32768
  ds_read_b128 v[72:75], v10 offset:33792
  v_mfma_f32_16x16x32_bf16 v[12:15], v[108:111], v[144:147], v[12:15]
  ds_read_b128 v[76:79], v10 offset:34816
  ds_read_b128 v[80:83], v10 offset:35840
  v_mfma_f32_16x16x32_bf16 v[16:19], v[112:115], v[144:147], v[16:19]
  v_mfma_f32_16x16x32_bf16 v[20:23], v[116:119], v[144:147], v[20:23]
  v_mfma_f32_16x16x32_bf16 v[24:27], v[120:123], v[144:147], v[24:27]
  v_mfma_f32_16x16x32_bf16 v[28:31], v[124:127], v[144:147], v[28:31]
  v_mfma_f32_16x16x32_bf16 v[32:35], v[128:131], v[144:147], v[32:35]
  s_waitcnt lgkmcnt(0)
  s_barrier
  v_mfma_f32_16x16x32_bf16 v[12:15], v[36:39], v[132:135], v[12:15]
  ds_read_b128 v[140:143], v7 offset:45056
  ds_read_b128 v[84:87], v9 offset:0
  v_mfma_f32_16x16x32_bf16 v[16:19], v[40:43], v[132:135], v[16:19]
  ds_read_b128 v[88:91], v9 offset:1024
  ds_read_b128 v[92:95], v9 offset:2048
  v_mfma_f32_16x16x32_bf16 v[20:23], v[44:47], v[132:135], v[20:23]
  ds_read_b128 v[96:99], v9 offset:3072
  ds_read_b128 v[100:103], v9 offset:4096
  v_mfma_f32_16x16x32_bf16 v[24:27], v[48:51], v[132:135], v[24:27]
  ds_read_b128 v[104:107], v9 offset:5120
  ds_read_b128 v[144:147], v7 offset:46080
  v_mfma_f32_16x16x32_bf16 v[28:31], v[52:55], v[132:135], v[28:31]
  ds_read_b128 v[108:111], v9 offset:6144
  ds_read_b128 v[112:115], v9 offset:7168
  v_mfma_f32_16x16x32_bf16 v[32:35], v[56:59], v[132:135], v[32:35]
  ds_read_b128 v[116:119], v9 offset:8192
  ds_read_b128 v[120:123], v9 offset:9216
  v_mfma_f32_16x16x32_bf16 v[12:15], v[60:63], v[136:139], v[12:15]
  ds_read_b128 v[124:127], v9 offset:10240
  ds_read_b128 v[128:131], v9 offset:11264
  v_mfma_f32_16x16x32_bf16 v[16:19], v[64:67], v[136:139], v[16:19]
  v_mfma_f32_16x16x32_bf16 v[20:23], v[68:71], v[136:139], v[20:23]
  v_mfma_f32_16x16x32_bf16 v[24:27], v[72:75], v[136:139], v[24:27]
  v_mfma_f32_16x16x32_bf16 v[28:31], v[76:79], v[136:139], v[28:31]
  v_mfma_f32_16x16x32_bf16 v[32:35], v[80:83], v[136:139], v[32:35]
  s_waitcnt lgkmcnt(0)
  s_barrier
  v_mfma_f32_16x16x32_bf16 v[12:15], v[84:87], v[140:143], v[12:15]
  ds_read_b128 v[132:135], v8 offset:4096
  ds_read_b128 v[36:39], v9 offset:12288
  v_mfma_f32_16x16x32_bf16 v[16:19], v[88:91], v[140:143], v[16:19]
  ds_read_b128 v[40:43], v9 offset:13312
  ds_read_b128 v[44:47], v9 offset:14336
  v_mfma_f32_16x16x32_bf16 v[20:23], v[92:95], v[140:143], v[20:23]
  ds_read_b128 v[48:51], v9 offset:15360
  ds_read_b128 v[52:55], v9 offset:16384
  v_mfma_f32_16x16x32_bf16 v[24:27], v[96:99], v[140:143], v[24:27]
  ds_read_b128 v[56:59], v9 offset:17408
  ds_read_b128 v[136:139], v8 offset:5120
  v_mfma_f32_16x16x32_bf16 v[28:31], v[100:103], v[140:143], v[28:31]
  ds_read_b128 v[60:63], v9 offset:18432
  ds_read_b128 v[64:67], v9 offset:19456
  v_mfma_f32_16x16x32_bf16 v[32:35], v[104:107], v[140:143], v[32:35]
  ds_read_b128 v[68:71], v9 offset:20480
  ds_read_b128 v[72:75], v9 offset:21504
  v_mfma_f32_16x16x32_bf16 v[12:15], v[108:111], v[144:147], v[12:15]
  ds_read_b128 v[76:79], v9 offset:22528
  ds_read_b128 v[80:83], v9 offset:23552
  v_mfma_f32_16x16x32_bf16 v[16:19], v[112:115], v[144:147], v[16:19]
  v_mfma_f32_16x16x32_bf16 v[20:23], v[116:119], v[144:147], v[20:23]
  v_mfma_f32_16x16x32_bf16 v[24:27], v[120:123], v[144:147], v[24:27]
  v_mfma_f32_16x16x32_bf16 v[28:31], v[124:127], v[144:147], v[28:31]
  v_mfma_f32_16x16x32_bf16 v[32:35], v[128:131], v[144:147], v[32:35]
  s_waitcnt lgkmcnt(0)
  v_mfma_f32_16x16x32_bf16 v[12:15], v[36:39], v[132:135], v[12:15]
  ds_read_b128 v[148:151], v214 offset:0
  ds_read_b128 v[152:155], v214 offset:64
  v_mfma_f32_16x16x32_bf16 v[16:19], v[40:43], v[132:135], v[16:19]
  ds_read_b128 v[156:159], v214 offset:128
  ds_read_b128 v[160:163], v213 offset:0
  v_mfma_f32_16x16x32_bf16 v[20:23], v[44:47], v[132:135], v[20:23]
  ds_read_b128 v[164:167], v213 offset:16
  ds_read_b128 v[168:171], v213 offset:128
  v_mfma_f32_16x16x32_bf16 v[24:27], v[48:51], v[132:135], v[24:27]
  ds_read_b128 v[172:175], v213 offset:144
  ds_read_b128 v[176:179], v213 offset:256
  v_mfma_f32_16x16x32_bf16 v[28:31], v[52:55], v[132:135], v[28:31]
  ds_read_b128 v[180:183], v213 offset:272
  ds_read_b128 v[184:187], v213 offset:384
  v_mfma_f32_16x16x32_bf16 v[32:35], v[56:59], v[132:135], v[32:35]
  ds_read_b128 v[188:191], v213 offset:400
  ds_read_b128 v[192:195], v213 offset:512
  v_mfma_f32_16x16x32_bf16 v[12:15], v[60:63], v[136:139], v[12:15]
  ds_read_b128 v[196:199], v213 offset:528
  ds_read_b128 v[200:203], v213 offset:640
  v_mfma_f32_16x16x32_bf16 v[16:19], v[64:67], v[136:139], v[16:19]
  ds_read_b128 v[204:207], v213 offset:656
  v_mfma_f32_16x16x32_bf16 v[20:23], v[68:71], v[136:139], v[20:23]
  v_mfma_f32_16x16x32_bf16 v[24:27], v[72:75], v[136:139], v[24:27]
  v_mfma_f32_16x16x32_bf16 v[28:31], v[76:79], v[136:139], v[28:31]
  v_mfma_f32_16x16x32_bf16 v[32:35], v[80:83], v[136:139], v[32:35]
  s_add_u32 s16, s6, 0x1365000
  s_addc_u32 s17, s7, 0
  s_mov_b32 s18, 0x240000
  s_mov_b32 s19, 0x20000
  s_add_u32 s20, s6, 0x15a5000
  s_addc_u32 s21, s7, 0
  s_mov_b32 s22, 0x240000
  s_mov_b32 s23, 0x20000
  s_add_u32 s24, s6, 0x17e5000
  s_addc_u32 s25, s7, 0
  s_mov_b32 s26, 0x18000
  s_mov_b32 s27, 0x20000
  v_permlane32_swap_b32 v12, v14
  v_permlane32_swap_b32 v13, v15
  v_permlane32_swap_b32 v16, v18
  v_permlane32_swap_b32 v17, v19
  v_permlane32_swap_b32 v20, v22
  v_permlane32_swap_b32 v21, v23
  v_permlane32_swap_b32 v24, v26
  v_permlane32_swap_b32 v25, v27
  v_permlane32_swap_b32 v28, v30
  v_permlane32_swap_b32 v29, v31
  v_permlane32_swap_b32 v32, v34
  v_permlane32_swap_b32 v33, v35
  v_permlane16_swap_b32 v12, v13
  v_permlane16_swap_b32 v14, v15
  v_permlane16_swap_b32 v16, v17
  v_permlane16_swap_b32 v18, v19
  v_permlane16_swap_b32 v20, v21
  v_permlane16_swap_b32 v22, v23
  v_permlane16_swap_b32 v24, v25
  v_permlane16_swap_b32 v26, v27
  v_permlane16_swap_b32 v28, v29
  v_permlane16_swap_b32 v30, v31
  v_permlane16_swap_b32 v32, v33
  v_permlane16_swap_b32 v34, v35
  s_waitcnt lgkmcnt(0)
  v_lshlrev_b32 v220, 16, v148
  v_and_b32 v221, 0xffff0000, v148
  v_lshlrev_b32 v222, 16, v149
  v_and_b32 v223, 0xffff0000, v149
  v_lshlrev_b32 v224, 16, v150
  v_and_b32 v225, 0xffff0000, v150
  v_lshlrev_b32 v226, 16, v151
  v_and_b32 v227, 0xffff0000, v151
  v_pk_fma_f32 v[220:221], v[160:161], v[12:13], v[220:221]
  v_pk_fma_f32 v[222:223], v[162:163], v[14:15], v[222:223]
  v_pk_fma_f32 v[224:225], v[164:165], v[16:17], v[224:225]
  v_pk_fma_f32 v[226:227], v[166:167], v[18:19], v[226:227]
  v_cvt_pk_bf16_f32 v148, v220, v221
  v_cvt_pk_bf16_f32 v149, v222, v223
  v_cvt_pk_bf16_f32 v150, v224, v225
  v_cvt_pk_bf16_f32 v151, v226, v227
  buffer_store_dwordx4 v[148:151], v210, s[16:19], 0 offen offset:0 sc1
  v_lshlrev_b32 v220, 16, v148
  v_and_b32 v221, 0xffff0000, v148
  v_lshlrev_b32 v222, 16, v149
  v_and_b32 v223, 0xffff0000, v149
  v_lshlrev_b32 v224, 16, v150
  v_and_b32 v225, 0xffff0000, v150
  v_lshlrev_b32 v226, 16, v151
  v_and_b32 v227, 0xffff0000, v151
  v_pk_mul_f32 v[184:185], v[184:185], v[220:221]
  v_pk_mul_f32 v[186:187], v[186:187], v[222:223]
  v_pk_mul_f32 v[188:189], v[188:189], v[224:225]
  v_pk_mul_f32 v[190:191], v[190:191], v[226:227]
  v_cvt_pk_bf16_f32 v228, v184, v185
  v_cvt_pk_bf16_f32 v229, v186, v187
  v_cvt_pk_bf16_f32 v230, v188, v189
  v_cvt_pk_bf16_f32 v231, v190, v191
  buffer_store_dwordx4 v[228:231], v211, s[20:23], 0 offen offset:0 sc1
  v_pk_add_f32 v[216:217], v[220:221], v[222:223]
  v_pk_mul_f32 v[218:219], v[220:221], v[220:221]
  v_pk_fma_f32 v[218:219], v[222:223], v[222:223], v[218:219]
  v_pk_add_f32 v[216:217], v[216:217], v[224:225]
  v_pk_fma_f32 v[218:219], v[224:225], v[224:225], v[218:219]
  v_pk_add_f32 v[216:217], v[216:217], v[226:227]
  v_pk_fma_f32 v[218:219], v[226:227], v[226:227], v[218:219]
  v_lshlrev_b32 v220, 16, v152
  v_and_b32 v221, 0xffff0000, v152
  v_lshlrev_b32 v222, 16, v153
  v_and_b32 v223, 0xffff0000, v153
  v_lshlrev_b32 v224, 16, v154
  v_and_b32 v225, 0xffff0000, v154
  v_lshlrev_b32 v226, 16, v155
  v_and_b32 v227, 0xffff0000, v155
  v_pk_fma_f32 v[220:221], v[168:169], v[20:21], v[220:221]
  v_pk_fma_f32 v[222:223], v[170:171], v[22:23], v[222:223]
  v_pk_fma_f32 v[224:225], v[172:173], v[24:25], v[224:225]
  v_pk_fma_f32 v[226:227], v[174:175], v[26:27], v[226:227]
  v_cvt_pk_bf16_f32 v152, v220, v221
  v_cvt_pk_bf16_f32 v153, v222, v223
  v_cvt_pk_bf16_f32 v154, v224, v225
  v_cvt_pk_bf16_f32 v155, v226, v227
  buffer_store_dwordx4 v[152:155], v210, s[16:19], 0 offen offset:64 sc1
  v_lshlrev_b32 v220, 16, v152
  v_and_b32 v221, 0xffff0000, v152
  v_lshlrev_b32 v222, 16, v153
  v_and_b32 v223, 0xffff0000, v153
  v_lshlrev_b32 v224, 16, v154
  v_and_b32 v225, 0xffff0000, v154
  v_lshlrev_b32 v226, 16, v155
  v_and_b32 v227, 0xffff0000, v155
  v_pk_mul_f32 v[192:193], v[192:193], v[220:221]
  v_pk_mul_f32 v[194:195], v[194:195], v[222:223]
  v_pk_mul_f32 v[196:197], v[196:197], v[224:225]
  v_pk_mul_f32 v[198:199], v[198:199], v[226:227]
  v_cvt_pk_bf16_f32 v232, v192, v193
  v_cvt_pk_bf16_f32 v233, v194, v195
  v_cvt_pk_bf16_f32 v234, v196, v197
  v_cvt_pk_bf16_f32 v235, v198, v199
  buffer_store_dwordx4 v[232:235], v211, s[20:23], 0 offen offset:1024 sc1
  v_pk_add_f32 v[216:217], v[216:217], v[220:221]
  v_pk_fma_f32 v[218:219], v[220:221], v[220:221], v[218:219]
  v_pk_add_f32 v[216:217], v[216:217], v[222:223]
  v_pk_fma_f32 v[218:219], v[222:223], v[222:223], v[218:219]
  v_pk_add_f32 v[216:217], v[216:217], v[224:225]
  v_pk_fma_f32 v[218:219], v[224:225], v[224:225], v[218:219]
  v_pk_add_f32 v[216:217], v[216:217], v[226:227]
  v_pk_fma_f32 v[218:219], v[226:227], v[226:227], v[218:219]
  v_lshlrev_b32 v220, 16, v156
  v_and_b32 v221, 0xffff0000, v156
  v_lshlrev_b32 v222, 16, v157
  v_and_b32 v223, 0xffff0000, v157
  v_lshlrev_b32 v224, 16, v158
  v_and_b32 v225, 0xffff0000, v158
  v_lshlrev_b32 v226, 16, v159
  v_and_b32 v227, 0xffff0000, v159
  v_pk_fma_f32 v[220:221], v[176:177], v[28:29], v[220:221]
  v_pk_fma_f32 v[222:223], v[178:179], v[30:31], v[222:223]
  v_pk_fma_f32 v[224:225], v[180:181], v[32:33], v[224:225]
  v_pk_fma_f32 v[226:227], v[182:183], v[34:35], v[226:227]
  v_cvt_pk_bf16_f32 v156, v220, v221
  v_cvt_pk_bf16_f32 v157, v222, v223
  v_cvt_pk_bf16_f32 v158, v224, v225
  v_cvt_pk_bf16_f32 v159, v226, v227
  buffer_store_dwordx4 v[156:159], v210, s[16:19], 0 offen offset:128 sc1
  v_lshlrev_b32 v220, 16, v156
  v_and_b32 v221, 0xffff0000, v156
  v_lshlrev_b32 v222, 16, v157
  v_and_b32 v223, 0xffff0000, v157
  v_lshlrev_b32 v224, 16, v158
  v_and_b32 v225, 0xffff0000, v158
  v_lshlrev_b32 v226, 16, v159
  v_and_b32 v227, 0xffff0000, v159
  v_pk_mul_f32 v[200:201], v[200:201], v[220:221]
  v_pk_mul_f32 v[202:203], v[202:203], v[222:223]
  v_pk_mul_f32 v[204:205], v[204:205], v[224:225]
  v_pk_mul_f32 v[206:207], v[206:207], v[226:227]
  v_cvt_pk_bf16_f32 v236, v200, v201
  v_cvt_pk_bf16_f32 v237, v202, v203
  v_cvt_pk_bf16_f32 v238, v204, v205
  v_cvt_pk_bf16_f32 v239, v206, v207
  buffer_store_dwordx4 v[236:239], v211, s[20:23], 0 offen offset:2048 sc1
  v_pk_add_f32 v[216:217], v[216:217], v[220:221]
  v_pk_fma_f32 v[218:219], v[220:221], v[220:221], v[218:219]
  v_pk_add_f32 v[216:217], v[216:217], v[222:223]
  v_pk_fma_f32 v[218:219], v[222:223], v[222:223], v[218:219]
  v_pk_add_f32 v[216:217], v[216:217], v[224:225]
  v_pk_fma_f32 v[218:219], v[224:225], v[224:225], v[218:219]
  v_pk_add_f32 v[216:217], v[216:217], v[226:227]
  v_pk_fma_f32 v[218:219], v[226:227], v[226:227], v[218:219]
  v_add_f32 v216, v216, v217
  v_add_f32 v218, v218, v219
  v_mov_b32 v2, v216
  s_nop 1
  v_permlane16_swap_b32 v216, v2
  v_add_f32 v216, v216, v2
  v_mov_b32 v3, v218
  s_nop 1
  v_permlane16_swap_b32 v218, v3
  v_add_f32 v218, v218, v3
  v_mov_b32 v2, v216
  s_nop 1
  v_permlane32_swap_b32 v216, v2
  v_add_f32 v216, v216, v2
  v_mov_b32 v3, v218
  s_nop 1
  v_permlane32_swap_b32 v218, v3
  v_add_f32 v218, v218, v3
  v_mov_b32 v220, v216
  v_mov_b32 v221, v218
  buffer_store_dwordx2 v[220:221], v212, s[24:27], 0 offen sc1
  s_add_u32 s24, s6, 0x2148000
  s_addc_u32 s25, s7, 0
  s_mov_b32 s26, 0x10000
  s_mov_b32 s27, 0x20000
  s_lshl_b32 s14, s12, 1
  s_lshr_b32 s15, s10, 1
  s_add_u32 s14, s14, s15
  s_lshl_b32 s14, s14, 7
  s_add_u32 s14, s14, 24576
  s_waitcnt vmcnt(0)
  s_mov_b64 exec, 1
  v_mov_b32 v222, 0
  v_mov_b32 v223, 1
  buffer_atomic_add v223, v222, s[24:27], s14 offen sc1
  s_mov_b64 exec, -1
  s_barrier
  s_branch L_k57_entry
L_k4_prod:
  s_sub_u32 s14, s10, 4
  s_lshl_b32 s15, s12, 2
  s_add_u32 s15, s15, s14
  s_mul_i32 s15, s15, 18432
  v_lshl_add_u32 v6, v1, 4, s15
  s_mul_i32 s15, s13, 110592
  s_mul_i32 s24, s14, 3072
  s_add_u32 s15, s15, s24
  v_lshl_add_u32 v7, v1, 4, s15
  s_lshl_b32 s23, s14, 11
  s_waitcnt lgkmcnt(0)
  s_add_u32 s28, s6, 0xb2b000
  s_addc_u32 s29, s7, 0
  s_mov_b32 s30, 0xa2000
  s_mov_b32 s31, 0x20000
  s_add_u32 s32, s6, 0x6e0000
  s_addc_u32 s33, s7, 0
  s_mov_b32 s34, 0x240000
  s_mov_b32 s35, 0x20000
  s_mov_b32 s26, 0
  s_add_u32 m0, s24, 0
  s_nop 0
  buffer_load_dwordx4 v7, s[28:31], s26 offen sc1 lds
  buffer_load_dwordx4 v7, s[28:31], s26 offen offset:1024 sc1 lds
  buffer_load_dwordx4 v7, s[28:31], s26 offen offset:2048 sc1 lds
  s_mov_b32 s26, 12288
  s_add_u32 m0, s24, 12288
  s_nop 0
  buffer_load_dwordx4 v7, s[28:31], s26 offen sc1 lds
  buffer_load_dwordx4 v7, s[28:31], s26 offen offset:1024 sc1 lds
  buffer_load_dwordx4 v7, s[28:31], s26 offen offset:2048 sc1 lds
  s_mov_b32 s26, 24576
  s_add_u32 m0, s24, 24576
  s_nop 0
  buffer_load_dwordx4 v7, s[28:31], s26 offen sc1 lds
  buffer_load_dwordx4 v7, s[28:31], s26 offen offset:1024 sc1 lds
  buffer_load_dwordx4 v7, s[28:31], s26 offen offset:2048 sc1 lds
  s_mov_b32 s26, 36864
  s_add_u32 m0, s24, 36864
  s_nop 0
  buffer_load_dwordx4 v7, s[28:31], s26 offen sc1 lds
  buffer_load_dwordx4 v7, s[28:31], s26 offen offset:1024 sc1 lds
  buffer_load_dwordx4 v7, s[28:31], s26 offen offset:2048 sc1 lds
  s_mov_b32 s26, 49152
  s_add_u32 m0, s24, 49152
  s_nop 0
  buffer_load_dwordx4 v7, s[28:31], s26 offen sc1 lds
  buffer_load_dwordx4 v7, s[28:31], s26 offen offset:1024 sc1 lds
  buffer_load_dwordx4 v7, s[28:31], s26 offen offset:2048 sc1 lds
  s_mov_b32 s26, 61440
  s_add_u32 m0, s24, 61440
  s_nop 0
  buffer_load_dwordx4 v7, s[28:31], s26 offen sc1 lds
  buffer_load_dwordx4 v7, s[28:31], s26 offen offset:1024 sc1 lds
  buffer_load_dwordx4 v7, s[28:31], s26 offen offset:2048 sc1 lds
  s_mov_b32 s26, 73728
  s_add_u32 m0, s24, 73728
  s_nop 0
  buffer_load_dwordx4 v7, s[28:31], s26 offen sc1 lds
  buffer_load_dwordx4 v7, s[28:31], s26 offen offset:1024 sc1 lds
  buffer_load_dwordx4 v7, s[28:31], s26 offen offset:2048 sc1 lds
  s_mov_b32 s36, s4
  s_mov_b32 s37, s5
  s_mov_b32 s38, 0x240000
  s_mov_b32 s39, 0x20000
  s_add_u32 s40, s6, 0x920000
  s_addc_u32 s41, s7, 0
  s_mov_b32 s42, 0x3600
  s_mov_b32 s43, 0x20000
  s_lshl_b32 s20, s12, 2
  s_add_u32 s20, s20, s14
  s_mul_i32 s20, s20, 18432
  s_mul_i32 s21, s13, 192
  s_add_u32 s20, s20, s21
  v_add_u32 v2, 0, v1
  v_lshrrev_b32 v3, 2, v2
  v_mul_u32_u24 v3, 86, v3
  v_lshrrev_b32 v3, 8, v3
  v_mul_u32_u24 v4, 12, v3
  v_sub_u32 v4, v2, v4
  v_mul_u32_u24 v3, 1152, v3
  v_lshl_add_u32 v9, v4, 4, v3
  v_add_u32 v2, 64, v1
  v_lshrrev_b32 v3, 2, v2
  v_mul_u32_u24 v3, 86, v3
  v_lshrrev_b32 v3, 8, v3
  v_mul_u32_u24 v4, 12, v3
  v_sub_u32 v4, v2, v4
  v_mul_u32_u24 v3, 1152, v3
  v_lshl_add_u32 v10, v4, 4, v3
  v_add_u32 v2, 128, v1
  v_lshrrev_b32 v3, 2, v2
  v_mul_u32_u24 v3, 86, v3
  v_lshrrev_b32 v3, 8, v3
  v_mul_u32_u24 v4, 12, v3
  v_sub_u32 v4, v2, v4
  v_mul_u32_u24 v3, 1152, v3
  v_lshl_add_u32 v11, v4, 4, v3
  s_mul_i32 s21, s14, 3072
  s_add_u32 s21, s21, 144384
  s_lshr_b32 s22, s14, 1
  s_mul_i32 s22, s22, 4608
  s_mul_i32 s27, s13, 384
  s_add_u32 s22, s22, s27
  s_and_b32 s27, s14, 1
  s_mul_i32 s27, s27, 192
  s_add_u32 s22, s22, s27
  s_add_u32 s22, s22, 4608
  s_mul_i32 s27, s14, 192
  s_add_u32 s27, s27, 156672
  v_lshlrev_b32 v8, 4, v1
  s_add_u32 m0, s21, 0
  s_nop 0
  buffer_load_dwordx4 v9, s[36:39], s20 offen lds
  s_add_u32 m0, s21, 1024
  s_nop 0
  buffer_load_dwordx4 v10, s[36:39], s20 offen lds
  s_add_u32 m0, s21, 2048
  s_nop 0
  buffer_load_dwordx4 v11, s[36:39], s20 offen lds
  s_lshl_b32 s20, s12, 1
  s_lshr_b32 s21, s14, 1
  s_add_u32 s20, s20, s21
  s_lshl_b32 s20, s20, 7
  s_add_u32 s20, s20, 16384
  s_add_u32 s44, s6, 0x2148000
  s_addc_u32 s45, s7, 0
  s_mov_b32 s46, 0x10000
  s_mov_b32 s47, 0x20000
  v_and_b32 v2, 7, v1
  v_lshlrev_b32 v2, 7, v2
  v_add_u32 v2, 6144, v2
  v_mov_b32 v3, 32
  v_mov_b32 v5, 0
  v_mov_b32 v12, 0x7fffffff
  s_bfm_b64 exec, 1, 0
  v_mov_b32 v12, 0
  buffer_atomic_add v12, v5, s[44:47], s20 offen sc0 sc1
  s_mov_b64 exec, -1
  s_waitcnt vmcnt(0)
  s_mov_b32 s17, 0x40000
L_k4_poll_chk:
  v_readfirstlane_b32 s16, v12
  s_nop 0
  s_cmp_ge_u32 s16, 32
  s_cbranch_scc1 L_k4_poll_ok
  s_sub_u32 s17, s17, 1
  s_cbranch_scc1 L_k4_poll_ok
  s_sleep 4
  v_mov_b32 v12, 0x7fffffff
  s_bfm_b64 exec, 1, 0
  v_mov_b32 v12, 0
  buffer_atomic_add v12, v5, s[44:47], s20 offen sc0 sc1
  s_mov_b64 exec, -1
  s_waitcnt vmcnt(0)
  s_branch L_k4_poll_chk
L_k4_poll_ok:
  s_mov_b32 s25, 0
  s_add_u32 m0, s23, 86016
  s_nop 0
  buffer_load_dwordx4 v6, s[32:35], s25 offen sc1 lds
  buffer_load_dwordx4 v6, s[32:35], s25 offen offset:1024 sc1 lds
  s_mov_b32 s25, 2048
  s_add_u32 m0, s23, 94208
  s_nop 0
  buffer_load_dwordx4 v6, s[32:35], s25 offen sc1 lds
  buffer_load_dwordx4 v6, s[32:35], s25 offen offset:1024 sc1 lds
  s_mov_b32 s25, 4096
  s_add_u32 m0, s23, 102400
  s_nop 0
  buffer_load_dwordx4 v6, s[32:35], s25 offen sc1 lds
  buffer_load_dwordx4 v6, s[32:35], s25 offen offset:1024 sc1 lds
  s_mov_b32 s25, 6144
  s_add_u32 m0, s23, 110592
  s_nop 0
  buffer_load_dwordx4 v6, s[32:35], s25 offen sc1 lds
  buffer_load_dwordx4 v6, s[32:35], s25 offen offset:1024 sc1 lds
  s_mov_b32 s25, 8192
  s_add_u32 m0, s23, 118784
  s_nop 0
  buffer_load_dwordx4 v6, s[32:35], s25 offen sc1 lds
  buffer_load_dwordx4 v6, s[32:35], s25 offen offset:1024 sc1 lds
  s_mov_b32 s25, 10240
  s_add_u32 m0, s23, 126976
  s_nop 0
  buffer_load_dwordx4 v6, s[32:35], s25 offen sc1 lds
  buffer_load_dwordx4 v6, s[32:35], s25 offen offset:1024 sc1 lds
  s_waitcnt vmcnt(10)
  s_barrier
  s_waitcnt vmcnt(8)
  s_barrier
  s_mov_b32 s25, 12288
  s_add_u32 m0, s23, 86016
  s_nop 0
  buffer_load_dwordx4 v6, s[32:35], s25 offen sc1 lds
  buffer_load_dwordx4 v6, s[32:35], s25 offen offset:1024 sc1 lds
  s_waitcnt vmcnt(8)
  s_barrier
  s_mov_b32 s25, 14336
  s_add_u32 m0, s23, 94208
  s_nop 0
  buffer_load_dwordx4 v6, s[32:35], s25 offen sc1 lds
  buffer_load_dwordx4 v6, s[32:35], s25 offen offset:1024 sc1 lds
  s_mov_b32 s26, 86016
  s_add_u32 m0, s24, 0
  s_nop 0
  buffer_load_dwordx4 v7, s[28:31], s26 offen sc1 lds
  buffer_load_dwordx4 v7, s[28:31], s26 offen offset:1024 sc1 lds
  buffer_load_dwordx4 v7, s[28:31], s26 offen offset:2048 sc1 lds
  s_waitcnt vmcnt(11)
  s_barrier
  s_mov_b32 s25, 16384
  s_add_u32 m0, s23, 102400
  s_nop 0
  buffer_load_dwordx4 v6, s[32:35], s25 offen sc1 lds
  buffer_load_dwordx4 v6, s[32:35], s25 offen offset:1024 sc1 lds
  s_mov_b32 s26, 98304
  s_add_u32 m0, s24, 12288
  s_nop 0
  buffer_load_dwordx4 v7, s[28:31], s26 offen sc1 lds
  buffer_load_dwordx4 v7, s[28:31], s26 offen offset:1024 sc1 lds
  buffer_load_dwordx4 v7, s[28:31], s26 offen offset:2048 sc1 lds
  s_add_u32 m0, s27, 0
  s_bfm_b64 exec, 12, 0
  buffer_load_dwordx4 v8, s[40:43], s22 offen sc1 lds
  s_mov_b64 exec, -1
  s_waitcnt vmcnt(15)
  s_barrier
  s_waitcnt vmcnt(13)
  s_barrier
  s_waitcnt vmcnt(11)
  s_barrier
  s_waitcnt vmcnt(6)
  s_barrier
  s_waitcnt vmcnt(0)
  s_barrier
  s_add_u32 s44, s6, 0x2148000
  s_addc_u32 s45, s7, 0
  s_mov_b32 s46, 0x10000
  s_mov_b32 s47, 0x20000
  v_and_b32 v2, 7, v1
  v_lshlrev_b32 v2, 7, v2
  v_add_u32 v2, 6144, v2
  v_mov_b32 v3, 32
  s_mov_b32 s16, 0x40000
L_k4_pollw_chk:
  buffer_load_dword v4, v2, s[44:47], 0 offen sc1
  s_waitcnt vmcnt(0)
  v_cmp_lt_u32 vcc, v4, v3
  s_nop 1
  s_cbranch_vccz L_k4_pollw_ok
  s_sub_u32 s16, s16, 1
  s_cbranch_scc1 L_k4_pollw_ok
  s_sleep 4
  s_branch L_k4_pollw_chk
L_k4_pollw_ok:
  s_branch L_k57_entry
L_k4_side:
  s_waitcnt lgkmcnt(0)
  s_add_u32 s44, s6, 0x2148000
  s_addc_u32 s45, s7, 0
  s_mov_b32 s46, 0x10000
  s_mov_b32 s47, 0x20000
  v_and_b32 v2, 7, v1
  v_lshlrev_b32 v2, 7, v2
  v_add_u32 v2, 6144, v2
  v_mov_b32 v3, 32
  s_and_b32 s20, s2, 63
  s_lshl_b32 s20, s20, 7
  s_add_u32 s20, s20, 16384
  v_mov_b32 v5, 0
  v_mov_b32 v4, 0x7fffffff
  s_bfm_b64 exec, 1, 0
  v_mov_b32 v4, 0
  buffer_atomic_add v4, v5, s[44:47], s20 offen sc0 sc1
  s_mov_b64 exec, -1
  s_waitcnt vmcnt(0)
  s_mov_b32 s22, 0x40000
L_k4_pollo_chk:
  v_readfirstlane_b32 s21, v4
  s_nop 0
  s_cmp_ge_u32 s21, 32
  s_cbranch_scc1 L_k4_pollo_ok
  s_sub_u32 s22, s22, 1
  s_cbranch_scc1 L_k4_pollo_ok
  s_sleep 8
  v_mov_b32 v4, 0x7fffffff
  s_bfm_b64 exec, 1, 0
  v_mov_b32 v4, 0
  buffer_atomic_add v4, v5, s[44:47], s20 offen sc0 sc1
  s_mov_b64 exec, -1
  s_waitcnt vmcnt(0)
  s_branch L_k4_pollo_chk
L_k4_pollo_ok:
  s_mov_b32 s20, 0x40000
L_k4_pollr_chk:
  buffer_load_dword v4, v2, s[44:47], 0 offen sc1
  s_waitcnt vmcnt(0)
  v_cmp_lt_u32 vcc, v4, v3
  s_nop 1
  s_cbranch_vccz L_k4_pollr_ok
  s_sub_u32 s20, s20, 1
  s_cbranch_scc1 L_k4_pollr_ok
  s_sleep 4
  s_branch L_k4_pollr_chk
L_k4_pollr_ok:
  s_sub_u32 s12, s12, 24
  s_lshl_b32 s12, s12, 3
  s_add_u32 s12, s12, s10
  s_cmp_ge_u32 s12, 36
  s_cbranch_scc1 L_k4_exit
  s_mul_i32 s13, s12, 7282
  s_lshr_b32 s13, s13, 16
  s_mul_i32 s14, s13, 9
  s_sub_u32 s14, s12, s14
  s_and_b32 s15, s11, 1
  s_lshl_b32 s15, s15, 4
  s_lshr_b32 s11, s11, 1
  s_lshl_b32 s11, s11, 2
  s_add_u32 s13, s13, s11
  s_add_u32 s13, s13, s15
  s_mul_i32 s15, s13, 165888
  s_lshl_b32 s24, s14, 10
  s_add_u32 s15, s15, s24
  v_lshl_add_u32 v157, v1, 4, s15
  v_and_b32 v2, 15, v1
  v_lshrrev_b32 v3, 4, v1
  v_lshlrev_b32 v156, 4, v3
  v_lshl_add_u32 v156, v2, 6, v156
  v_lshrrev_b32 v4, 1, v2
  v_lshl_or_b32 v156, v4, 20, v156
  s_waitcnt lgkmcnt(0)
  s_add_u32 s16, s6, 0x932000
  s_addc_u32 s17, s7, 0
  s_mov_b32 s18, 0x900
  s_mov_b32 s19, 0x20000
  s_add_u32 s20, s6, 0xbcd000
  s_addc_u32 s21, s7, 0
  s_mov_b32 s22, 0x510000
  s_mov_b32 s23, 0x20000
  s_add_u32 s24, s6, 0x17fd000
  s_addc_u32 s25, s7, 0
  s_mov_b32 s26, 0x9000
  s_mov_b32 s27, 0x20000
  s_mov_b32 s28, 0
  buffer_load_dwordx4 v[8:11], v156, s[16:19], 0 offen offset:0 sc1
  buffer_load_dwordx4 v[80:83], v157, s[20:23], s28 offen sc1
  s_mov_b32 s28, 9216
  buffer_load_dwordx4 v[12:15], v156, s[16:19], 0 offen offset:128 sc1
  buffer_load_dwordx4 v[84:87], v157, s[20:23], s28 offen sc1
  s_mov_b32 s28, 18432
  buffer_load_dwordx4 v[16:19], v156, s[16:19], 0 offen offset:256 sc1
  buffer_load_dwordx4 v[88:91], v157, s[20:23], s28 offen sc1
  s_mov_b32 s28, 27648
  buffer_load_dwordx4 v[20:23], v156, s[16:19], 0 offen offset:384 sc1
  buffer_load_dwordx4 v[92:95], v157, s[20:23], s28 offen sc1
  s_mov_b32 s28, 36864
  buffer_load_dwordx4 v[24:27], v156, s[16:19], 0 offen offset:512 sc1
  buffer_load_dwordx4 v[96:99], v157, s[20:23], s28 offen sc1
  s_mov_b32 s28, 46080
  buffer_load_dwordx4 v[28:31], v156, s[16:19], 0 offen offset:640 sc1
  buffer_load_dwordx4 v[100:103], v157, s[20:23], s28 offen sc1
  s_mov_b32 s28, 55296
  buffer_load_dwordx4 v[32:35], v156, s[16:19], 0 offen offset:768 sc1
  buffer_load_dwordx4 v[104:107], v157, s[20:23], s28 offen sc1
  s_mov_b32 s28, 64512
  buffer_load_dwordx4 v[36:39], v156, s[16:19], 0 offen offset:896 sc1
  buffer_load_dwordx4 v[108:111], v157, s[20:23], s28 offen sc1
  s_mov_b32 s28, 73728
  buffer_load_dwordx4 v[40:43], v156, s[16:19], 0 offen offset:1024 sc1
  buffer_load_dwordx4 v[112:115], v157, s[20:23], s28 offen sc1
  s_mov_b32 s28, 82944
  buffer_load_dwordx4 v[44:47], v156, s[16:19], 0 offen offset:1152 sc1
  buffer_load_dwordx4 v[116:119], v157, s[20:23], s28 offen sc1
  s_mov_b32 s28, 92160
  buffer_load_dwordx4 v[48:51], v156, s[16:19], 0 offen offset:1280 sc1
  buffer_load_dwordx4 v[120:123], v157, s[20:23], s28 offen sc1
  s_mov_b32 s28, 101376
  buffer_load_dwordx4 v[52:55], v156, s[16:19], 0 offen offset:1408 sc1
  buffer_load_dwordx4 v[124:127], v157, s[20:23], s28 offen sc1
  s_mov_b32 s28, 110592
  buffer_load_dwordx4 v[56:59], v156, s[16:19], 0 offen offset:1536 sc1
  buffer_load_dwordx4 v[128:131], v157, s[20:23], s28 offen sc1
  s_mov_b32 s28, 119808
  buffer_load_dwordx4 v[60:63], v156, s[16:19], 0 offen offset:1664 sc1
  buffer_load_dwordx4 v[132:135], v157, s[20:23], s28 offen sc1
  s_mov_b32 s28, 129024
  buffer_load_dwordx4 v[64:67], v156, s[16:19], 0 offen offset:1792 sc1
  buffer_load_dwordx4 v[136:139], v157, s[20:23], s28 offen sc1
  s_mov_b32 s28, 138240
  buffer_load_dwordx4 v[68:71], v156, s[16:19], 0 offen offset:1920 sc1
  buffer_load_dwordx4 v[140:143], v157, s[20:23], s28 offen sc1
  s_mov_b32 s28, 147456
  buffer_load_dwordx4 v[72:75], v156, s[16:19], 0 offen offset:2048 sc1
  buffer_load_dwordx4 v[144:147], v157, s[20:23], s28 offen sc1
  s_mov_b32 s28, 156672
  buffer_load_dwordx4 v[76:79], v156, s[16:19], 0 offen offset:2176 sc1
  buffer_load_dwordx4 v[148:151], v157, s[20:23], s28 offen sc1
  s_lshl_b32 s29, s13, 7
  s_add_u32 s29, s29, 2048
  s_mul_i32 s13, s13, 9
  s_add_u32 s13, s13, s14
  s_lshl_b32 s13, s13, 6
  v_lshl_add_u32 v156, v2, 2, s13
  v_lshl_or_b32 v156, v3, 20, v156
  s_waitcnt vmcnt(34)
  v_mfma_f32_16x16x32_bf16 v[152:155], v[8:11], v[80:83], 0
  s_waitcnt vmcnt(32)
  v_mfma_f32_16x16x32_bf16 v[152:155], v[12:15], v[84:87], v[152:155]
  s_waitcnt vmcnt(30)
  v_mfma_f32_16x16x32_bf16 v[152:155], v[16:19], v[88:91], v[152:155]
  s_waitcnt vmcnt(28)
  v_mfma_f32_16x16x32_bf16 v[152:155], v[20:23], v[92:95], v[152:155]
  s_waitcnt vmcnt(26)
  v_mfma_f32_16x16x32_bf16 v[152:155], v[24:27], v[96:99], v[152:155]
  s_waitcnt vmcnt(24)
  v_mfma_f32_16x16x32_bf16 v[152:155], v[28:31], v[100:103], v[152:155]
  s_waitcnt vmcnt(22)
  v_mfma_f32_16x16x32_bf16 v[152:155], v[32:35], v[104:107], v[152:155]
  s_waitcnt vmcnt(20)
  v_mfma_f32_16x16x32_bf16 v[152:155], v[36:39], v[108:111], v[152:155]
  s_waitcnt vmcnt(18)
  v_mfma_f32_16x16x32_bf16 v[152:155], v[40:43], v[112:115], v[152:155]
  s_waitcnt vmcnt(16)
  v_mfma_f32_16x16x32_bf16 v[152:155], v[44:47], v[116:119], v[152:155]
  s_waitcnt vmcnt(14)
  v_mfma_f32_16x16x32_bf16 v[152:155], v[48:51], v[120:123], v[152:155]
  s_waitcnt vmcnt(12)
  v_mfma_f32_16x16x32_bf16 v[152:155], v[52:55], v[124:127], v[152:155]
  s_waitcnt vmcnt(10)
  v_mfma_f32_16x16x32_bf16 v[152:155], v[56:59], v[128:131], v[152:155]
  s_waitcnt vmcnt(8)
  v_mfma_f32_16x16x32_bf16 v[152:155], v[60:63], v[132:135], v[152:155]
  s_waitcnt vmcnt(6)
  v_mfma_f32_16x16x32_bf16 v[152:155], v[64:67], v[136:139], v[152:155]
  s_waitcnt vmcnt(4)
  v_mfma_f32_16x16x32_bf16 v[152:155], v[68:71], v[140:143], v[152:155]
  s_waitcnt vmcnt(2)
  v_mfma_f32_16x16x32_bf16 v[152:155], v[72:75], v[144:147], v[152:155]
  s_waitcnt vmcnt(0)
  v_mfma_f32_16x16x32_bf16 v[152:155], v[76:79], v[148:151], v[152:155]
  s_mov_b32 s28, 18432
  s_nop 6
  buffer_store_dword v152, v156, s[24:27], 0 offen sc1
  buffer_store_dword v153, v156, s[24:27], s28 offen sc1
  s_add_u32 s24, s6, 0x2148000
  s_addc_u32 s25, s7, 0
  s_mov_b32 s26, 0x10000
  s_mov_b32 s27, 0x20000
  s_waitcnt vmcnt(0)
  s_mov_b64 exec, 1
  v_mov_b32 v8, 0
  v_mov_b32 v9, 1
  buffer_atomic_add v9, v8, s[24:27], s29 offen sc1
  s_mov_b64 exec, -1
L_k4_exit:
L_k57_entry:
  s_waitcnt lgkmcnt(0)
  s_load_dwordx2 s[6:7], s[0:1], 96
  s_load_dwordx4 s[60:63], s[0:1], 32
  s_load_dwordx2 s[4:5], s[0:1], 48
  s_load_dwordx2 s[8:9], s[0:1], 80
  v_lshrrev_b32 v2, 6, v0
  v_and_b32 v1, 63, v0
  v_readfirstlane_b32 s10, v2
  s_and_b32 s13, s2, 1
  s_lshl_b32 s13, s13, 3
  s_bfe_u32 s14, s2, 0x30003
  s_add_u32 s11, s13, s14
  s_bfe_u32 s13, s2, 0x20001
  s_lshl_b32 s13, s13, 2
  s_lshr_b32 s14, s2, 6
  s_add_u32 s12, s13, s14
  s_cmp_ge_u32 s10, 4
  s_cbranch_scc1 L_k57_prod
  v_lshlrev_b32 v240, 4, v1
  s_lshl_b32 s15, s10, 12
  v_add_u32 v236, s15, v240
  v_add_u32 v237, 1024, v236
  v_add_u32 v244, 144384, v236
  v_add_u32 v238, 65536, v240
  v_add_u32 v239, 102400, v240
  s_lshl_b32 s14, s11, 2
  s_add_u32 s14, s14, s10
  s_mov_b32 s26, 0xc0135761
  s_mov_b32 s27, 0xc0135761
  s_mov_b32 s28, 0xbdd2d3e8
  s_mov_b32 s29, 0xbdd2d3e8
  s_mov_b32 s30, 0x3f800000
  s_mov_b32 s31, 0x3f800000
  s_waitcnt lgkmcnt(0)
  s_add_u32 s16, s6, 0x1806000
  s_addc_u32 s17, s7, 0
  s_mov_b32 s18, 0x900000
  s_mov_b32 s19, 0x20000
  s_add_u32 s20, s6, 0x2106000
  s_addc_u32 s21, s7, 0
  s_mov_b32 s22, 0x40000
  s_mov_b32 s23, 0x20000
  s_lshl_b32 s24, s14, 8
  s_lshl_b32 s15, s12, 14
  s_add_u32 s15, s15, s24
  v_lshrrev_b32 v66, 2, v1
  v_lshl_add_u32 v68, v66, 4, s15
  v_and_b32 v66, 3, v1
  v_lshl_or_b32 v68, v66, 24, v68
  v_and_b32 v66, 15, v1
  v_lshrrev_b32 v64, 2, v66
  v_and_b32 v67, 3, v66
  v_lshl_add_u32 v67, v64, 3, v67
  s_lshl_b32 s15, s10, 7
  s_add_u32 s15, s15, 141568
  v_lshl_add_u32 v0, v67, 2, s15
  v_lshrrev_b32 v64, 4, v1
  v_bfe_u32 v65, v1, 1, 3
  v_xor_b32 v65, v64, v65
  v_lshlrev_b32 v65, 4, v65
  v_lshl_add_u32 v65, v66, 7, v65
  s_lshl_b32 s24, s10, 12
  v_add_u32 v3, s24, v65
  v_lshlrev_b32 v67, 2, v66
  v_add_u32 v67, 139264, v67
  v_lshl_add_u32 v66, v64, 5, s15
  v_lshlrev_b32 v2, 4, v64
  v_add_u32 v2, 140416, v2
  s_lshl_b32 s15, s10, 8
  s_add_u32 s15, s15, 143104
  v_lshl_add_u32 v241, v64, 5, s15
  v_mov_b32 v64, s26
  v_mov_b32 v65, s26
  s_mov_b32 s40, s6
  s_mov_b32 s41, s7
  s_mov_b32 s42, 0x900000
  s_mov_b32 s43, 0x20000
  s_mul_i32 s24, s14, 147456
  s_mul_i32 s15, s12, 9
  s_and_b32 s25, s12, 1
  s_add_u32 s36, s15, s25
  s_lshl_b32 s36, s36, 9
  s_add_u32 s36, s36, s24
  s_add_u32 s37, s36, 73728
  s_xor_b32 s38, s25, 1
  s_lshl_b32 s38, s38, 3
  s_add_u32 s38, s38, s15
  s_lshr_b32 s38, s38, 1
  s_lshl_b32 s38, s38, 10
  s_lshl_b32 s25, s25, 3
  s_add_u32 s38, s38, s25
  s_add_u32 s38, s38, s24
  s_add_u32 s39, s38, 73728
  s_mul_i32 s15, s12, 589824
  s_mul_i32 s24, s14, 9216
  s_add_u32 s15, s15, s24
  s_barrier
  ds_read_b128 v[220:223], v236 offset:0
  ds_read_b128 v[224:227], v236 offset:2048
  ds_read_b128 v[148:151], v238 offset:0
  ds_read_b128 v[152:155], v238 offset:1024
  ds_read_b128 v[156:159], v238 offset:2048
  ds_read_b128 v[160:163], v238 offset:3072
  ds_read_b128 v[164:167], v238 offset:4096
  ds_read_b128 v[168:171], v238 offset:5120
  ds_read_b128 v[172:175], v238 offset:6144
  ds_read_b128 v[176:179], v238 offset:7168
  ds_read_b128 v[180:183], v238 offset:8192
  s_waitcnt lgkmcnt(0)
  v_mfma_f32_16x16x32_bf16 v[76:79], v[220:223], v[148:151], 0
  ds_read_b128 v[228:231], v237 offset:0
  v_mfma_f32_16x16x32_bf16 v[80:83], v[224:227], v[148:151], 0
  ds_read_b128 v[232:235], v237 offset:2048
  v_mfma_f32_16x16x32_bf16 v[84:87], v[220:223], v[152:155], 0
  ds_read_b128 v[184:187], v238 offset:9216
  v_mfma_f32_16x16x32_bf16 v[88:91], v[224:227], v[152:155], 0
  ds_read_b128 v[188:191], v238 offset:10240
  v_mfma_f32_16x16x32_bf16 v[92:95], v[220:223], v[156:159], 0
  ds_read_b128 v[192:195], v238 offset:11264
  v_mfma_f32_16x16x32_bf16 v[96:99], v[224:227], v[156:159], 0
  ds_read_b128 v[196:199], v238 offset:12288
  v_mfma_f32_16x16x32_bf16 v[100:103], v[220:223], v[160:163], 0
  ds_read_b128 v[200:203], v238 offset:13312
  v_mfma_f32_16x16x32_bf16 v[104:107], v[224:227], v[160:163], 0
  ds_read_b128 v[204:207], v238 offset:14336
  v_mfma_f32_16x16x32_bf16 v[108:111], v[220:223], v[164:167], 0
  ds_read_b128 v[208:211], v238 offset:15360
  v_mfma_f32_16x16x32_bf16 v[112:115], v[224:227], v[164:167], 0
  ds_read_b128 v[212:215], v238 offset:16384
  v_mfma_f32_16x16x32_bf16 v[116:119], v[220:223], v[168:171], 0
  ds_read_b128 v[216:219], v238 offset:17408
  v_mfma_f32_16x16x32_bf16 v[120:123], v[224:227], v[168:171], 0
  v_mfma_f32_16x16x32_bf16 v[124:127], v[220:223], v[172:175], 0
  v_mfma_f32_16x16x32_bf16 v[128:131], v[224:227], v[172:175], 0
  v_mfma_f32_16x16x32_bf16 v[132:135], v[220:223], v[176:179], 0
  v_mfma_f32_16x16x32_bf16 v[136:139], v[224:227], v[176:179], 0
  v_mfma_f32_16x16x32_bf16 v[140:143], v[220:223], v[180:183], 0
  v_mfma_f32_16x16x32_bf16 v[144:147], v[224:227], v[180:183], 0
  s_waitcnt lgkmcnt(0)
  s_barrier
  v_mfma_f32_16x16x32_bf16 v[76:79], v[228:231], v[184:187], v[76:79]
  ds_read_b128 v[220:223], v236 offset:16384
  v_mfma_f32_16x16x32_bf16 v[80:83], v[232:235], v[184:187], v[80:83]
  ds_read_b128 v[224:227], v236 offset:18432
  v_mfma_f32_16x16x32_bf16 v[84:87], v[228:231], v[188:191], v[84:87]
  ds_read_b128 v[148:151], v238 offset:18432
  v_mfma_f32_16x16x32_bf16 v[88:91], v[232:235], v[188:191], v[88:91]
  ds_read_b128 v[152:155], v238 offset:19456
  v_mfma_f32_16x16x32_bf16 v[92:95], v[228:231], v[192:195], v[92:95]
  ds_read_b128 v[156:159], v238 offset:20480
  v_mfma_f32_16x16x32_bf16 v[96:99], v[232:235], v[192:195], v[96:99]
  ds_read_b128 v[160:163], v238 offset:21504
  v_mfma_f32_16x16x32_bf16 v[100:103], v[228:231], v[196:199], v[100:103]
  ds_read_b128 v[164:167], v238 offset:22528
  v_mfma_f32_16x16x32_bf16 v[104:107], v[232:235], v[196:199], v[104:107]
  ds_read_b128 v[168:171], v238 offset:23552
  v_mfma_f32_16x16x32_bf16 v[108:111], v[228:231], v[200:203], v[108:111]
  ds_read_b128 v[172:175], v238 offset:24576
  v_mfma_f32_16x16x32_bf16 v[112:115], v[232:235], v[200:203], v[112:115]
  ds_read_b128 v[176:179], v238 offset:25600
  v_mfma_f32_16x16x32_bf16 v[116:119], v[228:231], v[204:207], v[116:119]
  ds_read_b128 v[180:183], v238 offset:26624
  v_mfma_f32_16x16x32_bf16 v[120:123], v[232:235], v[204:207], v[120:123]
  v_mfma_f32_16x16x32_bf16 v[124:127], v[228:231], v[208:211], v[124:127]
  v_mfma_f32_16x16x32_bf16 v[128:131], v[232:235], v[208:211], v[128:131]
  v_mfma_f32_16x16x32_bf16 v[132:135], v[228:231], v[212:215], v[132:135]
  v_mfma_f32_16x16x32_bf16 v[136:139], v[232:235], v[212:215], v[136:139]
  v_mfma_f32_16x16x32_bf16 v[140:143], v[228:231], v[216:219], v[140:143]
  v_mfma_f32_16x16x32_bf16 v[144:147], v[232:235], v[216:219], v[144:147]
  s_waitcnt lgkmcnt(0)
  v_mfma_f32_16x16x32_bf16 v[76:79], v[220:223], v[148:151], v[76:79]
  ds_read_b128 v[228:231], v237 offset:16384
  v_mfma_f32_16x16x32_bf16 v[80:83], v[224:227], v[148:151], v[80:83]
  ds_read_b128 v[232:235], v237 offset:18432
  v_mfma_f32_16x16x32_bf16 v[84:87], v[220:223], v[152:155], v[84:87]
  ds_read_b128 v[184:187], v238 offset:27648
  v_mfma_f32_16x16x32_bf16 v[88:91], v[224:227], v[152:155], v[88:91]
  ds_read_b128 v[188:191], v238 offset:28672
  v_mfma_f32_16x16x32_bf16 v[92:95], v[220:223], v[156:159], v[92:95]
  ds_read_b128 v[192:195], v238 offset:29696
  v_mfma_f32_16x16x32_bf16 v[96:99], v[224:227], v[156:159], v[96:99]
  ds_read_b128 v[196:199], v238 offset:30720
  v_mfma_f32_16x16x32_bf16 v[100:103], v[220:223], v[160:163], v[100:103]
  ds_read_b128 v[200:203], v238 offset:31744
  v_mfma_f32_16x16x32_bf16 v[104:107], v[224:227], v[160:163], v[104:107]
  ds_read_b128 v[204:207], v238 offset:32768
  v_mfma_f32_16x16x32_bf16 v[108:111], v[220:223], v[164:167], v[108:111]
  ds_read_b128 v[208:211], v238 offset:33792
  v_mfma_f32_16x16x32_bf16 v[112:115], v[224:227], v[164:167], v[112:115]
  ds_read_b128 v[212:215], v238 offset:34816
  v_mfma_f32_16x16x32_bf16 v[116:119], v[220:223], v[168:171], v[116:119]
  ds_read_b128 v[216:219], v238 offset:35840
  v_mfma_f32_16x16x32_bf16 v[120:123], v[224:227], v[168:171], v[120:123]
  v_mfma_f32_16x16x32_bf16 v[124:127], v[220:223], v[172:175], v[124:127]
  v_mfma_f32_16x16x32_bf16 v[128:131], v[224:227], v[172:175], v[128:131]
  v_mfma_f32_16x16x32_bf16 v[132:135], v[220:223], v[176:179], v[132:135]
  v_mfma_f32_16x16x32_bf16 v[136:139], v[224:227], v[176:179], v[136:139]
  v_mfma_f32_16x16x32_bf16 v[140:143], v[220:223], v[180:183], v[140:143]
  v_mfma_f32_16x16x32_bf16 v[144:147], v[224:227], v[180:183], v[144:147]
  s_waitcnt lgkmcnt(0)
  s_barrier
  v_mfma_f32_16x16x32_bf16 v[76:79], v[228:231], v[184:187], v[76:79]
  ds_read_b128 v[220:223], v236 offset:32768
  v_mfma_f32_16x16x32_bf16 v[80:83], v[232:235], v[184:187], v[80:83]
  ds_read_b128 v[224:227], v236 offset:34816
  v_mfma_f32_16x16x32_bf16 v[84:87], v[228:231], v[188:191], v[84:87]
  ds_read_b128 v[148:151], v239 offset:0
  v_mfma_f32_16x16x32_bf16 v[88:91], v[232:235], v[188:191], v[88:91]
  ds_read_b128 v[152:155], v239 offset:1024
  v_mfma_f32_16x16x32_bf16 v[92:95], v[228:231], v[192:195], v[92:95]
  ds_read_b128 v[156:159], v239 offset:2048
  v_mfma_f32_16x16x32_bf16 v[96:99], v[232:235], v[192:195], v[96:99]
  ds_read_b128 v[160:163], v239 offset:3072
  v_mfma_f32_16x16x32_bf16 v[100:103], v[228:231], v[196:199], v[100:103]
  ds_read_b128 v[164:167], v239 offset:4096
  v_mfma_f32_16x16x32_bf16 v[104:107], v[232:235], v[196:199], v[104:107]
  ds_read_b128 v[168:171], v239 offset:5120
  v_mfma_f32_16x16x32_bf16 v[108:111], v[228:231], v[200:203], v[108:111]
  ds_read_b128 v[172:175], v239 offset:6144
  v_mfma_f32_16x16x32_bf16 v[112:115], v[232:235], v[200:203], v[112:115]
  ds_read_b128 v[176:179], v239 offset:7168
  v_mfma_f32_16x16x32_bf16 v[116:119], v[228:231], v[204:207], v[116:119]
  ds_read_b128 v[180:183], v239 offset:8192
  v_mfma_f32_16x16x32_bf16 v[120:123], v[232:235], v[204:207], v[120:123]
  v_mfma_f32_16x16x32_bf16 v[124:127], v[228:231], v[208:211], v[124:127]
  v_mfma_f32_16x16x32_bf16 v[128:131], v[232:235], v[208:211], v[128:131]
  v_mfma_f32_16x16x32_bf16 v[132:135], v[228:231], v[212:215], v[132:135]
  v_mfma_f32_16x16x32_bf16 v[136:139], v[232:235], v[212:215], v[136:139]
  v_mfma_f32_16x16x32_bf16 v[140:143], v[228:231], v[216:219], v[140:143]
  v_mfma_f32_16x16x32_bf16 v[144:147], v[232:235], v[216:219], v[144:147]
  s_waitcnt lgkmcnt(0)
  v_mfma_f32_16x16x32_bf16 v[76:79], v[220:223], v[148:151], v[76:79]
  ds_read_b128 v[228:231], v237 offset:32768
  v_mfma_f32_16x16x32_bf16 v[80:83], v[224:227], v[148:151], v[80:83]
  ds_read_b128 v[232:235], v237 offset:34816
  v_mfma_f32_16x16x32_bf16 v[84:87], v[220:223], v[152:155], v[84:87]
  ds_read_b128 v[184:187], v239 offset:9216
  v_mfma_f32_16x16x32_bf16 v[88:91], v[224:227], v[152:155], v[88:91]
  ds_read_b128 v[188:191], v239 offset:10240
  v_mfma_f32_16x16x32_bf16 v[92:95], v[220:223], v[156:159], v[92:95]
  ds_read_b128 v[192:195], v239 offset:11264
  v_mfma_f32_16x16x32_bf16 v[96:99], v[224:227], v[156:159], v[96:99]
  ds_read_b128 v[196:199], v239 offset:12288
  v_mfma_f32_16x16x32_bf16 v[100:103], v[220:223], v[160:163], v[100:103]
  ds_read_b128 v[200:203], v239 offset:13312
  v_mfma_f32_16x16x32_bf16 v[104:107], v[224:227], v[160:163], v[104:107]
  ds_read_b128 v[204:207], v239 offset:14336
  v_mfma_f32_16x16x32_bf16 v[108:111], v[220:223], v[164:167], v[108:111]
  ds_read_b128 v[208:211], v239 offset:15360
  v_mfma_f32_16x16x32_bf16 v[112:115], v[224:227], v[164:167], v[112:115]
  ds_read_b128 v[212:215], v239 offset:16384
  v_mfma_f32_16x16x32_bf16 v[116:119], v[220:223], v[168:171], v[116:119]
  ds_read_b128 v[216:219], v239 offset:17408
  v_mfma_f32_16x16x32_bf16 v[120:123], v[224:227], v[168:171], v[120:123]
  v_mfma_f32_16x16x32_bf16 v[124:127], v[220:223], v[172:175], v[124:127]
  v_mfma_f32_16x16x32_bf16 v[128:131], v[224:227], v[172:175], v[128:131]
  v_mfma_f32_16x16x32_bf16 v[132:135], v[220:223], v[176:179], v[132:135]
  v_mfma_f32_16x16x32_bf16 v[136:139], v[224:227], v[176:179], v[136:139]
  v_mfma_f32_16x16x32_bf16 v[140:143], v[220:223], v[180:183], v[140:143]
  v_mfma_f32_16x16x32_bf16 v[144:147], v[224:227], v[180:183], v[144:147]
  s_waitcnt lgkmcnt(0)
  s_barrier
  v_mfma_f32_16x16x32_bf16 v[76:79], v[228:231], v[184:187], v[76:79]
  ds_read_b128 v[220:223], v236 offset:49152
  v_mfma_f32_16x16x32_bf16 v[80:83], v[232:235], v[184:187], v[80:83]
  ds_read_b128 v[224:227], v236 offset:51200
  v_mfma_f32_16x16x32_bf16 v[84:87], v[228:231], v[188:191], v[84:87]
  ds_read_b128 v[148:151], v239 offset:18432
  v_mfma_f32_16x16x32_bf16 v[88:91], v[232:235], v[188:191], v[88:91]
  ds_read_b128 v[152:155], v239 offset:19456
  v_mfma_f32_16x16x32_bf16 v[92:95], v[228:231], v[192:195], v[92:95]
  ds_read_b128 v[156:159], v239 offset:20480
  v_mfma_f32_16x16x32_bf16 v[96:99], v[232:235], v[192:195], v[96:99]
  ds_read_b128 v[160:163], v239 offset:21504
  v_mfma_f32_16x16x32_bf16 v[100:103], v[228:231], v[196:199], v[100:103]
  ds_read_b128 v[164:167], v239 offset:22528
  v_mfma_f32_16x16x32_bf16 v[104:107], v[232:235], v[196:199], v[104:107]
  ds_read_b128 v[168:171], v239 offset:23552
  v_mfma_f32_16x16x32_bf16 v[108:111], v[228:231], v[200:203], v[108:111]
  ds_read_b128 v[172:175], v239 offset:24576
  v_mfma_f32_16x16x32_bf16 v[112:115], v[232:235], v[200:203], v[112:115]
  ds_read_b128 v[176:179], v239 offset:25600
  v_mfma_f32_16x16x32_bf16 v[116:119], v[228:231], v[204:207], v[116:119]
  ds_read_b128 v[180:183], v239 offset:26624
  v_mfma_f32_16x16x32_bf16 v[120:123], v[232:235], v[204:207], v[120:123]
  v_mfma_f32_16x16x32_bf16 v[124:127], v[228:231], v[208:211], v[124:127]
  v_mfma_f32_16x16x32_bf16 v[128:131], v[232:235], v[208:211], v[128:131]
  v_mfma_f32_16x16x32_bf16 v[132:135], v[228:231], v[212:215], v[132:135]
  v_mfma_f32_16x16x32_bf16 v[136:139], v[232:235], v[212:215], v[136:139]
  v_mfma_f32_16x16x32_bf16 v[140:143], v[228:231], v[216:219], v[140:143]
  v_mfma_f32_16x16x32_bf16 v[144:147], v[232:235], v[216:219], v[144:147]
  s_waitcnt lgkmcnt(0)
  v_mfma_f32_16x16x32_bf16 v[76:79], v[220:223], v[148:151], v[76:79]
  ds_read_b128 v[228:231], v237 offset:49152
  v_mfma_f32_16x16x32_bf16 v[80:83], v[224:227], v[148:151], v[80:83]
  ds_read_b128 v[232:235], v237 offset:51200
  v_mfma_f32_16x16x32_bf16 v[84:87], v[220:223], v[152:155], v[84:87]
  ds_read_b128 v[184:187], v239 offset:27648
  v_mfma_f32_16x16x32_bf16 v[88:91], v[224:227], v[152:155], v[88:91]
  ds_read_b128 v[188:191], v239 offset:28672
  v_mfma_f32_16x16x32_bf16 v[92:95], v[220:223], v[156:159], v[92:95]
  ds_read_b128 v[192:195], v239 offset:29696
  v_mfma_f32_16x16x32_bf16 v[96:99], v[224:227], v[156:159], v[96:99]
  ds_read_b128 v[196:199], v239 offset:30720
  v_mfma_f32_16x16x32_bf16 v[100:103], v[220:223], v[160:163], v[100:103]
  ds_read_b128 v[200:203], v239 offset:31744
  v_mfma_f32_16x16x32_bf16 v[104:107], v[224:227], v[160:163], v[104:107]
  ds_read_b128 v[204:207], v239 offset:32768
  v_mfma_f32_16x16x32_bf16 v[108:111], v[220:223], v[164:167], v[108:111]
  ds_read_b128 v[208:211], v239 offset:33792
  v_mfma_f32_16x16x32_bf16 v[112:115], v[224:227], v[164:167], v[112:115]
  ds_read_b128 v[212:215], v239 offset:34816
  v_mfma_f32_16x16x32_bf16 v[116:119], v[220:223], v[168:171], v[116:119]
  ds_read_b128 v[216:219], v239 offset:35840
  v_mfma_f32_16x16x32_bf16 v[120:123], v[224:227], v[168:171], v[120:123]
  v_mfma_f32_16x16x32_bf16 v[124:127], v[220:223], v[172:175], v[124:127]
  v_mfma_f32_16x16x32_bf16 v[128:131], v[224:227], v[172:175], v[128:131]
  v_mfma_f32_16x16x32_bf16 v[132:135], v[220:223], v[176:179], v[132:135]
  v_mfma_f32_16x16x32_bf16 v[136:139], v[224:227], v[176:179], v[136:139]
  v_mfma_f32_16x16x32_bf16 v[140:143], v[220:223], v[180:183], v[140:143]
  v_mfma_f32_16x16x32_bf16 v[144:147], v[224:227], v[180:183], v[144:147]
  s_waitcnt lgkmcnt(0)
  s_barrier
  v_mfma_f32_16x16x32_bf16 v[76:79], v[228:231], v[184:187], v[76:79]
  ds_read_b128 v[220:223], v244 offset:0
  v_mfma_f32_16x16x32_bf16 v[80:83], v[232:235], v[184:187], v[80:83]
  ds_read_b128 v[224:227], v244 offset:2048
  v_mfma_f32_16x16x32_bf16 v[84:87], v[228:231], v[188:191], v[84:87]
  ds_read_b128 v[148:151], v238 offset:0
  v_mfma_f32_16x16x32_bf16 v[88:91], v[232:235], v[188:191], v[88:91]
  ds_read_b128 v[152:155], v238 offset:1024
  v_mfma_f32_16x16x32_bf16 v[92:95], v[228:231], v[192:195], v[92:95]
  ds_read_b128 v[156:159], v238 offset:2048
  v_mfma_f32_16x16x32_bf16 v[96:99], v[232:235], v[192:195], v[96:99]
  ds_read_b128 v[160:163], v238 offset:3072
  v_mfma_f32_16x16x32_bf16 v[100:103], v[228:231], v[196:199], v[100:103]
  ds_read_b128 v[164:167], v238 offset:4096
  v_mfma_f32_16x16x32_bf16 v[104:107], v[232:235], v[196:199], v[104:107]
  ds_read_b128 v[168:171], v238 offset:5120
  v_mfma_f32_16x16x32_bf16 v[108:111], v[228:231], v[200:203], v[108:111]
  ds_read_b128 v[172:175], v238 offset:6144
  v_mfma_f32_16x16x32_bf16 v[112:115], v[232:235], v[200:203], v[112:115]
  ds_read_b128 v[176:179], v238 offset:7168
  v_mfma_f32_16x16x32_bf16 v[116:119], v[228:231], v[204:207], v[116:119]
  ds_read_b128 v[180:183], v238 offset:8192
  v_mfma_f32_16x16x32_bf16 v[120:123], v[232:235], v[204:207], v[120:123]
  v_mfma_f32_16x16x32_bf16 v[124:127], v[228:231], v[208:211], v[124:127]
  v_mfma_f32_16x16x32_bf16 v[128:131], v[232:235], v[208:211], v[128:131]
  v_mfma_f32_16x16x32_bf16 v[132:135], v[228:231], v[212:215], v[132:135]
  v_mfma_f32_16x16x32_bf16 v[136:139], v[232:235], v[212:215], v[136:139]
  v_mfma_f32_16x16x32_bf16 v[140:143], v[228:231], v[216:219], v[140:143]
  v_mfma_f32_16x16x32_bf16 v[144:147], v[232:235], v[216:219], v[144:147]
  s_waitcnt lgkmcnt(0)
  v_mfma_f32_16x16x32_bf16 v[76:79], v[220:223], v[148:151], v[76:79]
  ds_read_b128 v[228:231], v244 offset:1024
  v_mfma_f32_16x16x32_bf16 v[80:83], v[224:227], v[148:151], v[80:83]
  ds_read_b128 v[232:235], v244 offset:3072
  v_mfma_f32_16x16x32_bf16 v[84:87], v[220:223], v[152:155], v[84:87]
  ds_read_b128 v[184:187], v238 offset:9216
  v_mfma_f32_16x16x32_bf16 v[88:91], v[224:227], v[152:155], v[88:91]
  ds_read_b128 v[188:191], v238 offset:10240
  v_mfma_f32_16x16x32_bf16 v[92:95], v[220:223], v[156:159], v[92:95]
  ds_read_b128 v[192:195], v238 offset:11264
  v_mfma_f32_16x16x32_bf16 v[96:99], v[224:227], v[156:159], v[96:99]
  ds_read_b128 v[196:199], v238 offset:12288
  v_mfma_f32_16x16x32_bf16 v[100:103], v[220:223], v[160:163], v[100:103]
  ds_read_b128 v[200:203], v238 offset:13312
  v_mfma_f32_16x16x32_bf16 v[104:107], v[224:227], v[160:163], v[104:107]
  ds_read_b128 v[204:207], v238 offset:14336
  v_mfma_f32_16x16x32_bf16 v[108:111], v[220:223], v[164:167], v[108:111]
  ds_read_b128 v[208:211], v238 offset:15360
  v_mfma_f32_16x16x32_bf16 v[112:115], v[224:227], v[164:167], v[112:115]
  ds_read_b128 v[212:215], v238 offset:16384
  v_mfma_f32_16x16x32_bf16 v[116:119], v[220:223], v[168:171], v[116:119]
  ds_read_b128 v[216:219], v238 offset:17408
  v_mfma_f32_16x16x32_bf16 v[120:123], v[224:227], v[168:171], v[120:123]
  v_mfma_f32_16x16x32_bf16 v[124:127], v[220:223], v[172:175], v[124:127]
  v_mfma_f32_16x16x32_bf16 v[128:131], v[224:227], v[172:175], v[128:131]
  v_mfma_f32_16x16x32_bf16 v[132:135], v[220:223], v[176:179], v[132:135]
  v_mfma_f32_16x16x32_bf16 v[136:139], v[224:227], v[176:179], v[136:139]
  v_mfma_f32_16x16x32_bf16 v[140:143], v[220:223], v[180:183], v[140:143]
  v_mfma_f32_16x16x32_bf16 v[144:147], v[224:227], v[180:183], v[144:147]
  s_waitcnt lgkmcnt(0)
  s_barrier
  v_mfma_f32_16x16x32_bf16 v[76:79], v[228:231], v[184:187], v[76:79]
  ds_read_b128 v[220:223], v236 offset:16384
  v_mfma_f32_16x16x32_bf16 v[80:83], v[232:235], v[184:187], v[80:83]
  ds_read_b128 v[224:227], v236 offset:18432
  v_mfma_f32_16x16x32_bf16 v[84:87], v[228:231], v[188:191], v[84:87]
  ds_read_b128 v[148:151], v238 offset:18432
  v_mfma_f32_16x16x32_bf16 v[88:91], v[232:235], v[188:191], v[88:91]
  ds_read_b128 v[152:155], v238 offset:19456
  v_mfma_f32_16x16x32_bf16 v[92:95], v[228:231], v[192:195], v[92:95]
  ds_read_b128 v[156:159], v238 offset:20480
  v_mfma_f32_16x16x32_bf16 v[96:99], v[232:235], v[192:195], v[96:99]
  ds_read_b128 v[160:163], v238 offset:21504
  v_mfma_f32_16x16x32_bf16 v[100:103], v[228:231], v[196:199], v[100:103]
  ds_read_b128 v[164:167], v238 offset:22528
  v_mfma_f32_16x16x32_bf16 v[104:107], v[232:235], v[196:199], v[104:107]
  ds_read_b128 v[168:171], v238 offset:23552
  v_mfma_f32_16x16x32_bf16 v[108:111], v[228:231], v[200:203], v[108:111]
  ds_read_b128 v[172:175], v238 offset:24576
  v_mfma_f32_16x16x32_bf16 v[112:115], v[232:235], v[200:203], v[112:115]
  ds_read_b128 v[176:179], v238 offset:25600
  v_mfma_f32_16x16x32_bf16 v[116:119], v[228:231], v[204:207], v[116:119]
  ds_read_b128 v[180:183], v238 offset:26624
  v_mfma_f32_16x16x32_bf16 v[120:123], v[232:235], v[204:207], v[120:123]
  v_mfma_f32_16x16x32_bf16 v[124:127], v[228:231], v[208:211], v[124:127]
  v_mfma_f32_16x16x32_bf16 v[128:131], v[232:235], v[208:211], v[128:131]
  v_mfma_f32_16x16x32_bf16 v[132:135], v[228:231], v[212:215], v[132:135]
  v_mfma_f32_16x16x32_bf16 v[136:139], v[232:235], v[212:215], v[136:139]
  v_mfma_f32_16x16x32_bf16 v[140:143], v[228:231], v[216:219], v[140:143]
  v_mfma_f32_16x16x32_bf16 v[144:147], v[232:235], v[216:219], v[144:147]
  s_waitcnt lgkmcnt(0)
  v_mfma_f32_16x16x32_bf16 v[76:79], v[220:223], v[148:151], v[76:79]
  ds_read_b128 v[228:231], v237 offset:16384
  v_mfma_f32_16x16x32_bf16 v[80:83], v[224:227], v[148:151], v[80:83]
  ds_read_b128 v[232:235], v237 offset:18432
  v_mfma_f32_16x16x32_bf16 v[84:87], v[220:223], v[152:155], v[84:87]
  ds_read_b128 v[184:187], v238 offset:27648
  v_mfma_f32_16x16x32_bf16 v[88:91], v[224:227], v[152:155], v[88:91]
  ds_read_b128 v[188:191], v238 offset:28672
  v_mfma_f32_16x16x32_bf16 v[92:95], v[220:223], v[156:159], v[92:95]
  ds_read_b128 v[192:195], v238 offset:29696
  v_mfma_f32_16x16x32_bf16 v[96:99], v[224:227], v[156:159], v[96:99]
  ds_read_b128 v[196:199], v238 offset:30720
  v_mfma_f32_16x16x32_bf16 v[100:103], v[220:223], v[160:163], v[100:103]
  ds_read_b128 v[200:203], v238 offset:31744
  v_mfma_f32_16x16x32_bf16 v[104:107], v[224:227], v[160:163], v[104:107]
  ds_read_b128 v[204:207], v238 offset:32768
  v_mfma_f32_16x16x32_bf16 v[108:111], v[220:223], v[164:167], v[108:111]
  ds_read_b128 v[208:211], v238 offset:33792
  v_mfma_f32_16x16x32_bf16 v[112:115], v[224:227], v[164:167], v[112:115]
  ds_read_b128 v[212:215], v238 offset:34816
  v_mfma_f32_16x16x32_bf16 v[116:119], v[220:223], v[168:171], v[116:119]
  ds_read_b128 v[216:219], v238 offset:35840
  v_mfma_f32_16x16x32_bf16 v[120:123], v[224:227], v[168:171], v[120:123]
  v_mfma_f32_16x16x32_bf16 v[124:127], v[220:223], v[172:175], v[124:127]
  v_mfma_f32_16x16x32_bf16 v[128:131], v[224:227], v[172:175], v[128:131]
  v_mfma_f32_16x16x32_bf16 v[132:135], v[220:223], v[176:179], v[132:135]
  v_mfma_f32_16x16x32_bf16 v[136:139], v[224:227], v[176:179], v[136:139]
  v_mfma_f32_16x16x32_bf16 v[140:143], v[220:223], v[180:183], v[140:143]
  v_mfma_f32_16x16x32_bf16 v[144:147], v[224:227], v[180:183], v[144:147]
  s_waitcnt lgkmcnt(0)
  s_barrier
  v_mfma_f32_16x16x32_bf16 v[76:79], v[228:231], v[184:187], v[76:79]
  ds_read_b128 v[220:223], v236 offset:32768
  v_mfma_f32_16x16x32_bf16 v[80:83], v[232:235], v[184:187], v[80:83]
  ds_read_b128 v[224:227], v236 offset:34816
  v_mfma_f32_16x16x32_bf16 v[84:87], v[228:231], v[188:191], v[84:87]
  ds_read_b128 v[148:151], v239 offset:0
  v_mfma_f32_16x16x32_bf16 v[88:91], v[232:235], v[188:191], v[88:91]
  ds_read_b128 v[152:155], v239 offset:1024
  v_mfma_f32_16x16x32_bf16 v[92:95], v[228:231], v[192:195], v[92:95]
  ds_read_b128 v[156:159], v239 offset:2048
  v_mfma_f32_16x16x32_bf16 v[96:99], v[232:235], v[192:195], v[96:99]
  ds_read_b128 v[160:163], v239 offset:3072
  v_mfma_f32_16x16x32_bf16 v[100:103], v[228:231], v[196:199], v[100:103]
  ds_read_b128 v[164:167], v239 offset:4096
  v_mfma_f32_16x16x32_bf16 v[104:107], v[232:235], v[196:199], v[104:107]
  ds_read_b128 v[168:171], v239 offset:5120
  v_mfma_f32_16x16x32_bf16 v[108:111], v[228:231], v[200:203], v[108:111]
  ds_read_b128 v[172:175], v239 offset:6144
  v_mfma_f32_16x16x32_bf16 v[112:115], v[232:235], v[200:203], v[112:115]
  ds_read_b128 v[176:179], v239 offset:7168
  v_mfma_f32_16x16x32_bf16 v[116:119], v[228:231], v[204:207], v[116:119]
  ds_read_b128 v[180:183], v239 offset:8192
  v_mfma_f32_16x16x32_bf16 v[120:123], v[232:235], v[204:207], v[120:123]
  v_mfma_f32_16x16x32_bf16 v[124:127], v[228:231], v[208:211], v[124:127]
  v_mfma_f32_16x16x32_bf16 v[128:131], v[232:235], v[208:211], v[128:131]
  v_mfma_f32_16x16x32_bf16 v[132:135], v[228:231], v[212:215], v[132:135]
  v_mfma_f32_16x16x32_bf16 v[136:139], v[232:235], v[212:215], v[136:139]
  v_mfma_f32_16x16x32_bf16 v[140:143], v[228:231], v[216:219], v[140:143]
  v_mfma_f32_16x16x32_bf16 v[144:147], v[232:235], v[216:219], v[144:147]
  s_waitcnt lgkmcnt(0)
  v_mfma_f32_16x16x32_bf16 v[76:79], v[220:223], v[148:151], v[76:79]
  ds_read_b128 v[228:231], v237 offset:32768
  v_mfma_f32_16x16x32_bf16 v[80:83], v[224:227], v[148:151], v[80:83]
  ds_read_b128 v[232:235], v237 offset:34816
  v_mfma_f32_16x16x32_bf16 v[84:87], v[220:223], v[152:155], v[84:87]
  ds_read_b128 v[184:187], v239 offset:9216
  v_mfma_f32_16x16x32_bf16 v[88:91], v[224:227], v[152:155], v[88:91]
  ds_read_b128 v[188:191], v239 offset:10240
  v_mfma_f32_16x16x32_bf16 v[92:95], v[220:223], v[156:159], v[92:95]
  ds_read_b128 v[192:195], v239 offset:11264
  v_mfma_f32_16x16x32_bf16 v[96:99], v[224:227], v[156:159], v[96:99]
  ds_read_b128 v[196:199], v239 offset:12288
  v_mfma_f32_16x16x32_bf16 v[100:103], v[220:223], v[160:163], v[100:103]
  ds_read_b128 v[200:203], v239 offset:13312
  v_mfma_f32_16x16x32_bf16 v[104:107], v[224:227], v[160:163], v[104:107]
  ds_read_b128 v[204:207], v239 offset:14336
  v_mfma_f32_16x16x32_bf16 v[108:111], v[220:223], v[164:167], v[108:111]
  ds_read_b128 v[208:211], v239 offset:15360
  v_mfma_f32_16x16x32_bf16 v[112:115], v[224:227], v[164:167], v[112:115]
  ds_read_b128 v[212:215], v239 offset:16384
  v_mfma_f32_16x16x32_bf16 v[116:119], v[220:223], v[168:171], v[116:119]
  ds_read_b128 v[216:219], v239 offset:17408
  v_mfma_f32_16x16x32_bf16 v[120:123], v[224:227], v[168:171], v[120:123]
  v_mfma_f32_16x16x32_bf16 v[124:127], v[220:223], v[172:175], v[124:127]
  v_mfma_f32_16x16x32_bf16 v[128:131], v[224:227], v[172:175], v[128:131]
  v_mfma_f32_16x16x32_bf16 v[132:135], v[220:223], v[176:179], v[132:135]
  v_mfma_f32_16x16x32_bf16 v[136:139], v[224:227], v[176:179], v[136:139]
  v_mfma_f32_16x16x32_bf16 v[140:143], v[220:223], v[180:183], v[140:143]
  v_mfma_f32_16x16x32_bf16 v[144:147], v[224:227], v[180:183], v[144:147]
  s_waitcnt lgkmcnt(0)
  s_barrier
  v_mfma_f32_16x16x32_bf16 v[76:79], v[228:231], v[184:187], v[76:79]
  ds_read_b128 v[220:223], v236 offset:49152
  v_mfma_f32_16x16x32_bf16 v[80:83], v[232:235], v[184:187], v[80:83]
  ds_read_b128 v[224:227], v236 offset:51200
  v_mfma_f32_16x16x32_bf16 v[84:87], v[228:231], v[188:191], v[84:87]
  ds_read_b128 v[148:151], v239 offset:18432
  v_mfma_f32_16x16x32_bf16 v[88:91], v[232:235], v[188:191], v[88:91]
  ds_read_b128 v[152:155], v239 offset:19456
  v_mfma_f32_16x16x32_bf16 v[92:95], v[228:231], v[192:195], v[92:95]
  ds_read_b128 v[156:159], v239 offset:20480
  v_mfma_f32_16x16x32_bf16 v[96:99], v[232:235], v[192:195], v[96:99]
  ds_read_b128 v[160:163], v239 offset:21504
  v_mfma_f32_16x16x32_bf16 v[100:103], v[228:231], v[196:199], v[100:103]
  ds_read_b128 v[164:167], v239 offset:22528
  v_mfma_f32_16x16x32_bf16 v[104:107], v[232:235], v[196:199], v[104:107]
  ds_read_b128 v[168:171], v239 offset:23552
  v_mfma_f32_16x16x32_bf16 v[108:111], v[228:231], v[200:203], v[108:111]
  ds_read_b128 v[172:175], v239 offset:24576
  v_mfma_f32_16x16x32_bf16 v[112:115], v[232:235], v[200:203], v[112:115]
  ds_read_b128 v[176:179], v239 offset:25600
  v_mfma_f32_16x16x32_bf16 v[116:119], v[228:231], v[204:207], v[116:119]
  ds_read_b128 v[180:183], v239 offset:26624
  v_mfma_f32_16x16x32_bf16 v[120:123], v[232:235], v[204:207], v[120:123]
  v_mfma_f32_16x16x32_bf16 v[124:127], v[228:231], v[208:211], v[124:127]
  v_mfma_f32_16x16x32_bf16 v[128:131], v[232:235], v[208:211], v[128:131]
  v_mfma_f32_16x16x32_bf16 v[132:135], v[228:231], v[212:215], v[132:135]
  v_mfma_f32_16x16x32_bf16 v[136:139], v[232:235], v[212:215], v[136:139]
  v_mfma_f32_16x16x32_bf16 v[140:143], v[228:231], v[216:219], v[140:143]
  v_mfma_f32_16x16x32_bf16 v[144:147], v[232:235], v[216:219], v[144:147]
  s_waitcnt lgkmcnt(0)
  v_mfma_f32_16x16x32_bf16 v[76:79], v[220:223], v[148:151], v[76:79]
  ds_read_b128 v[228:231], v237 offset:49152
  v_mfma_f32_16x16x32_bf16 v[80:83], v[224:227], v[148:151], v[80:83]
  ds_read_b128 v[232:235], v237 offset:51200
  v_mfma_f32_16x16x32_bf16 v[84:87], v[220:223], v[152:155], v[84:87]
  ds_read_b128 v[184:187], v239 offset:27648
  v_mfma_f32_16x16x32_bf16 v[88:91], v[224:227], v[152:155], v[88:91]
  ds_read_b128 v[188:191], v239 offset:28672
  v_mfma_f32_16x16x32_bf16 v[92:95], v[220:223], v[156:159], v[92:95]
  ds_read_b128 v[192:195], v239 offset:29696
  v_mfma_f32_16x16x32_bf16 v[96:99], v[224:227], v[156:159], v[96:99]
  ds_read_b128 v[196:199], v239 offset:30720
  v_mfma_f32_16x16x32_bf16 v[100:103], v[220:223], v[160:163], v[100:103]
  ds_read_b128 v[200:203], v239 offset:31744
  v_mfma_f32_16x16x32_bf16 v[104:107], v[224:227], v[160:163], v[104:107]
  ds_read_b128 v[204:207], v239 offset:32768
  v_mfma_f32_16x16x32_bf16 v[108:111], v[220:223], v[164:167], v[108:111]
  ds_read_b128 v[208:211], v239 offset:33792
  v_mfma_f32_16x16x32_bf16 v[112:115], v[224:227], v[164:167], v[112:115]
  ds_read_b128 v[212:215], v239 offset:34816
  v_mfma_f32_16x16x32_bf16 v[116:119], v[220:223], v[168:171], v[116:119]
  ds_read_b128 v[216:219], v239 offset:35840
  v_mfma_f32_16x16x32_bf16 v[120:123], v[224:227], v[168:171], v[120:123]
  v_mfma_f32_16x16x32_bf16 v[124:127], v[220:223], v[172:175], v[124:127]
  v_mfma_f32_16x16x32_bf16 v[128:131], v[224:227], v[172:175], v[128:131]
  v_mfma_f32_16x16x32_bf16 v[132:135], v[220:223], v[176:179], v[132:135]
  v_mfma_f32_16x16x32_bf16 v[136:139], v[224:227], v[176:179], v[136:139]
  v_mfma_f32_16x16x32_bf16 v[140:143], v[220:223], v[180:183], v[140:143]
  v_mfma_f32_16x16x32_bf16 v[144:147], v[224:227], v[180:183], v[144:147]
  s_waitcnt lgkmcnt(0)
  s_barrier
  v_mfma_f32_16x16x32_bf16 v[76:79], v[228:231], v[184:187], v[76:79]
  ds_read_b128 v[220:223], v236 offset:0
  v_mfma_f32_16x16x32_bf16 v[80:83], v[232:235], v[184:187], v[80:83]
  ds_read_b128 v[224:227], v236 offset:2048
  v_mfma_f32_16x16x32_bf16 v[84:87], v[228:231], v[188:191], v[84:87]
  ds_read_b128 v[148:151], v238 offset:0
  v_mfma_f32_16x16x32_bf16 v[88:91], v[232:235], v[188:191], v[88:91]
  ds_read_b128 v[152:155], v238 offset:1024
  v_mfma_f32_16x16x32_bf16 v[92:95], v[228:231], v[192:195], v[92:95]
  ds_read_b128 v[156:159], v238 offset:2048
  v_mfma_f32_16x16x32_bf16 v[96:99], v[232:235], v[192:195], v[96:99]
  ds_read_b128 v[160:163], v238 offset:3072
  v_mfma_f32_16x16x32_bf16 v[100:103], v[228:231], v[196:199], v[100:103]
  ds_read_b128 v[164:167], v238 offset:4096
  v_mfma_f32_16x16x32_bf16 v[104:107], v[232:235], v[196:199], v[104:107]
  ds_read_b128 v[168:171], v238 offset:5120
  v_mfma_f32_16x16x32_bf16 v[108:111], v[228:231], v[200:203], v[108:111]
  ds_read_b128 v[172:175], v238 offset:6144
  v_mfma_f32_16x16x32_bf16 v[112:115], v[232:235], v[200:203], v[112:115]
  ds_read_b128 v[176:179], v238 offset:7168
  v_mfma_f32_16x16x32_bf16 v[116:119], v[228:231], v[204:207], v[116:119]
  ds_read_b128 v[180:183], v238 offset:8192
  v_mfma_f32_16x16x32_bf16 v[120:123], v[232:235], v[204:207], v[120:123]
  ds_read_b128 v[28:31], v66 offset:0
  v_mfma_f32_16x16x32_bf16 v[124:127], v[228:231], v[208:211], v[124:127]
  ds_read_b128 v[36:39], v66 offset:512
  v_mfma_f32_16x16x32_bf16 v[128:131], v[232:235], v[208:211], v[128:131]
  ds_read_b128 v[32:35], v66 offset:16
  v_mfma_f32_16x16x32_bf16 v[132:135], v[228:231], v[212:215], v[132:135]
  ds_read_b128 v[40:43], v66 offset:528
  v_mfma_f32_16x16x32_bf16 v[136:139], v[232:235], v[212:215], v[136:139]
  ds_read_b32 v44, v67 offset:0
  v_mfma_f32_16x16x32_bf16 v[140:143], v[228:231], v[216:219], v[140:143]
  ds_read_b32 v54, v67 offset:576
  v_mfma_f32_16x16x32_bf16 v[144:147], v[232:235], v[216:219], v[144:147]
  ds_read_b32 v45, v67 offset:64
  s_waitcnt lgkmcnt(0)
  v_mfma_f32_16x16x32_bf16 v[76:79], v[220:223], v[148:151], v[76:79]
  ds_read_b128 v[228:231], v237 offset:0
  v_mfma_f32_16x16x32_bf16 v[80:83], v[224:227], v[148:151], v[80:83]
  ds_read_b128 v[232:235], v237 offset:2048
  v_mfma_f32_16x16x32_bf16 v[84:87], v[220:223], v[152:155], v[84:87]
  ds_read_b128 v[184:187], v238 offset:9216
  v_mfma_f32_16x16x32_bf16 v[88:91], v[224:227], v[152:155], v[88:91]
  ds_read_b128 v[188:191], v238 offset:10240
  v_mfma_f32_16x16x32_bf16 v[92:95], v[220:223], v[156:159], v[92:95]
  ds_read_b128 v[192:195], v238 offset:11264
  v_mfma_f32_16x16x32_bf16 v[96:99], v[224:227], v[156:159], v[96:99]
  ds_read_b128 v[196:199], v238 offset:12288
  v_mfma_f32_16x16x32_bf16 v[100:103], v[220:223], v[160:163], v[100:103]
  ds_read_b128 v[200:203], v238 offset:13312
  v_mfma_f32_16x16x32_bf16 v[104:107], v[224:227], v[160:163], v[104:107]
  ds_read_b128 v[204:207], v238 offset:14336
  v_mfma_f32_16x16x32_bf16 v[108:111], v[220:223], v[164:167], v[108:111]
  ds_read_b128 v[208:211], v238 offset:15360
  v_mfma_f32_16x16x32_bf16 v[112:115], v[224:227], v[164:167], v[112:115]
  ds_read_b128 v[212:215], v238 offset:16384
  v_mfma_f32_16x16x32_bf16 v[116:119], v[220:223], v[168:171], v[116:119]
  ds_read_b128 v[216:219], v238 offset:17408
  v_mfma_f32_16x16x32_bf16 v[120:123], v[224:227], v[168:171], v[120:123]
  ds_read_b32 v55, v67 offset:640
  v_mfma_f32_16x16x32_bf16 v[124:127], v[220:223], v[172:175], v[124:127]
  ds_read_b32 v46, v67 offset:128
  v_mfma_f32_16x16x32_bf16 v[128:131], v[224:227], v[172:175], v[128:131]
  ds_read_b32 v56, v67 offset:704
  v_mfma_f32_16x16x32_bf16 v[132:135], v[220:223], v[176:179], v[132:135]
  ds_read_b32 v47, v67 offset:192
  v_mfma_f32_16x16x32_bf16 v[136:139], v[224:227], v[176:179], v[136:139]
  ds_read_b32 v57, v67 offset:768
  v_mfma_f32_16x16x32_bf16 v[140:143], v[220:223], v[180:183], v[140:143]
  ds_read_b32 v48, v67 offset:256
  v_mfma_f32_16x16x32_bf16 v[144:147], v[224:227], v[180:183], v[144:147]
  ds_read_b32 v58, v67 offset:832
  s_waitcnt lgkmcnt(0)
  s_barrier
  v_mfma_f32_16x16x32_bf16 v[76:79], v[228:231], v[184:187], v[76:79]
  ds_read_b128 v[220:223], v236 offset:16384
  ds_read_b128 v[224:227], v236 offset:18432
  v_mfma_f32_16x16x32_bf16 v[80:83], v[232:235], v[184:187], v[80:83]
  ds_read_b128 v[148:151], v238 offset:18432
  v_mfma_f32_16x16x32_bf16 v[84:87], v[228:231], v[188:191], v[84:87]
  ds_read_b128 v[152:155], v238 offset:19456
  v_mfma_f32_16x16x32_bf16 v[88:91], v[232:235], v[188:191], v[88:91]
  ds_read_b128 v[156:159], v238 offset:20480
  v_mfma_f32_16x16x32_bf16 v[92:95], v[228:231], v[192:195], v[92:95]
  ds_read_b128 v[160:163], v238 offset:21504
  v_mfma_f32_16x16x32_bf16 v[96:99], v[232:235], v[192:195], v[96:99]
  ds_read_b128 v[164:167], v238 offset:22528
  v_mfma_f32_16x16x32_bf16 v[100:103], v[228:231], v[196:199], v[100:103]
  ds_read_b128 v[168:171], v238 offset:23552
  v_mfma_f32_16x16x32_bf16 v[104:107], v[232:235], v[196:199], v[104:107]
  ds_read_b128 v[172:175], v238 offset:24576
  v_mfma_f32_16x16x32_bf16 v[108:111], v[228:231], v[200:203], v[108:111]
  ds_read_b128 v[176:179], v238 offset:25600
  v_mfma_f32_16x16x32_bf16 v[112:115], v[232:235], v[200:203], v[112:115]
  ds_read_b128 v[180:183], v238 offset:26624
  v_mfma_f32_16x16x32_bf16 v[116:119], v[228:231], v[204:207], v[116:119]
  ds_read_b32 v49, v67 offset:320
  v_mfma_f32_16x16x32_bf16 v[120:123], v[232:235], v[204:207], v[120:123]
  ds_read_b32 v59, v67 offset:896
  v_mfma_f32_16x16x32_bf16 v[124:127], v[228:231], v[208:211], v[124:127]
  ds_read_b32 v50, v67 offset:384
  v_mfma_f32_16x16x32_bf16 v[128:131], v[232:235], v[208:211], v[128:131]
  ds_read_b32 v60, v67 offset:960
  v_mfma_f32_16x16x32_bf16 v[132:135], v[228:231], v[212:215], v[132:135]
  ds_read_b32 v51, v67 offset:448
  v_mfma_f32_16x16x32_bf16 v[136:139], v[232:235], v[212:215], v[136:139]
  ds_read_b32 v61, v67 offset:1024
  v_mfma_f32_16x16x32_bf16 v[140:143], v[228:231], v[216:219], v[140:143]
  ds_read_b32 v52, v67 offset:512
  v_mfma_f32_16x16x32_bf16 v[144:147], v[232:235], v[216:219], v[144:147]
  ds_read_b32 v62, v67 offset:1088
L_c_geluz:
  s_nop 7
  s_waitcnt lgkmcnt(0)
  v_pk_fma_f32 v[4:5], v[44:45], v[36:37], v[54:55] op_sel:[0,0,0] op_sel_hi:[0,1,0]
  v_pk_fma_f32 v[6:7], v[44:45], v[38:39], v[54:55] op_sel:[0,0,0] op_sel_hi:[0,1,0]
  v_pk_fma_f32 v[8:9], v[44:45], v[40:41], v[54:55] op_sel:[0,0,0] op_sel_hi:[0,1,0]
  v_pk_fma_f32 v[10:11], v[44:45], v[42:43], v[54:55] op_sel:[0,0,0] op_sel_hi:[0,1,0]
  v_pk_fma_f32 v[76:77], v[76:77], v[28:29], v[4:5]
  v_pk_fma_f32 v[78:79], v[78:79], v[30:31], v[6:7]
  v_pk_fma_f32 v[80:81], v[80:81], v[32:33], v[8:9]
  v_pk_fma_f32 v[82:83], v[82:83], v[34:35], v[10:11]
  v_pk_mul_f32 v[4:5], v[76:77], v[76:77]
  v_pk_mul_f32 v[6:7], v[78:79], v[78:79]
  v_pk_mul_f32 v[8:9], v[80:81], v[80:81]
  v_pk_mul_f32 v[10:11], v[82:83], v[82:83]
  v_pk_fma_f32 v[4:5], v[4:5], s[28:29], v[64:65]
  v_pk_fma_f32 v[6:7], v[6:7], s[28:29], v[64:65]
  v_pk_fma_f32 v[8:9], v[8:9], s[28:29], v[64:65]
  v_pk_fma_f32 v[10:11], v[10:11], s[28:29], v[64:65]
  v_pk_mul_f32 v[4:5], v[4:5], v[76:77]
  v_pk_mul_f32 v[6:7], v[6:7], v[78:79]
  v_pk_mul_f32 v[8:9], v[8:9], v[80:81]
  v_pk_mul_f32 v[10:11], v[10:11], v[82:83]
  v_exp_f32 v4, v4
  v_exp_f32 v5, v5
  v_exp_f32 v6, v6
  v_exp_f32 v7, v7
  v_exp_f32 v8, v8
  v_exp_f32 v9, v9
  v_exp_f32 v10, v10
  v_exp_f32 v11, v11
  v_pk_add_f32 v[4:5], v[4:5], s[30:31]
  v_pk_add_f32 v[6:7], v[6:7], s[30:31]
  v_pk_add_f32 v[8:9], v[8:9], s[30:31]
  v_pk_add_f32 v[10:11], v[10:11], s[30:31]
  v_rcp_f32 v4, v4
  v_rcp_f32 v5, v5
  v_rcp_f32 v6, v6
  v_rcp_f32 v7, v7
  v_rcp_f32 v8, v8
  v_rcp_f32 v9, v9
  v_rcp_f32 v10, v10
  v_rcp_f32 v11, v11
  v_pk_mul_f32 v[76:77], v[76:77], v[4:5]
  v_pk_mul_f32 v[78:79], v[78:79], v[6:7]
  v_pk_mul_f32 v[80:81], v[80:81], v[8:9]
  v_pk_mul_f32 v[82:83], v[82:83], v[10:11]
  v_pk_mul_f32 v[20:21], v[76:77], v[76:77]
  v_pk_mul_f32 v[12:13], v[76:77], s[30:31]
  v_pk_mul_f32 v[22:23], v[78:79], v[78:79]
  v_pk_mul_f32 v[14:15], v[78:79], s[30:31]
  v_pk_mul_f32 v[24:25], v[80:81], v[80:81]
  v_pk_mul_f32 v[16:17], v[80:81], s[30:31]
  v_pk_mul_f32 v[26:27], v[82:83], v[82:83]
  v_pk_mul_f32 v[18:19], v[82:83], s[30:31]
  v_cvt_pk_bf16_f32 v76, v76, v77
  v_cvt_pk_bf16_f32 v77, v78, v79
  v_cvt_pk_bf16_f32 v78, v80, v81
  v_cvt_pk_bf16_f32 v79, v82, v83
  v_pk_fma_f32 v[4:5], v[44:45], v[36:37], v[54:55] op_sel:[1,0,1] op_sel_hi:[1,1,1]
  v_pk_fma_f32 v[6:7], v[44:45], v[38:39], v[54:55] op_sel:[1,0,1] op_sel_hi:[1,1,1]
  v_pk_fma_f32 v[8:9], v[44:45], v[40:41], v[54:55] op_sel:[1,0,1] op_sel_hi:[1,1,1]
  v_pk_fma_f32 v[10:11], v[44:45], v[42:43], v[54:55] op_sel:[1,0,1] op_sel_hi:[1,1,1]
  v_pk_fma_f32 v[84:85], v[84:85], v[28:29], v[4:5]
  v_pk_fma_f32 v[86:87], v[86:87], v[30:31], v[6:7]
  v_pk_fma_f32 v[88:89], v[88:89], v[32:33], v[8:9]
  v_pk_fma_f32 v[90:91], v[90:91], v[34:35], v[10:11]
  v_pk_mul_f32 v[4:5], v[84:85], v[84:85]
  v_pk_mul_f32 v[6:7], v[86:87], v[86:87]
  v_pk_mul_f32 v[8:9], v[88:89], v[88:89]
  v_pk_mul_f32 v[10:11], v[90:91], v[90:91]
  v_pk_fma_f32 v[4:5], v[4:5], s[28:29], v[64:65]
  v_pk_fma_f32 v[6:7], v[6:7], s[28:29], v[64:65]
  v_pk_fma_f32 v[8:9], v[8:9], s[28:29], v[64:65]
  v_pk_fma_f32 v[10:11], v[10:11], s[28:29], v[64:65]
  v_pk_mul_f32 v[4:5], v[4:5], v[84:85]
  v_pk_mul_f32 v[6:7], v[6:7], v[86:87]
  v_pk_mul_f32 v[8:9], v[8:9], v[88:89]
  v_pk_mul_f32 v[10:11], v[10:11], v[90:91]
  v_exp_f32 v4, v4
  v_exp_f32 v5, v5
  v_exp_f32 v6, v6
  v_exp_f32 v7, v7
  v_exp_f32 v8, v8
  v_exp_f32 v9, v9
  v_exp_f32 v10, v10
  v_exp_f32 v11, v11
  v_pk_add_f32 v[4:5], v[4:5], s[30:31]
  v_pk_add_f32 v[6:7], v[6:7], s[30:31]
  v_pk_add_f32 v[8:9], v[8:9], s[30:31]
  v_pk_add_f32 v[10:11], v[10:11], s[30:31]
  v_rcp_f32 v4, v4
  v_rcp_f32 v5, v5
  v_rcp_f32 v6, v6
  v_rcp_f32 v7, v7
  v_rcp_f32 v8, v8
  v_rcp_f32 v9, v9
  v_rcp_f32 v10, v10
  v_rcp_f32 v11, v11
  v_pk_mul_f32 v[84:85], v[84:85], v[4:5]
  v_pk_mul_f32 v[86:87], v[86:87], v[6:7]
  v_pk_mul_f32 v[88:89], v[88:89], v[8:9]
  v_pk_mul_f32 v[90:91], v[90:91], v[10:11]
  v_pk_add_f32 v[12:13], v[12:13], v[84:85]
  v_pk_fma_f32 v[20:21], v[84:85], v[84:85], v[20:21]
  v_pk_add_f32 v[14:15], v[14:15], v[86:87]
  v_pk_fma_f32 v[22:23], v[86:87], v[86:87], v[22:23]
  v_pk_add_f32 v[16:17], v[16:17], v[88:89]
  v_pk_fma_f32 v[24:25], v[88:89], v[88:89], v[24:25]
  v_pk_add_f32 v[18:19], v[18:19], v[90:91]
  v_pk_fma_f32 v[26:27], v[90:91], v[90:91], v[26:27]
  v_cvt_pk_bf16_f32 v80, v84, v85
  v_cvt_pk_bf16_f32 v81, v86, v87
  v_cvt_pk_bf16_f32 v82, v88, v89
  v_cvt_pk_bf16_f32 v83, v90, v91
  v_pk_fma_f32 v[4:5], v[46:47], v[36:37], v[56:57] op_sel:[0,0,0] op_sel_hi:[0,1,0]
  v_pk_fma_f32 v[6:7], v[46:47], v[38:39], v[56:57] op_sel:[0,0,0] op_sel_hi:[0,1,0]
  v_pk_fma_f32 v[8:9], v[46:47], v[40:41], v[56:57] op_sel:[0,0,0] op_sel_hi:[0,1,0]
  v_pk_fma_f32 v[10:11], v[46:47], v[42:43], v[56:57] op_sel:[0,0,0] op_sel_hi:[0,1,0]
  v_pk_fma_f32 v[92:93], v[92:93], v[28:29], v[4:5]
  v_pk_fma_f32 v[94:95], v[94:95], v[30:31], v[6:7]
  v_pk_fma_f32 v[96:97], v[96:97], v[32:33], v[8:9]
  v_pk_fma_f32 v[98:99], v[98:99], v[34:35], v[10:11]
  v_pk_mul_f32 v[4:5], v[92:93], v[92:93]
  v_pk_mul_f32 v[6:7], v[94:95], v[94:95]
  v_pk_mul_f32 v[8:9], v[96:97], v[96:97]
  v_pk_mul_f32 v[10:11], v[98:99], v[98:99]
  v_pk_fma_f32 v[4:5], v[4:5], s[28:29], v[64:65]
  v_pk_fma_f32 v[6:7], v[6:7], s[28:29], v[64:65]
  v_pk_fma_f32 v[8:9], v[8:9], s[28:29], v[64:65]
  v_pk_fma_f32 v[10:11], v[10:11], s[28:29], v[64:65]
  v_pk_mul_f32 v[4:5], v[4:5], v[92:93]
  v_pk_mul_f32 v[6:7], v[6:7], v[94:95]
  v_pk_mul_f32 v[8:9], v[8:9], v[96:97]
  v_pk_mul_f32 v[10:11], v[10:11], v[98:99]
  v_exp_f32 v4, v4
  v_exp_f32 v5, v5
  v_exp_f32 v6, v6
  v_exp_f32 v7, v7
  v_exp_f32 v8, v8
  v_exp_f32 v9, v9
  v_exp_f32 v10, v10
  v_exp_f32 v11, v11
  v_pk_add_f32 v[4:5], v[4:5], s[30:31]
  v_pk_add_f32 v[6:7], v[6:7], s[30:31]
  v_pk_add_f32 v[8:9], v[8:9], s[30:31]
  v_pk_add_f32 v[10:11], v[10:11], s[30:31]
  v_rcp_f32 v4, v4
  v_rcp_f32 v5, v5
  v_rcp_f32 v6, v6
  v_rcp_f32 v7, v7
  v_rcp_f32 v8, v8
  v_rcp_f32 v9, v9
  v_rcp_f32 v10, v10
  v_rcp_f32 v11, v11
  v_pk_mul_f32 v[92:93], v[92:93], v[4:5]
  v_pk_mul_f32 v[94:95], v[94:95], v[6:7]
  v_pk_mul_f32 v[96:97], v[96:97], v[8:9]
  v_pk_mul_f32 v[98:99], v[98:99], v[10:11]
  v_pk_add_f32 v[12:13], v[12:13], v[92:93]
  v_pk_fma_f32 v[20:21], v[92:93], v[92:93], v[20:21]
  v_pk_add_f32 v[14:15], v[14:15], v[94:95]
  v_pk_fma_f32 v[22:23], v[94:95], v[94:95], v[22:23]
  v_pk_add_f32 v[16:17], v[16:17], v[96:97]
  v_pk_fma_f32 v[24:25], v[96:97], v[96:97], v[24:25]
  v_pk_add_f32 v[18:19], v[18:19], v[98:99]
  v_pk_fma_f32 v[26:27], v[98:99], v[98:99], v[26:27]
  v_cvt_pk_bf16_f32 v84, v92, v93
  v_cvt_pk_bf16_f32 v85, v94, v95
  v_cvt_pk_bf16_f32 v86, v96, v97
  v_cvt_pk_bf16_f32 v87, v98, v99
  v_pk_fma_f32 v[4:5], v[46:47], v[36:37], v[56:57] op_sel:[1,0,1] op_sel_hi:[1,1,1]
  v_pk_fma_f32 v[6:7], v[46:47], v[38:39], v[56:57] op_sel:[1,0,1] op_sel_hi:[1,1,1]
  v_pk_fma_f32 v[8:9], v[46:47], v[40:41], v[56:57] op_sel:[1,0,1] op_sel_hi:[1,1,1]
  v_pk_fma_f32 v[10:11], v[46:47], v[42:43], v[56:57] op_sel:[1,0,1] op_sel_hi:[1,1,1]
  v_pk_fma_f32 v[100:101], v[100:101], v[28:29], v[4:5]
  v_pk_fma_f32 v[102:103], v[102:103], v[30:31], v[6:7]
  v_pk_fma_f32 v[104:105], v[104:105], v[32:33], v[8:9]
  v_pk_fma_f32 v[106:107], v[106:107], v[34:35], v[10:11]
  v_pk_mul_f32 v[4:5], v[100:101], v[100:101]
  v_pk_mul_f32 v[6:7], v[102:103], v[102:103]
  v_pk_mul_f32 v[8:9], v[104:105], v[104:105]
  v_pk_mul_f32 v[10:11], v[106:107], v[106:107]
  v_pk_fma_f32 v[4:5], v[4:5], s[28:29], v[64:65]
  v_pk_fma_f32 v[6:7], v[6:7], s[28:29], v[64:65]
  v_pk_fma_f32 v[8:9], v[8:9], s[28:29], v[64:65]
  v_pk_fma_f32 v[10:11], v[10:11], s[28:29], v[64:65]
  v_pk_mul_f32 v[4:5], v[4:5], v[100:101]
  v_pk_mul_f32 v[6:7], v[6:7], v[102:103]
  v_pk_mul_f32 v[8:9], v[8:9], v[104:105]
  v_pk_mul_f32 v[10:11], v[10:11], v[106:107]
  v_exp_f32 v4, v4
  v_exp_f32 v5, v5
  v_exp_f32 v6, v6
  v_exp_f32 v7, v7
  v_exp_f32 v8, v8
  v_exp_f32 v9, v9
  v_exp_f32 v10, v10
  v_exp_f32 v11, v11
  v_pk_add_f32 v[4:5], v[4:5], s[30:31]
  v_pk_add_f32 v[6:7], v[6:7], s[30:31]
  v_pk_add_f32 v[8:9], v[8:9], s[30:31]
  v_pk_add_f32 v[10:11], v[10:11], s[30:31]
  v_rcp_f32 v4, v4
  v_rcp_f32 v5, v5
  v_rcp_f32 v6, v6
  v_rcp_f32 v7, v7
  v_rcp_f32 v8, v8
  v_rcp_f32 v9, v9
  v_rcp_f32 v10, v10
  v_rcp_f32 v11, v11
  v_pk_mul_f32 v[100:101], v[100:101], v[4:5]
  v_pk_mul_f32 v[102:103], v[102:103], v[6:7]
  v_pk_mul_f32 v[104:105], v[104:105], v[8:9]
  v_pk_mul_f32 v[106:107], v[106:107], v[10:11]
  v_pk_add_f32 v[12:13], v[12:13], v[100:101]
  v_pk_fma_f32 v[20:21], v[100:101], v[100:101], v[20:21]
  v_pk_add_f32 v[14:15], v[14:15], v[102:103]
  v_pk_fma_f32 v[22:23], v[102:103], v[102:103], v[22:23]
  v_pk_add_f32 v[16:17], v[16:17], v[104:105]
  v_pk_fma_f32 v[24:25], v[104:105], v[104:105], v[24:25]
  v_pk_add_f32 v[18:19], v[18:19], v[106:107]
  v_pk_fma_f32 v[26:27], v[106:107], v[106:107], v[26:27]
  v_cvt_pk_bf16_f32 v88, v100, v101
  v_cvt_pk_bf16_f32 v89, v102, v103
  v_cvt_pk_bf16_f32 v90, v104, v105
  v_cvt_pk_bf16_f32 v91, v106, v107
  v_pk_fma_f32 v[4:5], v[48:49], v[36:37], v[58:59] op_sel:[0,0,0] op_sel_hi:[0,1,0]
  v_pk_fma_f32 v[6:7], v[48:49], v[38:39], v[58:59] op_sel:[0,0,0] op_sel_hi:[0,1,0]
  v_pk_fma_f32 v[8:9], v[48:49], v[40:41], v[58:59] op_sel:[0,0,0] op_sel_hi:[0,1,0]
  v_pk_fma_f32 v[10:11], v[48:49], v[42:43], v[58:59] op_sel:[0,0,0] op_sel_hi:[0,1,0]
  v_pk_fma_f32 v[108:109], v[108:109], v[28:29], v[4:5]
  v_pk_fma_f32 v[110:111], v[110:111], v[30:31], v[6:7]
  v_pk_fma_f32 v[112:113], v[112:113], v[32:33], v[8:9]
  v_pk_fma_f32 v[114:115], v[114:115], v[34:35], v[10:11]
  v_pk_mul_f32 v[4:5], v[108:109], v[108:109]
  v_pk_mul_f32 v[6:7], v[110:111], v[110:111]
  v_pk_mul_f32 v[8:9], v[112:113], v[112:113]
  v_pk_mul_f32 v[10:11], v[114:115], v[114:115]
  v_pk_fma_f32 v[4:5], v[4:5], s[28:29], v[64:65]
  v_pk_fma_f32 v[6:7], v[6:7], s[28:29], v[64:65]
  v_pk_fma_f32 v[8:9], v[8:9], s[28:29], v[64:65]
  v_pk_fma_f32 v[10:11], v[10:11], s[28:29], v[64:65]
  v_pk_mul_f32 v[4:5], v[4:5], v[108:109]
  v_pk_mul_f32 v[6:7], v[6:7], v[110:111]
  v_pk_mul_f32 v[8:9], v[8:9], v[112:113]
  v_pk_mul_f32 v[10:11], v[10:11], v[114:115]
  v_exp_f32 v4, v4
  v_exp_f32 v5, v5
  v_exp_f32 v6, v6
  v_exp_f32 v7, v7
  v_exp_f32 v8, v8
  v_exp_f32 v9, v9
  v_exp_f32 v10, v10
  v_exp_f32 v11, v11
  v_pk_add_f32 v[4:5], v[4:5], s[30:31]
  v_pk_add_f32 v[6:7], v[6:7], s[30:31]
  v_pk_add_f32 v[8:9], v[8:9], s[30:31]
  v_pk_add_f32 v[10:11], v[10:11], s[30:31]
  v_rcp_f32 v4, v4
  v_rcp_f32 v5, v5
  v_rcp_f32 v6, v6
  v_rcp_f32 v7, v7
  v_rcp_f32 v8, v8
  v_rcp_f32 v9, v9
  v_rcp_f32 v10, v10
  v_rcp_f32 v11, v11
  v_pk_mul_f32 v[108:109], v[108:109], v[4:5]
  v_pk_mul_f32 v[110:111], v[110:111], v[6:7]
  v_pk_mul_f32 v[112:113], v[112:113], v[8:9]
  v_pk_mul_f32 v[114:115], v[114:115], v[10:11]
  v_pk_add_f32 v[12:13], v[12:13], v[108:109]
  v_pk_fma_f32 v[20:21], v[108:109], v[108:109], v[20:21]
  v_pk_add_f32 v[14:15], v[14:15], v[110:111]
  v_pk_fma_f32 v[22:23], v[110:111], v[110:111], v[22:23]
  v_pk_add_f32 v[16:17], v[16:17], v[112:113]
  v_pk_fma_f32 v[24:25], v[112:113], v[112:113], v[24:25]
  v_pk_add_f32 v[18:19], v[18:19], v[114:115]
  v_pk_fma_f32 v[26:27], v[114:115], v[114:115], v[26:27]
  v_cvt_pk_bf16_f32 v92, v108, v109
  v_cvt_pk_bf16_f32 v93, v110, v111
  v_cvt_pk_bf16_f32 v94, v112, v113
  v_cvt_pk_bf16_f32 v95, v114, v115
  v_pk_fma_f32 v[4:5], v[48:49], v[36:37], v[58:59] op_sel:[1,0,1] op_sel_hi:[1,1,1]
  v_pk_fma_f32 v[6:7], v[48:49], v[38:39], v[58:59] op_sel:[1,0,1] op_sel_hi:[1,1,1]
  v_pk_fma_f32 v[8:9], v[48:49], v[40:41], v[58:59] op_sel:[1,0,1] op_sel_hi:[1,1,1]
  v_pk_fma_f32 v[10:11], v[48:49], v[42:43], v[58:59] op_sel:[1,0,1] op_sel_hi:[1,1,1]
  v_pk_fma_f32 v[116:117], v[116:117], v[28:29], v[4:5]
  v_pk_fma_f32 v[118:119], v[118:119], v[30:31], v[6:7]
  v_pk_fma_f32 v[120:121], v[120:121], v[32:33], v[8:9]
  v_pk_fma_f32 v[122:123], v[122:123], v[34:35], v[10:11]
  v_pk_mul_f32 v[4:5], v[116:117], v[116:117]
  v_pk_mul_f32 v[6:7], v[118:119], v[118:119]
  v_pk_mul_f32 v[8:9], v[120:121], v[120:121]
  v_pk_mul_f32 v[10:11], v[122:123], v[122:123]
  v_pk_fma_f32 v[4:5], v[4:5], s[28:29], v[64:65]
  v_pk_fma_f32 v[6:7], v[6:7], s[28:29], v[64:65]
  v_pk_fma_f32 v[8:9], v[8:9], s[28:29], v[64:65]
  v_pk_fma_f32 v[10:11], v[10:11], s[28:29], v[64:65]
  v_pk_mul_f32 v[4:5], v[4:5], v[116:117]
  v_pk_mul_f32 v[6:7], v[6:7], v[118:119]
  v_pk_mul_f32 v[8:9], v[8:9], v[120:121]
  v_pk_mul_f32 v[10:11], v[10:11], v[122:123]
  v_exp_f32 v4, v4
  v_exp_f32 v5, v5
  v_exp_f32 v6, v6
  v_exp_f32 v7, v7
  v_exp_f32 v8, v8
  v_exp_f32 v9, v9
  v_exp_f32 v10, v10
  v_exp_f32 v11, v11
  v_pk_add_f32 v[4:5], v[4:5], s[30:31]
  v_pk_add_f32 v[6:7], v[6:7], s[30:31]
  v_pk_add_f32 v[8:9], v[8:9], s[30:31]
  v_pk_add_f32 v[10:11], v[10:11], s[30:31]
  v_rcp_f32 v4, v4
  v_rcp_f32 v5, v5
  v_rcp_f32 v6, v6
  v_rcp_f32 v7, v7
  v_rcp_f32 v8, v8
  v_rcp_f32 v9, v9
  v_rcp_f32 v10, v10
  v_rcp_f32 v11, v11
  v_pk_mul_f32 v[116:117], v[116:117], v[4:5]
  v_pk_mul_f32 v[118:119], v[118:119], v[6:7]
  v_pk_mul_f32 v[120:121], v[120:121], v[8:9]
  v_pk_mul_f32 v[122:123], v[122:123], v[10:11]
  v_pk_add_f32 v[12:13], v[12:13], v[116:117]
  v_pk_fma_f32 v[20:21], v[116:117], v[116:117], v[20:21]
  v_pk_add_f32 v[14:15], v[14:15], v[118:119]
  v_pk_fma_f32 v[22:23], v[118:119], v[118:119], v[22:23]
  v_pk_add_f32 v[16:17], v[16:17], v[120:121]
  v_pk_fma_f32 v[24:25], v[120:121], v[120:121], v[24:25]
  v_pk_add_f32 v[18:19], v[18:19], v[122:123]
  v_pk_fma_f32 v[26:27], v[122:123], v[122:123], v[26:27]
  v_cvt_pk_bf16_f32 v96, v116, v117
  v_cvt_pk_bf16_f32 v97, v118, v119
  v_cvt_pk_bf16_f32 v98, v120, v121
  v_cvt_pk_bf16_f32 v99, v122, v123
  v_pk_fma_f32 v[4:5], v[50:51], v[36:37], v[60:61] op_sel:[0,0,0] op_sel_hi:[0,1,0]
  v_pk_fma_f32 v[6:7], v[50:51], v[38:39], v[60:61] op_sel:[0,0,0] op_sel_hi:[0,1,0]
  v_pk_fma_f32 v[8:9], v[50:51], v[40:41], v[60:61] op_sel:[0,0,0] op_sel_hi:[0,1,0]
  v_pk_fma_f32 v[10:11], v[50:51], v[42:43], v[60:61] op_sel:[0,0,0] op_sel_hi:[0,1,0]
  v_pk_fma_f32 v[124:125], v[124:125], v[28:29], v[4:5]
  v_pk_fma_f32 v[126:127], v[126:127], v[30:31], v[6:7]
  v_pk_fma_f32 v[128:129], v[128:129], v[32:33], v[8:9]
  v_pk_fma_f32 v[130:131], v[130:131], v[34:35], v[10:11]
  v_pk_mul_f32 v[4:5], v[124:125], v[124:125]
  v_pk_mul_f32 v[6:7], v[126:127], v[126:127]
  v_pk_mul_f32 v[8:9], v[128:129], v[128:129]
  v_pk_mul_f32 v[10:11], v[130:131], v[130:131]
  v_pk_fma_f32 v[4:5], v[4:5], s[28:29], v[64:65]
  v_pk_fma_f32 v[6:7], v[6:7], s[28:29], v[64:65]
  v_pk_fma_f32 v[8:9], v[8:9], s[28:29], v[64:65]
  v_pk_fma_f32 v[10:11], v[10:11], s[28:29], v[64:65]
  v_pk_mul_f32 v[4:5], v[4:5], v[124:125]
  v_pk_mul_f32 v[6:7], v[6:7], v[126:127]
  v_pk_mul_f32 v[8:9], v[8:9], v[128:129]
  v_pk_mul_f32 v[10:11], v[10:11], v[130:131]
  v_exp_f32 v4, v4
  v_exp_f32 v5, v5
  v_exp_f32 v6, v6
  v_exp_f32 v7, v7
  v_exp_f32 v8, v8
  v_exp_f32 v9, v9
  v_exp_f32 v10, v10
  v_exp_f32 v11, v11
  v_pk_add_f32 v[4:5], v[4:5], s[30:31]
  v_pk_add_f32 v[6:7], v[6:7], s[30:31]
  v_pk_add_f32 v[8:9], v[8:9], s[30:31]
  v_pk_add_f32 v[10:11], v[10:11], s[30:31]
  v_rcp_f32 v4, v4
  v_rcp_f32 v5, v5
  v_rcp_f32 v6, v6
  v_rcp_f32 v7, v7
  v_rcp_f32 v8, v8
  v_rcp_f32 v9, v9
  v_rcp_f32 v10, v10
  v_rcp_f32 v11, v11
  v_pk_mul_f32 v[124:125], v[124:125], v[4:5]
  v_pk_mul_f32 v[126:127], v[126:127], v[6:7]
  v_pk_mul_f32 v[128:129], v[128:129], v[8:9]
  v_pk_mul_f32 v[130:131], v[130:131], v[10:11]
  v_pk_add_f32 v[12:13], v[12:13], v[124:125]
  v_pk_fma_f32 v[20:21], v[124:125], v[124:125], v[20:21]
  v_pk_add_f32 v[14:15], v[14:15], v[126:127]
  v_pk_fma_f32 v[22:23], v[126:127], v[126:127], v[22:23]
  v_pk_add_f32 v[16:17], v[16:17], v[128:129]
  v_pk_fma_f32 v[24:25], v[128:129], v[128:129], v[24:25]
  v_pk_add_f32 v[18:19], v[18:19], v[130:131]
  v_pk_fma_f32 v[26:27], v[130:131], v[130:131], v[26:27]
  v_cvt_pk_bf16_f32 v100, v124, v125
  v_cvt_pk_bf16_f32 v101, v126, v127
  v_cvt_pk_bf16_f32 v102, v128, v129
  v_cvt_pk_bf16_f32 v103, v130, v131
  v_pk_fma_f32 v[4:5], v[50:51], v[36:37], v[60:61] op_sel:[1,0,1] op_sel_hi:[1,1,1]
  v_pk_fma_f32 v[6:7], v[50:51], v[38:39], v[60:61] op_sel:[1,0,1] op_sel_hi:[1,1,1]
  v_pk_fma_f32 v[8:9], v[50:51], v[40:41], v[60:61] op_sel:[1,0,1] op_sel_hi:[1,1,1]
  v_pk_fma_f32 v[10:11], v[50:51], v[42:43], v[60:61] op_sel:[1,0,1] op_sel_hi:[1,1,1]
  v_pk_fma_f32 v[132:133], v[132:133], v[28:29], v[4:5]
  v_pk_fma_f32 v[134:135], v[134:135], v[30:31], v[6:7]
  v_pk_fma_f32 v[136:137], v[136:137], v[32:33], v[8:9]
  v_pk_fma_f32 v[138:139], v[138:139], v[34:35], v[10:11]
  v_pk_mul_f32 v[4:5], v[132:133], v[132:133]
  v_pk_mul_f32 v[6:7], v[134:135], v[134:135]
  v_pk_mul_f32 v[8:9], v[136:137], v[136:137]
  v_pk_mul_f32 v[10:11], v[138:139], v[138:139]
  v_pk_fma_f32 v[4:5], v[4:5], s[28:29], v[64:65]
  v_pk_fma_f32 v[6:7], v[6:7], s[28:29], v[64:65]
  v_pk_fma_f32 v[8:9], v[8:9], s[28:29], v[64:65]
  v_pk_fma_f32 v[10:11], v[10:11], s[28:29], v[64:65]
  v_pk_mul_f32 v[4:5], v[4:5], v[132:133]
  v_pk_mul_f32 v[6:7], v[6:7], v[134:135]
  v_pk_mul_f32 v[8:9], v[8:9], v[136:137]
  v_pk_mul_f32 v[10:11], v[10:11], v[138:139]
  v_exp_f32 v4, v4
  v_exp_f32 v5, v5
  v_exp_f32 v6, v6
  v_exp_f32 v7, v7
  v_exp_f32 v8, v8
  v_exp_f32 v9, v9
  v_exp_f32 v10, v10
  v_exp_f32 v11, v11
  v_pk_add_f32 v[4:5], v[4:5], s[30:31]
  v_pk_add_f32 v[6:7], v[6:7], s[30:31]
  v_pk_add_f32 v[8:9], v[8:9], s[30:31]
  v_pk_add_f32 v[10:11], v[10:11], s[30:31]
  v_rcp_f32 v4, v4
  v_rcp_f32 v5, v5
  v_rcp_f32 v6, v6
  v_rcp_f32 v7, v7
  v_rcp_f32 v8, v8
  v_rcp_f32 v9, v9
  v_rcp_f32 v10, v10
  v_rcp_f32 v11, v11
  v_pk_mul_f32 v[132:133], v[132:133], v[4:5]
  v_pk_mul_f32 v[134:135], v[134:135], v[6:7]
  v_pk_mul_f32 v[136:137], v[136:137], v[8:9]
  v_pk_mul_f32 v[138:139], v[138:139], v[10:11]
  v_pk_add_f32 v[12:13], v[12:13], v[132:133]
  v_pk_fma_f32 v[20:21], v[132:133], v[132:133], v[20:21]
  v_pk_add_f32 v[14:15], v[14:15], v[134:135]
  v_pk_fma_f32 v[22:23], v[134:135], v[134:135], v[22:23]
  v_pk_add_f32 v[16:17], v[16:17], v[136:137]
  v_pk_fma_f32 v[24:25], v[136:137], v[136:137], v[24:25]
  v_pk_add_f32 v[18:19], v[18:19], v[138:139]
  v_pk_fma_f32 v[26:27], v[138:139], v[138:139], v[26:27]
  v_cvt_pk_bf16_f32 v104, v132, v133
  v_cvt_pk_bf16_f32 v105, v134, v135
  v_cvt_pk_bf16_f32 v106, v136, v137
  v_cvt_pk_bf16_f32 v107, v138, v139
  v_pk_fma_f32 v[4:5], v[52:53], v[36:37], v[62:63] op_sel:[0,0,0] op_sel_hi:[0,1,0]
  v_pk_fma_f32 v[6:7], v[52:53], v[38:39], v[62:63] op_sel:[0,0,0] op_sel_hi:[0,1,0]
  v_pk_fma_f32 v[8:9], v[52:53], v[40:41], v[62:63] op_sel:[0,0,0] op_sel_hi:[0,1,0]
  v_pk_fma_f32 v[10:11], v[52:53], v[42:43], v[62:63] op_sel:[0,0,0] op_sel_hi:[0,1,0]
  v_pk_fma_f32 v[140:141], v[140:141], v[28:29], v[4:5]
  v_pk_fma_f32 v[142:143], v[142:143], v[30:31], v[6:7]
  v_pk_fma_f32 v[144:145], v[144:145], v[32:33], v[8:9]
  v_pk_fma_f32 v[146:147], v[146:147], v[34:35], v[10:11]
  v_pk_mul_f32 v[4:5], v[140:141], v[140:141]
  v_pk_mul_f32 v[6:7], v[142:143], v[142:143]
  v_pk_mul_f32 v[8:9], v[144:145], v[144:145]
  v_pk_mul_f32 v[10:11], v[146:147], v[146:147]
  v_pk_fma_f32 v[4:5], v[4:5], s[28:29], v[64:65]
  v_pk_fma_f32 v[6:7], v[6:7], s[28:29], v[64:65]
  v_pk_fma_f32 v[8:9], v[8:9], s[28:29], v[64:65]
  v_pk_fma_f32 v[10:11], v[10:11], s[28:29], v[64:65]
  v_pk_mul_f32 v[4:5], v[4:5], v[140:141]
  v_pk_mul_f32 v[6:7], v[6:7], v[142:143]
  v_pk_mul_f32 v[8:9], v[8:9], v[144:145]
  v_pk_mul_f32 v[10:11], v[10:11], v[146:147]
  v_exp_f32 v4, v4
  v_exp_f32 v5, v5
  v_exp_f32 v6, v6
  v_exp_f32 v7, v7
  v_exp_f32 v8, v8
  v_exp_f32 v9, v9
  v_exp_f32 v10, v10
  v_exp_f32 v11, v11
  v_pk_add_f32 v[4:5], v[4:5], s[30:31]
  v_pk_add_f32 v[6:7], v[6:7], s[30:31]
  v_pk_add_f32 v[8:9], v[8:9], s[30:31]
  v_pk_add_f32 v[10:11], v[10:11], s[30:31]
  v_rcp_f32 v4, v4
  v_rcp_f32 v5, v5
  v_rcp_f32 v6, v6
  v_rcp_f32 v7, v7
  v_rcp_f32 v8, v8
  v_rcp_f32 v9, v9
  v_rcp_f32 v10, v10
  v_rcp_f32 v11, v11
  v_pk_mul_f32 v[140:141], v[140:141], v[4:5]
  v_pk_mul_f32 v[142:143], v[142:143], v[6:7]
  v_pk_mul_f32 v[144:145], v[144:145], v[8:9]
  v_pk_mul_f32 v[146:147], v[146:147], v[10:11]
  v_pk_add_f32 v[12:13], v[12:13], v[140:141]
  v_pk_fma_f32 v[20:21], v[140:141], v[140:141], v[20:21]
  v_pk_add_f32 v[14:15], v[14:15], v[142:143]
  v_pk_fma_f32 v[22:23], v[142:143], v[142:143], v[22:23]
  v_pk_add_f32 v[16:17], v[16:17], v[144:145]
  v_pk_fma_f32 v[24:25], v[144:145], v[144:145], v[24:25]
  v_pk_add_f32 v[18:19], v[18:19], v[146:147]
  v_pk_fma_f32 v[26:27], v[146:147], v[146:147], v[26:27]
  v_cvt_pk_bf16_f32 v108, v140, v141
  v_cvt_pk_bf16_f32 v109, v142, v143
  v_cvt_pk_bf16_f32 v110, v144, v145
  v_cvt_pk_bf16_f32 v111, v146, v147
  v_add_f32_dpp v12, v12, v12 row_ror:8 row_mask:0xf bank_mask:0x3
  v_add_f32_dpp v13, v13, v13 row_ror:8 row_mask:0xf bank_mask:0x3
  v_add_f32_dpp v14, v14, v14 row_ror:8 row_mask:0xf bank_mask:0x3
  v_add_f32_dpp v15, v15, v15 row_ror:8 row_mask:0xf bank_mask:0x3
  v_add_f32_dpp v12, v16, v16 row_ror:8 row_mask:0xf bank_mask:0xc
  v_add_f32_dpp v13, v17, v17 row_ror:8 row_mask:0xf bank_mask:0xc
  v_add_f32_dpp v14, v18, v18 row_ror:8 row_mask:0xf bank_mask:0xc
  v_add_f32_dpp v15, v19, v19 row_ror:8 row_mask:0xf bank_mask:0xc
  v_add_f32_dpp v20, v20, v20 row_ror:8 row_mask:0xf bank_mask:0x3
  v_add_f32_dpp v21, v21, v21 row_ror:8 row_mask:0xf bank_mask:0x3
  v_add_f32_dpp v22, v22, v22 row_ror:8 row_mask:0xf bank_mask:0x3
  v_add_f32_dpp v23, v23, v23 row_ror:8 row_mask:0xf bank_mask:0x3
  v_add_f32_dpp v20, v24, v24 row_ror:8 row_mask:0xf bank_mask:0xc
  v_add_f32_dpp v21, v25, v25 row_ror:8 row_mask:0xf bank_mask:0xc
  v_add_f32_dpp v22, v26, v26 row_ror:8 row_mask:0xf bank_mask:0xc
  v_add_f32_dpp v23, v27, v27 row_ror:8 row_mask:0xf bank_mask:0xc
  v_add_f32_dpp v12, v12, v12 row_half_mirror row_mask:0xf bank_mask:0x5
  v_add_f32_dpp v13, v13, v13 row_half_mirror row_mask:0xf bank_mask:0x5
  v_add_f32_dpp v20, v20, v20 row_half_mirror row_mask:0xf bank_mask:0x5
  v_add_f32_dpp v21, v21, v21 row_half_mirror row_mask:0xf bank_mask:0x5
  v_add_f32_dpp v12, v14, v14 row_half_mirror row_mask:0xf bank_mask:0xa
  v_add_f32_dpp v13, v15, v15 row_half_mirror row_mask:0xf bank_mask:0xa
  v_add_f32_dpp v20, v22, v22 row_half_mirror row_mask:0xf bank_mask:0xa
  v_add_f32_dpp v21, v23, v23 row_half_mirror row_mask:0xf bank_mask:0xa
  v_add_f32_dpp v12, v12, v12 quad_perm:[1,0,3,2] row_mask:0xf bank_mask:0xf
  v_add_f32_dpp v20, v20, v20 quad_perm:[1,0,3,2] row_mask:0xf bank_mask:0xf
  v_add_f32_dpp v13, v13, v13 quad_perm:[1,0,3,2] row_mask:0xf bank_mask:0xf
  v_add_f32_dpp v21, v21, v21 quad_perm:[1,0,3,2] row_mask:0xf bank_mask:0xf
  v_add_f32_dpp v12, v12, v12 quad_perm:[2,3,0,1] row_mask:0xf bank_mask:0xf
  v_add_f32_dpp v20, v20, v20 quad_perm:[2,3,0,1] row_mask:0xf bank_mask:0xf
  v_add_f32_dpp v13, v13, v13 quad_perm:[2,3,0,1] row_mask:0xf bank_mask:0xf
  v_add_f32_dpp v21, v21, v21 quad_perm:[2,3,0,1] row_mask:0xf bank_mask:0xf
  v_mov_b32 v144, v12
  v_mov_b32 v145, v20
  v_mov_b32 v146, v13
  v_mov_b32 v147, v21
  buffer_store_dwordx4 v[144:147], v68, s[20:23], 0 offen sc1
  s_waitcnt lgkmcnt(0)
  v_mfma_f32_16x16x32_bf16 v[4:7], v[148:151], v[220:223], 0
  ds_read_b128 v[228:231], v237 offset:16384
  v_mfma_f32_16x16x32_bf16 v[8:11], v[148:151], v[224:227], 0
  ds_read_b128 v[232:235], v237 offset:18432
  v_mfma_f32_16x16x32_bf16 v[12:15], v[152:155], v[220:223], 0
  ds_read_b128 v[184:187], v238 offset:27648
  v_mfma_f32_16x16x32_bf16 v[16:19], v[152:155], v[224:227], 0
  ds_read_b128 v[188:191], v238 offset:28672
  v_mfma_f32_16x16x32_bf16 v[20:23], v[156:159], v[220:223], 0
  ds_read_b128 v[192:195], v238 offset:29696
  v_mfma_f32_16x16x32_bf16 v[24:27], v[156:159], v[224:227], 0
  ds_read_b128 v[196:199], v238 offset:30720
  v_mfma_f32_16x16x32_bf16 v[28:31], v[160:163], v[220:223], 0
  ds_read_b128 v[200:203], v238 offset:31744
  v_mfma_f32_16x16x32_bf16 v[32:35], v[160:163], v[224:227], 0
  ds_read_b128 v[204:207], v238 offset:32768
  v_mfma_f32_16x16x32_bf16 v[36:39], v[164:167], v[220:223], 0
  ds_read_b128 v[208:211], v238 offset:33792
  v_mfma_f32_16x16x32_bf16 v[40:43], v[164:167], v[224:227], 0
  ds_read_b128 v[212:215], v238 offset:34816
  v_mfma_f32_16x16x32_bf16 v[44:47], v[168:171], v[220:223], 0
  ds_read_b128 v[216:219], v238 offset:35840
  v_mfma_f32_16x16x32_bf16 v[48:51], v[168:171], v[224:227], 0
  v_mfma_f32_16x16x32_bf16 v[52:55], v[172:175], v[220:223], 0
  v_mfma_f32_16x16x32_bf16 v[56:59], v[172:175], v[224:227], 0
  v_mfma_f32_16x16x32_bf16 v[60:63], v[176:179], v[220:223], 0
  v_mfma_f32_16x16x32_bf16 v[64:67], v[176:179], v[224:227], 0
  v_mfma_f32_16x16x32_bf16 v[68:71], v[180:183], v[220:223], 0
  v_mfma_f32_16x16x32_bf16 v[72:75], v[180:183], v[224:227], 0
  s_waitcnt lgkmcnt(0)
  s_barrier
  v_mfma_f32_16x16x32_bf16 v[4:7], v[184:187], v[228:231], v[4:7]
  ds_read_b128 v[220:223], v236 offset:32768
  v_mfma_f32_16x16x32_bf16 v[8:11], v[184:187], v[232:235], v[8:11]
  ds_read_b128 v[224:227], v236 offset:34816
  v_mfma_f32_16x16x32_bf16 v[12:15], v[188:191], v[228:231], v[12:15]
  ds_read_b128 v[148:151], v239 offset:0
  v_mfma_f32_16x16x32_bf16 v[16:19], v[188:191], v[232:235], v[16:19]
  ds_read_b128 v[152:155], v239 offset:1024
  v_mfma_f32_16x16x32_bf16 v[20:23], v[192:195], v[228:231], v[20:23]
  ds_read_b128 v[156:159], v239 offset:2048
  v_mfma_f32_16x16x32_bf16 v[24:27], v[192:195], v[232:235], v[24:27]
  ds_read_b128 v[160:163], v239 offset:3072
  v_mfma_f32_16x16x32_bf16 v[28:31], v[196:199], v[228:231], v[28:31]
  ds_read_b128 v[164:167], v239 offset:4096
  v_mfma_f32_16x16x32_bf16 v[32:35], v[196:199], v[232:235], v[32:35]
  ds_read_b128 v[168:171], v239 offset:5120
  v_mfma_f32_16x16x32_bf16 v[36:39], v[200:203], v[228:231], v[36:39]
  ds_read_b128 v[172:175], v239 offset:6144
  v_mfma_f32_16x16x32_bf16 v[40:43], v[200:203], v[232:235], v[40:43]
  ds_read_b128 v[176:179], v239 offset:7168
  v_mfma_f32_16x16x32_bf16 v[44:47], v[204:207], v[228:231], v[44:47]
  ds_read_b128 v[180:183], v239 offset:8192
  v_mfma_f32_16x16x32_bf16 v[48:51], v[204:207], v[232:235], v[48:51]
  v_mfma_f32_16x16x32_bf16 v[52:55], v[208:211], v[228:231], v[52:55]
  v_mfma_f32_16x16x32_bf16 v[56:59], v[208:211], v[232:235], v[56:59]
  v_mfma_f32_16x16x32_bf16 v[60:63], v[212:215], v[228:231], v[60:63]
  v_mfma_f32_16x16x32_bf16 v[64:67], v[212:215], v[232:235], v[64:67]
  v_mfma_f32_16x16x32_bf16 v[68:71], v[216:219], v[228:231], v[68:71]
  v_mfma_f32_16x16x32_bf16 v[72:75], v[216:219], v[232:235], v[72:75]
  s_waitcnt lgkmcnt(0)
  v_mfma_f32_16x16x32_bf16 v[4:7], v[148:151], v[220:223], v[4:7]
  ds_read_b128 v[228:231], v237 offset:32768
  v_mfma_f32_16x16x32_bf16 v[8:11], v[148:151], v[224:227], v[8:11]
  ds_read_b128 v[232:235], v237 offset:34816
  v_mfma_f32_16x16x32_bf16 v[12:15], v[152:155], v[220:223], v[12:15]
  ds_read_b128 v[184:187], v239 offset:9216
  v_mfma_f32_16x16x32_bf16 v[16:19], v[152:155], v[224:227], v[16:19]
  ds_read_b128 v[188:191], v239 offset:10240
  v_mfma_f32_16x16x32_bf16 v[20:23], v[156:159], v[220:223], v[20:23]
  ds_read_b128 v[192:195], v239 offset:11264
  v_mfma_f32_16x16x32_bf16 v[24:27], v[156:159], v[224:227], v[24:27]
  ds_read_b128 v[196:199], v239 offset:12288
  v_mfma_f32_16x16x32_bf16 v[28:31], v[160:163], v[220:223], v[28:31]
  ds_read_b128 v[200:203], v239 offset:13312
  v_mfma_f32_16x16x32_bf16 v[32:35], v[160:163], v[224:227], v[32:35]
  ds_read_b128 v[204:207], v239 offset:14336
  v_mfma_f32_16x16x32_bf16 v[36:39], v[164:167], v[220:223], v[36:39]
  ds_read_b128 v[208:211], v239 offset:15360
  v_mfma_f32_16x16x32_bf16 v[40:43], v[164:167], v[224:227], v[40:43]
  ds_read_b128 v[212:215], v239 offset:16384
  v_mfma_f32_16x16x32_bf16 v[44:47], v[168:171], v[220:223], v[44:47]
  ds_read_b128 v[216:219], v239 offset:17408
  v_mfma_f32_16x16x32_bf16 v[48:51], v[168:171], v[224:227], v[48:51]
  v_mfma_f32_16x16x32_bf16 v[52:55], v[172:175], v[220:223], v[52:55]
  v_mfma_f32_16x16x32_bf16 v[56:59], v[172:175], v[224:227], v[56:59]
  v_mfma_f32_16x16x32_bf16 v[60:63], v[176:179], v[220:223], v[60:63]
  v_mfma_f32_16x16x32_bf16 v[64:67], v[176:179], v[224:227], v[64:67]
  v_mfma_f32_16x16x32_bf16 v[68:71], v[180:183], v[220:223], v[68:71]
  v_mfma_f32_16x16x32_bf16 v[72:75], v[180:183], v[224:227], v[72:75]
  s_waitcnt lgkmcnt(0)
  s_barrier
  v_mfma_f32_16x16x32_bf16 v[4:7], v[184:187], v[228:231], v[4:7]
  ds_read_b128 v[220:223], v236 offset:49152
  v_mfma_f32_16x16x32_bf16 v[8:11], v[184:187], v[232:235], v[8:11]
  ds_read_b128 v[224:227], v236 offset:51200
  v_mfma_f32_16x16x32_bf16 v[12:15], v[188:191], v[228:231], v[12:15]
  ds_read_b128 v[148:151], v239 offset:18432
  v_mfma_f32_16x16x32_bf16 v[16:19], v[188:191], v[232:235], v[16:19]
  ds_read_b128 v[152:155], v239 offset:19456
  v_mfma_f32_16x16x32_bf16 v[20:23], v[192:195], v[228:231], v[20:23]
  ds_read_b128 v[156:159], v239 offset:20480
  v_mfma_f32_16x16x32_bf16 v[24:27], v[192:195], v[232:235], v[24:27]
  ds_read_b128 v[160:163], v239 offset:21504
  v_mfma_f32_16x16x32_bf16 v[28:31], v[196:199], v[228:231], v[28:31]
  ds_read_b128 v[164:167], v239 offset:22528
  v_mfma_f32_16x16x32_bf16 v[32:35], v[196:199], v[232:235], v[32:35]
  ds_read_b128 v[168:171], v239 offset:23552
  v_mfma_f32_16x16x32_bf16 v[36:39], v[200:203], v[228:231], v[36:39]
  ds_read_b128 v[172:175], v239 offset:24576
  v_mfma_f32_16x16x32_bf16 v[40:43], v[200:203], v[232:235], v[40:43]
  ds_read_b128 v[176:179], v239 offset:25600
  v_mfma_f32_16x16x32_bf16 v[44:47], v[204:207], v[228:231], v[44:47]
  ds_read_b128 v[180:183], v239 offset:26624
  v_mfma_f32_16x16x32_bf16 v[48:51], v[204:207], v[232:235], v[48:51]
  v_mfma_f32_16x16x32_bf16 v[52:55], v[208:211], v[228:231], v[52:55]
  v_mfma_f32_16x16x32_bf16 v[56:59], v[208:211], v[232:235], v[56:59]
  v_mfma_f32_16x16x32_bf16 v[60:63], v[212:215], v[228:231], v[60:63]
  v_mfma_f32_16x16x32_bf16 v[64:67], v[212:215], v[232:235], v[64:67]
  v_mfma_f32_16x16x32_bf16 v[68:71], v[216:219], v[228:231], v[68:71]
  v_mfma_f32_16x16x32_bf16 v[72:75], v[216:219], v[232:235], v[72:75]
  s_waitcnt lgkmcnt(0)
  v_mfma_f32_16x16x32_bf16 v[4:7], v[148:151], v[220:223], v[4:7]
  ds_read_b128 v[228:231], v237 offset:49152
  v_mfma_f32_16x16x32_bf16 v[8:11], v[148:151], v[224:227], v[8:11]
  ds_read_b128 v[232:235], v237 offset:51200
  v_mfma_f32_16x16x32_bf16 v[12:15], v[152:155], v[220:223], v[12:15]
  ds_read_b128 v[184:187], v239 offset:27648
  v_mfma_f32_16x16x32_bf16 v[16:19], v[152:155], v[224:227], v[16:19]
  ds_read_b128 v[188:191], v239 offset:28672
  v_mfma_f32_16x16x32_bf16 v[20:23], v[156:159], v[220:223], v[20:23]
  ds_read_b128 v[192:195], v239 offset:29696
  v_mfma_f32_16x16x32_bf16 v[24:27], v[156:159], v[224:227], v[24:27]
  ds_read_b128 v[196:199], v239 offset:30720
  v_mfma_f32_16x16x32_bf16 v[28:31], v[160:163], v[220:223], v[28:31]
  ds_read_b128 v[200:203], v239 offset:31744
  v_mfma_f32_16x16x32_bf16 v[32:35], v[160:163], v[224:227], v[32:35]
  ds_read_b128 v[204:207], v239 offset:32768
  v_mfma_f32_16x16x32_bf16 v[36:39], v[164:167], v[220:223], v[36:39]
  ds_read_b128 v[208:211], v239 offset:33792
  v_mfma_f32_16x16x32_bf16 v[40:43], v[164:167], v[224:227], v[40:43]
  ds_read_b128 v[212:215], v239 offset:34816
  v_mfma_f32_16x16x32_bf16 v[44:47], v[168:171], v[220:223], v[44:47]
  ds_read_b128 v[216:219], v239 offset:35840
  v_mfma_f32_16x16x32_bf16 v[48:51], v[168:171], v[224:227], v[48:51]
  v_mfma_f32_16x16x32_bf16 v[52:55], v[172:175], v[220:223], v[52:55]
  v_mfma_f32_16x16x32_bf16 v[56:59], v[172:175], v[224:227], v[56:59]
  v_mfma_f32_16x16x32_bf16 v[60:63], v[176:179], v[220:223], v[60:63]
  v_mfma_f32_16x16x32_bf16 v[64:67], v[176:179], v[224:227], v[64:67]
  v_mfma_f32_16x16x32_bf16 v[68:71], v[180:183], v[220:223], v[68:71]
  v_mfma_f32_16x16x32_bf16 v[72:75], v[180:183], v[224:227], v[72:75]
  s_waitcnt lgkmcnt(0)
  s_barrier
  v_mfma_f32_16x16x32_bf16 v[4:7], v[184:187], v[228:231], v[4:7]
  ds_read_b128 v[220:223], v236 offset:0
  v_mfma_f32_16x16x32_bf16 v[8:11], v[184:187], v[232:235], v[8:11]
  ds_read_b128 v[224:227], v236 offset:2048
  v_mfma_f32_16x16x32_bf16 v[12:15], v[188:191], v[228:231], v[12:15]
  ds_read_b128 v[148:151], v238 offset:0
  v_mfma_f32_16x16x32_bf16 v[16:19], v[188:191], v[232:235], v[16:19]
  ds_read_b128 v[152:155], v238 offset:1024
  v_mfma_f32_16x16x32_bf16 v[20:23], v[192:195], v[228:231], v[20:23]
  ds_read_b128 v[156:159], v238 offset:2048
  v_mfma_f32_16x16x32_bf16 v[24:27], v[192:195], v[232:235], v[24:27]
  ds_read_b128 v[160:163], v238 offset:3072
  v_mfma_f32_16x16x32_bf16 v[28:31], v[196:199], v[228:231], v[28:31]
  ds_read_b128 v[164:167], v238 offset:4096
  v_mfma_f32_16x16x32_bf16 v[32:35], v[196:199], v[232:235], v[32:35]
  ds_read_b128 v[168:171], v238 offset:5120
  v_mfma_f32_16x16x32_bf16 v[36:39], v[200:203], v[228:231], v[36:39]
  ds_read_b128 v[172:175], v238 offset:6144
  v_mfma_f32_16x16x32_bf16 v[40:43], v[200:203], v[232:235], v[40:43]
  ds_read_b128 v[176:179], v238 offset:7168
  v_mfma_f32_16x16x32_bf16 v[44:47], v[204:207], v[228:231], v[44:47]
  ds_read_b128 v[180:183], v238 offset:8192
  v_mfma_f32_16x16x32_bf16 v[48:51], v[204:207], v[232:235], v[48:51]
  ds_read_b128 v[128:131], v241 offset:0
  v_mfma_f32_16x16x32_bf16 v[52:55], v[208:211], v[228:231], v[52:55]
  ds_read_b128 v[132:135], v241 offset:16
  v_mfma_f32_16x16x32_bf16 v[56:59], v[208:211], v[232:235], v[56:59]
  ds_read_b128 v[136:139], v241 offset:128
  v_mfma_f32_16x16x32_bf16 v[60:63], v[212:215], v[228:231], v[60:63]
  ds_read_b128 v[140:143], v241 offset:144
  v_mfma_f32_16x16x32_bf16 v[64:67], v[212:215], v[232:235], v[64:67]
  v_mfma_f32_16x16x32_bf16 v[68:71], v[216:219], v[228:231], v[68:71]
  v_mfma_f32_16x16x32_bf16 v[72:75], v[216:219], v[232:235], v[72:75]
  s_waitcnt lgkmcnt(0)
  v_lshlrev_b32 v112, 16, v76
  v_and_b32 v113, 0xffff0000, v76
  v_lshlrev_b32 v114, 16, v77
  v_and_b32 v115, 0xffff0000, v77
  v_lshlrev_b32 v116, 16, v78
  v_and_b32 v117, 0xffff0000, v78
  v_lshlrev_b32 v118, 16, v79
  v_and_b32 v119, 0xffff0000, v79
  v_pk_fma_f32 v[112:113], v[112:113], v[128:129], v[136:137]
  v_pk_fma_f32 v[114:115], v[114:115], v[130:131], v[138:139]
  v_pk_fma_f32 v[116:117], v[116:117], v[132:133], v[140:141]
  v_pk_fma_f32 v[118:119], v[118:119], v[134:135], v[142:143]
  v_cvt_pk_bf16_f32 v76, v112, v113
  v_cvt_pk_bf16_f32 v77, v114, v115
  v_cvt_pk_bf16_f32 v78, v116, v117
  v_cvt_pk_bf16_f32 v79, v118, v119
  v_lshlrev_b32 v120, 16, v80
  v_and_b32 v121, 0xffff0000, v80
  v_lshlrev_b32 v122, 16, v81
  v_and_b32 v123, 0xffff0000, v81
  v_lshlrev_b32 v124, 16, v82
  v_and_b32 v125, 0xffff0000, v82
  v_lshlrev_b32 v126, 16, v83
  v_and_b32 v127, 0xffff0000, v83
  v_pk_fma_f32 v[120:121], v[120:121], v[128:129], v[136:137]
  v_pk_fma_f32 v[122:123], v[122:123], v[130:131], v[138:139]
  v_pk_fma_f32 v[124:125], v[124:125], v[132:133], v[140:141]
  v_pk_fma_f32 v[126:127], v[126:127], v[134:135], v[142:143]
  v_cvt_pk_bf16_f32 v80, v120, v121
  v_cvt_pk_bf16_f32 v81, v122, v123
  v_cvt_pk_bf16_f32 v82, v124, v125
  v_cvt_pk_bf16_f32 v83, v126, v127
  v_lshlrev_b32 v112, 16, v84
  v_and_b32 v113, 0xffff0000, v84
  v_lshlrev_b32 v114, 16, v85
  v_and_b32 v115, 0xffff0000, v85
  v_lshlrev_b32 v116, 16, v86
  v_and_b32 v117, 0xffff0000, v86
  v_lshlrev_b32 v118, 16, v87
  v_and_b32 v119, 0xffff0000, v87
  v_pk_fma_f32 v[112:113], v[112:113], v[128:129], v[136:137]
  v_pk_fma_f32 v[114:115], v[114:115], v[130:131], v[138:139]
  v_pk_fma_f32 v[116:117], v[116:117], v[132:133], v[140:141]
  v_pk_fma_f32 v[118:119], v[118:119], v[134:135], v[142:143]
  v_cvt_pk_bf16_f32 v84, v112, v113
  v_cvt_pk_bf16_f32 v85, v114, v115
  v_cvt_pk_bf16_f32 v86, v116, v117
  v_cvt_pk_bf16_f32 v87, v118, v119
  v_lshlrev_b32 v120, 16, v88
  v_and_b32 v121, 0xffff0000, v88
  v_lshlrev_b32 v122, 16, v89
  v_and_b32 v123, 0xffff0000, v89
  v_lshlrev_b32 v124, 16, v90
  v_and_b32 v125, 0xffff0000, v90
  v_lshlrev_b32 v126, 16, v91
  v_and_b32 v127, 0xffff0000, v91
  v_pk_fma_f32 v[120:121], v[120:121], v[128:129], v[136:137]
  v_pk_fma_f32 v[122:123], v[122:123], v[130:131], v[138:139]
  v_pk_fma_f32 v[124:125], v[124:125], v[132:133], v[140:141]
  v_pk_fma_f32 v[126:127], v[126:127], v[134:135], v[142:143]
  v_cvt_pk_bf16_f32 v88, v120, v121
  v_cvt_pk_bf16_f32 v89, v122, v123
  v_cvt_pk_bf16_f32 v90, v124, v125
  v_cvt_pk_bf16_f32 v91, v126, v127
  v_lshlrev_b32 v112, 16, v92
  v_and_b32 v113, 0xffff0000, v92
  v_lshlrev_b32 v114, 16, v93
  v_and_b32 v115, 0xffff0000, v93
  v_lshlrev_b32 v116, 16, v94
  v_and_b32 v117, 0xffff0000, v94
  v_lshlrev_b32 v118, 16, v95
  v_and_b32 v119, 0xffff0000, v95
  v_pk_fma_f32 v[112:113], v[112:113], v[128:129], v[136:137]
  v_pk_fma_f32 v[114:115], v[114:115], v[130:131], v[138:139]
  v_pk_fma_f32 v[116:117], v[116:117], v[132:133], v[140:141]
  v_pk_fma_f32 v[118:119], v[118:119], v[134:135], v[142:143]
  v_cvt_pk_bf16_f32 v92, v112, v113
  v_cvt_pk_bf16_f32 v93, v114, v115
  v_cvt_pk_bf16_f32 v94, v116, v117
  v_cvt_pk_bf16_f32 v95, v118, v119
  v_lshlrev_b32 v120, 16, v96
  v_and_b32 v121, 0xffff0000, v96
  v_lshlrev_b32 v122, 16, v97
  v_and_b32 v123, 0xffff0000, v97
  v_lshlrev_b32 v124, 16, v98
  v_and_b32 v125, 0xffff0000, v98
  v_lshlrev_b32 v126, 16, v99
  v_and_b32 v127, 0xffff0000, v99
  v_pk_fma_f32 v[120:121], v[120:121], v[128:129], v[136:137]
  v_pk_fma_f32 v[122:123], v[122:123], v[130:131], v[138:139]
  v_pk_fma_f32 v[124:125], v[124:125], v[132:133], v[140:141]
  v_pk_fma_f32 v[126:127], v[126:127], v[134:135], v[142:143]
  v_cvt_pk_bf16_f32 v96, v120, v121
  v_cvt_pk_bf16_f32 v97, v122, v123
  v_cvt_pk_bf16_f32 v98, v124, v125
  v_cvt_pk_bf16_f32 v99, v126, v127
  v_lshlrev_b32 v112, 16, v100
  v_and_b32 v113, 0xffff0000, v100
  v_lshlrev_b32 v114, 16, v101
  v_and_b32 v115, 0xffff0000, v101
  v_lshlrev_b32 v116, 16, v102
  v_and_b32 v117, 0xffff0000, v102
  v_lshlrev_b32 v118, 16, v103
  v_and_b32 v119, 0xffff0000, v103
  v_pk_fma_f32 v[112:113], v[112:113], v[128:129], v[136:137]
  v_pk_fma_f32 v[114:115], v[114:115], v[130:131], v[138:139]
  v_pk_fma_f32 v[116:117], v[116:117], v[132:133], v[140:141]
  v_pk_fma_f32 v[118:119], v[118:119], v[134:135], v[142:143]
  v_cvt_pk_bf16_f32 v100, v112, v113
  v_cvt_pk_bf16_f32 v101, v114, v115
  v_cvt_pk_bf16_f32 v102, v116, v117
  v_cvt_pk_bf16_f32 v103, v118, v119
  v_lshlrev_b32 v120, 16, v104
  v_and_b32 v121, 0xffff0000, v104
  v_lshlrev_b32 v122, 16, v105
  v_and_b32 v123, 0xffff0000, v105
  v_lshlrev_b32 v124, 16, v106
  v_and_b32 v125, 0xffff0000, v106
  v_lshlrev_b32 v126, 16, v107
  v_and_b32 v127, 0xffff0000, v107
  v_pk_fma_f32 v[120:121], v[120:121], v[128:129], v[136:137]
  v_pk_fma_f32 v[122:123], v[122:123], v[130:131], v[138:139]
  v_pk_fma_f32 v[124:125], v[124:125], v[132:133], v[140:141]
  v_pk_fma_f32 v[126:127], v[126:127], v[134:135], v[142:143]
  v_cvt_pk_bf16_f32 v104, v120, v121
  v_cvt_pk_bf16_f32 v105, v122, v123
  v_cvt_pk_bf16_f32 v106, v124, v125
  v_cvt_pk_bf16_f32 v107, v126, v127
  v_lshlrev_b32 v112, 16, v108
  v_and_b32 v113, 0xffff0000, v108
  v_lshlrev_b32 v114, 16, v109
  v_and_b32 v115, 0xffff0000, v109
  v_lshlrev_b32 v116, 16, v110
  v_and_b32 v117, 0xffff0000, v110
  v_lshlrev_b32 v118, 16, v111
  v_and_b32 v119, 0xffff0000, v111
  v_pk_fma_f32 v[112:113], v[112:113], v[128:129], v[136:137]
  v_pk_fma_f32 v[114:115], v[114:115], v[130:131], v[138:139]
  v_pk_fma_f32 v[116:117], v[116:117], v[132:133], v[140:141]
  v_pk_fma_f32 v[118:119], v[118:119], v[134:135], v[142:143]
  v_cvt_pk_bf16_f32 v108, v112, v113
  v_cvt_pk_bf16_f32 v109, v114, v115
  v_cvt_pk_bf16_f32 v110, v116, v117
  v_cvt_pk_bf16_f32 v111, v118, v119
  s_waitcnt lgkmcnt(0)
  v_mfma_f32_16x16x32_bf16 v[4:7], v[148:151], v[220:223], v[4:7]
  ds_read_b128 v[228:231], v237 offset:0
  v_mfma_f32_16x16x32_bf16 v[8:11], v[148:151], v[224:227], v[8:11]
  ds_read_b128 v[232:235], v237 offset:2048
  v_mfma_f32_16x16x32_bf16 v[12:15], v[152:155], v[220:223], v[12:15]
  ds_read_b128 v[184:187], v238 offset:9216
  v_mfma_f32_16x16x32_bf16 v[16:19], v[152:155], v[224:227], v[16:19]
  ds_read_b128 v[188:191], v238 offset:10240
  v_mfma_f32_16x16x32_bf16 v[20:23], v[156:159], v[220:223], v[20:23]
  ds_read_b128 v[192:195], v238 offset:11264
  v_mfma_f32_16x16x32_bf16 v[24:27], v[156:159], v[224:227], v[24:27]
  ds_read_b128 v[196:199], v238 offset:12288
  v_mfma_f32_16x16x32_bf16 v[28:31], v[160:163], v[220:223], v[28:31]
  ds_read_b128 v[200:203], v238 offset:13312
  v_mfma_f32_16x16x32_bf16 v[32:35], v[160:163], v[224:227], v[32:35]
  ds_read_b128 v[204:207], v238 offset:14336
  v_mfma_f32_16x16x32_bf16 v[36:39], v[164:167], v[220:223], v[36:39]
  ds_read_b128 v[208:211], v238 offset:15360
  v_mfma_f32_16x16x32_bf16 v[40:43], v[164:167], v[224:227], v[40:43]
  ds_read_b128 v[212:215], v238 offset:16384
  v_mfma_f32_16x16x32_bf16 v[44:47], v[168:171], v[220:223], v[44:47]
  ds_read_b128 v[216:219], v238 offset:17408
  v_mfma_f32_16x16x32_bf16 v[48:51], v[168:171], v[224:227], v[48:51]
  v_mfma_f32_16x16x32_bf16 v[52:55], v[172:175], v[220:223], v[52:55]
  buffer_store_dwordx4 v[76:79], v240, s[16:19], s15 offen offset:0 sc1
  v_mfma_f32_16x16x32_bf16 v[56:59], v[172:175], v[224:227], v[56:59]
  v_mfma_f32_16x16x32_bf16 v[60:63], v[176:179], v[220:223], v[60:63]
  v_mfma_f32_16x16x32_bf16 v[64:67], v[176:179], v[224:227], v[64:67]
  buffer_store_dwordx4 v[80:83], v240, s[16:19], s15 offen offset:1024 sc1
  v_mfma_f32_16x16x32_bf16 v[68:71], v[180:183], v[220:223], v[68:71]
  v_mfma_f32_16x16x32_bf16 v[72:75], v[180:183], v[224:227], v[72:75]
  s_waitcnt lgkmcnt(0)
  s_barrier
  v_mfma_f32_16x16x32_bf16 v[4:7], v[184:187], v[228:231], v[4:7]
  ds_read_b128 v[220:223], v244 offset:0
  v_mfma_f32_16x16x32_bf16 v[8:11], v[184:187], v[232:235], v[8:11]
  ds_read_b128 v[224:227], v244 offset:2048
  v_mfma_f32_16x16x32_bf16 v[12:15], v[188:191], v[228:231], v[12:15]
  ds_read_b128 v[148:151], v238 offset:18432
  v_mfma_f32_16x16x32_bf16 v[16:19], v[188:191], v[232:235], v[16:19]
  ds_read_b128 v[152:155], v238 offset:19456
  v_mfma_f32_16x16x32_bf16 v[20:23], v[192:195], v[228:231], v[20:23]
  ds_read_b128 v[156:159], v238 offset:20480
  v_mfma_f32_16x16x32_bf16 v[24:27], v[192:195], v[232:235], v[24:27]
  ds_read_b128 v[160:163], v238 offset:21504
  v_mfma_f32_16x16x32_bf16 v[28:31], v[196:199], v[228:231], v[28:31]
  ds_read_b128 v[164:167], v238 offset:22528
  v_mfma_f32_16x16x32_bf16 v[32:35], v[196:199], v[232:235], v[32:35]
  ds_read_b128 v[168:171], v238 offset:23552
  v_mfma_f32_16x16x32_bf16 v[36:39], v[200:203], v[228:231], v[36:39]
  ds_read_b128 v[172:175], v238 offset:24576
  v_mfma_f32_16x16x32_bf16 v[40:43], v[200:203], v[232:235], v[40:43]
  ds_read_b128 v[176:179], v238 offset:25600
  v_mfma_f32_16x16x32_bf16 v[44:47], v[204:207], v[228:231], v[44:47]
  ds_read_b128 v[180:183], v238 offset:26624
  v_mfma_f32_16x16x32_bf16 v[48:51], v[204:207], v[232:235], v[48:51]
  v_mfma_f32_16x16x32_bf16 v[52:55], v[208:211], v[228:231], v[52:55]
  buffer_store_dwordx4 v[84:87], v240, s[16:19], s15 offen offset:2048 sc1
  v_mfma_f32_16x16x32_bf16 v[56:59], v[208:211], v[232:235], v[56:59]
  v_mfma_f32_16x16x32_bf16 v[60:63], v[212:215], v[228:231], v[60:63]
  v_mfma_f32_16x16x32_bf16 v[64:67], v[212:215], v[232:235], v[64:67]
  buffer_store_dwordx4 v[88:91], v240, s[16:19], s15 offen offset:3072 sc1
  s_add_u32 s15, s15, 4096
  v_mfma_f32_16x16x32_bf16 v[68:71], v[216:219], v[228:231], v[68:71]
  v_mfma_f32_16x16x32_bf16 v[72:75], v[216:219], v[232:235], v[72:75]
  s_waitcnt lgkmcnt(0)
  v_mfma_f32_16x16x32_bf16 v[4:7], v[148:151], v[220:223], v[4:7]
  ds_read_b128 v[228:231], v244 offset:1024
  v_mfma_f32_16x16x32_bf16 v[8:11], v[148:151], v[224:227], v[8:11]
  ds_read_b128 v[232:235], v244 offset:3072
  v_mfma_f32_16x16x32_bf16 v[12:15], v[152:155], v[220:223], v[12:15]
  ds_read_b128 v[184:187], v238 offset:27648
  v_mfma_f32_16x16x32_bf16 v[16:19], v[152:155], v[224:227], v[16:19]
  ds_read_b128 v[188:191], v238 offset:28672
  v_mfma_f32_16x16x32_bf16 v[20:23], v[156:159], v[220:223], v[20:23]
  ds_read_b128 v[192:195], v238 offset:29696
  v_mfma_f32_16x16x32_bf16 v[24:27], v[156:159], v[224:227], v[24:27]
  ds_read_b128 v[196:199], v238 offset:30720
  v_mfma_f32_16x16x32_bf16 v[28:31], v[160:163], v[220:223], v[28:31]
  ds_read_b128 v[200:203], v238 offset:31744
  v_mfma_f32_16x16x32_bf16 v[32:35], v[160:163], v[224:227], v[32:35]
  ds_read_b128 v[204:207], v238 offset:32768
  v_mfma_f32_16x16x32_bf16 v[36:39], v[164:167], v[220:223], v[36:39]
  ds_read_b128 v[208:211], v238 offset:33792
  v_mfma_f32_16x16x32_bf16 v[40:43], v[164:167], v[224:227], v[40:43]
  ds_read_b128 v[212:215], v238 offset:34816
  v_mfma_f32_16x16x32_bf16 v[44:47], v[168:171], v[220:223], v[44:47]
  ds_read_b128 v[216:219], v238 offset:35840
  v_mfma_f32_16x16x32_bf16 v[48:51], v[168:171], v[224:227], v[48:51]
  v_mfma_f32_16x16x32_bf16 v[52:55], v[172:175], v[220:223], v[52:55]
  buffer_store_dwordx4 v[92:95], v240, s[16:19], s15 offen offset:0 sc1
  v_mfma_f32_16x16x32_bf16 v[56:59], v[172:175], v[224:227], v[56:59]
  v_mfma_f32_16x16x32_bf16 v[60:63], v[176:179], v[220:223], v[60:63]
  v_mfma_f32_16x16x32_bf16 v[64:67], v[176:179], v[224:227], v[64:67]
  buffer_store_dwordx4 v[96:99], v240, s[16:19], s15 offen offset:1024 sc1
  v_mfma_f32_16x16x32_bf16 v[68:71], v[180:183], v[220:223], v[68:71]
  v_mfma_f32_16x16x32_bf16 v[72:75], v[180:183], v[224:227], v[72:75]
  s_waitcnt lgkmcnt(0)
  s_barrier
  v_mfma_f32_16x16x32_bf16 v[4:7], v[184:187], v[228:231], v[4:7]
  ds_read_b128 v[220:223], v236 offset:32768
  v_mfma_f32_16x16x32_bf16 v[8:11], v[184:187], v[232:235], v[8:11]
  ds_read_b128 v[224:227], v236 offset:34816
  v_mfma_f32_16x16x32_bf16 v[12:15], v[188:191], v[228:231], v[12:15]
  ds_read_b128 v[148:151], v239 offset:0
  v_mfma_f32_16x16x32_bf16 v[16:19], v[188:191], v[232:235], v[16:19]
  ds_read_b128 v[152:155], v239 offset:1024
  v_mfma_f32_16x16x32_bf16 v[20:23], v[192:195], v[228:231], v[20:23]
  ds_read_b128 v[156:159], v239 offset:2048
  v_mfma_f32_16x16x32_bf16 v[24:27], v[192:195], v[232:235], v[24:27]
  ds_read_b128 v[160:163], v239 offset:3072
  v_mfma_f32_16x16x32_bf16 v[28:31], v[196:199], v[228:231], v[28:31]
  ds_read_b128 v[164:167], v239 offset:4096
  v_mfma_f32_16x16x32_bf16 v[32:35], v[196:199], v[232:235], v[32:35]
  ds_read_b128 v[168:171], v239 offset:5120
  v_mfma_f32_16x16x32_bf16 v[36:39], v[200:203], v[228:231], v[36:39]
  ds_read_b128 v[172:175], v239 offset:6144
  v_mfma_f32_16x16x32_bf16 v[40:43], v[200:203], v[232:235], v[40:43]
  ds_read_b128 v[176:179], v239 offset:7168
  v_mfma_f32_16x16x32_bf16 v[44:47], v[204:207], v[228:231], v[44:47]
  ds_read_b128 v[180:183], v239 offset:8192
  v_mfma_f32_16x16x32_bf16 v[48:51], v[204:207], v[232:235], v[48:51]
  v_mfma_f32_16x16x32_bf16 v[52:55], v[208:211], v[228:231], v[52:55]
  buffer_store_dwordx4 v[100:103], v240, s[16:19], s15 offen offset:2048 sc1
  v_mfma_f32_16x16x32_bf16 v[56:59], v[208:211], v[232:235], v[56:59]
  v_mfma_f32_16x16x32_bf16 v[60:63], v[212:215], v[228:231], v[60:63]
  v_mfma_f32_16x16x32_bf16 v[64:67], v[212:215], v[232:235], v[64:67]
  buffer_store_dwordx4 v[104:107], v240, s[16:19], s15 offen offset:3072 sc1
  s_add_u32 s15, s15, 4096
  v_mfma_f32_16x16x32_bf16 v[68:71], v[216:219], v[228:231], v[68:71]
  v_mfma_f32_16x16x32_bf16 v[72:75], v[216:219], v[232:235], v[72:75]
  s_waitcnt lgkmcnt(0)
  v_mfma_f32_16x16x32_bf16 v[4:7], v[148:151], v[220:223], v[4:7]
  ds_read_b128 v[228:231], v237 offset:32768
  v_mfma_f32_16x16x32_bf16 v[8:11], v[148:151], v[224:227], v[8:11]
  ds_read_b128 v[232:235], v237 offset:34816
  v_mfma_f32_16x16x32_bf16 v[12:15], v[152:155], v[220:223], v[12:15]
  ds_read_b128 v[184:187], v239 offset:9216
  v_mfma_f32_16x16x32_bf16 v[16:19], v[152:155], v[224:227], v[16:19]
  ds_read_b128 v[188:191], v239 offset:10240
  v_mfma_f32_16x16x32_bf16 v[20:23], v[156:159], v[220:223], v[20:23]
  ds_read_b128 v[192:195], v239 offset:11264
  v_mfma_f32_16x16x32_bf16 v[24:27], v[156:159], v[224:227], v[24:27]
  ds_read_b128 v[196:199], v239 offset:12288
  v_mfma_f32_16x16x32_bf16 v[28:31], v[160:163], v[220:223], v[28:31]
  ds_read_b128 v[200:203], v239 offset:13312
  v_mfma_f32_16x16x32_bf16 v[32:35], v[160:163], v[224:227], v[32:35]
  ds_read_b128 v[204:207], v239 offset:14336
  v_mfma_f32_16x16x32_bf16 v[36:39], v[164:167], v[220:223], v[36:39]
  ds_read_b128 v[208:211], v239 offset:15360
  v_mfma_f32_16x16x32_bf16 v[40:43], v[164:167], v[224:227], v[40:43]
  ds_read_b128 v[212:215], v239 offset:16384
  v_mfma_f32_16x16x32_bf16 v[44:47], v[168:171], v[220:223], v[44:47]
  ds_read_b128 v[216:219], v239 offset:17408
  v_mfma_f32_16x16x32_bf16 v[48:51], v[168:171], v[224:227], v[48:51]
  v_mfma_f32_16x16x32_bf16 v[52:55], v[172:175], v[220:223], v[52:55]
  buffer_store_dwordx4 v[108:111], v240, s[16:19], s15 offen offset:0 sc1
  v_mfma_f32_16x16x32_bf16 v[56:59], v[172:175], v[224:227], v[56:59]
  v_mfma_f32_16x16x32_bf16 v[60:63], v[176:179], v[220:223], v[60:63]
  v_mfma_f32_16x16x32_bf16 v[64:67], v[176:179], v[224:227], v[64:67]
  v_mfma_f32_16x16x32_bf16 v[68:71], v[180:183], v[220:223], v[68:71]
  v_mfma_f32_16x16x32_bf16 v[72:75], v[180:183], v[224:227], v[72:75]
  s_waitcnt lgkmcnt(0)
  s_barrier
  v_mfma_f32_16x16x32_bf16 v[4:7], v[184:187], v[228:231], v[4:7]
  ds_read_b128 v[220:223], v236 offset:49152
  v_mfma_f32_16x16x32_bf16 v[8:11], v[184:187], v[232:235], v[8:11]
  ds_read_b128 v[224:227], v236 offset:51200
  v_mfma_f32_16x16x32_bf16 v[12:15], v[188:191], v[228:231], v[12:15]
  ds_read_b128 v[148:151], v239 offset:18432
  v_mfma_f32_16x16x32_bf16 v[16:19], v[188:191], v[232:235], v[16:19]
  ds_read_b128 v[152:155], v239 offset:19456
  v_mfma_f32_16x16x32_bf16 v[20:23], v[192:195], v[228:231], v[20:23]
  ds_read_b128 v[156:159], v239 offset:20480
  v_mfma_f32_16x16x32_bf16 v[24:27], v[192:195], v[232:235], v[24:27]
  ds_read_b128 v[160:163], v239 offset:21504
  v_mfma_f32_16x16x32_bf16 v[28:31], v[196:199], v[228:231], v[28:31]
  ds_read_b128 v[164:167], v239 offset:22528
  v_mfma_f32_16x16x32_bf16 v[32:35], v[196:199], v[232:235], v[32:35]
  ds_read_b128 v[168:171], v239 offset:23552
  v_mfma_f32_16x16x32_bf16 v[36:39], v[200:203], v[228:231], v[36:39]
  ds_read_b128 v[172:175], v239 offset:24576
  v_mfma_f32_16x16x32_bf16 v[40:43], v[200:203], v[232:235], v[40:43]
  ds_read_b128 v[176:179], v239 offset:25600
  v_mfma_f32_16x16x32_bf16 v[44:47], v[204:207], v[228:231], v[44:47]
  ds_read_b128 v[180:183], v239 offset:26624
  v_mfma_f32_16x16x32_bf16 v[48:51], v[204:207], v[232:235], v[48:51]
  v_mfma_f32_16x16x32_bf16 v[52:55], v[208:211], v[228:231], v[52:55]
  v_mfma_f32_16x16x32_bf16 v[56:59], v[208:211], v[232:235], v[56:59]
  v_mfma_f32_16x16x32_bf16 v[60:63], v[212:215], v[228:231], v[60:63]
  v_mfma_f32_16x16x32_bf16 v[64:67], v[212:215], v[232:235], v[64:67]
  v_mfma_f32_16x16x32_bf16 v[68:71], v[216:219], v[228:231], v[68:71]
  v_mfma_f32_16x16x32_bf16 v[72:75], v[216:219], v[232:235], v[72:75]
  s_waitcnt lgkmcnt(0)
  v_mfma_f32_16x16x32_bf16 v[4:7], v[148:151], v[220:223], v[4:7]
  ds_read_b128 v[228:231], v237 offset:49152
  v_mfma_f32_16x16x32_bf16 v[8:11], v[148:151], v[224:227], v[8:11]
  ds_read_b128 v[232:235], v237 offset:51200
  v_mfma_f32_16x16x32_bf16 v[12:15], v[152:155], v[220:223], v[12:15]
  ds_read_b128 v[184:187], v239 offset:27648
  v_mfma_f32_16x16x32_bf16 v[16:19], v[152:155], v[224:227], v[16:19]
  ds_read_b128 v[188:191], v239 offset:28672
  v_mfma_f32_16x16x32_bf16 v[20:23], v[156:159], v[220:223], v[20:23]
  ds_read_b128 v[192:195], v239 offset:29696
  v_mfma_f32_16x16x32_bf16 v[24:27], v[156:159], v[224:227], v[24:27]
  ds_read_b128 v[196:199], v239 offset:30720
  v_mfma_f32_16x16x32_bf16 v[28:31], v[160:163], v[220:223], v[28:31]
  ds_read_b128 v[200:203], v239 offset:31744
  v_mfma_f32_16x16x32_bf16 v[32:35], v[160:163], v[224:227], v[32:35]
  ds_read_b128 v[204:207], v239 offset:32768
  v_mfma_f32_16x16x32_bf16 v[36:39], v[164:167], v[220:223], v[36:39]
  ds_read_b128 v[208:211], v239 offset:33792
  v_mfma_f32_16x16x32_bf16 v[40:43], v[164:167], v[224:227], v[40:43]
  ds_read_b128 v[212:215], v239 offset:34816
  v_mfma_f32_16x16x32_bf16 v[44:47], v[168:171], v[220:223], v[44:47]
  ds_read_b128 v[216:219], v239 offset:35840
  v_mfma_f32_16x16x32_bf16 v[48:51], v[168:171], v[224:227], v[48:51]
  v_mfma_f32_16x16x32_bf16 v[52:55], v[172:175], v[220:223], v[52:55]
  v_mfma_f32_16x16x32_bf16 v[56:59], v[172:175], v[224:227], v[56:59]
  v_mfma_f32_16x16x32_bf16 v[60:63], v[176:179], v[220:223], v[60:63]
  v_mfma_f32_16x16x32_bf16 v[64:67], v[176:179], v[224:227], v[64:67]
  v_mfma_f32_16x16x32_bf16 v[68:71], v[180:183], v[220:223], v[68:71]
  v_mfma_f32_16x16x32_bf16 v[72:75], v[180:183], v[224:227], v[72:75]
  s_waitcnt lgkmcnt(0)
  s_waitcnt vmcnt(0)
  s_barrier
  v_mfma_f32_16x16x32_bf16 v[4:7], v[184:187], v[228:231], v[4:7]
  ds_read_b128 v[220:223], v236 offset:0
  v_mfma_f32_16x16x32_bf16 v[8:11], v[184:187], v[232:235], v[8:11]
  ds_read_b128 v[224:227], v236 offset:2048
  v_mfma_f32_16x16x32_bf16 v[12:15], v[188:191], v[228:231], v[12:15]
  ds_read_b128 v[148:151], v238 offset:0
  v_mfma_f32_16x16x32_bf16 v[16:19], v[188:191], v[232:235], v[16:19]
  ds_read_b128 v[152:155], v238 offset:1024
  v_mfma_f32_16x16x32_bf16 v[20:23], v[192:195], v[228:231], v[20:23]
  ds_read_b128 v[156:159], v238 offset:2048
  v_mfma_f32_16x16x32_bf16 v[24:27], v[192:195], v[232:235], v[24:27]
  ds_read_b128 v[160:163], v238 offset:3072
  v_mfma_f32_16x16x32_bf16 v[28:31], v[196:199], v[228:231], v[28:31]
  ds_read_b128 v[164:167], v238 offset:4096
  v_mfma_f32_16x16x32_bf16 v[32:35], v[196:199], v[232:235], v[32:35]
  ds_read_b128 v[168:171], v238 offset:5120
  v_mfma_f32_16x16x32_bf16 v[36:39], v[200:203], v[228:231], v[36:39]
  ds_read_b128 v[172:175], v238 offset:6144
  v_mfma_f32_16x16x32_bf16 v[40:43], v[200:203], v[232:235], v[40:43]
  ds_read_b128 v[176:179], v238 offset:7168
  v_mfma_f32_16x16x32_bf16 v[44:47], v[204:207], v[228:231], v[44:47]
  ds_read_b128 v[180:183], v238 offset:8192
  v_mfma_f32_16x16x32_bf16 v[48:51], v[204:207], v[232:235], v[48:51]
  v_mfma_f32_16x16x32_bf16 v[52:55], v[208:211], v[228:231], v[52:55]
  v_mfma_f32_16x16x32_bf16 v[56:59], v[208:211], v[232:235], v[56:59]
  v_mfma_f32_16x16x32_bf16 v[60:63], v[212:215], v[228:231], v[60:63]
  v_mfma_f32_16x16x32_bf16 v[64:67], v[212:215], v[232:235], v[64:67]
  v_mfma_f32_16x16x32_bf16 v[68:71], v[216:219], v[228:231], v[68:71]
  v_mfma_f32_16x16x32_bf16 v[72:75], v[216:219], v[232:235], v[72:75]
  s_waitcnt lgkmcnt(0)
  v_mfma_f32_16x16x32_bf16 v[4:7], v[148:151], v[220:223], v[4:7]
  ds_read_b128 v[228:231], v237 offset:0
  v_mfma_f32_16x16x32_bf16 v[8:11], v[148:151], v[224:227], v[8:11]
  ds_read_b128 v[232:235], v237 offset:2048
  v_mfma_f32_16x16x32_bf16 v[12:15], v[152:155], v[220:223], v[12:15]
  ds_read_b128 v[184:187], v238 offset:9216
  v_mfma_f32_16x16x32_bf16 v[16:19], v[152:155], v[224:227], v[16:19]
  ds_read_b128 v[188:191], v238 offset:10240
  v_mfma_f32_16x16x32_bf16 v[20:23], v[156:159], v[220:223], v[20:23]
  ds_read_b128 v[192:195], v238 offset:11264
  v_mfma_f32_16x16x32_bf16 v[24:27], v[156:159], v[224:227], v[24:27]
  ds_read_b128 v[196:199], v238 offset:12288
  v_mfma_f32_16x16x32_bf16 v[28:31], v[160:163], v[220:223], v[28:31]
  ds_read_b128 v[200:203], v238 offset:13312
  v_mfma_f32_16x16x32_bf16 v[32:35], v[160:163], v[224:227], v[32:35]
  ds_read_b128 v[204:207], v238 offset:14336
  v_mfma_f32_16x16x32_bf16 v[36:39], v[164:167], v[220:223], v[36:39]
  ds_read_b128 v[208:211], v238 offset:15360
  v_mfma_f32_16x16x32_bf16 v[40:43], v[164:167], v[224:227], v[40:43]
  ds_read_b128 v[212:215], v238 offset:16384
  v_mfma_f32_16x16x32_bf16 v[44:47], v[168:171], v[220:223], v[44:47]
  ds_read_b128 v[216:219], v238 offset:17408
  v_mfma_f32_16x16x32_bf16 v[48:51], v[168:171], v[224:227], v[48:51]
  v_mfma_f32_16x16x32_bf16 v[52:55], v[172:175], v[220:223], v[52:55]
  v_mfma_f32_16x16x32_bf16 v[56:59], v[172:175], v[224:227], v[56:59]
  v_mfma_f32_16x16x32_bf16 v[60:63], v[176:179], v[220:223], v[60:63]
  v_mfma_f32_16x16x32_bf16 v[64:67], v[176:179], v[224:227], v[64:67]
  v_mfma_f32_16x16x32_bf16 v[68:71], v[180:183], v[220:223], v[68:71]
  v_mfma_f32_16x16x32_bf16 v[72:75], v[180:183], v[224:227], v[72:75]
  s_waitcnt lgkmcnt(0)
  s_barrier
  v_mfma_f32_16x16x32_bf16 v[4:7], v[184:187], v[228:231], v[4:7]
  ds_read_b128 v[220:223], v236 offset:16384
  v_mfma_f32_16x16x32_bf16 v[8:11], v[184:187], v[232:235], v[8:11]
  ds_read_b128 v[224:227], v236 offset:18432
  v_mfma_f32_16x16x32_bf16 v[12:15], v[188:191], v[228:231], v[12:15]
  ds_read_b128 v[148:151], v238 offset:18432
  v_mfma_f32_16x16x32_bf16 v[16:19], v[188:191], v[232:235], v[16:19]
  ds_read_b128 v[152:155], v238 offset:19456
  v_mfma_f32_16x16x32_bf16 v[20:23], v[192:195], v[228:231], v[20:23]
  ds_read_b128 v[156:159], v238 offset:20480
  v_mfma_f32_16x16x32_bf16 v[24:27], v[192:195], v[232:235], v[24:27]
  ds_read_b128 v[160:163], v238 offset:21504
  v_mfma_f32_16x16x32_bf16 v[28:31], v[196:199], v[228:231], v[28:31]
  ds_read_b128 v[164:167], v238 offset:22528
  v_mfma_f32_16x16x32_bf16 v[32:35], v[196:199], v[232:235], v[32:35]
  ds_read_b128 v[168:171], v238 offset:23552
  v_mfma_f32_16x16x32_bf16 v[36:39], v[200:203], v[228:231], v[36:39]
  ds_read_b128 v[172:175], v238 offset:24576
  v_mfma_f32_16x16x32_bf16 v[40:43], v[200:203], v[232:235], v[40:43]
  ds_read_b128 v[176:179], v238 offset:25600
  v_mfma_f32_16x16x32_bf16 v[44:47], v[204:207], v[228:231], v[44:47]
  ds_read_b128 v[180:183], v238 offset:26624
  v_mfma_f32_16x16x32_bf16 v[48:51], v[204:207], v[232:235], v[48:51]
  v_mfma_f32_16x16x32_bf16 v[52:55], v[208:211], v[228:231], v[52:55]
  v_mfma_f32_16x16x32_bf16 v[56:59], v[208:211], v[232:235], v[56:59]
  v_mfma_f32_16x16x32_bf16 v[60:63], v[212:215], v[228:231], v[60:63]
  v_mfma_f32_16x16x32_bf16 v[64:67], v[212:215], v[232:235], v[64:67]
  v_mfma_f32_16x16x32_bf16 v[68:71], v[216:219], v[228:231], v[68:71]
  v_mfma_f32_16x16x32_bf16 v[72:75], v[216:219], v[232:235], v[72:75]
  s_waitcnt lgkmcnt(0)
  v_mfma_f32_16x16x32_bf16 v[4:7], v[148:151], v[220:223], v[4:7]
  ds_read_b128 v[228:231], v237 offset:16384
  v_mfma_f32_16x16x32_bf16 v[8:11], v[148:151], v[224:227], v[8:11]
  ds_read_b128 v[232:235], v237 offset:18432
  v_mfma_f32_16x16x32_bf16 v[12:15], v[152:155], v[220:223], v[12:15]
  ds_read_b128 v[184:187], v238 offset:27648
  v_mfma_f32_16x16x32_bf16 v[16:19], v[152:155], v[224:227], v[16:19]
  ds_read_b128 v[188:191], v238 offset:28672
  v_mfma_f32_16x16x32_bf16 v[20:23], v[156:159], v[220:223], v[20:23]
  ds_read_b128 v[192:195], v238 offset:29696
  v_mfma_f32_16x16x32_bf16 v[24:27], v[156:159], v[224:227], v[24:27]
  ds_read_b128 v[196:199], v238 offset:30720
  v_mfma_f32_16x16x32_bf16 v[28:31], v[160:163], v[220:223], v[28:31]
  ds_read_b128 v[200:203], v238 offset:31744
  v_mfma_f32_16x16x32_bf16 v[32:35], v[160:163], v[224:227], v[32:35]
  ds_read_b128 v[204:207], v238 offset:32768
  v_mfma_f32_16x16x32_bf16 v[36:39], v[164:167], v[220:223], v[36:39]
  ds_read_b128 v[208:211], v238 offset:33792
  v_mfma_f32_16x16x32_bf16 v[40:43], v[164:167], v[224:227], v[40:43]
  ds_read_b128 v[212:215], v238 offset:34816
  v_mfma_f32_16x16x32_bf16 v[44:47], v[168:171], v[220:223], v[44:47]
  ds_read_b128 v[216:219], v238 offset:35840
  v_mfma_f32_16x16x32_bf16 v[48:51], v[168:171], v[224:227], v[48:51]
  v_mfma_f32_16x16x32_bf16 v[52:55], v[172:175], v[220:223], v[52:55]
  v_mfma_f32_16x16x32_bf16 v[56:59], v[172:175], v[224:227], v[56:59]
  v_mfma_f32_16x16x32_bf16 v[60:63], v[176:179], v[220:223], v[60:63]
  v_mfma_f32_16x16x32_bf16 v[64:67], v[176:179], v[224:227], v[64:67]
  v_mfma_f32_16x16x32_bf16 v[68:71], v[180:183], v[220:223], v[68:71]
  v_mfma_f32_16x16x32_bf16 v[72:75], v[180:183], v[224:227], v[72:75]
  s_waitcnt lgkmcnt(0)
  v_mfma_f32_16x16x32_bf16 v[4:7], v[184:187], v[228:231], v[4:7]
  ds_read_b32 v220, v0 offset:0
  ds_read_b32 v221, v0 offset:512
  v_mfma_f32_16x16x32_bf16 v[8:11], v[184:187], v[232:235], v[8:11]
  ds_read_b32 v222, v0 offset:16
  v_mfma_f32_16x16x32_bf16 v[12:15], v[188:191], v[228:231], v[12:15]
  ds_read_b32 v223, v0 offset:528
  v_mfma_f32_16x16x32_bf16 v[16:19], v[188:191], v[232:235], v[16:19]
  ds_read_b128 v[76:79], v2 offset:0
  ds_read_b128 v[112:115], v2 offset:576
  v_mfma_f32_16x16x32_bf16 v[20:23], v[192:195], v[228:231], v[20:23]
  ds_read_b128 v[80:83], v2 offset:64
  v_mfma_f32_16x16x32_bf16 v[24:27], v[192:195], v[232:235], v[24:27]
  ds_read_b128 v[116:119], v2 offset:640
  v_mfma_f32_16x16x32_bf16 v[28:31], v[196:199], v[228:231], v[28:31]
  ds_read_b128 v[84:87], v2 offset:128
  ds_read_b128 v[120:123], v2 offset:704
  v_mfma_f32_16x16x32_bf16 v[32:35], v[196:199], v[232:235], v[32:35]
  ds_read_b128 v[88:91], v2 offset:192
  v_mfma_f32_16x16x32_bf16 v[36:39], v[200:203], v[228:231], v[36:39]
  ds_read_b128 v[124:127], v2 offset:768
  v_mfma_f32_16x16x32_bf16 v[40:43], v[200:203], v[232:235], v[40:43]
  ds_read_b128 v[92:95], v2 offset:256
  ds_read_b128 v[128:131], v2 offset:832
  v_mfma_f32_16x16x32_bf16 v[44:47], v[204:207], v[228:231], v[44:47]
  ds_read_b128 v[96:99], v2 offset:320
  v_mfma_f32_16x16x32_bf16 v[48:51], v[204:207], v[232:235], v[48:51]
  ds_read_b128 v[132:135], v2 offset:896
  v_mfma_f32_16x16x32_bf16 v[52:55], v[208:211], v[228:231], v[52:55]
  ds_read_b128 v[100:103], v2 offset:384
  ds_read_b128 v[136:139], v2 offset:960
  v_mfma_f32_16x16x32_bf16 v[56:59], v[208:211], v[232:235], v[56:59]
  ds_read_b128 v[104:107], v2 offset:448
  v_mfma_f32_16x16x32_bf16 v[60:63], v[212:215], v[228:231], v[60:63]
  ds_read_b128 v[140:143], v2 offset:1024
  v_mfma_f32_16x16x32_bf16 v[64:67], v[212:215], v[232:235], v[64:67]
  ds_read_b128 v[108:111], v2 offset:512
  ds_read_b128 v[144:147], v2 offset:1088
  v_mfma_f32_16x16x32_bf16 v[68:71], v[216:219], v[228:231], v[68:71]
  ds_read_b32 v242, v0 offset:1024
  v_mfma_f32_16x16x32_bf16 v[72:75], v[216:219], v[232:235], v[72:75]
  ds_read_b32 v243, v0 offset:1040
L_c_gelua:
  s_nop 7
  v_mov_b32 v236, v3
  v_xor_b32 v237, 64, v3
  v_mov_b32 v224, s26
  v_mov_b32 v225, s26
  s_waitcnt lgkmcnt(0)
  v_pk_fma_f32 v[148:149], v[76:77], v[220:221], v[112:113] op_sel:[0,1,0] op_sel_hi:[1,1,1]
  v_pk_fma_f32 v[150:151], v[78:79], v[220:221], v[114:115] op_sel:[0,1,0] op_sel_hi:[1,1,1]
  v_pk_fma_f32 v[152:153], v[76:77], v[222:223], v[112:113] op_sel:[0,1,0] op_sel_hi:[1,1,1]
  v_pk_fma_f32 v[154:155], v[78:79], v[222:223], v[114:115] op_sel:[0,1,0] op_sel_hi:[1,1,1]
  v_pk_fma_f32 v[4:5], v[4:5], v[220:221], v[148:149] op_sel:[0,0,0] op_sel_hi:[1,0,1]
  v_pk_fma_f32 v[6:7], v[6:7], v[220:221], v[150:151] op_sel:[0,0,0] op_sel_hi:[1,0,1]
  v_pk_fma_f32 v[8:9], v[8:9], v[222:223], v[152:153] op_sel:[0,0,0] op_sel_hi:[1,0,1]
  v_pk_fma_f32 v[10:11], v[10:11], v[222:223], v[154:155] op_sel:[0,0,0] op_sel_hi:[1,0,1]
  v_pk_mul_f32 v[148:149], v[4:5], v[4:5]
  v_pk_mul_f32 v[150:151], v[6:7], v[6:7]
  v_pk_mul_f32 v[152:153], v[8:9], v[8:9]
  v_pk_mul_f32 v[154:155], v[10:11], v[10:11]
  v_pk_fma_f32 v[148:149], v[148:149], s[28:29], v[224:225]
  v_pk_fma_f32 v[150:151], v[150:151], s[28:29], v[224:225]
  v_pk_fma_f32 v[152:153], v[152:153], s[28:29], v[224:225]
  v_pk_fma_f32 v[154:155], v[154:155], s[28:29], v[224:225]
  v_pk_mul_f32 v[148:149], v[148:149], v[4:5]
  v_pk_mul_f32 v[150:151], v[150:151], v[6:7]
  v_pk_mul_f32 v[152:153], v[152:153], v[8:9]
  v_pk_mul_f32 v[154:155], v[154:155], v[10:11]
  v_exp_f32 v148, v148
  v_exp_f32 v149, v149
  v_exp_f32 v150, v150
  v_exp_f32 v151, v151
  v_exp_f32 v152, v152
  v_exp_f32 v153, v153
  v_exp_f32 v154, v154
  v_exp_f32 v155, v155
  v_pk_add_f32 v[148:149], v[148:149], s[30:31]
  v_pk_add_f32 v[150:151], v[150:151], s[30:31]
  v_pk_add_f32 v[152:153], v[152:153], s[30:31]
  v_pk_add_f32 v[154:155], v[154:155], s[30:31]
  v_rcp_f32 v148, v148
  v_rcp_f32 v149, v149
  v_rcp_f32 v150, v150
  v_rcp_f32 v151, v151
  v_rcp_f32 v152, v152
  v_rcp_f32 v153, v153
  v_rcp_f32 v154, v154
  v_rcp_f32 v155, v155
  v_pk_mul_f32 v[4:5], v[4:5], v[148:149]
  v_pk_mul_f32 v[6:7], v[6:7], v[150:151]
  v_pk_mul_f32 v[8:9], v[8:9], v[152:153]
  v_pk_mul_f32 v[10:11], v[10:11], v[154:155]
  v_pk_fma_f32 v[148:149], v[80:81], v[220:221], v[116:117] op_sel:[0,1,0] op_sel_hi:[1,1,1]
  v_pk_fma_f32 v[150:151], v[82:83], v[220:221], v[118:119] op_sel:[0,1,0] op_sel_hi:[1,1,1]
  v_pk_fma_f32 v[152:153], v[80:81], v[222:223], v[116:117] op_sel:[0,1,0] op_sel_hi:[1,1,1]
  v_pk_fma_f32 v[154:155], v[82:83], v[222:223], v[118:119] op_sel:[0,1,0] op_sel_hi:[1,1,1]
  v_pk_fma_f32 v[12:13], v[12:13], v[220:221], v[148:149] op_sel:[0,0,0] op_sel_hi:[1,0,1]
  v_pk_fma_f32 v[14:15], v[14:15], v[220:221], v[150:151] op_sel:[0,0,0] op_sel_hi:[1,0,1]
  v_pk_fma_f32 v[16:17], v[16:17], v[222:223], v[152:153] op_sel:[0,0,0] op_sel_hi:[1,0,1]
  v_pk_fma_f32 v[18:19], v[18:19], v[222:223], v[154:155] op_sel:[0,0,0] op_sel_hi:[1,0,1]
  v_pk_mul_f32 v[148:149], v[12:13], v[12:13]
  v_pk_mul_f32 v[150:151], v[14:15], v[14:15]
  v_pk_mul_f32 v[152:153], v[16:17], v[16:17]
  v_pk_mul_f32 v[154:155], v[18:19], v[18:19]
  v_pk_fma_f32 v[148:149], v[148:149], s[28:29], v[224:225]
  v_pk_fma_f32 v[150:151], v[150:151], s[28:29], v[224:225]
  v_pk_fma_f32 v[152:153], v[152:153], s[28:29], v[224:225]
  v_pk_fma_f32 v[154:155], v[154:155], s[28:29], v[224:225]
  v_pk_mul_f32 v[148:149], v[148:149], v[12:13]
  v_pk_mul_f32 v[150:151], v[150:151], v[14:15]
  v_pk_mul_f32 v[152:153], v[152:153], v[16:17]
  v_pk_mul_f32 v[154:155], v[154:155], v[18:19]
  v_exp_f32 v148, v148
  v_exp_f32 v149, v149
  v_exp_f32 v150, v150
  v_exp_f32 v151, v151
  v_exp_f32 v152, v152
  v_exp_f32 v153, v153
  v_exp_f32 v154, v154
  v_exp_f32 v155, v155
  v_pk_add_f32 v[148:149], v[148:149], s[30:31]
  v_pk_add_f32 v[150:151], v[150:151], s[30:31]
  v_pk_add_f32 v[152:153], v[152:153], s[30:31]
  v_pk_add_f32 v[154:155], v[154:155], s[30:31]
  v_rcp_f32 v148, v148
  v_rcp_f32 v149, v149
  v_rcp_f32 v150, v150
  v_rcp_f32 v151, v151
  v_rcp_f32 v152, v152
  v_rcp_f32 v153, v153
  v_rcp_f32 v154, v154
  v_rcp_f32 v155, v155
  v_pk_mul_f32 v[12:13], v[12:13], v[148:149]
  v_pk_mul_f32 v[14:15], v[14:15], v[150:151]
  v_pk_mul_f32 v[16:17], v[16:17], v[152:153]
  v_pk_mul_f32 v[18:19], v[18:19], v[154:155]
  v_pk_fma_f32 v[148:149], v[84:85], v[220:221], v[120:121] op_sel:[0,1,0] op_sel_hi:[1,1,1]
  v_pk_fma_f32 v[150:151], v[86:87], v[220:221], v[122:123] op_sel:[0,1,0] op_sel_hi:[1,1,1]
  v_pk_fma_f32 v[152:153], v[84:85], v[222:223], v[120:121] op_sel:[0,1,0] op_sel_hi:[1,1,1]
  v_pk_fma_f32 v[154:155], v[86:87], v[222:223], v[122:123] op_sel:[0,1,0] op_sel_hi:[1,1,1]
  v_pk_fma_f32 v[20:21], v[20:21], v[220:221], v[148:149] op_sel:[0,0,0] op_sel_hi:[1,0,1]
  v_pk_fma_f32 v[22:23], v[22:23], v[220:221], v[150:151] op_sel:[0,0,0] op_sel_hi:[1,0,1]
  v_pk_fma_f32 v[24:25], v[24:25], v[222:223], v[152:153] op_sel:[0,0,0] op_sel_hi:[1,0,1]
  v_pk_fma_f32 v[26:27], v[26:27], v[222:223], v[154:155] op_sel:[0,0,0] op_sel_hi:[1,0,1]
  v_pk_mul_f32 v[148:149], v[20:21], v[20:21]
  v_pk_mul_f32 v[150:151], v[22:23], v[22:23]
  v_pk_mul_f32 v[152:153], v[24:25], v[24:25]
  v_pk_mul_f32 v[154:155], v[26:27], v[26:27]
  v_pk_fma_f32 v[148:149], v[148:149], s[28:29], v[224:225]
  v_pk_fma_f32 v[150:151], v[150:151], s[28:29], v[224:225]
  v_pk_fma_f32 v[152:153], v[152:153], s[28:29], v[224:225]
  v_pk_fma_f32 v[154:155], v[154:155], s[28:29], v[224:225]
  v_pk_mul_f32 v[148:149], v[148:149], v[20:21]
  v_pk_mul_f32 v[150:151], v[150:151], v[22:23]
  v_pk_mul_f32 v[152:153], v[152:153], v[24:25]
  v_pk_mul_f32 v[154:155], v[154:155], v[26:27]
  v_exp_f32 v148, v148
  v_exp_f32 v149, v149
  v_exp_f32 v150, v150
  v_exp_f32 v151, v151
  v_exp_f32 v152, v152
  v_exp_f32 v153, v153
  v_exp_f32 v154, v154
  v_exp_f32 v155, v155
  v_pk_add_f32 v[148:149], v[148:149], s[30:31]
  v_pk_add_f32 v[150:151], v[150:151], s[30:31]
  v_pk_add_f32 v[152:153], v[152:153], s[30:31]
  v_pk_add_f32 v[154:155], v[154:155], s[30:31]
  v_rcp_f32 v148, v148
  v_rcp_f32 v149, v149
  v_rcp_f32 v150, v150
  v_rcp_f32 v151, v151
  v_rcp_f32 v152, v152
  v_rcp_f32 v153, v153
  v_rcp_f32 v154, v154
  v_rcp_f32 v155, v155
  v_pk_mul_f32 v[20:21], v[20:21], v[148:149]
  v_pk_mul_f32 v[22:23], v[22:23], v[150:151]
  v_pk_mul_f32 v[24:25], v[24:25], v[152:153]
  v_pk_mul_f32 v[26:27], v[26:27], v[154:155]
  v_pk_fma_f32 v[148:149], v[88:89], v[220:221], v[124:125] op_sel:[0,1,0] op_sel_hi:[1,1,1]
  v_pk_fma_f32 v[150:151], v[90:91], v[220:221], v[126:127] op_sel:[0,1,0] op_sel_hi:[1,1,1]
  v_pk_fma_f32 v[152:153], v[88:89], v[222:223], v[124:125] op_sel:[0,1,0] op_sel_hi:[1,1,1]
  v_pk_fma_f32 v[154:155], v[90:91], v[222:223], v[126:127] op_sel:[0,1,0] op_sel_hi:[1,1,1]
  v_pk_fma_f32 v[28:29], v[28:29], v[220:221], v[148:149] op_sel:[0,0,0] op_sel_hi:[1,0,1]
  v_pk_fma_f32 v[30:31], v[30:31], v[220:221], v[150:151] op_sel:[0,0,0] op_sel_hi:[1,0,1]
  v_pk_fma_f32 v[32:33], v[32:33], v[222:223], v[152:153] op_sel:[0,0,0] op_sel_hi:[1,0,1]
  v_pk_fma_f32 v[34:35], v[34:35], v[222:223], v[154:155] op_sel:[0,0,0] op_sel_hi:[1,0,1]
  v_pk_mul_f32 v[148:149], v[28:29], v[28:29]
  v_pk_mul_f32 v[150:151], v[30:31], v[30:31]
  v_pk_mul_f32 v[152:153], v[32:33], v[32:33]
  v_pk_mul_f32 v[154:155], v[34:35], v[34:35]
  v_pk_fma_f32 v[148:149], v[148:149], s[28:29], v[224:225]
  v_pk_fma_f32 v[150:151], v[150:151], s[28:29], v[224:225]
  v_pk_fma_f32 v[152:153], v[152:153], s[28:29], v[224:225]
  v_pk_fma_f32 v[154:155], v[154:155], s[28:29], v[224:225]
  v_pk_mul_f32 v[148:149], v[148:149], v[28:29]
  v_pk_mul_f32 v[150:151], v[150:151], v[30:31]
  v_pk_mul_f32 v[152:153], v[152:153], v[32:33]
  v_pk_mul_f32 v[154:155], v[154:155], v[34:35]
  v_exp_f32 v148, v148
  v_exp_f32 v149, v149
  v_exp_f32 v150, v150
  v_exp_f32 v151, v151
  v_exp_f32 v152, v152
  v_exp_f32 v153, v153
  v_exp_f32 v154, v154
  v_exp_f32 v155, v155
  v_pk_add_f32 v[148:149], v[148:149], s[30:31]
  v_pk_add_f32 v[150:151], v[150:151], s[30:31]
  v_pk_add_f32 v[152:153], v[152:153], s[30:31]
  v_pk_add_f32 v[154:155], v[154:155], s[30:31]
  v_rcp_f32 v148, v148
  v_rcp_f32 v149, v149
  v_rcp_f32 v150, v150
  v_rcp_f32 v151, v151
  v_rcp_f32 v152, v152
  v_rcp_f32 v153, v153
  v_rcp_f32 v154, v154
  v_rcp_f32 v155, v155
  v_pk_mul_f32 v[28:29], v[28:29], v[148:149]
  v_pk_mul_f32 v[30:31], v[30:31], v[150:151]
  v_pk_mul_f32 v[32:33], v[32:33], v[152:153]
  v_pk_mul_f32 v[34:35], v[34:35], v[154:155]
  v_pk_fma_f32 v[148:149], v[92:93], v[220:221], v[128:129] op_sel:[0,1,0] op_sel_hi:[1,1,1]
  v_pk_fma_f32 v[150:151], v[94:95], v[220:221], v[130:131] op_sel:[0,1,0] op_sel_hi:[1,1,1]
  v_pk_fma_f32 v[152:153], v[92:93], v[222:223], v[128:129] op_sel:[0,1,0] op_sel_hi:[1,1,1]
  v_pk_fma_f32 v[154:155], v[94:95], v[222:223], v[130:131] op_sel:[0,1,0] op_sel_hi:[1,1,1]
  v_pk_fma_f32 v[36:37], v[36:37], v[220:221], v[148:149] op_sel:[0,0,0] op_sel_hi:[1,0,1]
  v_pk_fma_f32 v[38:39], v[38:39], v[220:221], v[150:151] op_sel:[0,0,0] op_sel_hi:[1,0,1]
  v_pk_fma_f32 v[40:41], v[40:41], v[222:223], v[152:153] op_sel:[0,0,0] op_sel_hi:[1,0,1]
  v_pk_fma_f32 v[42:43], v[42:43], v[222:223], v[154:155] op_sel:[0,0,0] op_sel_hi:[1,0,1]
  v_pk_mul_f32 v[148:149], v[36:37], v[36:37]
  v_pk_mul_f32 v[150:151], v[38:39], v[38:39]
  v_pk_mul_f32 v[152:153], v[40:41], v[40:41]
  v_pk_mul_f32 v[154:155], v[42:43], v[42:43]
  v_pk_fma_f32 v[148:149], v[148:149], s[28:29], v[224:225]
  v_pk_fma_f32 v[150:151], v[150:151], s[28:29], v[224:225]
  v_pk_fma_f32 v[152:153], v[152:153], s[28:29], v[224:225]
  v_pk_fma_f32 v[154:155], v[154:155], s[28:29], v[224:225]
  v_pk_mul_f32 v[148:149], v[148:149], v[36:37]
  v_pk_mul_f32 v[150:151], v[150:151], v[38:39]
  v_pk_mul_f32 v[152:153], v[152:153], v[40:41]
  v_pk_mul_f32 v[154:155], v[154:155], v[42:43]
  v_exp_f32 v148, v148
  v_exp_f32 v149, v149
  v_exp_f32 v150, v150
  v_exp_f32 v151, v151
  v_exp_f32 v152, v152
  v_exp_f32 v153, v153
  v_exp_f32 v154, v154
  v_exp_f32 v155, v155
  v_pk_add_f32 v[148:149], v[148:149], s[30:31]
  v_pk_add_f32 v[150:151], v[150:151], s[30:31]
  v_pk_add_f32 v[152:153], v[152:153], s[30:31]
  v_pk_add_f32 v[154:155], v[154:155], s[30:31]
  v_rcp_f32 v148, v148
  v_rcp_f32 v149, v149
  v_rcp_f32 v150, v150
  v_rcp_f32 v151, v151
  v_rcp_f32 v152, v152
  v_rcp_f32 v153, v153
  v_rcp_f32 v154, v154
  v_rcp_f32 v155, v155
  v_pk_mul_f32 v[36:37], v[36:37], v[148:149]
  v_pk_mul_f32 v[38:39], v[38:39], v[150:151]
  v_pk_mul_f32 v[40:41], v[40:41], v[152:153]
  v_pk_mul_f32 v[42:43], v[42:43], v[154:155]
  v_pk_fma_f32 v[148:149], v[96:97], v[220:221], v[132:133] op_sel:[0,1,0] op_sel_hi:[1,1,1]
  v_pk_fma_f32 v[150:151], v[98:99], v[220:221], v[134:135] op_sel:[0,1,0] op_sel_hi:[1,1,1]
  v_pk_fma_f32 v[152:153], v[96:97], v[222:223], v[132:133] op_sel:[0,1,0] op_sel_hi:[1,1,1]
  v_pk_fma_f32 v[154:155], v[98:99], v[222:223], v[134:135] op_sel:[0,1,0] op_sel_hi:[1,1,1]
  v_pk_fma_f32 v[44:45], v[44:45], v[220:221], v[148:149] op_sel:[0,0,0] op_sel_hi:[1,0,1]
  v_pk_fma_f32 v[46:47], v[46:47], v[220:221], v[150:151] op_sel:[0,0,0] op_sel_hi:[1,0,1]
  v_pk_fma_f32 v[48:49], v[48:49], v[222:223], v[152:153] op_sel:[0,0,0] op_sel_hi:[1,0,1]
  v_pk_fma_f32 v[50:51], v[50:51], v[222:223], v[154:155] op_sel:[0,0,0] op_sel_hi:[1,0,1]
  v_pk_mul_f32 v[148:149], v[44:45], v[44:45]
  v_pk_mul_f32 v[150:151], v[46:47], v[46:47]
  v_pk_mul_f32 v[152:153], v[48:49], v[48:49]
  v_pk_mul_f32 v[154:155], v[50:51], v[50:51]
  v_pk_fma_f32 v[148:149], v[148:149], s[28:29], v[224:225]
  v_pk_fma_f32 v[150:151], v[150:151], s[28:29], v[224:225]
  v_pk_fma_f32 v[152:153], v[152:153], s[28:29], v[224:225]
  v_pk_fma_f32 v[154:155], v[154:155], s[28:29], v[224:225]
  v_pk_mul_f32 v[148:149], v[148:149], v[44:45]
  v_pk_mul_f32 v[150:151], v[150:151], v[46:47]
  v_pk_mul_f32 v[152:153], v[152:153], v[48:49]
  v_pk_mul_f32 v[154:155], v[154:155], v[50:51]
  v_exp_f32 v148, v148
  v_exp_f32 v149, v149
  v_exp_f32 v150, v150
  v_exp_f32 v151, v151
  v_exp_f32 v152, v152
  v_exp_f32 v153, v153
  v_exp_f32 v154, v154
  v_exp_f32 v155, v155
  v_pk_add_f32 v[148:149], v[148:149], s[30:31]
  v_pk_add_f32 v[150:151], v[150:151], s[30:31]
  v_pk_add_f32 v[152:153], v[152:153], s[30:31]
  v_pk_add_f32 v[154:155], v[154:155], s[30:31]
  v_rcp_f32 v148, v148
  v_rcp_f32 v149, v149
  v_rcp_f32 v150, v150
  v_rcp_f32 v151, v151
  v_rcp_f32 v152, v152
  v_rcp_f32 v153, v153
  v_rcp_f32 v154, v154
  v_rcp_f32 v155, v155
  v_pk_mul_f32 v[44:45], v[44:45], v[148:149]
  v_pk_mul_f32 v[46:47], v[46:47], v[150:151]
  v_pk_mul_f32 v[48:49], v[48:49], v[152:153]
  v_pk_mul_f32 v[50:51], v[50:51], v[154:155]
  v_pk_fma_f32 v[148:149], v[100:101], v[220:221], v[136:137] op_sel:[0,1,0] op_sel_hi:[1,1,1]
  v_pk_fma_f32 v[150:151], v[102:103], v[220:221], v[138:139] op_sel:[0,1,0] op_sel_hi:[1,1,1]
  v_pk_fma_f32 v[152:153], v[100:101], v[222:223], v[136:137] op_sel:[0,1,0] op_sel_hi:[1,1,1]
  v_pk_fma_f32 v[154:155], v[102:103], v[222:223], v[138:139] op_sel:[0,1,0] op_sel_hi:[1,1,1]
  v_pk_fma_f32 v[52:53], v[52:53], v[220:221], v[148:149] op_sel:[0,0,0] op_sel_hi:[1,0,1]
  v_pk_fma_f32 v[54:55], v[54:55], v[220:221], v[150:151] op_sel:[0,0,0] op_sel_hi:[1,0,1]
  v_pk_fma_f32 v[56:57], v[56:57], v[222:223], v[152:153] op_sel:[0,0,0] op_sel_hi:[1,0,1]
  v_pk_fma_f32 v[58:59], v[58:59], v[222:223], v[154:155] op_sel:[0,0,0] op_sel_hi:[1,0,1]
  v_pk_mul_f32 v[148:149], v[52:53], v[52:53]
  v_pk_mul_f32 v[150:151], v[54:55], v[54:55]
  v_pk_mul_f32 v[152:153], v[56:57], v[56:57]
  v_pk_mul_f32 v[154:155], v[58:59], v[58:59]
  v_pk_fma_f32 v[148:149], v[148:149], s[28:29], v[224:225]
  v_pk_fma_f32 v[150:151], v[150:151], s[28:29], v[224:225]
  v_pk_fma_f32 v[152:153], v[152:153], s[28:29], v[224:225]
  v_pk_fma_f32 v[154:155], v[154:155], s[28:29], v[224:225]
  v_pk_mul_f32 v[148:149], v[148:149], v[52:53]
  v_pk_mul_f32 v[150:151], v[150:151], v[54:55]
  v_pk_mul_f32 v[152:153], v[152:153], v[56:57]
  v_pk_mul_f32 v[154:155], v[154:155], v[58:59]
  v_exp_f32 v148, v148
  v_exp_f32 v149, v149
  v_exp_f32 v150, v150
  v_exp_f32 v151, v151
  v_exp_f32 v152, v152
  v_exp_f32 v153, v153
  v_exp_f32 v154, v154
  v_exp_f32 v155, v155
  v_pk_add_f32 v[148:149], v[148:149], s[30:31]
  v_pk_add_f32 v[150:151], v[150:151], s[30:31]
  v_pk_add_f32 v[152:153], v[152:153], s[30:31]
  v_pk_add_f32 v[154:155], v[154:155], s[30:31]
  v_rcp_f32 v148, v148
  v_rcp_f32 v149, v149
  v_rcp_f32 v150, v150
  v_rcp_f32 v151, v151
  v_rcp_f32 v152, v152
  v_rcp_f32 v153, v153
  v_rcp_f32 v154, v154
  v_rcp_f32 v155, v155
  v_pk_mul_f32 v[52:53], v[52:53], v[148:149]
  v_pk_mul_f32 v[54:55], v[54:55], v[150:151]
  v_pk_mul_f32 v[56:57], v[56:57], v[152:153]
  v_pk_mul_f32 v[58:59], v[58:59], v[154:155]
  v_pk_fma_f32 v[148:149], v[104:105], v[220:221], v[140:141] op_sel:[0,1,0] op_sel_hi:[1,1,1]
  v_pk_fma_f32 v[150:151], v[106:107], v[220:221], v[142:143] op_sel:[0,1,0] op_sel_hi:[1,1,1]
  v_pk_fma_f32 v[152:153], v[104:105], v[222:223], v[140:141] op_sel:[0,1,0] op_sel_hi:[1,1,1]
  v_pk_fma_f32 v[154:155], v[106:107], v[222:223], v[142:143] op_sel:[0,1,0] op_sel_hi:[1,1,1]
  v_pk_fma_f32 v[60:61], v[60:61], v[220:221], v[148:149] op_sel:[0,0,0] op_sel_hi:[1,0,1]
  v_pk_fma_f32 v[62:63], v[62:63], v[220:221], v[150:151] op_sel:[0,0,0] op_sel_hi:[1,0,1]
  v_pk_fma_f32 v[64:65], v[64:65], v[222:223], v[152:153] op_sel:[0,0,0] op_sel_hi:[1,0,1]
  v_pk_fma_f32 v[66:67], v[66:67], v[222:223], v[154:155] op_sel:[0,0,0] op_sel_hi:[1,0,1]
  v_pk_mul_f32 v[148:149], v[60:61], v[60:61]
  v_pk_mul_f32 v[150:151], v[62:63], v[62:63]
  v_pk_mul_f32 v[152:153], v[64:65], v[64:65]
  v_pk_mul_f32 v[154:155], v[66:67], v[66:67]
  v_pk_fma_f32 v[148:149], v[148:149], s[28:29], v[224:225]
  v_pk_fma_f32 v[150:151], v[150:151], s[28:29], v[224:225]
  v_pk_fma_f32 v[152:153], v[152:153], s[28:29], v[224:225]
  v_pk_fma_f32 v[154:155], v[154:155], s[28:29], v[224:225]
  v_pk_mul_f32 v[148:149], v[148:149], v[60:61]
  v_pk_mul_f32 v[150:151], v[150:151], v[62:63]
  v_pk_mul_f32 v[152:153], v[152:153], v[64:65]
  v_pk_mul_f32 v[154:155], v[154:155], v[66:67]
  v_exp_f32 v148, v148
  v_exp_f32 v149, v149
  v_exp_f32 v150, v150
  v_exp_f32 v151, v151
  v_exp_f32 v152, v152
  v_exp_f32 v153, v153
  v_exp_f32 v154, v154
  v_exp_f32 v155, v155
  v_pk_add_f32 v[148:149], v[148:149], s[30:31]
  v_pk_add_f32 v[150:151], v[150:151], s[30:31]
  v_pk_add_f32 v[152:153], v[152:153], s[30:31]
  v_pk_add_f32 v[154:155], v[154:155], s[30:31]
  v_rcp_f32 v148, v148
  v_rcp_f32 v149, v149
  v_rcp_f32 v150, v150
  v_rcp_f32 v151, v151
  v_rcp_f32 v152, v152
  v_rcp_f32 v153, v153
  v_rcp_f32 v154, v154
  v_rcp_f32 v155, v155
  v_pk_mul_f32 v[60:61], v[60:61], v[148:149]
  v_pk_mul_f32 v[62:63], v[62:63], v[150:151]
  v_pk_mul_f32 v[64:65], v[64:65], v[152:153]
  v_pk_mul_f32 v[66:67], v[66:67], v[154:155]
  v_pk_fma_f32 v[148:149], v[108:109], v[220:221], v[144:145] op_sel:[0,1,0] op_sel_hi:[1,1,1]
  v_pk_fma_f32 v[150:151], v[110:111], v[220:221], v[146:147] op_sel:[0,1,0] op_sel_hi:[1,1,1]
  v_pk_fma_f32 v[152:153], v[108:109], v[222:223], v[144:145] op_sel:[0,1,0] op_sel_hi:[1,1,1]
  v_pk_fma_f32 v[154:155], v[110:111], v[222:223], v[146:147] op_sel:[0,1,0] op_sel_hi:[1,1,1]
  v_pk_fma_f32 v[68:69], v[68:69], v[220:221], v[148:149] op_sel:[0,0,0] op_sel_hi:[1,0,1]
  v_pk_fma_f32 v[70:71], v[70:71], v[220:221], v[150:151] op_sel:[0,0,0] op_sel_hi:[1,0,1]
  v_pk_fma_f32 v[72:73], v[72:73], v[222:223], v[152:153] op_sel:[0,0,0] op_sel_hi:[1,0,1]
  v_pk_fma_f32 v[74:75], v[74:75], v[222:223], v[154:155] op_sel:[0,0,0] op_sel_hi:[1,0,1]
  v_pk_mul_f32 v[148:149], v[68:69], v[68:69]
  v_pk_mul_f32 v[150:151], v[70:71], v[70:71]
  v_pk_mul_f32 v[152:153], v[72:73], v[72:73]
  v_pk_mul_f32 v[154:155], v[74:75], v[74:75]
  v_pk_fma_f32 v[148:149], v[148:149], s[28:29], v[224:225]
  v_pk_fma_f32 v[150:151], v[150:151], s[28:29], v[224:225]
  v_pk_fma_f32 v[152:153], v[152:153], s[28:29], v[224:225]
  v_pk_fma_f32 v[154:155], v[154:155], s[28:29], v[224:225]
  v_pk_mul_f32 v[148:149], v[148:149], v[68:69]
  v_pk_mul_f32 v[150:151], v[150:151], v[70:71]
  v_pk_mul_f32 v[152:153], v[152:153], v[72:73]
  v_pk_mul_f32 v[154:155], v[154:155], v[74:75]
  v_exp_f32 v148, v148
  v_exp_f32 v149, v149
  v_exp_f32 v150, v150
  v_exp_f32 v151, v151
  v_exp_f32 v152, v152
  v_exp_f32 v153, v153
  v_exp_f32 v154, v154
  v_exp_f32 v155, v155
  v_pk_add_f32 v[148:149], v[148:149], s[30:31]
  v_pk_add_f32 v[150:151], v[150:151], s[30:31]
  v_pk_add_f32 v[152:153], v[152:153], s[30:31]
  v_pk_add_f32 v[154:155], v[154:155], s[30:31]
  v_rcp_f32 v148, v148
  v_rcp_f32 v149, v149
  v_rcp_f32 v150, v150
  v_rcp_f32 v151, v151
  v_rcp_f32 v152, v152
  v_rcp_f32 v153, v153
  v_rcp_f32 v154, v154
  v_rcp_f32 v155, v155
  v_pk_mul_f32 v[68:69], v[68:69], v[148:149]
  v_pk_mul_f32 v[70:71], v[70:71], v[150:151]
  v_pk_mul_f32 v[72:73], v[72:73], v[152:153]
  v_pk_mul_f32 v[74:75], v[74:75], v[154:155]
  s_barrier
  ds_read_b128 v[220:223], v236 offset:32768
  ds_read_b128 v[224:227], v236 offset:34816
  ds_read_b128 v[148:151], v239 offset:0
  ds_read_b128 v[152:155], v239 offset:1024
  ds_read_b128 v[156:159], v239 offset:2048
  ds_read_b128 v[160:163], v239 offset:3072
  ds_read_b128 v[164:167], v239 offset:4096
  ds_read_b128 v[168:171], v239 offset:5120
  ds_read_b128 v[172:175], v239 offset:6144
  ds_read_b128 v[176:179], v239 offset:7168
  ds_read_b128 v[180:183], v239 offset:8192
  s_waitcnt lgkmcnt(0)
  v_mfma_f32_16x16x32_bf16 v[76:79], v[148:151], v[220:223], 0
  ds_read_b128 v[228:231], v237 offset:32768
  v_mfma_f32_16x16x32_bf16 v[80:83], v[148:151], v[224:227], 0
  ds_read_b128 v[232:235], v237 offset:34816
  v_mfma_f32_16x16x32_bf16 v[84:87], v[152:155], v[220:223], 0
  ds_read_b128 v[184:187], v239 offset:9216
  v_mfma_f32_16x16x32_bf16 v[88:91], v[152:155], v[224:227], 0
  ds_read_b128 v[188:191], v239 offset:10240
  v_mfma_f32_16x16x32_bf16 v[92:95], v[156:159], v[220:223], 0
  ds_read_b128 v[192:195], v239 offset:11264
  v_mfma_f32_16x16x32_bf16 v[96:99], v[156:159], v[224:227], 0
  ds_read_b128 v[196:199], v239 offset:12288
  v_mfma_f32_16x16x32_bf16 v[100:103], v[160:163], v[220:223], 0
  ds_read_b128 v[200:203], v239 offset:13312
  v_mfma_f32_16x16x32_bf16 v[104:107], v[160:163], v[224:227], 0
  ds_read_b128 v[204:207], v239 offset:14336
  v_mfma_f32_16x16x32_bf16 v[108:111], v[164:167], v[220:223], 0
  ds_read_b128 v[208:211], v239 offset:15360
  v_mfma_f32_16x16x32_bf16 v[112:115], v[164:167], v[224:227], 0
  ds_read_b128 v[212:215], v239 offset:16384
  v_mfma_f32_16x16x32_bf16 v[116:119], v[168:171], v[220:223], 0
  ds_read_b128 v[216:219], v239 offset:17408
  v_mfma_f32_16x16x32_bf16 v[120:123], v[168:171], v[224:227], 0
  v_mfma_f32_16x16x32_bf16 v[124:127], v[172:175], v[220:223], 0
  v_mfma_f32_16x16x32_bf16 v[128:131], v[172:175], v[224:227], 0
  v_mfma_f32_16x16x32_bf16 v[132:135], v[176:179], v[220:223], 0
  v_mfma_f32_16x16x32_bf16 v[136:139], v[176:179], v[224:227], 0
  v_mfma_f32_16x16x32_bf16 v[140:143], v[180:183], v[220:223], 0
  v_mfma_f32_16x16x32_bf16 v[144:147], v[180:183], v[224:227], 0
  s_waitcnt lgkmcnt(0)
  s_barrier
  v_mfma_f32_16x16x32_bf16 v[76:79], v[184:187], v[228:231], v[76:79]
  ds_read_b128 v[220:223], v236 offset:49152
  v_mfma_f32_16x16x32_bf16 v[80:83], v[184:187], v[232:235], v[80:83]
  ds_read_b128 v[224:227], v236 offset:51200
  v_mfma_f32_16x16x32_bf16 v[84:87], v[188:191], v[228:231], v[84:87]
  ds_read_b128 v[148:151], v239 offset:18432
  v_mfma_f32_16x16x32_bf16 v[88:91], v[188:191], v[232:235], v[88:91]
  ds_read_b128 v[152:155], v239 offset:19456
  v_mfma_f32_16x16x32_bf16 v[92:95], v[192:195], v[228:231], v[92:95]
  ds_read_b128 v[156:159], v239 offset:20480
  v_mfma_f32_16x16x32_bf16 v[96:99], v[192:195], v[232:235], v[96:99]
  ds_read_b128 v[160:163], v239 offset:21504
  v_mfma_f32_16x16x32_bf16 v[100:103], v[196:199], v[228:231], v[100:103]
  ds_read_b128 v[164:167], v239 offset:22528
  v_mfma_f32_16x16x32_bf16 v[104:107], v[196:199], v[232:235], v[104:107]
  ds_read_b128 v[168:171], v239 offset:23552
  v_mfma_f32_16x16x32_bf16 v[108:111], v[200:203], v[228:231], v[108:111]
  ds_read_b128 v[172:175], v239 offset:24576
  v_mfma_f32_16x16x32_bf16 v[112:115], v[200:203], v[232:235], v[112:115]
  ds_read_b128 v[176:179], v239 offset:25600
  v_mfma_f32_16x16x32_bf16 v[116:119], v[204:207], v[228:231], v[116:119]
  ds_read_b128 v[180:183], v239 offset:26624
  v_mfma_f32_16x16x32_bf16 v[120:123], v[204:207], v[232:235], v[120:123]
  v_mfma_f32_16x16x32_bf16 v[124:127], v[208:211], v[228:231], v[124:127]
  v_mfma_f32_16x16x32_bf16 v[128:131], v[208:211], v[232:235], v[128:131]
  v_mfma_f32_16x16x32_bf16 v[132:135], v[212:215], v[228:231], v[132:135]
  v_mfma_f32_16x16x32_bf16 v[136:139], v[212:215], v[232:235], v[136:139]
  v_mfma_f32_16x16x32_bf16 v[140:143], v[216:219], v[228:231], v[140:143]
  v_mfma_f32_16x16x32_bf16 v[144:147], v[216:219], v[232:235], v[144:147]
  s_waitcnt lgkmcnt(0)
  v_mfma_f32_16x16x32_bf16 v[76:79], v[148:151], v[220:223], v[76:79]
  ds_read_b128 v[228:231], v237 offset:49152
  v_mfma_f32_16x16x32_bf16 v[80:83], v[148:151], v[224:227], v[80:83]
  ds_read_b128 v[232:235], v237 offset:51200
  v_mfma_f32_16x16x32_bf16 v[84:87], v[152:155], v[220:223], v[84:87]
  ds_read_b128 v[184:187], v239 offset:27648
  v_mfma_f32_16x16x32_bf16 v[88:91], v[152:155], v[224:227], v[88:91]
  ds_read_b128 v[188:191], v239 offset:28672
  v_mfma_f32_16x16x32_bf16 v[92:95], v[156:159], v[220:223], v[92:95]
  ds_read_b128 v[192:195], v239 offset:29696
  v_mfma_f32_16x16x32_bf16 v[96:99], v[156:159], v[224:227], v[96:99]
  ds_read_b128 v[196:199], v239 offset:30720
  v_mfma_f32_16x16x32_bf16 v[100:103], v[160:163], v[220:223], v[100:103]
  ds_read_b128 v[200:203], v239 offset:31744
  v_mfma_f32_16x16x32_bf16 v[104:107], v[160:163], v[224:227], v[104:107]
  ds_read_b128 v[204:207], v239 offset:32768
  v_mfma_f32_16x16x32_bf16 v[108:111], v[164:167], v[220:223], v[108:111]
  ds_read_b128 v[208:211], v239 offset:33792
  v_mfma_f32_16x16x32_bf16 v[112:115], v[164:167], v[224:227], v[112:115]
  ds_read_b128 v[212:215], v239 offset:34816
  v_mfma_f32_16x16x32_bf16 v[116:119], v[168:171], v[220:223], v[116:119]
  ds_read_b128 v[216:219], v239 offset:35840
  v_mfma_f32_16x16x32_bf16 v[120:123], v[168:171], v[224:227], v[120:123]
  v_mfma_f32_16x16x32_bf16 v[124:127], v[172:175], v[220:223], v[124:127]
  v_mfma_f32_16x16x32_bf16 v[128:131], v[172:175], v[224:227], v[128:131]
  v_mfma_f32_16x16x32_bf16 v[132:135], v[176:179], v[220:223], v[132:135]
  v_mfma_f32_16x16x32_bf16 v[136:139], v[176:179], v[224:227], v[136:139]
  v_mfma_f32_16x16x32_bf16 v[140:143], v[180:183], v[220:223], v[140:143]
  v_mfma_f32_16x16x32_bf16 v[144:147], v[180:183], v[224:227], v[144:147]
  s_waitcnt lgkmcnt(0)
  s_barrier
  v_mfma_f32_16x16x32_bf16 v[76:79], v[184:187], v[228:231], v[76:79]
  ds_read_b128 v[220:223], v236 offset:0
  v_mfma_f32_16x16x32_bf16 v[80:83], v[184:187], v[232:235], v[80:83]
  ds_read_b128 v[224:227], v236 offset:2048
  v_mfma_f32_16x16x32_bf16 v[84:87], v[188:191], v[228:231], v[84:87]
  ds_read_b128 v[148:151], v238 offset:0
  v_mfma_f32_16x16x32_bf16 v[88:91], v[188:191], v[232:235], v[88:91]
  ds_read_b128 v[152:155], v238 offset:1024
  v_mfma_f32_16x16x32_bf16 v[92:95], v[192:195], v[228:231], v[92:95]
  ds_read_b128 v[156:159], v238 offset:2048
  v_mfma_f32_16x16x32_bf16 v[96:99], v[192:195], v[232:235], v[96:99]
  ds_read_b128 v[160:163], v238 offset:3072
  v_mfma_f32_16x16x32_bf16 v[100:103], v[196:199], v[228:231], v[100:103]
  ds_read_b128 v[164:167], v238 offset:4096
  v_mfma_f32_16x16x32_bf16 v[104:107], v[196:199], v[232:235], v[104:107]
  ds_read_b128 v[168:171], v238 offset:5120
  v_mfma_f32_16x16x32_bf16 v[108:111], v[200:203], v[228:231], v[108:111]
  ds_read_b128 v[172:175], v238 offset:6144
  v_mfma_f32_16x16x32_bf16 v[112:115], v[200:203], v[232:235], v[112:115]
  ds_read_b128 v[176:179], v238 offset:7168
  v_mfma_f32_16x16x32_bf16 v[116:119], v[204:207], v[228:231], v[116:119]
  ds_read_b128 v[180:183], v238 offset:8192
  v_mfma_f32_16x16x32_bf16 v[120:123], v[204:207], v[232:235], v[120:123]
  v_mfma_f32_16x16x32_bf16 v[124:127], v[208:211], v[228:231], v[124:127]
  v_mfma_f32_16x16x32_bf16 v[128:131], v[208:211], v[232:235], v[128:131]
  v_mfma_f32_16x16x32_bf16 v[132:135], v[212:215], v[228:231], v[132:135]
  v_mfma_f32_16x16x32_bf16 v[136:139], v[212:215], v[232:235], v[136:139]
  v_mfma_f32_16x16x32_bf16 v[140:143], v[216:219], v[228:231], v[140:143]
  v_mfma_f32_16x16x32_bf16 v[144:147], v[216:219], v[232:235], v[144:147]
  s_waitcnt lgkmcnt(0)
  v_mfma_f32_16x16x32_bf16 v[76:79], v[148:151], v[220:223], v[76:79]
  ds_read_b128 v[228:231], v237 offset:0
  v_mfma_f32_16x16x32_bf16 v[80:83], v[148:151], v[224:227], v[80:83]
  ds_read_b128 v[232:235], v237 offset:2048
  v_mfma_f32_16x16x32_bf16 v[84:87], v[152:155], v[220:223], v[84:87]
  ds_read_b128 v[184:187], v238 offset:9216
  v_mfma_f32_16x16x32_bf16 v[88:91], v[152:155], v[224:227], v[88:91]
  ds_read_b128 v[188:191], v238 offset:10240
  v_mfma_f32_16x16x32_bf16 v[92:95], v[156:159], v[220:223], v[92:95]
  ds_read_b128 v[192:195], v238 offset:11264
  v_mfma_f32_16x16x32_bf16 v[96:99], v[156:159], v[224:227], v[96:99]
  ds_read_b128 v[196:199], v238 offset:12288
  v_mfma_f32_16x16x32_bf16 v[100:103], v[160:163], v[220:223], v[100:103]
  ds_read_b128 v[200:203], v238 offset:13312
  v_mfma_f32_16x16x32_bf16 v[104:107], v[160:163], v[224:227], v[104:107]
  ds_read_b128 v[204:207], v238 offset:14336
  v_mfma_f32_16x16x32_bf16 v[108:111], v[164:167], v[220:223], v[108:111]
  ds_read_b128 v[208:211], v238 offset:15360
  v_mfma_f32_16x16x32_bf16 v[112:115], v[164:167], v[224:227], v[112:115]
  ds_read_b128 v[212:215], v238 offset:16384
  v_mfma_f32_16x16x32_bf16 v[116:119], v[168:171], v[220:223], v[116:119]
  ds_read_b128 v[216:219], v238 offset:17408
  v_mfma_f32_16x16x32_bf16 v[120:123], v[168:171], v[224:227], v[120:123]
  v_mfma_f32_16x16x32_bf16 v[124:127], v[172:175], v[220:223], v[124:127]
  v_mfma_f32_16x16x32_bf16 v[128:131], v[172:175], v[224:227], v[128:131]
  v_mfma_f32_16x16x32_bf16 v[132:135], v[176:179], v[220:223], v[132:135]
  v_mfma_f32_16x16x32_bf16 v[136:139], v[176:179], v[224:227], v[136:139]
  v_mfma_f32_16x16x32_bf16 v[140:143], v[180:183], v[220:223], v[140:143]
  v_mfma_f32_16x16x32_bf16 v[144:147], v[180:183], v[224:227], v[144:147]
  s_waitcnt lgkmcnt(0)
  s_barrier
  v_mfma_f32_16x16x32_bf16 v[76:79], v[184:187], v[228:231], v[76:79]
  ds_read_b128 v[220:223], v236 offset:16384
  v_mfma_f32_16x16x32_bf16 v[80:83], v[184:187], v[232:235], v[80:83]
  ds_read_b128 v[224:227], v236 offset:18432
  v_mfma_f32_16x16x32_bf16 v[84:87], v[188:191], v[228:231], v[84:87]
  ds_read_b128 v[148:151], v238 offset:18432
  v_mfma_f32_16x16x32_bf16 v[88:91], v[188:191], v[232:235], v[88:91]
  ds_read_b128 v[152:155], v238 offset:19456
  v_mfma_f32_16x16x32_bf16 v[92:95], v[192:195], v[228:231], v[92:95]
  ds_read_b128 v[156:159], v238 offset:20480
  v_mfma_f32_16x16x32_bf16 v[96:99], v[192:195], v[232:235], v[96:99]
  ds_read_b128 v[160:163], v238 offset:21504
  v_mfma_f32_16x16x32_bf16 v[100:103], v[196:199], v[228:231], v[100:103]
  ds_read_b128 v[164:167], v238 offset:22528
  v_mfma_f32_16x16x32_bf16 v[104:107], v[196:199], v[232:235], v[104:107]
  ds_read_b128 v[168:171], v238 offset:23552
  v_mfma_f32_16x16x32_bf16 v[108:111], v[200:203], v[228:231], v[108:111]
  ds_read_b128 v[172:175], v238 offset:24576
  v_mfma_f32_16x16x32_bf16 v[112:115], v[200:203], v[232:235], v[112:115]
  ds_read_b128 v[176:179], v238 offset:25600
  v_mfma_f32_16x16x32_bf16 v[116:119], v[204:207], v[228:231], v[116:119]
  ds_read_b128 v[180:183], v238 offset:26624
  v_mfma_f32_16x16x32_bf16 v[120:123], v[204:207], v[232:235], v[120:123]
  v_mfma_f32_16x16x32_bf16 v[124:127], v[208:211], v[228:231], v[124:127]
  v_mfma_f32_16x16x32_bf16 v[128:131], v[208:211], v[232:235], v[128:131]
  v_mfma_f32_16x16x32_bf16 v[132:135], v[212:215], v[228:231], v[132:135]
  v_mfma_f32_16x16x32_bf16 v[136:139], v[212:215], v[232:235], v[136:139]
  v_mfma_f32_16x16x32_bf16 v[140:143], v[216:219], v[228:231], v[140:143]
  v_mfma_f32_16x16x32_bf16 v[144:147], v[216:219], v[232:235], v[144:147]
  s_waitcnt lgkmcnt(0)
  v_mfma_f32_16x16x32_bf16 v[76:79], v[148:151], v[220:223], v[76:79]
  ds_read_b128 v[228:231], v237 offset:16384
  v_mfma_f32_16x16x32_bf16 v[80:83], v[148:151], v[224:227], v[80:83]
  ds_read_b128 v[232:235], v237 offset:18432
  v_mfma_f32_16x16x32_bf16 v[84:87], v[152:155], v[220:223], v[84:87]
  ds_read_b128 v[184:187], v238 offset:27648
  v_mfma_f32_16x16x32_bf16 v[88:91], v[152:155], v[224:227], v[88:91]
  ds_read_b128 v[188:191], v238 offset:28672
  v_mfma_f32_16x16x32_bf16 v[92:95], v[156:159], v[220:223], v[92:95]
  ds_read_b128 v[192:195], v238 offset:29696
  v_mfma_f32_16x16x32_bf16 v[96:99], v[156:159], v[224:227], v[96:99]
  ds_read_b128 v[196:199], v238 offset:30720
  v_mfma_f32_16x16x32_bf16 v[100:103], v[160:163], v[220:223], v[100:103]
  ds_read_b128 v[200:203], v238 offset:31744
  v_mfma_f32_16x16x32_bf16 v[104:107], v[160:163], v[224:227], v[104:107]
  ds_read_b128 v[204:207], v238 offset:32768
  v_mfma_f32_16x16x32_bf16 v[108:111], v[164:167], v[220:223], v[108:111]
  ds_read_b128 v[208:211], v238 offset:33792
  v_mfma_f32_16x16x32_bf16 v[112:115], v[164:167], v[224:227], v[112:115]
  ds_read_b128 v[212:215], v238 offset:34816
  v_mfma_f32_16x16x32_bf16 v[116:119], v[168:171], v[220:223], v[116:119]
  ds_read_b128 v[216:219], v238 offset:35840
  v_mfma_f32_16x16x32_bf16 v[120:123], v[168:171], v[224:227], v[120:123]
  v_mfma_f32_16x16x32_bf16 v[124:127], v[172:175], v[220:223], v[124:127]
  v_mfma_f32_16x16x32_bf16 v[128:131], v[172:175], v[224:227], v[128:131]
  v_mfma_f32_16x16x32_bf16 v[132:135], v[176:179], v[220:223], v[132:135]
  v_mfma_f32_16x16x32_bf16 v[136:139], v[176:179], v[224:227], v[136:139]
  v_mfma_f32_16x16x32_bf16 v[140:143], v[180:183], v[220:223], v[140:143]
  v_mfma_f32_16x16x32_bf16 v[144:147], v[180:183], v[224:227], v[144:147]
  s_waitcnt lgkmcnt(0)
  s_barrier
  v_mfma_f32_16x16x32_bf16 v[76:79], v[184:187], v[228:231], v[76:79]
  ds_read_b128 v[220:223], v236 offset:32768
  v_mfma_f32_16x16x32_bf16 v[80:83], v[184:187], v[232:235], v[80:83]
  ds_read_b128 v[224:227], v236 offset:34816
  v_mfma_f32_16x16x32_bf16 v[84:87], v[188:191], v[228:231], v[84:87]
  ds_read_b128 v[148:151], v239 offset:0
  v_mfma_f32_16x16x32_bf16 v[88:91], v[188:191], v[232:235], v[88:91]
  ds_read_b128 v[152:155], v239 offset:1024
  v_mfma_f32_16x16x32_bf16 v[92:95], v[192:195], v[228:231], v[92:95]
  ds_read_b128 v[156:159], v239 offset:2048
  v_mfma_f32_16x16x32_bf16 v[96:99], v[192:195], v[232:235], v[96:99]
  ds_read_b128 v[160:163], v239 offset:3072
  v_mfma_f32_16x16x32_bf16 v[100:103], v[196:199], v[228:231], v[100:103]
  ds_read_b128 v[164:167], v239 offset:4096
  v_mfma_f32_16x16x32_bf16 v[104:107], v[196:199], v[232:235], v[104:107]
  ds_read_b128 v[168:171], v239 offset:5120
  v_mfma_f32_16x16x32_bf16 v[108:111], v[200:203], v[228:231], v[108:111]
  ds_read_b128 v[172:175], v239 offset:6144
  v_mfma_f32_16x16x32_bf16 v[112:115], v[200:203], v[232:235], v[112:115]
  ds_read_b128 v[176:179], v239 offset:7168
  v_mfma_f32_16x16x32_bf16 v[116:119], v[204:207], v[228:231], v[116:119]
  ds_read_b128 v[180:183], v239 offset:8192
  v_mfma_f32_16x16x32_bf16 v[120:123], v[204:207], v[232:235], v[120:123]
  v_mfma_f32_16x16x32_bf16 v[124:127], v[208:211], v[228:231], v[124:127]
  v_mfma_f32_16x16x32_bf16 v[128:131], v[208:211], v[232:235], v[128:131]
  v_mfma_f32_16x16x32_bf16 v[132:135], v[212:215], v[228:231], v[132:135]
  v_mfma_f32_16x16x32_bf16 v[136:139], v[212:215], v[232:235], v[136:139]
  v_mfma_f32_16x16x32_bf16 v[140:143], v[216:219], v[228:231], v[140:143]
  v_mfma_f32_16x16x32_bf16 v[144:147], v[216:219], v[232:235], v[144:147]
  s_waitcnt lgkmcnt(0)
  v_mfma_f32_16x16x32_bf16 v[76:79], v[148:151], v[220:223], v[76:79]
  ds_read_b128 v[228:231], v237 offset:32768
  v_mfma_f32_16x16x32_bf16 v[80:83], v[148:151], v[224:227], v[80:83]
  ds_read_b128 v[232:235], v237 offset:34816
  v_mfma_f32_16x16x32_bf16 v[84:87], v[152:155], v[220:223], v[84:87]
  ds_read_b128 v[184:187], v239 offset:9216
  v_mfma_f32_16x16x32_bf16 v[88:91], v[152:155], v[224:227], v[88:91]
  ds_read_b128 v[188:191], v239 offset:10240
  v_mfma_f32_16x16x32_bf16 v[92:95], v[156:159], v[220:223], v[92:95]
  ds_read_b128 v[192:195], v239 offset:11264
  v_mfma_f32_16x16x32_bf16 v[96:99], v[156:159], v[224:227], v[96:99]
  ds_read_b128 v[196:199], v239 offset:12288
  v_mfma_f32_16x16x32_bf16 v[100:103], v[160:163], v[220:223], v[100:103]
  ds_read_b128 v[200:203], v239 offset:13312
  v_mfma_f32_16x16x32_bf16 v[104:107], v[160:163], v[224:227], v[104:107]
  ds_read_b128 v[204:207], v239 offset:14336
  v_mfma_f32_16x16x32_bf16 v[108:111], v[164:167], v[220:223], v[108:111]
  ds_read_b128 v[208:211], v239 offset:15360
  v_mfma_f32_16x16x32_bf16 v[112:115], v[164:167], v[224:227], v[112:115]
  ds_read_b128 v[212:215], v239 offset:16384
  v_mfma_f32_16x16x32_bf16 v[116:119], v[168:171], v[220:223], v[116:119]
  ds_read_b128 v[216:219], v239 offset:17408
  v_mfma_f32_16x16x32_bf16 v[120:123], v[168:171], v[224:227], v[120:123]
  v_mfma_f32_16x16x32_bf16 v[124:127], v[172:175], v[220:223], v[124:127]
  v_mfma_f32_16x16x32_bf16 v[128:131], v[172:175], v[224:227], v[128:131]
  v_mfma_f32_16x16x32_bf16 v[132:135], v[176:179], v[220:223], v[132:135]
  v_mfma_f32_16x16x32_bf16 v[136:139], v[176:179], v[224:227], v[136:139]
  v_mfma_f32_16x16x32_bf16 v[140:143], v[180:183], v[220:223], v[140:143]
  v_mfma_f32_16x16x32_bf16 v[144:147], v[180:183], v[224:227], v[144:147]
  s_waitcnt lgkmcnt(0)
  s_barrier
  v_mfma_f32_16x16x32_bf16 v[76:79], v[184:187], v[228:231], v[76:79]
  ds_read_b128 v[220:223], v236 offset:49152
  v_mfma_f32_16x16x32_bf16 v[80:83], v[184:187], v[232:235], v[80:83]
  ds_read_b128 v[224:227], v236 offset:51200
  v_mfma_f32_16x16x32_bf16 v[84:87], v[188:191], v[228:231], v[84:87]
  ds_read_b128 v[148:151], v239 offset:18432
  v_mfma_f32_16x16x32_bf16 v[88:91], v[188:191], v[232:235], v[88:91]
  ds_read_b128 v[152:155], v239 offset:19456
  v_mfma_f32_16x16x32_bf16 v[92:95], v[192:195], v[228:231], v[92:95]
  ds_read_b128 v[156:159], v239 offset:20480
  v_mfma_f32_16x16x32_bf16 v[96:99], v[192:195], v[232:235], v[96:99]
  ds_read_b128 v[160:163], v239 offset:21504
  v_mfma_f32_16x16x32_bf16 v[100:103], v[196:199], v[228:231], v[100:103]
  ds_read_b128 v[164:167], v239 offset:22528
  v_mfma_f32_16x16x32_bf16 v[104:107], v[196:199], v[232:235], v[104:107]
  ds_read_b128 v[168:171], v239 offset:23552
  v_mfma_f32_16x16x32_bf16 v[108:111], v[200:203], v[228:231], v[108:111]
  ds_read_b128 v[172:175], v239 offset:24576
  v_mfma_f32_16x16x32_bf16 v[112:115], v[200:203], v[232:235], v[112:115]
  ds_read_b128 v[176:179], v239 offset:25600
  v_mfma_f32_16x16x32_bf16 v[116:119], v[204:207], v[228:231], v[116:119]
  ds_read_b128 v[180:183], v239 offset:26624
  v_mfma_f32_16x16x32_bf16 v[120:123], v[204:207], v[232:235], v[120:123]
  v_mfma_f32_16x16x32_bf16 v[124:127], v[208:211], v[228:231], v[124:127]
  v_mfma_f32_16x16x32_bf16 v[128:131], v[208:211], v[232:235], v[128:131]
  v_mfma_f32_16x16x32_bf16 v[132:135], v[212:215], v[228:231], v[132:135]
  v_mfma_f32_16x16x32_bf16 v[136:139], v[212:215], v[232:235], v[136:139]
  v_mfma_f32_16x16x32_bf16 v[140:143], v[216:219], v[228:231], v[140:143]
  v_mfma_f32_16x16x32_bf16 v[144:147], v[216:219], v[232:235], v[144:147]
  s_waitcnt lgkmcnt(0)
  v_mfma_f32_16x16x32_bf16 v[76:79], v[148:151], v[220:223], v[76:79]
  ds_read_b128 v[228:231], v237 offset:49152
  v_mfma_f32_16x16x32_bf16 v[80:83], v[148:151], v[224:227], v[80:83]
  ds_read_b128 v[232:235], v237 offset:51200
  v_mfma_f32_16x16x32_bf16 v[84:87], v[152:155], v[220:223], v[84:87]
  ds_read_b128 v[184:187], v239 offset:27648
  v_mfma_f32_16x16x32_bf16 v[88:91], v[152:155], v[224:227], v[88:91]
  ds_read_b128 v[188:191], v239 offset:28672
  v_mfma_f32_16x16x32_bf16 v[92:95], v[156:159], v[220:223], v[92:95]
  ds_read_b128 v[192:195], v239 offset:29696
  v_mfma_f32_16x16x32_bf16 v[96:99], v[156:159], v[224:227], v[96:99]
  ds_read_b128 v[196:199], v239 offset:30720
  v_mfma_f32_16x16x32_bf16 v[100:103], v[160:163], v[220:223], v[100:103]
  ds_read_b128 v[200:203], v239 offset:31744
  v_mfma_f32_16x16x32_bf16 v[104:107], v[160:163], v[224:227], v[104:107]
  ds_read_b128 v[204:207], v239 offset:32768
  v_mfma_f32_16x16x32_bf16 v[108:111], v[164:167], v[220:223], v[108:111]
  ds_read_b128 v[208:211], v239 offset:33792
  v_mfma_f32_16x16x32_bf16 v[112:115], v[164:167], v[224:227], v[112:115]
  ds_read_b128 v[212:215], v239 offset:34816
  v_mfma_f32_16x16x32_bf16 v[116:119], v[168:171], v[220:223], v[116:119]
  ds_read_b128 v[216:219], v239 offset:35840
  v_mfma_f32_16x16x32_bf16 v[120:123], v[168:171], v[224:227], v[120:123]
  v_mfma_f32_16x16x32_bf16 v[124:127], v[172:175], v[220:223], v[124:127]
  v_mfma_f32_16x16x32_bf16 v[128:131], v[172:175], v[224:227], v[128:131]
  v_mfma_f32_16x16x32_bf16 v[132:135], v[176:179], v[220:223], v[132:135]
  v_mfma_f32_16x16x32_bf16 v[136:139], v[176:179], v[224:227], v[136:139]
  v_mfma_f32_16x16x32_bf16 v[140:143], v[180:183], v[220:223], v[140:143]
  v_mfma_f32_16x16x32_bf16 v[144:147], v[180:183], v[224:227], v[144:147]
  s_waitcnt lgkmcnt(0)
  s_barrier
  v_mfma_f32_16x16x32_bf16 v[76:79], v[184:187], v[228:231], v[76:79]
  ds_read_b128 v[220:223], v236 offset:0
  v_mfma_f32_16x16x32_bf16 v[80:83], v[184:187], v[232:235], v[80:83]
  ds_read_b128 v[224:227], v236 offset:2048
  v_mfma_f32_16x16x32_bf16 v[84:87], v[188:191], v[228:231], v[84:87]
  ds_read_b128 v[148:151], v238 offset:0
  v_mfma_f32_16x16x32_bf16 v[88:91], v[188:191], v[232:235], v[88:91]
  ds_read_b128 v[152:155], v238 offset:1024
  v_mfma_f32_16x16x32_bf16 v[92:95], v[192:195], v[228:231], v[92:95]
  ds_read_b128 v[156:159], v238 offset:2048
  v_mfma_f32_16x16x32_bf16 v[96:99], v[192:195], v[232:235], v[96:99]
  ds_read_b128 v[160:163], v238 offset:3072
  v_mfma_f32_16x16x32_bf16 v[100:103], v[196:199], v[228:231], v[100:103]
  ds_read_b128 v[164:167], v238 offset:4096
  v_mfma_f32_16x16x32_bf16 v[104:107], v[196:199], v[232:235], v[104:107]
  ds_read_b128 v[168:171], v238 offset:5120
  v_mfma_f32_16x16x32_bf16 v[108:111], v[200:203], v[228:231], v[108:111]
  ds_read_b128 v[172:175], v238 offset:6144
  v_mfma_f32_16x16x32_bf16 v[112:115], v[200:203], v[232:235], v[112:115]
  ds_read_b128 v[176:179], v238 offset:7168
  v_mfma_f32_16x16x32_bf16 v[116:119], v[204:207], v[228:231], v[116:119]
  ds_read_b128 v[180:183], v238 offset:8192
  v_mfma_f32_16x16x32_bf16 v[120:123], v[204:207], v[232:235], v[120:123]
  v_mfma_f32_16x16x32_bf16 v[124:127], v[208:211], v[228:231], v[124:127]
  v_mfma_f32_16x16x32_bf16 v[128:131], v[208:211], v[232:235], v[128:131]
  v_mfma_f32_16x16x32_bf16 v[132:135], v[212:215], v[228:231], v[132:135]
  v_mfma_f32_16x16x32_bf16 v[136:139], v[212:215], v[232:235], v[136:139]
  v_mfma_f32_16x16x32_bf16 v[140:143], v[216:219], v[228:231], v[140:143]
  v_mfma_f32_16x16x32_bf16 v[144:147], v[216:219], v[232:235], v[144:147]
  s_waitcnt lgkmcnt(0)
  v_mfma_f32_16x16x32_bf16 v[76:79], v[148:151], v[220:223], v[76:79]
  ds_read_b128 v[228:231], v237 offset:0
  v_mfma_f32_16x16x32_bf16 v[80:83], v[148:151], v[224:227], v[80:83]
  ds_read_b128 v[232:235], v237 offset:2048
  v_mfma_f32_16x16x32_bf16 v[84:87], v[152:155], v[220:223], v[84:87]
  ds_read_b128 v[184:187], v238 offset:9216
  v_mfma_f32_16x16x32_bf16 v[88:91], v[152:155], v[224:227], v[88:91]
  ds_read_b128 v[188:191], v238 offset:10240
  v_mfma_f32_16x16x32_bf16 v[92:95], v[156:159], v[220:223], v[92:95]
  ds_read_b128 v[192:195], v238 offset:11264
  v_mfma_f32_16x16x32_bf16 v[96:99], v[156:159], v[224:227], v[96:99]
  ds_read_b128 v[196:199], v238 offset:12288
  v_mfma_f32_16x16x32_bf16 v[100:103], v[160:163], v[220:223], v[100:103]
  ds_read_b128 v[200:203], v238 offset:13312
  v_mfma_f32_16x16x32_bf16 v[104:107], v[160:163], v[224:227], v[104:107]
  ds_read_b128 v[204:207], v238 offset:14336
  v_mfma_f32_16x16x32_bf16 v[108:111], v[164:167], v[220:223], v[108:111]
  ds_read_b128 v[208:211], v238 offset:15360
  v_mfma_f32_16x16x32_bf16 v[112:115], v[164:167], v[224:227], v[112:115]
  ds_read_b128 v[212:215], v238 offset:16384
  v_mfma_f32_16x16x32_bf16 v[116:119], v[168:171], v[220:223], v[116:119]
  ds_read_b128 v[216:219], v238 offset:17408
  v_mfma_f32_16x16x32_bf16 v[120:123], v[168:171], v[224:227], v[120:123]
  v_mfma_f32_16x16x32_bf16 v[124:127], v[172:175], v[220:223], v[124:127]
  v_mfma_f32_16x16x32_bf16 v[128:131], v[172:175], v[224:227], v[128:131]
  v_mfma_f32_16x16x32_bf16 v[132:135], v[176:179], v[220:223], v[132:135]
  v_mfma_f32_16x16x32_bf16 v[136:139], v[176:179], v[224:227], v[136:139]
  v_mfma_f32_16x16x32_bf16 v[140:143], v[180:183], v[220:223], v[140:143]
  v_mfma_f32_16x16x32_bf16 v[144:147], v[180:183], v[224:227], v[144:147]
  s_waitcnt lgkmcnt(0)
  s_barrier
  v_mfma_f32_16x16x32_bf16 v[76:79], v[184:187], v[228:231], v[76:79]
  ds_read_b128 v[220:223], v236 offset:16384
  v_mfma_f32_16x16x32_bf16 v[80:83], v[184:187], v[232:235], v[80:83]
  ds_read_b128 v[224:227], v236 offset:18432
  v_mfma_f32_16x16x32_bf16 v[84:87], v[188:191], v[228:231], v[84:87]
  ds_read_b128 v[148:151], v238 offset:18432
  v_mfma_f32_16x16x32_bf16 v[88:91], v[188:191], v[232:235], v[88:91]
  ds_read_b128 v[152:155], v238 offset:19456
  v_mfma_f32_16x16x32_bf16 v[92:95], v[192:195], v[228:231], v[92:95]
  ds_read_b128 v[156:159], v238 offset:20480
  v_mfma_f32_16x16x32_bf16 v[96:99], v[192:195], v[232:235], v[96:99]
  ds_read_b128 v[160:163], v238 offset:21504
  v_mfma_f32_16x16x32_bf16 v[100:103], v[196:199], v[228:231], v[100:103]
  ds_read_b128 v[164:167], v238 offset:22528
  v_mfma_f32_16x16x32_bf16 v[104:107], v[196:199], v[232:235], v[104:107]
  ds_read_b128 v[168:171], v238 offset:23552
  v_mfma_f32_16x16x32_bf16 v[108:111], v[200:203], v[228:231], v[108:111]
  ds_read_b128 v[172:175], v238 offset:24576
  v_mfma_f32_16x16x32_bf16 v[112:115], v[200:203], v[232:235], v[112:115]
  ds_read_b128 v[176:179], v238 offset:25600
  v_mfma_f32_16x16x32_bf16 v[116:119], v[204:207], v[228:231], v[116:119]
  ds_read_b128 v[180:183], v238 offset:26624
  v_mfma_f32_16x16x32_bf16 v[120:123], v[204:207], v[232:235], v[120:123]
  v_mfma_f32_16x16x32_bf16 v[124:127], v[208:211], v[228:231], v[124:127]
  v_mfma_f32_16x16x32_bf16 v[128:131], v[208:211], v[232:235], v[128:131]
  v_mfma_f32_16x16x32_bf16 v[132:135], v[212:215], v[228:231], v[132:135]
  v_mfma_f32_16x16x32_bf16 v[136:139], v[212:215], v[232:235], v[136:139]
  v_mfma_f32_16x16x32_bf16 v[140:143], v[216:219], v[228:231], v[140:143]
  v_mfma_f32_16x16x32_bf16 v[144:147], v[216:219], v[232:235], v[144:147]
  s_waitcnt lgkmcnt(0)
  v_mfma_f32_16x16x32_bf16 v[76:79], v[148:151], v[220:223], v[76:79]
  ds_read_b128 v[228:231], v237 offset:16384
  v_mfma_f32_16x16x32_bf16 v[80:83], v[148:151], v[224:227], v[80:83]
  ds_read_b128 v[232:235], v237 offset:18432
  v_mfma_f32_16x16x32_bf16 v[84:87], v[152:155], v[220:223], v[84:87]
  ds_read_b128 v[184:187], v238 offset:27648
  v_mfma_f32_16x16x32_bf16 v[88:91], v[152:155], v[224:227], v[88:91]
  ds_read_b128 v[188:191], v238 offset:28672
  v_mfma_f32_16x16x32_bf16 v[92:95], v[156:159], v[220:223], v[92:95]
  ds_read_b128 v[192:195], v238 offset:29696
  v_mfma_f32_16x16x32_bf16 v[96:99], v[156:159], v[224:227], v[96:99]
  ds_read_b128 v[196:199], v238 offset:30720
  v_mfma_f32_16x16x32_bf16 v[100:103], v[160:163], v[220:223], v[100:103]
  ds_read_b128 v[200:203], v238 offset:31744
  v_mfma_f32_16x16x32_bf16 v[104:107], v[160:163], v[224:227], v[104:107]
  ds_read_b128 v[204:207], v238 offset:32768
  v_mfma_f32_16x16x32_bf16 v[108:111], v[164:167], v[220:223], v[108:111]
  ds_read_b128 v[208:211], v238 offset:33792
  v_mfma_f32_16x16x32_bf16 v[112:115], v[164:167], v[224:227], v[112:115]
  ds_read_b128 v[212:215], v238 offset:34816
  v_mfma_f32_16x16x32_bf16 v[116:119], v[168:171], v[220:223], v[116:119]
  ds_read_b128 v[216:219], v238 offset:35840
  v_mfma_f32_16x16x32_bf16 v[120:123], v[168:171], v[224:227], v[120:123]
  v_mfma_f32_16x16x32_bf16 v[124:127], v[172:175], v[220:223], v[124:127]
  v_mfma_f32_16x16x32_bf16 v[128:131], v[172:175], v[224:227], v[128:131]
  v_mfma_f32_16x16x32_bf16 v[132:135], v[176:179], v[220:223], v[132:135]
  v_mfma_f32_16x16x32_bf16 v[136:139], v[176:179], v[224:227], v[136:139]
  v_mfma_f32_16x16x32_bf16 v[140:143], v[180:183], v[220:223], v[140:143]
  v_mfma_f32_16x16x32_bf16 v[144:147], v[180:183], v[224:227], v[144:147]
  s_waitcnt lgkmcnt(0)
  s_barrier
  v_mfma_f32_16x16x32_bf16 v[76:79], v[184:187], v[228:231], v[76:79]
  ds_read_b128 v[220:223], v236 offset:32768
  v_mfma_f32_16x16x32_bf16 v[80:83], v[184:187], v[232:235], v[80:83]
  ds_read_b128 v[224:227], v236 offset:34816
  v_mfma_f32_16x16x32_bf16 v[84:87], v[188:191], v[228:231], v[84:87]
  ds_read_b128 v[148:151], v239 offset:0
  v_mfma_f32_16x16x32_bf16 v[88:91], v[188:191], v[232:235], v[88:91]
  ds_read_b128 v[152:155], v239 offset:1024
  v_mfma_f32_16x16x32_bf16 v[92:95], v[192:195], v[228:231], v[92:95]
  ds_read_b128 v[156:159], v239 offset:2048
  v_mfma_f32_16x16x32_bf16 v[96:99], v[192:195], v[232:235], v[96:99]
  ds_read_b128 v[160:163], v239 offset:3072
  v_mfma_f32_16x16x32_bf16 v[100:103], v[196:199], v[228:231], v[100:103]
  ds_read_b128 v[164:167], v239 offset:4096
  v_mfma_f32_16x16x32_bf16 v[104:107], v[196:199], v[232:235], v[104:107]
  ds_read_b128 v[168:171], v239 offset:5120
  v_mfma_f32_16x16x32_bf16 v[108:111], v[200:203], v[228:231], v[108:111]
  ds_read_b128 v[172:175], v239 offset:6144
  v_mfma_f32_16x16x32_bf16 v[112:115], v[200:203], v[232:235], v[112:115]
  ds_read_b128 v[176:179], v239 offset:7168
  v_mfma_f32_16x16x32_bf16 v[116:119], v[204:207], v[228:231], v[116:119]
  ds_read_b128 v[180:183], v239 offset:8192
  v_mfma_f32_16x16x32_bf16 v[120:123], v[204:207], v[232:235], v[120:123]
  v_mfma_f32_16x16x32_bf16 v[124:127], v[208:211], v[228:231], v[124:127]
  v_mfma_f32_16x16x32_bf16 v[128:131], v[208:211], v[232:235], v[128:131]
  v_mfma_f32_16x16x32_bf16 v[132:135], v[212:215], v[228:231], v[132:135]
  v_mfma_f32_16x16x32_bf16 v[136:139], v[212:215], v[232:235], v[136:139]
  v_mfma_f32_16x16x32_bf16 v[140:143], v[216:219], v[228:231], v[140:143]
  v_mfma_f32_16x16x32_bf16 v[144:147], v[216:219], v[232:235], v[144:147]
  s_waitcnt lgkmcnt(0)
  v_mfma_f32_16x16x32_bf16 v[76:79], v[148:151], v[220:223], v[76:79]
  ds_read_b128 v[228:231], v237 offset:32768
  v_mfma_f32_16x16x32_bf16 v[80:83], v[148:151], v[224:227], v[80:83]
  ds_read_b128 v[232:235], v237 offset:34816
  v_mfma_f32_16x16x32_bf16 v[84:87], v[152:155], v[220:223], v[84:87]
  ds_read_b128 v[184:187], v239 offset:9216
  v_mfma_f32_16x16x32_bf16 v[88:91], v[152:155], v[224:227], v[88:91]
  ds_read_b128 v[188:191], v239 offset:10240
  v_mfma_f32_16x16x32_bf16 v[92:95], v[156:159], v[220:223], v[92:95]
  ds_read_b128 v[192:195], v239 offset:11264
  v_mfma_f32_16x16x32_bf16 v[96:99], v[156:159], v[224:227], v[96:99]
  ds_read_b128 v[196:199], v239 offset:12288
  v_mfma_f32_16x16x32_bf16 v[100:103], v[160:163], v[220:223], v[100:103]
  ds_read_b128 v[200:203], v239 offset:13312
  v_mfma_f32_16x16x32_bf16 v[104:107], v[160:163], v[224:227], v[104:107]
  ds_read_b128 v[204:207], v239 offset:14336
  v_mfma_f32_16x16x32_bf16 v[108:111], v[164:167], v[220:223], v[108:111]
  ds_read_b128 v[208:211], v239 offset:15360
  v_mfma_f32_16x16x32_bf16 v[112:115], v[164:167], v[224:227], v[112:115]
  ds_read_b128 v[212:215], v239 offset:16384
  v_mfma_f32_16x16x32_bf16 v[116:119], v[168:171], v[220:223], v[116:119]
  ds_read_b128 v[216:219], v239 offset:17408
  v_mfma_f32_16x16x32_bf16 v[120:123], v[168:171], v[224:227], v[120:123]
  v_mfma_f32_16x16x32_bf16 v[124:127], v[172:175], v[220:223], v[124:127]
  v_mfma_f32_16x16x32_bf16 v[128:131], v[172:175], v[224:227], v[128:131]
  v_mfma_f32_16x16x32_bf16 v[132:135], v[176:179], v[220:223], v[132:135]
  v_mfma_f32_16x16x32_bf16 v[136:139], v[176:179], v[224:227], v[136:139]
  v_mfma_f32_16x16x32_bf16 v[140:143], v[180:183], v[220:223], v[140:143]
  v_mfma_f32_16x16x32_bf16 v[144:147], v[180:183], v[224:227], v[144:147]
  s_waitcnt lgkmcnt(0)
  s_barrier
  v_mfma_f32_16x16x32_bf16 v[76:79], v[184:187], v[228:231], v[76:79]
  ds_read_b128 v[220:223], v236 offset:49152
  v_mfma_f32_16x16x32_bf16 v[80:83], v[184:187], v[232:235], v[80:83]
  ds_read_b128 v[224:227], v236 offset:51200
  v_mfma_f32_16x16x32_bf16 v[84:87], v[188:191], v[228:231], v[84:87]
  ds_read_b128 v[148:151], v239 offset:18432
  v_mfma_f32_16x16x32_bf16 v[88:91], v[188:191], v[232:235], v[88:91]
  ds_read_b128 v[152:155], v239 offset:19456
  v_mfma_f32_16x16x32_bf16 v[92:95], v[192:195], v[228:231], v[92:95]
  ds_read_b128 v[156:159], v239 offset:20480
  v_mfma_f32_16x16x32_bf16 v[96:99], v[192:195], v[232:235], v[96:99]
  ds_read_b128 v[160:163], v239 offset:21504
  v_mfma_f32_16x16x32_bf16 v[100:103], v[196:199], v[228:231], v[100:103]
  ds_read_b128 v[164:167], v239 offset:22528
  v_mfma_f32_16x16x32_bf16 v[104:107], v[196:199], v[232:235], v[104:107]
  ds_read_b128 v[168:171], v239 offset:23552
  v_mfma_f32_16x16x32_bf16 v[108:111], v[200:203], v[228:231], v[108:111]
  ds_read_b128 v[172:175], v239 offset:24576
  v_mfma_f32_16x16x32_bf16 v[112:115], v[200:203], v[232:235], v[112:115]
  ds_read_b128 v[176:179], v239 offset:25600
  v_mfma_f32_16x16x32_bf16 v[116:119], v[204:207], v[228:231], v[116:119]
  ds_read_b128 v[180:183], v239 offset:26624
  v_mfma_f32_16x16x32_bf16 v[120:123], v[204:207], v[232:235], v[120:123]
  v_mfma_f32_16x16x32_bf16 v[124:127], v[208:211], v[228:231], v[124:127]
  v_mfma_f32_16x16x32_bf16 v[128:131], v[208:211], v[232:235], v[128:131]
  v_mfma_f32_16x16x32_bf16 v[132:135], v[212:215], v[228:231], v[132:135]
  v_mfma_f32_16x16x32_bf16 v[136:139], v[212:215], v[232:235], v[136:139]
  v_mfma_f32_16x16x32_bf16 v[140:143], v[216:219], v[228:231], v[140:143]
  v_mfma_f32_16x16x32_bf16 v[144:147], v[216:219], v[232:235], v[144:147]
  s_waitcnt lgkmcnt(0)
  v_mfma_f32_16x16x32_bf16 v[76:79], v[148:151], v[220:223], v[76:79]
  ds_read_b128 v[228:231], v237 offset:49152
  v_mfma_f32_16x16x32_bf16 v[80:83], v[148:151], v[224:227], v[80:83]
  ds_read_b128 v[232:235], v237 offset:51200
  v_mfma_f32_16x16x32_bf16 v[84:87], v[152:155], v[220:223], v[84:87]
  ds_read_b128 v[184:187], v239 offset:27648
  v_mfma_f32_16x16x32_bf16 v[88:91], v[152:155], v[224:227], v[88:91]
  ds_read_b128 v[188:191], v239 offset:28672
  v_mfma_f32_16x16x32_bf16 v[92:95], v[156:159], v[220:223], v[92:95]
  ds_read_b128 v[192:195], v239 offset:29696
  v_mfma_f32_16x16x32_bf16 v[96:99], v[156:159], v[224:227], v[96:99]
  ds_read_b128 v[196:199], v239 offset:30720
  v_mfma_f32_16x16x32_bf16 v[100:103], v[160:163], v[220:223], v[100:103]
  ds_read_b128 v[200:203], v239 offset:31744
  v_mfma_f32_16x16x32_bf16 v[104:107], v[160:163], v[224:227], v[104:107]
  ds_read_b128 v[204:207], v239 offset:32768
  v_mfma_f32_16x16x32_bf16 v[108:111], v[164:167], v[220:223], v[108:111]
  ds_read_b128 v[208:211], v239 offset:33792
  v_mfma_f32_16x16x32_bf16 v[112:115], v[164:167], v[224:227], v[112:115]
  ds_read_b128 v[212:215], v239 offset:34816
  v_mfma_f32_16x16x32_bf16 v[116:119], v[168:171], v[220:223], v[116:119]
  ds_read_b128 v[216:219], v239 offset:35840
  v_mfma_f32_16x16x32_bf16 v[120:123], v[168:171], v[224:227], v[120:123]
  v_mfma_f32_16x16x32_bf16 v[124:127], v[172:175], v[220:223], v[124:127]
  v_mfma_f32_16x16x32_bf16 v[128:131], v[172:175], v[224:227], v[128:131]
  v_mfma_f32_16x16x32_bf16 v[132:135], v[176:179], v[220:223], v[132:135]
  v_mfma_f32_16x16x32_bf16 v[136:139], v[176:179], v[224:227], v[136:139]
  v_mfma_f32_16x16x32_bf16 v[140:143], v[180:183], v[220:223], v[140:143]
  v_mfma_f32_16x16x32_bf16 v[144:147], v[180:183], v[224:227], v[144:147]
  s_waitcnt lgkmcnt(0)
  s_barrier
  v_mfma_f32_16x16x32_bf16 v[76:79], v[184:187], v[228:231], v[76:79]
  ds_read_b128 v[220:223], v236 offset:0
  v_mfma_f32_16x16x32_bf16 v[80:83], v[184:187], v[232:235], v[80:83]
  ds_read_b128 v[224:227], v236 offset:2048
  v_mfma_f32_16x16x32_bf16 v[84:87], v[188:191], v[228:231], v[84:87]
  ds_read_b128 v[148:151], v238 offset:0
  v_mfma_f32_16x16x32_bf16 v[88:91], v[188:191], v[232:235], v[88:91]
  ds_read_b128 v[152:155], v238 offset:1024
  v_mfma_f32_16x16x32_bf16 v[92:95], v[192:195], v[228:231], v[92:95]
  ds_read_b128 v[156:159], v238 offset:2048
  v_mfma_f32_16x16x32_bf16 v[96:99], v[192:195], v[232:235], v[96:99]
  ds_read_b128 v[160:163], v238 offset:3072
  v_mfma_f32_16x16x32_bf16 v[100:103], v[196:199], v[228:231], v[100:103]
  ds_read_b128 v[164:167], v238 offset:4096
  v_mfma_f32_16x16x32_bf16 v[104:107], v[196:199], v[232:235], v[104:107]
  ds_read_b128 v[168:171], v238 offset:5120
  v_mfma_f32_16x16x32_bf16 v[108:111], v[200:203], v[228:231], v[108:111]
  ds_read_b128 v[172:175], v238 offset:6144
  v_mfma_f32_16x16x32_bf16 v[112:115], v[200:203], v[232:235], v[112:115]
  ds_read_b128 v[176:179], v238 offset:7168
  v_mfma_f32_16x16x32_bf16 v[116:119], v[204:207], v[228:231], v[116:119]
  ds_read_b128 v[180:183], v238 offset:8192
  v_mfma_f32_16x16x32_bf16 v[120:123], v[204:207], v[232:235], v[120:123]
  v_mfma_f32_16x16x32_bf16 v[124:127], v[208:211], v[228:231], v[124:127]
  v_mfma_f32_16x16x32_bf16 v[128:131], v[208:211], v[232:235], v[128:131]
  v_mfma_f32_16x16x32_bf16 v[132:135], v[212:215], v[228:231], v[132:135]
  v_mfma_f32_16x16x32_bf16 v[136:139], v[212:215], v[232:235], v[136:139]
  v_mfma_f32_16x16x32_bf16 v[140:143], v[216:219], v[228:231], v[140:143]
  v_mfma_f32_16x16x32_bf16 v[144:147], v[216:219], v[232:235], v[144:147]
  s_waitcnt lgkmcnt(0)
  v_mfma_f32_16x16x32_bf16 v[76:79], v[148:151], v[220:223], v[76:79]
  ds_read_b128 v[228:231], v237 offset:0
  v_mfma_f32_16x16x32_bf16 v[80:83], v[148:151], v[224:227], v[80:83]
  ds_read_b128 v[232:235], v237 offset:2048
  v_mfma_f32_16x16x32_bf16 v[84:87], v[152:155], v[220:223], v[84:87]
  ds_read_b128 v[184:187], v238 offset:9216
  v_mfma_f32_16x16x32_bf16 v[88:91], v[152:155], v[224:227], v[88:91]
  ds_read_b128 v[188:191], v238 offset:10240
  v_mfma_f32_16x16x32_bf16 v[92:95], v[156:159], v[220:223], v[92:95]
  ds_read_b128 v[192:195], v238 offset:11264
  v_mfma_f32_16x16x32_bf16 v[96:99], v[156:159], v[224:227], v[96:99]
  ds_read_b128 v[196:199], v238 offset:12288
  v_mfma_f32_16x16x32_bf16 v[100:103], v[160:163], v[220:223], v[100:103]
  ds_read_b128 v[200:203], v238 offset:13312
  v_mfma_f32_16x16x32_bf16 v[104:107], v[160:163], v[224:227], v[104:107]
  ds_read_b128 v[204:207], v238 offset:14336
  v_mfma_f32_16x16x32_bf16 v[108:111], v[164:167], v[220:223], v[108:111]
  ds_read_b128 v[208:211], v238 offset:15360
  v_mfma_f32_16x16x32_bf16 v[112:115], v[164:167], v[224:227], v[112:115]
  ds_read_b128 v[212:215], v238 offset:16384
  v_mfma_f32_16x16x32_bf16 v[116:119], v[168:171], v[220:223], v[116:119]
  ds_read_b128 v[216:219], v238 offset:17408
  v_mfma_f32_16x16x32_bf16 v[120:123], v[168:171], v[224:227], v[120:123]
  v_mfma_f32_16x16x32_bf16 v[124:127], v[172:175], v[220:223], v[124:127]
  v_mfma_f32_16x16x32_bf16 v[128:131], v[172:175], v[224:227], v[128:131]
  v_mfma_f32_16x16x32_bf16 v[132:135], v[176:179], v[220:223], v[132:135]
  v_mfma_f32_16x16x32_bf16 v[136:139], v[176:179], v[224:227], v[136:139]
  v_mfma_f32_16x16x32_bf16 v[140:143], v[180:183], v[220:223], v[140:143]
  v_mfma_f32_16x16x32_bf16 v[144:147], v[180:183], v[224:227], v[144:147]
  s_waitcnt lgkmcnt(0)
  s_barrier
  v_mfma_f32_16x16x32_bf16 v[76:79], v[184:187], v[228:231], v[76:79]
  ds_read_b128 v[220:223], v236 offset:16384
  v_mfma_f32_16x16x32_bf16 v[80:83], v[184:187], v[232:235], v[80:83]
  ds_read_b128 v[224:227], v236 offset:18432
  v_mfma_f32_16x16x32_bf16 v[84:87], v[188:191], v[228:231], v[84:87]
  ds_read_b128 v[148:151], v238 offset:18432
  v_mfma_f32_16x16x32_bf16 v[88:91], v[188:191], v[232:235], v[88:91]
  ds_read_b128 v[152:155], v238 offset:19456
  v_mfma_f32_16x16x32_bf16 v[92:95], v[192:195], v[228:231], v[92:95]
  ds_read_b128 v[156:159], v238 offset:20480
  v_mfma_f32_16x16x32_bf16 v[96:99], v[192:195], v[232:235], v[96:99]
  ds_read_b128 v[160:163], v238 offset:21504
  v_mfma_f32_16x16x32_bf16 v[100:103], v[196:199], v[228:231], v[100:103]
  ds_read_b128 v[164:167], v238 offset:22528
  v_mfma_f32_16x16x32_bf16 v[104:107], v[196:199], v[232:235], v[104:107]
  ds_read_b128 v[168:171], v238 offset:23552
  v_mfma_f32_16x16x32_bf16 v[108:111], v[200:203], v[228:231], v[108:111]
  ds_read_b128 v[172:175], v238 offset:24576
  v_mfma_f32_16x16x32_bf16 v[112:115], v[200:203], v[232:235], v[112:115]
  ds_read_b128 v[176:179], v238 offset:25600
  v_mfma_f32_16x16x32_bf16 v[116:119], v[204:207], v[228:231], v[116:119]
  ds_read_b128 v[180:183], v238 offset:26624
  v_mfma_f32_16x16x32_bf16 v[120:123], v[204:207], v[232:235], v[120:123]
  v_mfma_f32_16x16x32_bf16 v[124:127], v[208:211], v[228:231], v[124:127]
  v_mfma_f32_16x16x32_bf16 v[128:131], v[208:211], v[232:235], v[128:131]
  v_mfma_f32_16x16x32_bf16 v[132:135], v[212:215], v[228:231], v[132:135]
  v_mfma_f32_16x16x32_bf16 v[136:139], v[212:215], v[232:235], v[136:139]
  v_mfma_f32_16x16x32_bf16 v[140:143], v[216:219], v[228:231], v[140:143]
  v_mfma_f32_16x16x32_bf16 v[144:147], v[216:219], v[232:235], v[144:147]
  s_waitcnt lgkmcnt(0)
  v_mfma_f32_16x16x32_bf16 v[76:79], v[148:151], v[220:223], v[76:79]
  ds_read_b128 v[228:231], v237 offset:16384
  v_mfma_f32_16x16x32_bf16 v[80:83], v[148:151], v[224:227], v[80:83]
  ds_read_b128 v[232:235], v237 offset:18432
  v_mfma_f32_16x16x32_bf16 v[84:87], v[152:155], v[220:223], v[84:87]
  ds_read_b128 v[184:187], v238 offset:27648
  v_mfma_f32_16x16x32_bf16 v[88:91], v[152:155], v[224:227], v[88:91]
  ds_read_b128 v[188:191], v238 offset:28672
  v_mfma_f32_16x16x32_bf16 v[92:95], v[156:159], v[220:223], v[92:95]
  ds_read_b128 v[192:195], v238 offset:29696
  v_mfma_f32_16x16x32_bf16 v[96:99], v[156:159], v[224:227], v[96:99]
  ds_read_b128 v[196:199], v238 offset:30720
  v_mfma_f32_16x16x32_bf16 v[100:103], v[160:163], v[220:223], v[100:103]
  ds_read_b128 v[200:203], v238 offset:31744
  v_mfma_f32_16x16x32_bf16 v[104:107], v[160:163], v[224:227], v[104:107]
  ds_read_b128 v[204:207], v238 offset:32768
  v_mfma_f32_16x16x32_bf16 v[108:111], v[164:167], v[220:223], v[108:111]
  ds_read_b128 v[208:211], v238 offset:33792
  v_mfma_f32_16x16x32_bf16 v[112:115], v[164:167], v[224:227], v[112:115]
  ds_read_b128 v[212:215], v238 offset:34816
  v_mfma_f32_16x16x32_bf16 v[116:119], v[168:171], v[220:223], v[116:119]
  ds_read_b128 v[216:219], v238 offset:35840
  v_mfma_f32_16x16x32_bf16 v[120:123], v[168:171], v[224:227], v[120:123]
  v_mfma_f32_16x16x32_bf16 v[124:127], v[172:175], v[220:223], v[124:127]
  v_mfma_f32_16x16x32_bf16 v[128:131], v[172:175], v[224:227], v[128:131]
  v_mfma_f32_16x16x32_bf16 v[132:135], v[176:179], v[220:223], v[132:135]
  v_mfma_f32_16x16x32_bf16 v[136:139], v[176:179], v[224:227], v[136:139]
  v_mfma_f32_16x16x32_bf16 v[140:143], v[180:183], v[220:223], v[140:143]
  v_mfma_f32_16x16x32_bf16 v[144:147], v[180:183], v[224:227], v[144:147]
  s_waitcnt lgkmcnt(0)
  s_barrier
  v_mfma_f32_16x16x32_bf16 v[76:79], v[184:187], v[228:231], v[76:79]
  ds_read_b128 v[220:223], v236 offset:32768
  v_mfma_f32_16x16x32_bf16 v[80:83], v[184:187], v[232:235], v[80:83]
  ds_read_b128 v[224:227], v236 offset:34816
  v_mfma_f32_16x16x32_bf16 v[84:87], v[188:191], v[228:231], v[84:87]
  ds_read_b128 v[148:151], v239 offset:0
  v_mfma_f32_16x16x32_bf16 v[88:91], v[188:191], v[232:235], v[88:91]
  ds_read_b128 v[152:155], v239 offset:1024
  v_mfma_f32_16x16x32_bf16 v[92:95], v[192:195], v[228:231], v[92:95]
  ds_read_b128 v[156:159], v239 offset:2048
  v_mfma_f32_16x16x32_bf16 v[96:99], v[192:195], v[232:235], v[96:99]
  ds_read_b128 v[160:163], v239 offset:3072
  v_mfma_f32_16x16x32_bf16 v[100:103], v[196:199], v[228:231], v[100:103]
  ds_read_b128 v[164:167], v239 offset:4096
  v_mfma_f32_16x16x32_bf16 v[104:107], v[196:199], v[232:235], v[104:107]
  ds_read_b128 v[168:171], v239 offset:5120
  v_mfma_f32_16x16x32_bf16 v[108:111], v[200:203], v[228:231], v[108:111]
  ds_read_b128 v[172:175], v239 offset:6144
  v_mfma_f32_16x16x32_bf16 v[112:115], v[200:203], v[232:235], v[112:115]
  ds_read_b128 v[176:179], v239 offset:7168
  v_mfma_f32_16x16x32_bf16 v[116:119], v[204:207], v[228:231], v[116:119]
  ds_read_b128 v[180:183], v239 offset:8192
  v_mfma_f32_16x16x32_bf16 v[120:123], v[204:207], v[232:235], v[120:123]
  v_mfma_f32_16x16x32_bf16 v[124:127], v[208:211], v[228:231], v[124:127]
  v_mfma_f32_16x16x32_bf16 v[128:131], v[208:211], v[232:235], v[128:131]
  v_mfma_f32_16x16x32_bf16 v[132:135], v[212:215], v[228:231], v[132:135]
  v_mfma_f32_16x16x32_bf16 v[136:139], v[212:215], v[232:235], v[136:139]
  v_mfma_f32_16x16x32_bf16 v[140:143], v[216:219], v[228:231], v[140:143]
  v_mfma_f32_16x16x32_bf16 v[144:147], v[216:219], v[232:235], v[144:147]
  s_waitcnt lgkmcnt(0)
  v_mfma_f32_16x16x32_bf16 v[76:79], v[148:151], v[220:223], v[76:79]
  ds_read_b128 v[228:231], v237 offset:32768
  v_mfma_f32_16x16x32_bf16 v[80:83], v[148:151], v[224:227], v[80:83]
  ds_read_b128 v[232:235], v237 offset:34816
  v_mfma_f32_16x16x32_bf16 v[84:87], v[152:155], v[220:223], v[84:87]
  ds_read_b128 v[184:187], v239 offset:9216
  v_mfma_f32_16x16x32_bf16 v[88:91], v[152:155], v[224:227], v[88:91]
  ds_read_b128 v[188:191], v239 offset:10240
  v_mfma_f32_16x16x32_bf16 v[92:95], v[156:159], v[220:223], v[92:95]
  ds_read_b128 v[192:195], v239 offset:11264
  v_mfma_f32_16x16x32_bf16 v[96:99], v[156:159], v[224:227], v[96:99]
  ds_read_b128 v[196:199], v239 offset:12288
  v_mfma_f32_16x16x32_bf16 v[100:103], v[160:163], v[220:223], v[100:103]
  ds_read_b128 v[200:203], v239 offset:13312
  v_mfma_f32_16x16x32_bf16 v[104:107], v[160:163], v[224:227], v[104:107]
  ds_read_b128 v[204:207], v239 offset:14336
  v_mfma_f32_16x16x32_bf16 v[108:111], v[164:167], v[220:223], v[108:111]
  ds_read_b128 v[208:211], v239 offset:15360
  v_mfma_f32_16x16x32_bf16 v[112:115], v[164:167], v[224:227], v[112:115]
  ds_read_b128 v[212:215], v239 offset:16384
  v_mfma_f32_16x16x32_bf16 v[116:119], v[168:171], v[220:223], v[116:119]
  ds_read_b128 v[216:219], v239 offset:17408
  v_mfma_f32_16x16x32_bf16 v[120:123], v[168:171], v[224:227], v[120:123]
  v_mfma_f32_16x16x32_bf16 v[124:127], v[172:175], v[220:223], v[124:127]
  v_mfma_f32_16x16x32_bf16 v[128:131], v[172:175], v[224:227], v[128:131]
  v_mfma_f32_16x16x32_bf16 v[132:135], v[176:179], v[220:223], v[132:135]
  v_mfma_f32_16x16x32_bf16 v[136:139], v[176:179], v[224:227], v[136:139]
  v_mfma_f32_16x16x32_bf16 v[140:143], v[180:183], v[220:223], v[140:143]
  v_mfma_f32_16x16x32_bf16 v[144:147], v[180:183], v[224:227], v[144:147]
  s_waitcnt lgkmcnt(0)
  s_barrier
  v_mfma_f32_16x16x32_bf16 v[76:79], v[184:187], v[228:231], v[76:79]
  ds_read_b128 v[220:223], v236 offset:49152
  v_mfma_f32_16x16x32_bf16 v[80:83], v[184:187], v[232:235], v[80:83]
  ds_read_b128 v[224:227], v236 offset:51200
  v_mfma_f32_16x16x32_bf16 v[84:87], v[188:191], v[228:231], v[84:87]
  ds_read_b128 v[148:151], v239 offset:18432
  v_mfma_f32_16x16x32_bf16 v[88:91], v[188:191], v[232:235], v[88:91]
  ds_read_b128 v[152:155], v239 offset:19456
  v_mfma_f32_16x16x32_bf16 v[92:95], v[192:195], v[228:231], v[92:95]
  ds_read_b128 v[156:159], v239 offset:20480
  v_mfma_f32_16x16x32_bf16 v[96:99], v[192:195], v[232:235], v[96:99]
  ds_read_b128 v[160:163], v239 offset:21504
  v_mfma_f32_16x16x32_bf16 v[100:103], v[196:199], v[228:231], v[100:103]
  ds_read_b128 v[164:167], v239 offset:22528
  v_mfma_f32_16x16x32_bf16 v[104:107], v[196:199], v[232:235], v[104:107]
  ds_read_b128 v[168:171], v239 offset:23552
  v_mfma_f32_16x16x32_bf16 v[108:111], v[200:203], v[228:231], v[108:111]
  ds_read_b128 v[172:175], v239 offset:24576
  v_mfma_f32_16x16x32_bf16 v[112:115], v[200:203], v[232:235], v[112:115]
  ds_read_b128 v[176:179], v239 offset:25600
  v_mfma_f32_16x16x32_bf16 v[116:119], v[204:207], v[228:231], v[116:119]
  ds_read_b128 v[180:183], v239 offset:26624
  v_mfma_f32_16x16x32_bf16 v[120:123], v[204:207], v[232:235], v[120:123]
  v_mfma_f32_16x16x32_bf16 v[124:127], v[208:211], v[228:231], v[124:127]
  v_mfma_f32_16x16x32_bf16 v[128:131], v[208:211], v[232:235], v[128:131]
  v_mfma_f32_16x16x32_bf16 v[132:135], v[212:215], v[228:231], v[132:135]
  v_mfma_f32_16x16x32_bf16 v[136:139], v[212:215], v[232:235], v[136:139]
  v_mfma_f32_16x16x32_bf16 v[140:143], v[216:219], v[228:231], v[140:143]
  v_mfma_f32_16x16x32_bf16 v[144:147], v[216:219], v[232:235], v[144:147]
  s_waitcnt lgkmcnt(0)
  v_mfma_f32_16x16x32_bf16 v[76:79], v[148:151], v[220:223], v[76:79]
  ds_read_b128 v[228:231], v237 offset:49152
  v_mfma_f32_16x16x32_bf16 v[80:83], v[148:151], v[224:227], v[80:83]
  ds_read_b128 v[232:235], v237 offset:51200
  v_mfma_f32_16x16x32_bf16 v[84:87], v[152:155], v[220:223], v[84:87]
  ds_read_b128 v[184:187], v239 offset:27648
  v_mfma_f32_16x16x32_bf16 v[88:91], v[152:155], v[224:227], v[88:91]
  ds_read_b128 v[188:191], v239 offset:28672
  v_mfma_f32_16x16x32_bf16 v[92:95], v[156:159], v[220:223], v[92:95]
  ds_read_b128 v[192:195], v239 offset:29696
  v_mfma_f32_16x16x32_bf16 v[96:99], v[156:159], v[224:227], v[96:99]
  ds_read_b128 v[196:199], v239 offset:30720
  v_mfma_f32_16x16x32_bf16 v[100:103], v[160:163], v[220:223], v[100:103]
  ds_read_b128 v[200:203], v239 offset:31744
  v_mfma_f32_16x16x32_bf16 v[104:107], v[160:163], v[224:227], v[104:107]
  ds_read_b128 v[204:207], v239 offset:32768
  v_mfma_f32_16x16x32_bf16 v[108:111], v[164:167], v[220:223], v[108:111]
  ds_read_b128 v[208:211], v239 offset:33792
  v_mfma_f32_16x16x32_bf16 v[112:115], v[164:167], v[224:227], v[112:115]
  ds_read_b128 v[212:215], v239 offset:34816
  v_mfma_f32_16x16x32_bf16 v[116:119], v[168:171], v[220:223], v[116:119]
  ds_read_b128 v[216:219], v239 offset:35840
  v_mfma_f32_16x16x32_bf16 v[120:123], v[168:171], v[224:227], v[120:123]
  v_mfma_f32_16x16x32_bf16 v[124:127], v[172:175], v[220:223], v[124:127]
  v_mfma_f32_16x16x32_bf16 v[128:131], v[172:175], v[224:227], v[128:131]
  v_mfma_f32_16x16x32_bf16 v[132:135], v[176:179], v[220:223], v[132:135]
  v_mfma_f32_16x16x32_bf16 v[136:139], v[176:179], v[224:227], v[136:139]
  v_mfma_f32_16x16x32_bf16 v[140:143], v[180:183], v[220:223], v[140:143]
  v_mfma_f32_16x16x32_bf16 v[144:147], v[180:183], v[224:227], v[144:147]
  s_waitcnt lgkmcnt(0)
  s_barrier
  v_mfma_f32_16x16x32_bf16 v[76:79], v[184:187], v[228:231], v[76:79]
  ds_read_b128 v[220:223], v236 offset:0
  v_mfma_f32_16x16x32_bf16 v[80:83], v[184:187], v[232:235], v[80:83]
  ds_read_b128 v[224:227], v236 offset:2048
  v_mfma_f32_16x16x32_bf16 v[84:87], v[188:191], v[228:231], v[84:87]
  ds_read_b128 v[148:151], v238 offset:0
  v_mfma_f32_16x16x32_bf16 v[88:91], v[188:191], v[232:235], v[88:91]
  ds_read_b128 v[152:155], v238 offset:1024
  v_mfma_f32_16x16x32_bf16 v[92:95], v[192:195], v[228:231], v[92:95]
  ds_read_b128 v[156:159], v238 offset:2048
  v_mfma_f32_16x16x32_bf16 v[96:99], v[192:195], v[232:235], v[96:99]
  ds_read_b128 v[160:163], v238 offset:3072
  v_mfma_f32_16x16x32_bf16 v[100:103], v[196:199], v[228:231], v[100:103]
  ds_read_b128 v[164:167], v238 offset:4096
  v_mfma_f32_16x16x32_bf16 v[104:107], v[196:199], v[232:235], v[104:107]
  ds_read_b128 v[168:171], v238 offset:5120
  v_mfma_f32_16x16x32_bf16 v[108:111], v[200:203], v[228:231], v[108:111]
  ds_read_b128 v[172:175], v238 offset:6144
  v_mfma_f32_16x16x32_bf16 v[112:115], v[200:203], v[232:235], v[112:115]
  ds_read_b128 v[176:179], v238 offset:7168
  v_mfma_f32_16x16x32_bf16 v[116:119], v[204:207], v[228:231], v[116:119]
  ds_read_b128 v[180:183], v238 offset:8192
  v_mfma_f32_16x16x32_bf16 v[120:123], v[204:207], v[232:235], v[120:123]
  v_mfma_f32_16x16x32_bf16 v[124:127], v[208:211], v[228:231], v[124:127]
  v_mfma_f32_16x16x32_bf16 v[128:131], v[208:211], v[232:235], v[128:131]
  v_mfma_f32_16x16x32_bf16 v[132:135], v[212:215], v[228:231], v[132:135]
  v_mfma_f32_16x16x32_bf16 v[136:139], v[212:215], v[232:235], v[136:139]
  v_mfma_f32_16x16x32_bf16 v[140:143], v[216:219], v[228:231], v[140:143]
  v_mfma_f32_16x16x32_bf16 v[144:147], v[216:219], v[232:235], v[144:147]
  s_waitcnt lgkmcnt(0)
  v_mfma_f32_16x16x32_bf16 v[76:79], v[148:151], v[220:223], v[76:79]
  ds_read_b128 v[228:231], v237 offset:0
  v_mfma_f32_16x16x32_bf16 v[80:83], v[148:151], v[224:227], v[80:83]
  ds_read_b128 v[232:235], v237 offset:2048
  v_mfma_f32_16x16x32_bf16 v[84:87], v[152:155], v[220:223], v[84:87]
  ds_read_b128 v[184:187], v238 offset:9216
  v_mfma_f32_16x16x32_bf16 v[88:91], v[152:155], v[224:227], v[88:91]
  ds_read_b128 v[188:191], v238 offset:10240
  v_mfma_f32_16x16x32_bf16 v[92:95], v[156:159], v[220:223], v[92:95]
  ds_read_b128 v[192:195], v238 offset:11264
  v_mfma_f32_16x16x32_bf16 v[96:99], v[156:159], v[224:227], v[96:99]
  ds_read_b128 v[196:199], v238 offset:12288
  v_mfma_f32_16x16x32_bf16 v[100:103], v[160:163], v[220:223], v[100:103]
  ds_read_b128 v[200:203], v238 offset:13312
  v_mfma_f32_16x16x32_bf16 v[104:107], v[160:163], v[224:227], v[104:107]
  ds_read_b128 v[204:207], v238 offset:14336
  v_mfma_f32_16x16x32_bf16 v[108:111], v[164:167], v[220:223], v[108:111]
  ds_read_b128 v[208:211], v238 offset:15360
  v_mfma_f32_16x16x32_bf16 v[112:115], v[164:167], v[224:227], v[112:115]
  ds_read_b128 v[212:215], v238 offset:16384
  v_mfma_f32_16x16x32_bf16 v[116:119], v[168:171], v[220:223], v[116:119]
  ds_read_b128 v[216:219], v238 offset:17408
  v_mfma_f32_16x16x32_bf16 v[120:123], v[168:171], v[224:227], v[120:123]
  v_mfma_f32_16x16x32_bf16 v[124:127], v[172:175], v[220:223], v[124:127]
  v_mfma_f32_16x16x32_bf16 v[128:131], v[172:175], v[224:227], v[128:131]
  v_mfma_f32_16x16x32_bf16 v[132:135], v[176:179], v[220:223], v[132:135]
  v_mfma_f32_16x16x32_bf16 v[136:139], v[176:179], v[224:227], v[136:139]
  v_mfma_f32_16x16x32_bf16 v[140:143], v[180:183], v[220:223], v[140:143]
  v_mfma_f32_16x16x32_bf16 v[144:147], v[180:183], v[224:227], v[144:147]
  s_waitcnt lgkmcnt(0)
  s_barrier
  v_mfma_f32_16x16x32_bf16 v[76:79], v[184:187], v[228:231], v[76:79]
  ds_read_b128 v[220:223], v236 offset:16384
  v_mfma_f32_16x16x32_bf16 v[80:83], v[184:187], v[232:235], v[80:83]
  ds_read_b128 v[224:227], v236 offset:18432
  v_mfma_f32_16x16x32_bf16 v[84:87], v[188:191], v[228:231], v[84:87]
  ds_read_b128 v[148:151], v238 offset:18432
  v_mfma_f32_16x16x32_bf16 v[88:91], v[188:191], v[232:235], v[88:91]
  ds_read_b128 v[152:155], v238 offset:19456
  v_mfma_f32_16x16x32_bf16 v[92:95], v[192:195], v[228:231], v[92:95]
  ds_read_b128 v[156:159], v238 offset:20480
  v_mfma_f32_16x16x32_bf16 v[96:99], v[192:195], v[232:235], v[96:99]
  ds_read_b128 v[160:163], v238 offset:21504
  v_mfma_f32_16x16x32_bf16 v[100:103], v[196:199], v[228:231], v[100:103]
  ds_read_b128 v[164:167], v238 offset:22528
  v_mfma_f32_16x16x32_bf16 v[104:107], v[196:199], v[232:235], v[104:107]
  ds_read_b128 v[168:171], v238 offset:23552
  v_mfma_f32_16x16x32_bf16 v[108:111], v[200:203], v[228:231], v[108:111]
  ds_read_b128 v[172:175], v238 offset:24576
  v_mfma_f32_16x16x32_bf16 v[112:115], v[200:203], v[232:235], v[112:115]
  ds_read_b128 v[176:179], v238 offset:25600
  v_mfma_f32_16x16x32_bf16 v[116:119], v[204:207], v[228:231], v[116:119]
  ds_read_b128 v[180:183], v238 offset:26624
  v_mfma_f32_16x16x32_bf16 v[120:123], v[204:207], v[232:235], v[120:123]
  v_mfma_f32_16x16x32_bf16 v[124:127], v[208:211], v[228:231], v[124:127]
  v_mfma_f32_16x16x32_bf16 v[128:131], v[208:211], v[232:235], v[128:131]
  v_mfma_f32_16x16x32_bf16 v[132:135], v[212:215], v[228:231], v[132:135]
  v_mfma_f32_16x16x32_bf16 v[136:139], v[212:215], v[232:235], v[136:139]
  v_mfma_f32_16x16x32_bf16 v[140:143], v[216:219], v[228:231], v[140:143]
  v_mfma_f32_16x16x32_bf16 v[144:147], v[216:219], v[232:235], v[144:147]
  s_waitcnt lgkmcnt(0)
  v_mfma_f32_16x16x32_bf16 v[76:79], v[148:151], v[220:223], v[76:79]
  ds_read_b128 v[228:231], v237 offset:16384
  v_mfma_f32_16x16x32_bf16 v[80:83], v[148:151], v[224:227], v[80:83]
  ds_read_b128 v[232:235], v237 offset:18432
  v_mfma_f32_16x16x32_bf16 v[84:87], v[152:155], v[220:223], v[84:87]
  ds_read_b128 v[184:187], v238 offset:27648
  v_mfma_f32_16x16x32_bf16 v[88:91], v[152:155], v[224:227], v[88:91]
  ds_read_b128 v[188:191], v238 offset:28672
  v_mfma_f32_16x16x32_bf16 v[92:95], v[156:159], v[220:223], v[92:95]
  ds_read_b128 v[192:195], v238 offset:29696
  v_mfma_f32_16x16x32_bf16 v[96:99], v[156:159], v[224:227], v[96:99]
  ds_read_b128 v[196:199], v238 offset:30720
  v_mfma_f32_16x16x32_bf16 v[100:103], v[160:163], v[220:223], v[100:103]
  ds_read_b128 v[200:203], v238 offset:31744
  v_mfma_f32_16x16x32_bf16 v[104:107], v[160:163], v[224:227], v[104:107]
  ds_read_b128 v[204:207], v238 offset:32768
  v_mfma_f32_16x16x32_bf16 v[108:111], v[164:167], v[220:223], v[108:111]
  ds_read_b128 v[208:211], v238 offset:33792
  v_mfma_f32_16x16x32_bf16 v[112:115], v[164:167], v[224:227], v[112:115]
  ds_read_b128 v[212:215], v238 offset:34816
  v_mfma_f32_16x16x32_bf16 v[116:119], v[168:171], v[220:223], v[116:119]
  ds_read_b128 v[216:219], v238 offset:35840
  v_mfma_f32_16x16x32_bf16 v[120:123], v[168:171], v[224:227], v[120:123]
  v_mfma_f32_16x16x32_bf16 v[124:127], v[172:175], v[220:223], v[124:127]
  v_mfma_f32_16x16x32_bf16 v[128:131], v[172:175], v[224:227], v[128:131]
  v_mfma_f32_16x16x32_bf16 v[132:135], v[176:179], v[220:223], v[132:135]
  v_mfma_f32_16x16x32_bf16 v[136:139], v[176:179], v[224:227], v[136:139]
  v_mfma_f32_16x16x32_bf16 v[140:143], v[180:183], v[220:223], v[140:143]
  v_mfma_f32_16x16x32_bf16 v[144:147], v[180:183], v[224:227], v[144:147]
  s_waitcnt lgkmcnt(0)
  s_barrier
  v_mfma_f32_16x16x32_bf16 v[76:79], v[184:187], v[228:231], v[76:79]
  ds_read_b128 v[220:223], v236 offset:32768
  v_mfma_f32_16x16x32_bf16 v[80:83], v[184:187], v[232:235], v[80:83]
  ds_read_b128 v[224:227], v236 offset:34816
  v_mfma_f32_16x16x32_bf16 v[84:87], v[188:191], v[228:231], v[84:87]
  ds_read_b128 v[148:151], v239 offset:0
  v_mfma_f32_16x16x32_bf16 v[88:91], v[188:191], v[232:235], v[88:91]
  ds_read_b128 v[152:155], v239 offset:1024
  v_mfma_f32_16x16x32_bf16 v[92:95], v[192:195], v[228:231], v[92:95]
  ds_read_b128 v[156:159], v239 offset:2048
  v_mfma_f32_16x16x32_bf16 v[96:99], v[192:195], v[232:235], v[96:99]
  ds_read_b128 v[160:163], v239 offset:3072
  v_mfma_f32_16x16x32_bf16 v[100:103], v[196:199], v[228:231], v[100:103]
  ds_read_b128 v[164:167], v239 offset:4096
  v_mfma_f32_16x16x32_bf16 v[104:107], v[196:199], v[232:235], v[104:107]
  ds_read_b128 v[168:171], v239 offset:5120
  v_mfma_f32_16x16x32_bf16 v[108:111], v[200:203], v[228:231], v[108:111]
  ds_read_b128 v[172:175], v239 offset:6144
  v_mfma_f32_16x16x32_bf16 v[112:115], v[200:203], v[232:235], v[112:115]
  ds_read_b128 v[176:179], v239 offset:7168
  v_mfma_f32_16x16x32_bf16 v[116:119], v[204:207], v[228:231], v[116:119]
  ds_read_b128 v[180:183], v239 offset:8192
  v_mfma_f32_16x16x32_bf16 v[120:123], v[204:207], v[232:235], v[120:123]
  v_mfma_f32_16x16x32_bf16 v[124:127], v[208:211], v[228:231], v[124:127]
  v_mfma_f32_16x16x32_bf16 v[128:131], v[208:211], v[232:235], v[128:131]
  v_mfma_f32_16x16x32_bf16 v[132:135], v[212:215], v[228:231], v[132:135]
  v_mfma_f32_16x16x32_bf16 v[136:139], v[212:215], v[232:235], v[136:139]
  v_mfma_f32_16x16x32_bf16 v[140:143], v[216:219], v[228:231], v[140:143]
  v_mfma_f32_16x16x32_bf16 v[144:147], v[216:219], v[232:235], v[144:147]
  s_waitcnt lgkmcnt(0)
  v_mfma_f32_16x16x32_bf16 v[76:79], v[148:151], v[220:223], v[76:79]
  ds_read_b128 v[228:231], v237 offset:32768
  v_mfma_f32_16x16x32_bf16 v[80:83], v[148:151], v[224:227], v[80:83]
  ds_read_b128 v[232:235], v237 offset:34816
  v_mfma_f32_16x16x32_bf16 v[84:87], v[152:155], v[220:223], v[84:87]
  ds_read_b128 v[184:187], v239 offset:9216
  v_mfma_f32_16x16x32_bf16 v[88:91], v[152:155], v[224:227], v[88:91]
  ds_read_b128 v[188:191], v239 offset:10240
  v_mfma_f32_16x16x32_bf16 v[92:95], v[156:159], v[220:223], v[92:95]
  ds_read_b128 v[192:195], v239 offset:11264
  v_mfma_f32_16x16x32_bf16 v[96:99], v[156:159], v[224:227], v[96:99]
  ds_read_b128 v[196:199], v239 offset:12288
  v_mfma_f32_16x16x32_bf16 v[100:103], v[160:163], v[220:223], v[100:103]
  ds_read_b128 v[200:203], v239 offset:13312
  v_mfma_f32_16x16x32_bf16 v[104:107], v[160:163], v[224:227], v[104:107]
  ds_read_b128 v[204:207], v239 offset:14336
  v_mfma_f32_16x16x32_bf16 v[108:111], v[164:167], v[220:223], v[108:111]
  ds_read_b128 v[208:211], v239 offset:15360
  v_mfma_f32_16x16x32_bf16 v[112:115], v[164:167], v[224:227], v[112:115]
  ds_read_b128 v[212:215], v239 offset:16384
  v_mfma_f32_16x16x32_bf16 v[116:119], v[168:171], v[220:223], v[116:119]
  ds_read_b128 v[216:219], v239 offset:17408
  v_mfma_f32_16x16x32_bf16 v[120:123], v[168:171], v[224:227], v[120:123]
  v_mfma_f32_16x16x32_bf16 v[124:127], v[172:175], v[220:223], v[124:127]
  v_mfma_f32_16x16x32_bf16 v[128:131], v[172:175], v[224:227], v[128:131]
  v_mfma_f32_16x16x32_bf16 v[132:135], v[176:179], v[220:223], v[132:135]
  v_mfma_f32_16x16x32_bf16 v[136:139], v[176:179], v[224:227], v[136:139]
  v_mfma_f32_16x16x32_bf16 v[140:143], v[180:183], v[220:223], v[140:143]
  v_mfma_f32_16x16x32_bf16 v[144:147], v[180:183], v[224:227], v[144:147]
  s_waitcnt lgkmcnt(0)
  s_barrier
  v_mfma_f32_16x16x32_bf16 v[76:79], v[184:187], v[228:231], v[76:79]
  ds_read_b128 v[220:223], v236 offset:49152
  v_mfma_f32_16x16x32_bf16 v[80:83], v[184:187], v[232:235], v[80:83]
  ds_read_b128 v[224:227], v236 offset:51200
  v_mfma_f32_16x16x32_bf16 v[84:87], v[188:191], v[228:231], v[84:87]
  ds_read_b128 v[148:151], v239 offset:18432
  v_mfma_f32_16x16x32_bf16 v[88:91], v[188:191], v[232:235], v[88:91]
  ds_read_b128 v[152:155], v239 offset:19456
  v_mfma_f32_16x16x32_bf16 v[92:95], v[192:195], v[228:231], v[92:95]
  ds_read_b128 v[156:159], v239 offset:20480
  v_mfma_f32_16x16x32_bf16 v[96:99], v[192:195], v[232:235], v[96:99]
  ds_read_b128 v[160:163], v239 offset:21504
  v_mfma_f32_16x16x32_bf16 v[100:103], v[196:199], v[228:231], v[100:103]
  ds_read_b128 v[164:167], v239 offset:22528
  v_mfma_f32_16x16x32_bf16 v[104:107], v[196:199], v[232:235], v[104:107]
  ds_read_b128 v[168:171], v239 offset:23552
  v_mfma_f32_16x16x32_bf16 v[108:111], v[200:203], v[228:231], v[108:111]
  ds_read_b128 v[172:175], v239 offset:24576
  v_mfma_f32_16x16x32_bf16 v[112:115], v[200:203], v[232:235], v[112:115]
  ds_read_b128 v[176:179], v239 offset:25600
  v_mfma_f32_16x16x32_bf16 v[116:119], v[204:207], v[228:231], v[116:119]
  ds_read_b128 v[180:183], v239 offset:26624
  v_mfma_f32_16x16x32_bf16 v[120:123], v[204:207], v[232:235], v[120:123]
  v_mfma_f32_16x16x32_bf16 v[124:127], v[208:211], v[228:231], v[124:127]
  v_mfma_f32_16x16x32_bf16 v[128:131], v[208:211], v[232:235], v[128:131]
  v_mfma_f32_16x16x32_bf16 v[132:135], v[212:215], v[228:231], v[132:135]
  v_mfma_f32_16x16x32_bf16 v[136:139], v[212:215], v[232:235], v[136:139]
  v_mfma_f32_16x16x32_bf16 v[140:143], v[216:219], v[228:231], v[140:143]
  v_mfma_f32_16x16x32_bf16 v[144:147], v[216:219], v[232:235], v[144:147]
  s_waitcnt lgkmcnt(0)
  v_mfma_f32_16x16x32_bf16 v[76:79], v[148:151], v[220:223], v[76:79]
  ds_read_b128 v[228:231], v237 offset:49152
  v_mfma_f32_16x16x32_bf16 v[80:83], v[148:151], v[224:227], v[80:83]
  ds_read_b128 v[232:235], v237 offset:51200
  v_mfma_f32_16x16x32_bf16 v[84:87], v[152:155], v[220:223], v[84:87]
  ds_read_b128 v[184:187], v239 offset:27648
  v_mfma_f32_16x16x32_bf16 v[88:91], v[152:155], v[224:227], v[88:91]
  ds_read_b128 v[188:191], v239 offset:28672
  v_mfma_f32_16x16x32_bf16 v[92:95], v[156:159], v[220:223], v[92:95]
  ds_read_b128 v[192:195], v239 offset:29696
  v_mfma_f32_16x16x32_bf16 v[96:99], v[156:159], v[224:227], v[96:99]
  ds_read_b128 v[196:199], v239 offset:30720
  v_mfma_f32_16x16x32_bf16 v[100:103], v[160:163], v[220:223], v[100:103]
  ds_read_b128 v[200:203], v239 offset:31744
  v_mfma_f32_16x16x32_bf16 v[104:107], v[160:163], v[224:227], v[104:107]
  ds_read_b128 v[204:207], v239 offset:32768
  v_mfma_f32_16x16x32_bf16 v[108:111], v[164:167], v[220:223], v[108:111]
  ds_read_b128 v[208:211], v239 offset:33792
  v_mfma_f32_16x16x32_bf16 v[112:115], v[164:167], v[224:227], v[112:115]
  ds_read_b128 v[212:215], v239 offset:34816
  v_mfma_f32_16x16x32_bf16 v[116:119], v[168:171], v[220:223], v[116:119]
  ds_read_b128 v[216:219], v239 offset:35840
  v_mfma_f32_16x16x32_bf16 v[120:123], v[168:171], v[224:227], v[120:123]
  v_mfma_f32_16x16x32_bf16 v[124:127], v[172:175], v[220:223], v[124:127]
  v_mfma_f32_16x16x32_bf16 v[128:131], v[172:175], v[224:227], v[128:131]
  v_mfma_f32_16x16x32_bf16 v[132:135], v[176:179], v[220:223], v[132:135]
  v_mfma_f32_16x16x32_bf16 v[136:139], v[176:179], v[224:227], v[136:139]
  v_mfma_f32_16x16x32_bf16 v[140:143], v[180:183], v[220:223], v[140:143]
  v_mfma_f32_16x16x32_bf16 v[144:147], v[180:183], v[224:227], v[144:147]
  s_waitcnt lgkmcnt(0)
  s_barrier
  v_mfma_f32_16x16x32_bf16 v[76:79], v[184:187], v[228:231], v[76:79]
  ds_read_b128 v[220:223], v236 offset:0
  v_mfma_f32_16x16x32_bf16 v[80:83], v[184:187], v[232:235], v[80:83]
  ds_read_b128 v[224:227], v236 offset:2048
  v_mfma_f32_16x16x32_bf16 v[84:87], v[188:191], v[228:231], v[84:87]
  ds_read_b128 v[148:151], v238 offset:0
  v_mfma_f32_16x16x32_bf16 v[88:91], v[188:191], v[232:235], v[88:91]
  ds_read_b128 v[152:155], v238 offset:1024
  v_mfma_f32_16x16x32_bf16 v[92:95], v[192:195], v[228:231], v[92:95]
  ds_read_b128 v[156:159], v238 offset:2048
  v_mfma_f32_16x16x32_bf16 v[96:99], v[192:195], v[232:235], v[96:99]
  ds_read_b128 v[160:163], v238 offset:3072
  v_mfma_f32_16x16x32_bf16 v[100:103], v[196:199], v[228:231], v[100:103]
  ds_read_b128 v[164:167], v238 offset:4096
  v_mfma_f32_16x16x32_bf16 v[104:107], v[196:199], v[232:235], v[104:107]
  ds_read_b128 v[168:171], v238 offset:5120
  v_mfma_f32_16x16x32_bf16 v[108:111], v[200:203], v[228:231], v[108:111]
  ds_read_b128 v[172:175], v238 offset:6144
  v_mfma_f32_16x16x32_bf16 v[112:115], v[200:203], v[232:235], v[112:115]
  ds_read_b128 v[176:179], v238 offset:7168
  v_mfma_f32_16x16x32_bf16 v[116:119], v[204:207], v[228:231], v[116:119]
  ds_read_b128 v[180:183], v238 offset:8192
  v_mfma_f32_16x16x32_bf16 v[120:123], v[204:207], v[232:235], v[120:123]
  v_mfma_f32_16x16x32_bf16 v[124:127], v[208:211], v[228:231], v[124:127]
  v_mfma_f32_16x16x32_bf16 v[128:131], v[208:211], v[232:235], v[128:131]
  v_mfma_f32_16x16x32_bf16 v[132:135], v[212:215], v[228:231], v[132:135]
  v_mfma_f32_16x16x32_bf16 v[136:139], v[212:215], v[232:235], v[136:139]
  v_mfma_f32_16x16x32_bf16 v[140:143], v[216:219], v[228:231], v[140:143]
  v_mfma_f32_16x16x32_bf16 v[144:147], v[216:219], v[232:235], v[144:147]
  s_waitcnt lgkmcnt(0)
  v_mfma_f32_16x16x32_bf16 v[76:79], v[148:151], v[220:223], v[76:79]
  ds_read_b128 v[228:231], v237 offset:0
  v_mfma_f32_16x16x32_bf16 v[80:83], v[148:151], v[224:227], v[80:83]
  ds_read_b128 v[232:235], v237 offset:2048
  v_mfma_f32_16x16x32_bf16 v[84:87], v[152:155], v[220:223], v[84:87]
  ds_read_b128 v[184:187], v238 offset:9216
  v_mfma_f32_16x16x32_bf16 v[88:91], v[152:155], v[224:227], v[88:91]
  ds_read_b128 v[188:191], v238 offset:10240
  v_mfma_f32_16x16x32_bf16 v[92:95], v[156:159], v[220:223], v[92:95]
  ds_read_b128 v[192:195], v238 offset:11264
  v_mfma_f32_16x16x32_bf16 v[96:99], v[156:159], v[224:227], v[96:99]
  ds_read_b128 v[196:199], v238 offset:12288
  v_mfma_f32_16x16x32_bf16 v[100:103], v[160:163], v[220:223], v[100:103]
  ds_read_b128 v[200:203], v238 offset:13312
  v_mfma_f32_16x16x32_bf16 v[104:107], v[160:163], v[224:227], v[104:107]
  ds_read_b128 v[204:207], v238 offset:14336
  v_mfma_f32_16x16x32_bf16 v[108:111], v[164:167], v[220:223], v[108:111]
  ds_read_b128 v[208:211], v238 offset:15360
  v_mfma_f32_16x16x32_bf16 v[112:115], v[164:167], v[224:227], v[112:115]
  ds_read_b128 v[212:215], v238 offset:16384
  v_mfma_f32_16x16x32_bf16 v[116:119], v[168:171], v[220:223], v[116:119]
  ds_read_b128 v[216:219], v238 offset:17408
  v_mfma_f32_16x16x32_bf16 v[120:123], v[168:171], v[224:227], v[120:123]
  v_mfma_f32_16x16x32_bf16 v[124:127], v[172:175], v[220:223], v[124:127]
  v_mfma_f32_16x16x32_bf16 v[128:131], v[172:175], v[224:227], v[128:131]
  v_mfma_f32_16x16x32_bf16 v[132:135], v[176:179], v[220:223], v[132:135]
  v_mfma_f32_16x16x32_bf16 v[136:139], v[176:179], v[224:227], v[136:139]
  v_mfma_f32_16x16x32_bf16 v[140:143], v[180:183], v[220:223], v[140:143]
  v_mfma_f32_16x16x32_bf16 v[144:147], v[180:183], v[224:227], v[144:147]
  s_waitcnt lgkmcnt(0)
  s_barrier
  v_mfma_f32_16x16x32_bf16 v[76:79], v[184:187], v[228:231], v[76:79]
  ds_read_b128 v[220:223], v236 offset:16384
  v_mfma_f32_16x16x32_bf16 v[80:83], v[184:187], v[232:235], v[80:83]
  ds_read_b128 v[224:227], v236 offset:18432
  v_mfma_f32_16x16x32_bf16 v[84:87], v[188:191], v[228:231], v[84:87]
  ds_read_b128 v[148:151], v238 offset:18432
  v_mfma_f32_16x16x32_bf16 v[88:91], v[188:191], v[232:235], v[88:91]
  ds_read_b128 v[152:155], v238 offset:19456
  v_mfma_f32_16x16x32_bf16 v[92:95], v[192:195], v[228:231], v[92:95]
  ds_read_b128 v[156:159], v238 offset:20480
  v_mfma_f32_16x16x32_bf16 v[96:99], v[192:195], v[232:235], v[96:99]
  ds_read_b128 v[160:163], v238 offset:21504
  v_mfma_f32_16x16x32_bf16 v[100:103], v[196:199], v[228:231], v[100:103]
  ds_read_b128 v[164:167], v238 offset:22528
  v_mfma_f32_16x16x32_bf16 v[104:107], v[196:199], v[232:235], v[104:107]
  ds_read_b128 v[168:171], v238 offset:23552
  v_mfma_f32_16x16x32_bf16 v[108:111], v[200:203], v[228:231], v[108:111]
  ds_read_b128 v[172:175], v238 offset:24576
  v_mfma_f32_16x16x32_bf16 v[112:115], v[200:203], v[232:235], v[112:115]
  ds_read_b128 v[176:179], v238 offset:25600
  v_mfma_f32_16x16x32_bf16 v[116:119], v[204:207], v[228:231], v[116:119]
  ds_read_b128 v[180:183], v238 offset:26624
  v_mfma_f32_16x16x32_bf16 v[120:123], v[204:207], v[232:235], v[120:123]
  v_mfma_f32_16x16x32_bf16 v[124:127], v[208:211], v[228:231], v[124:127]
  v_mfma_f32_16x16x32_bf16 v[128:131], v[208:211], v[232:235], v[128:131]
  v_mfma_f32_16x16x32_bf16 v[132:135], v[212:215], v[228:231], v[132:135]
  v_mfma_f32_16x16x32_bf16 v[136:139], v[212:215], v[232:235], v[136:139]
  v_mfma_f32_16x16x32_bf16 v[140:143], v[216:219], v[228:231], v[140:143]
  v_mfma_f32_16x16x32_bf16 v[144:147], v[216:219], v[232:235], v[144:147]
  s_waitcnt lgkmcnt(0)
  v_mfma_f32_16x16x32_bf16 v[76:79], v[148:151], v[220:223], v[76:79]
  ds_read_b128 v[228:231], v237 offset:16384
  v_mfma_f32_16x16x32_bf16 v[80:83], v[148:151], v[224:227], v[80:83]
  ds_read_b128 v[232:235], v237 offset:18432
  v_mfma_f32_16x16x32_bf16 v[84:87], v[152:155], v[220:223], v[84:87]
  ds_read_b128 v[184:187], v238 offset:27648
  v_mfma_f32_16x16x32_bf16 v[88:91], v[152:155], v[224:227], v[88:91]
  ds_read_b128 v[188:191], v238 offset:28672
  v_mfma_f32_16x16x32_bf16 v[92:95], v[156:159], v[220:223], v[92:95]
  ds_read_b128 v[192:195], v238 offset:29696
  v_mfma_f32_16x16x32_bf16 v[96:99], v[156:159], v[224:227], v[96:99]
  ds_read_b128 v[196:199], v238 offset:30720
  v_mfma_f32_16x16x32_bf16 v[100:103], v[160:163], v[220:223], v[100:103]
  ds_read_b128 v[200:203], v238 offset:31744
  v_mfma_f32_16x16x32_bf16 v[104:107], v[160:163], v[224:227], v[104:107]
  ds_read_b128 v[204:207], v238 offset:32768
  v_mfma_f32_16x16x32_bf16 v[108:111], v[164:167], v[220:223], v[108:111]
  ds_read_b128 v[208:211], v238 offset:33792
  v_mfma_f32_16x16x32_bf16 v[112:115], v[164:167], v[224:227], v[112:115]
  ds_read_b128 v[212:215], v238 offset:34816
  v_mfma_f32_16x16x32_bf16 v[116:119], v[168:171], v[220:223], v[116:119]
  ds_read_b128 v[216:219], v238 offset:35840
  v_mfma_f32_16x16x32_bf16 v[120:123], v[168:171], v[224:227], v[120:123]
  v_mfma_f32_16x16x32_bf16 v[124:127], v[172:175], v[220:223], v[124:127]
  v_mfma_f32_16x16x32_bf16 v[128:131], v[172:175], v[224:227], v[128:131]
  v_mfma_f32_16x16x32_bf16 v[132:135], v[176:179], v[220:223], v[132:135]
  v_mfma_f32_16x16x32_bf16 v[136:139], v[176:179], v[224:227], v[136:139]
  v_mfma_f32_16x16x32_bf16 v[140:143], v[180:183], v[220:223], v[140:143]
  v_mfma_f32_16x16x32_bf16 v[144:147], v[180:183], v[224:227], v[144:147]
  s_waitcnt lgkmcnt(0)
  s_barrier
  v_mfma_f32_16x16x32_bf16 v[76:79], v[184:187], v[228:231], v[76:79]
  ds_read_b128 v[220:223], v236 offset:32768
  v_mfma_f32_16x16x32_bf16 v[80:83], v[184:187], v[232:235], v[80:83]
  ds_read_b128 v[224:227], v236 offset:34816
  v_mfma_f32_16x16x32_bf16 v[84:87], v[188:191], v[228:231], v[84:87]
  ds_read_b128 v[148:151], v239 offset:0
  v_mfma_f32_16x16x32_bf16 v[88:91], v[188:191], v[232:235], v[88:91]
  ds_read_b128 v[152:155], v239 offset:1024
  v_mfma_f32_16x16x32_bf16 v[92:95], v[192:195], v[228:231], v[92:95]
  ds_read_b128 v[156:159], v239 offset:2048
  v_mfma_f32_16x16x32_bf16 v[96:99], v[192:195], v[232:235], v[96:99]
  ds_read_b128 v[160:163], v239 offset:3072
  v_mfma_f32_16x16x32_bf16 v[100:103], v[196:199], v[228:231], v[100:103]
  ds_read_b128 v[164:167], v239 offset:4096
  v_mfma_f32_16x16x32_bf16 v[104:107], v[196:199], v[232:235], v[104:107]
  ds_read_b128 v[168:171], v239 offset:5120
  v_mfma_f32_16x16x32_bf16 v[108:111], v[200:203], v[228:231], v[108:111]
  ds_read_b128 v[172:175], v239 offset:6144
  v_mfma_f32_16x16x32_bf16 v[112:115], v[200:203], v[232:235], v[112:115]
  ds_read_b128 v[176:179], v239 offset:7168
  v_mfma_f32_16x16x32_bf16 v[116:119], v[204:207], v[228:231], v[116:119]
  ds_read_b128 v[180:183], v239 offset:8192
  v_mfma_f32_16x16x32_bf16 v[120:123], v[204:207], v[232:235], v[120:123]
  v_mfma_f32_16x16x32_bf16 v[124:127], v[208:211], v[228:231], v[124:127]
  v_mfma_f32_16x16x32_bf16 v[128:131], v[208:211], v[232:235], v[128:131]
  v_mfma_f32_16x16x32_bf16 v[132:135], v[212:215], v[228:231], v[132:135]
  v_mfma_f32_16x16x32_bf16 v[136:139], v[212:215], v[232:235], v[136:139]
  v_mfma_f32_16x16x32_bf16 v[140:143], v[216:219], v[228:231], v[140:143]
  v_mfma_f32_16x16x32_bf16 v[144:147], v[216:219], v[232:235], v[144:147]
  s_waitcnt lgkmcnt(0)
  v_mfma_f32_16x16x32_bf16 v[76:79], v[148:151], v[220:223], v[76:79]
  ds_read_b128 v[228:231], v237 offset:32768
  v_mfma_f32_16x16x32_bf16 v[80:83], v[148:151], v[224:227], v[80:83]
  ds_read_b128 v[232:235], v237 offset:34816
  v_mfma_f32_16x16x32_bf16 v[84:87], v[152:155], v[220:223], v[84:87]
  ds_read_b128 v[184:187], v239 offset:9216
  v_mfma_f32_16x16x32_bf16 v[88:91], v[152:155], v[224:227], v[88:91]
  ds_read_b128 v[188:191], v239 offset:10240
  v_mfma_f32_16x16x32_bf16 v[92:95], v[156:159], v[220:223], v[92:95]
  ds_read_b128 v[192:195], v239 offset:11264
  v_mfma_f32_16x16x32_bf16 v[96:99], v[156:159], v[224:227], v[96:99]
  ds_read_b128 v[196:199], v239 offset:12288
  v_mfma_f32_16x16x32_bf16 v[100:103], v[160:163], v[220:223], v[100:103]
  ds_read_b128 v[200:203], v239 offset:13312
  v_mfma_f32_16x16x32_bf16 v[104:107], v[160:163], v[224:227], v[104:107]
  ds_read_b128 v[204:207], v239 offset:14336
  v_mfma_f32_16x16x32_bf16 v[108:111], v[164:167], v[220:223], v[108:111]
  ds_read_b128 v[208:211], v239 offset:15360
  v_mfma_f32_16x16x32_bf16 v[112:115], v[164:167], v[224:227], v[112:115]
  ds_read_b128 v[212:215], v239 offset:16384
  v_mfma_f32_16x16x32_bf16 v[116:119], v[168:171], v[220:223], v[116:119]
  ds_read_b128 v[216:219], v239 offset:17408
  v_mfma_f32_16x16x32_bf16 v[120:123], v[168:171], v[224:227], v[120:123]
  v_mfma_f32_16x16x32_bf16 v[124:127], v[172:175], v[220:223], v[124:127]
  v_mfma_f32_16x16x32_bf16 v[128:131], v[172:175], v[224:227], v[128:131]
  v_mfma_f32_16x16x32_bf16 v[132:135], v[176:179], v[220:223], v[132:135]
  v_mfma_f32_16x16x32_bf16 v[136:139], v[176:179], v[224:227], v[136:139]
  v_mfma_f32_16x16x32_bf16 v[140:143], v[180:183], v[220:223], v[140:143]
  v_mfma_f32_16x16x32_bf16 v[144:147], v[180:183], v[224:227], v[144:147]
  s_waitcnt lgkmcnt(0)
  s_barrier
  v_mfma_f32_16x16x32_bf16 v[76:79], v[184:187], v[228:231], v[76:79]
  ds_read_b128 v[220:223], v236 offset:49152
  v_mfma_f32_16x16x32_bf16 v[80:83], v[184:187], v[232:235], v[80:83]
  ds_read_b128 v[224:227], v236 offset:51200
  v_mfma_f32_16x16x32_bf16 v[84:87], v[188:191], v[228:231], v[84:87]
  ds_read_b128 v[148:151], v239 offset:18432
  v_mfma_f32_16x16x32_bf16 v[88:91], v[188:191], v[232:235], v[88:91]
  ds_read_b128 v[152:155], v239 offset:19456
  v_mfma_f32_16x16x32_bf16 v[92:95], v[192:195], v[228:231], v[92:95]
  ds_read_b128 v[156:159], v239 offset:20480
  v_mfma_f32_16x16x32_bf16 v[96:99], v[192:195], v[232:235], v[96:99]
  ds_read_b128 v[160:163], v239 offset:21504
  v_mfma_f32_16x16x32_bf16 v[100:103], v[196:199], v[228:231], v[100:103]
  ds_read_b128 v[164:167], v239 offset:22528
  v_mfma_f32_16x16x32_bf16 v[104:107], v[196:199], v[232:235], v[104:107]
  ds_read_b128 v[168:171], v239 offset:23552
  v_mfma_f32_16x16x32_bf16 v[108:111], v[200:203], v[228:231], v[108:111]
  ds_read_b128 v[172:175], v239 offset:24576
  v_mfma_f32_16x16x32_bf16 v[112:115], v[200:203], v[232:235], v[112:115]
  ds_read_b128 v[176:179], v239 offset:25600
  v_mfma_f32_16x16x32_bf16 v[116:119], v[204:207], v[228:231], v[116:119]
  ds_read_b128 v[180:183], v239 offset:26624
  v_mfma_f32_16x16x32_bf16 v[120:123], v[204:207], v[232:235], v[120:123]
  v_mfma_f32_16x16x32_bf16 v[124:127], v[208:211], v[228:231], v[124:127]
  v_mfma_f32_16x16x32_bf16 v[128:131], v[208:211], v[232:235], v[128:131]
  v_mfma_f32_16x16x32_bf16 v[132:135], v[212:215], v[228:231], v[132:135]
  v_mfma_f32_16x16x32_bf16 v[136:139], v[212:215], v[232:235], v[136:139]
  v_mfma_f32_16x16x32_bf16 v[140:143], v[216:219], v[228:231], v[140:143]
  v_mfma_f32_16x16x32_bf16 v[144:147], v[216:219], v[232:235], v[144:147]
  s_waitcnt lgkmcnt(0)
  v_mfma_f32_16x16x32_bf16 v[76:79], v[148:151], v[220:223], v[76:79]
  ds_read_b128 v[228:231], v237 offset:49152
  v_mfma_f32_16x16x32_bf16 v[80:83], v[148:151], v[224:227], v[80:83]
  ds_read_b128 v[232:235], v237 offset:51200
  v_mfma_f32_16x16x32_bf16 v[84:87], v[152:155], v[220:223], v[84:87]
  ds_read_b128 v[184:187], v239 offset:27648
  v_mfma_f32_16x16x32_bf16 v[88:91], v[152:155], v[224:227], v[88:91]
  ds_read_b128 v[188:191], v239 offset:28672
  v_mfma_f32_16x16x32_bf16 v[92:95], v[156:159], v[220:223], v[92:95]
  ds_read_b128 v[192:195], v239 offset:29696
  v_mfma_f32_16x16x32_bf16 v[96:99], v[156:159], v[224:227], v[96:99]
  ds_read_b128 v[196:199], v239 offset:30720
  v_mfma_f32_16x16x32_bf16 v[100:103], v[160:163], v[220:223], v[100:103]
  ds_read_b128 v[200:203], v239 offset:31744
  v_mfma_f32_16x16x32_bf16 v[104:107], v[160:163], v[224:227], v[104:107]
  ds_read_b128 v[204:207], v239 offset:32768
  v_mfma_f32_16x16x32_bf16 v[108:111], v[164:167], v[220:223], v[108:111]
  ds_read_b128 v[208:211], v239 offset:33792
  v_mfma_f32_16x16x32_bf16 v[112:115], v[164:167], v[224:227], v[112:115]
  ds_read_b128 v[212:215], v239 offset:34816
  v_mfma_f32_16x16x32_bf16 v[116:119], v[168:171], v[220:223], v[116:119]
  ds_read_b128 v[216:219], v239 offset:35840
  v_mfma_f32_16x16x32_bf16 v[120:123], v[168:171], v[224:227], v[120:123]
  v_mfma_f32_16x16x32_bf16 v[124:127], v[172:175], v[220:223], v[124:127]
  v_mfma_f32_16x16x32_bf16 v[128:131], v[172:175], v[224:227], v[128:131]
  v_mfma_f32_16x16x32_bf16 v[132:135], v[176:179], v[220:223], v[132:135]
  v_mfma_f32_16x16x32_bf16 v[136:139], v[176:179], v[224:227], v[136:139]
  v_mfma_f32_16x16x32_bf16 v[140:143], v[180:183], v[220:223], v[140:143]
  v_mfma_f32_16x16x32_bf16 v[144:147], v[180:183], v[224:227], v[144:147]
  s_waitcnt lgkmcnt(0)
  s_barrier
  v_mfma_f32_16x16x32_bf16 v[76:79], v[184:187], v[228:231], v[76:79]
  ds_read_b128 v[220:223], v236 offset:0
  v_mfma_f32_16x16x32_bf16 v[80:83], v[184:187], v[232:235], v[80:83]
  ds_read_b128 v[224:227], v236 offset:2048
  v_mfma_f32_16x16x32_bf16 v[84:87], v[188:191], v[228:231], v[84:87]
  ds_read_b128 v[148:151], v238 offset:0
  v_mfma_f32_16x16x32_bf16 v[88:91], v[188:191], v[232:235], v[88:91]
  ds_read_b128 v[152:155], v238 offset:1024
  v_mfma_f32_16x16x32_bf16 v[92:95], v[192:195], v[228:231], v[92:95]
  ds_read_b128 v[156:159], v238 offset:2048
  v_mfma_f32_16x16x32_bf16 v[96:99], v[192:195], v[232:235], v[96:99]
  ds_read_b128 v[160:163], v238 offset:3072
  v_mfma_f32_16x16x32_bf16 v[100:103], v[196:199], v[228:231], v[100:103]
  ds_read_b128 v[164:167], v238 offset:4096
  v_mfma_f32_16x16x32_bf16 v[104:107], v[196:199], v[232:235], v[104:107]
  ds_read_b128 v[168:171], v238 offset:5120
  v_mfma_f32_16x16x32_bf16 v[108:111], v[200:203], v[228:231], v[108:111]
  ds_read_b128 v[172:175], v238 offset:6144
  v_mfma_f32_16x16x32_bf16 v[112:115], v[200:203], v[232:235], v[112:115]
  ds_read_b128 v[176:179], v238 offset:7168
  v_mfma_f32_16x16x32_bf16 v[116:119], v[204:207], v[228:231], v[116:119]
  ds_read_b128 v[180:183], v238 offset:8192
  v_mfma_f32_16x16x32_bf16 v[120:123], v[204:207], v[232:235], v[120:123]
  v_mfma_f32_16x16x32_bf16 v[124:127], v[208:211], v[228:231], v[124:127]
  v_mfma_f32_16x16x32_bf16 v[128:131], v[208:211], v[232:235], v[128:131]
  v_mfma_f32_16x16x32_bf16 v[132:135], v[212:215], v[228:231], v[132:135]
  v_mfma_f32_16x16x32_bf16 v[136:139], v[212:215], v[232:235], v[136:139]
  v_mfma_f32_16x16x32_bf16 v[140:143], v[216:219], v[228:231], v[140:143]
  v_mfma_f32_16x16x32_bf16 v[144:147], v[216:219], v[232:235], v[144:147]
  s_waitcnt lgkmcnt(0)
  v_mfma_f32_16x16x32_bf16 v[76:79], v[148:151], v[220:223], v[76:79]
  ds_read_b128 v[228:231], v237 offset:0
  v_mfma_f32_16x16x32_bf16 v[80:83], v[148:151], v[224:227], v[80:83]
  ds_read_b128 v[232:235], v237 offset:2048
  v_mfma_f32_16x16x32_bf16 v[84:87], v[152:155], v[220:223], v[84:87]
  ds_read_b128 v[184:187], v238 offset:9216
  v_mfma_f32_16x16x32_bf16 v[88:91], v[152:155], v[224:227], v[88:91]
  ds_read_b128 v[188:191], v238 offset:10240
  v_mfma_f32_16x16x32_bf16 v[92:95], v[156:159], v[220:223], v[92:95]
  ds_read_b128 v[192:195], v238 offset:11264
  v_mfma_f32_16x16x32_bf16 v[96:99], v[156:159], v[224:227], v[96:99]
  ds_read_b128 v[196:199], v238 offset:12288
  v_mfma_f32_16x16x32_bf16 v[100:103], v[160:163], v[220:223], v[100:103]
  ds_read_b128 v[200:203], v238 offset:13312
  v_mfma_f32_16x16x32_bf16 v[104:107], v[160:163], v[224:227], v[104:107]
  ds_read_b128 v[204:207], v238 offset:14336
  v_mfma_f32_16x16x32_bf16 v[108:111], v[164:167], v[220:223], v[108:111]
  ds_read_b128 v[208:211], v238 offset:15360
  v_mfma_f32_16x16x32_bf16 v[112:115], v[164:167], v[224:227], v[112:115]
  ds_read_b128 v[212:215], v238 offset:16384
  v_mfma_f32_16x16x32_bf16 v[116:119], v[168:171], v[220:223], v[116:119]
  ds_read_b128 v[216:219], v238 offset:17408
  v_mfma_f32_16x16x32_bf16 v[120:123], v[168:171], v[224:227], v[120:123]
  v_mfma_f32_16x16x32_bf16 v[124:127], v[172:175], v[220:223], v[124:127]
  v_mfma_f32_16x16x32_bf16 v[128:131], v[172:175], v[224:227], v[128:131]
  v_mfma_f32_16x16x32_bf16 v[132:135], v[176:179], v[220:223], v[132:135]
  v_mfma_f32_16x16x32_bf16 v[136:139], v[176:179], v[224:227], v[136:139]
  v_mfma_f32_16x16x32_bf16 v[140:143], v[180:183], v[220:223], v[140:143]
  v_mfma_f32_16x16x32_bf16 v[144:147], v[180:183], v[224:227], v[144:147]
  s_waitcnt lgkmcnt(0)
  s_barrier
  v_mfma_f32_16x16x32_bf16 v[76:79], v[184:187], v[228:231], v[76:79]
  ds_read_b128 v[220:223], v236 offset:16384
  v_mfma_f32_16x16x32_bf16 v[80:83], v[184:187], v[232:235], v[80:83]
  ds_read_b128 v[224:227], v236 offset:18432
  v_mfma_f32_16x16x32_bf16 v[84:87], v[188:191], v[228:231], v[84:87]
  ds_read_b128 v[148:151], v238 offset:18432
  v_mfma_f32_16x16x32_bf16 v[88:91], v[188:191], v[232:235], v[88:91]
  ds_read_b128 v[152:155], v238 offset:19456
  v_mfma_f32_16x16x32_bf16 v[92:95], v[192:195], v[228:231], v[92:95]
  ds_read_b128 v[156:159], v238 offset:20480
  v_mfma_f32_16x16x32_bf16 v[96:99], v[192:195], v[232:235], v[96:99]
  ds_read_b128 v[160:163], v238 offset:21504
  v_mfma_f32_16x16x32_bf16 v[100:103], v[196:199], v[228:231], v[100:103]
  ds_read_b128 v[164:167], v238 offset:22528
  v_mfma_f32_16x16x32_bf16 v[104:107], v[196:199], v[232:235], v[104:107]
  ds_read_b128 v[168:171], v238 offset:23552
  v_mfma_f32_16x16x32_bf16 v[108:111], v[200:203], v[228:231], v[108:111]
  ds_read_b128 v[172:175], v238 offset:24576
  v_mfma_f32_16x16x32_bf16 v[112:115], v[200:203], v[232:235], v[112:115]
  ds_read_b128 v[176:179], v238 offset:25600
  v_mfma_f32_16x16x32_bf16 v[116:119], v[204:207], v[228:231], v[116:119]
  ds_read_b128 v[180:183], v238 offset:26624
  v_mfma_f32_16x16x32_bf16 v[120:123], v[204:207], v[232:235], v[120:123]
  v_mfma_f32_16x16x32_bf16 v[124:127], v[208:211], v[228:231], v[124:127]
  v_mfma_f32_16x16x32_bf16 v[128:131], v[208:211], v[232:235], v[128:131]
  v_mfma_f32_16x16x32_bf16 v[132:135], v[212:215], v[228:231], v[132:135]
  v_mfma_f32_16x16x32_bf16 v[136:139], v[212:215], v[232:235], v[136:139]
  v_mfma_f32_16x16x32_bf16 v[140:143], v[216:219], v[228:231], v[140:143]
  v_mfma_f32_16x16x32_bf16 v[144:147], v[216:219], v[232:235], v[144:147]
  s_waitcnt lgkmcnt(0)
  v_mfma_f32_16x16x32_bf16 v[76:79], v[148:151], v[220:223], v[76:79]
  ds_read_b128 v[228:231], v237 offset:16384
  v_mfma_f32_16x16x32_bf16 v[80:83], v[148:151], v[224:227], v[80:83]
  ds_read_b128 v[232:235], v237 offset:18432
  v_mfma_f32_16x16x32_bf16 v[84:87], v[152:155], v[220:223], v[84:87]
  ds_read_b128 v[184:187], v238 offset:27648
  v_mfma_f32_16x16x32_bf16 v[88:91], v[152:155], v[224:227], v[88:91]
  ds_read_b128 v[188:191], v238 offset:28672
  v_mfma_f32_16x16x32_bf16 v[92:95], v[156:159], v[220:223], v[92:95]
  ds_read_b128 v[192:195], v238 offset:29696
  v_mfma_f32_16x16x32_bf16 v[96:99], v[156:159], v[224:227], v[96:99]
  ds_read_b128 v[196:199], v238 offset:30720
  v_mfma_f32_16x16x32_bf16 v[100:103], v[160:163], v[220:223], v[100:103]
  ds_read_b128 v[200:203], v238 offset:31744
  v_mfma_f32_16x16x32_bf16 v[104:107], v[160:163], v[224:227], v[104:107]
  ds_read_b128 v[204:207], v238 offset:32768
  v_mfma_f32_16x16x32_bf16 v[108:111], v[164:167], v[220:223], v[108:111]
  ds_read_b128 v[208:211], v238 offset:33792
  v_mfma_f32_16x16x32_bf16 v[112:115], v[164:167], v[224:227], v[112:115]
  ds_read_b128 v[212:215], v238 offset:34816
  v_mfma_f32_16x16x32_bf16 v[116:119], v[168:171], v[220:223], v[116:119]
  ds_read_b128 v[216:219], v238 offset:35840
  v_mfma_f32_16x16x32_bf16 v[120:123], v[168:171], v[224:227], v[120:123]
  v_mfma_f32_16x16x32_bf16 v[124:127], v[172:175], v[220:223], v[124:127]
  v_mfma_f32_16x16x32_bf16 v[128:131], v[172:175], v[224:227], v[128:131]
  v_mfma_f32_16x16x32_bf16 v[132:135], v[176:179], v[220:223], v[132:135]
  v_mfma_f32_16x16x32_bf16 v[136:139], v[176:179], v[224:227], v[136:139]
  v_mfma_f32_16x16x32_bf16 v[140:143], v[180:183], v[220:223], v[140:143]
  v_mfma_f32_16x16x32_bf16 v[144:147], v[180:183], v[224:227], v[144:147]
  s_waitcnt lgkmcnt(0)
  s_barrier
  v_mfma_f32_16x16x32_bf16 v[76:79], v[184:187], v[228:231], v[76:79]
  ds_read_b128 v[220:223], v236 offset:32768
  v_mfma_f32_16x16x32_bf16 v[80:83], v[184:187], v[232:235], v[80:83]
  ds_read_b128 v[224:227], v236 offset:34816
  v_mfma_f32_16x16x32_bf16 v[84:87], v[188:191], v[228:231], v[84:87]
  ds_read_b128 v[148:151], v239 offset:0
  v_mfma_f32_16x16x32_bf16 v[88:91], v[188:191], v[232:235], v[88:91]
  ds_read_b128 v[152:155], v239 offset:1024
  v_mfma_f32_16x16x32_bf16 v[92:95], v[192:195], v[228:231], v[92:95]
  ds_read_b128 v[156:159], v239 offset:2048
  v_mfma_f32_16x16x32_bf16 v[96:99], v[192:195], v[232:235], v[96:99]
  ds_read_b128 v[160:163], v239 offset:3072
  v_mfma_f32_16x16x32_bf16 v[100:103], v[196:199], v[228:231], v[100:103]
  ds_read_b128 v[164:167], v239 offset:4096
  v_mfma_f32_16x16x32_bf16 v[104:107], v[196:199], v[232:235], v[104:107]
  ds_read_b128 v[168:171], v239 offset:5120
  v_mfma_f32_16x16x32_bf16 v[108:111], v[200:203], v[228:231], v[108:111]
  ds_read_b128 v[172:175], v239 offset:6144
  v_mfma_f32_16x16x32_bf16 v[112:115], v[200:203], v[232:235], v[112:115]
  ds_read_b128 v[176:179], v239 offset:7168
  v_mfma_f32_16x16x32_bf16 v[116:119], v[204:207], v[228:231], v[116:119]
  ds_read_b128 v[180:183], v239 offset:8192
  v_mfma_f32_16x16x32_bf16 v[120:123], v[204:207], v[232:235], v[120:123]
  v_mfma_f32_16x16x32_bf16 v[124:127], v[208:211], v[228:231], v[124:127]
  v_mfma_f32_16x16x32_bf16 v[128:131], v[208:211], v[232:235], v[128:131]
  v_mfma_f32_16x16x32_bf16 v[132:135], v[212:215], v[228:231], v[132:135]
  v_mfma_f32_16x16x32_bf16 v[136:139], v[212:215], v[232:235], v[136:139]
  v_mfma_f32_16x16x32_bf16 v[140:143], v[216:219], v[228:231], v[140:143]
  v_mfma_f32_16x16x32_bf16 v[144:147], v[216:219], v[232:235], v[144:147]
  s_waitcnt lgkmcnt(0)
  v_mfma_f32_16x16x32_bf16 v[76:79], v[148:151], v[220:223], v[76:79]
  ds_read_b128 v[228:231], v237 offset:32768
  v_mfma_f32_16x16x32_bf16 v[80:83], v[148:151], v[224:227], v[80:83]
  ds_read_b128 v[232:235], v237 offset:34816
  v_mfma_f32_16x16x32_bf16 v[84:87], v[152:155], v[220:223], v[84:87]
  ds_read_b128 v[184:187], v239 offset:9216
  v_mfma_f32_16x16x32_bf16 v[88:91], v[152:155], v[224:227], v[88:91]
  ds_read_b128 v[188:191], v239 offset:10240
  v_mfma_f32_16x16x32_bf16 v[92:95], v[156:159], v[220:223], v[92:95]
  ds_read_b128 v[192:195], v239 offset:11264
  v_mfma_f32_16x16x32_bf16 v[96:99], v[156:159], v[224:227], v[96:99]
  ds_read_b128 v[196:199], v239 offset:12288
  v_mfma_f32_16x16x32_bf16 v[100:103], v[160:163], v[220:223], v[100:103]
  ds_read_b128 v[200:203], v239 offset:13312
  v_mfma_f32_16x16x32_bf16 v[104:107], v[160:163], v[224:227], v[104:107]
  ds_read_b128 v[204:207], v239 offset:14336
  v_mfma_f32_16x16x32_bf16 v[108:111], v[164:167], v[220:223], v[108:111]
  ds_read_b128 v[208:211], v239 offset:15360
  v_mfma_f32_16x16x32_bf16 v[112:115], v[164:167], v[224:227], v[112:115]
  ds_read_b128 v[212:215], v239 offset:16384
  v_mfma_f32_16x16x32_bf16 v[116:119], v[168:171], v[220:223], v[116:119]
  ds_read_b128 v[216:219], v239 offset:17408
  v_mfma_f32_16x16x32_bf16 v[120:123], v[168:171], v[224:227], v[120:123]
  v_mfma_f32_16x16x32_bf16 v[124:127], v[172:175], v[220:223], v[124:127]
  v_mfma_f32_16x16x32_bf16 v[128:131], v[172:175], v[224:227], v[128:131]
  v_mfma_f32_16x16x32_bf16 v[132:135], v[176:179], v[220:223], v[132:135]
  v_mfma_f32_16x16x32_bf16 v[136:139], v[176:179], v[224:227], v[136:139]
  v_mfma_f32_16x16x32_bf16 v[140:143], v[180:183], v[220:223], v[140:143]
  v_mfma_f32_16x16x32_bf16 v[144:147], v[180:183], v[224:227], v[144:147]
  s_waitcnt lgkmcnt(0)
  s_barrier
  v_mfma_f32_16x16x32_bf16 v[76:79], v[184:187], v[228:231], v[76:79]
  ds_read_b128 v[220:223], v236 offset:49152
  v_mfma_f32_16x16x32_bf16 v[80:83], v[184:187], v[232:235], v[80:83]
  ds_read_b128 v[224:227], v236 offset:51200
  v_mfma_f32_16x16x32_bf16 v[84:87], v[188:191], v[228:231], v[84:87]
  ds_read_b128 v[148:151], v239 offset:18432
  v_mfma_f32_16x16x32_bf16 v[88:91], v[188:191], v[232:235], v[88:91]
  ds_read_b128 v[152:155], v239 offset:19456
  v_mfma_f32_16x16x32_bf16 v[92:95], v[192:195], v[228:231], v[92:95]
  ds_read_b128 v[156:159], v239 offset:20480
  v_mfma_f32_16x16x32_bf16 v[96:99], v[192:195], v[232:235], v[96:99]
  ds_read_b128 v[160:163], v239 offset:21504
  v_mfma_f32_16x16x32_bf16 v[100:103], v[196:199], v[228:231], v[100:103]
  ds_read_b128 v[164:167], v239 offset:22528
  v_mfma_f32_16x16x32_bf16 v[104:107], v[196:199], v[232:235], v[104:107]
  ds_read_b128 v[168:171], v239 offset:23552
  v_mfma_f32_16x16x32_bf16 v[108:111], v[200:203], v[228:231], v[108:111]
  ds_read_b128 v[172:175], v239 offset:24576
  v_mfma_f32_16x16x32_bf16 v[112:115], v[200:203], v[232:235], v[112:115]
  ds_read_b128 v[176:179], v239 offset:25600
  v_mfma_f32_16x16x32_bf16 v[116:119], v[204:207], v[228:231], v[116:119]
  ds_read_b128 v[180:183], v239 offset:26624
  v_mfma_f32_16x16x32_bf16 v[120:123], v[204:207], v[232:235], v[120:123]
  v_mfma_f32_16x16x32_bf16 v[124:127], v[208:211], v[228:231], v[124:127]
  v_mfma_f32_16x16x32_bf16 v[128:131], v[208:211], v[232:235], v[128:131]
  v_mfma_f32_16x16x32_bf16 v[132:135], v[212:215], v[228:231], v[132:135]
  v_mfma_f32_16x16x32_bf16 v[136:139], v[212:215], v[232:235], v[136:139]
  v_mfma_f32_16x16x32_bf16 v[140:143], v[216:219], v[228:231], v[140:143]
  v_mfma_f32_16x16x32_bf16 v[144:147], v[216:219], v[232:235], v[144:147]
  s_waitcnt lgkmcnt(0)
  v_mfma_f32_16x16x32_bf16 v[76:79], v[148:151], v[220:223], v[76:79]
  ds_read_b128 v[228:231], v237 offset:49152
  v_mfma_f32_16x16x32_bf16 v[80:83], v[148:151], v[224:227], v[80:83]
  ds_read_b128 v[232:235], v237 offset:51200
  v_mfma_f32_16x16x32_bf16 v[84:87], v[152:155], v[220:223], v[84:87]
  ds_read_b128 v[184:187], v239 offset:27648
  v_mfma_f32_16x16x32_bf16 v[88:91], v[152:155], v[224:227], v[88:91]
  ds_read_b128 v[188:191], v239 offset:28672
  v_mfma_f32_16x16x32_bf16 v[92:95], v[156:159], v[220:223], v[92:95]
  ds_read_b128 v[192:195], v239 offset:29696
  v_mfma_f32_16x16x32_bf16 v[96:99], v[156:159], v[224:227], v[96:99]
  ds_read_b128 v[196:199], v239 offset:30720
  v_mfma_f32_16x16x32_bf16 v[100:103], v[160:163], v[220:223], v[100:103]
  ds_read_b128 v[200:203], v239 offset:31744
  v_mfma_f32_16x16x32_bf16 v[104:107], v[160:163], v[224:227], v[104:107]
  ds_read_b128 v[204:207], v239 offset:32768
  v_mfma_f32_16x16x32_bf16 v[108:111], v[164:167], v[220:223], v[108:111]
  ds_read_b128 v[208:211], v239 offset:33792
  v_mfma_f32_16x16x32_bf16 v[112:115], v[164:167], v[224:227], v[112:115]
  ds_read_b128 v[212:215], v239 offset:34816
  v_mfma_f32_16x16x32_bf16 v[116:119], v[168:171], v[220:223], v[116:119]
  ds_read_b128 v[216:219], v239 offset:35840
  v_mfma_f32_16x16x32_bf16 v[120:123], v[168:171], v[224:227], v[120:123]
  v_mfma_f32_16x16x32_bf16 v[124:127], v[172:175], v[220:223], v[124:127]
  v_mfma_f32_16x16x32_bf16 v[128:131], v[172:175], v[224:227], v[128:131]
  v_mfma_f32_16x16x32_bf16 v[132:135], v[176:179], v[220:223], v[132:135]
  v_mfma_f32_16x16x32_bf16 v[136:139], v[176:179], v[224:227], v[136:139]
  v_mfma_f32_16x16x32_bf16 v[140:143], v[180:183], v[220:223], v[140:143]
  v_mfma_f32_16x16x32_bf16 v[144:147], v[180:183], v[224:227], v[144:147]
  s_waitcnt lgkmcnt(0)
  s_barrier
  v_mfma_f32_16x16x32_bf16 v[76:79], v[184:187], v[228:231], v[76:79]
  ds_read_b128 v[220:223], v236 offset:0
  v_mfma_f32_16x16x32_bf16 v[80:83], v[184:187], v[232:235], v[80:83]
  ds_read_b128 v[224:227], v236 offset:2048
  v_mfma_f32_16x16x32_bf16 v[84:87], v[188:191], v[228:231], v[84:87]
  ds_read_b128 v[148:151], v238 offset:0
  v_mfma_f32_16x16x32_bf16 v[88:91], v[188:191], v[232:235], v[88:91]
  ds_read_b128 v[152:155], v238 offset:1024
  v_mfma_f32_16x16x32_bf16 v[92:95], v[192:195], v[228:231], v[92:95]
  ds_read_b128 v[156:159], v238 offset:2048
  v_mfma_f32_16x16x32_bf16 v[96:99], v[192:195], v[232:235], v[96:99]
  ds_read_b128 v[160:163], v238 offset:3072
  v_mfma_f32_16x16x32_bf16 v[100:103], v[196:199], v[228:231], v[100:103]
  ds_read_b128 v[164:167], v238 offset:4096
  v_mfma_f32_16x16x32_bf16 v[104:107], v[196:199], v[232:235], v[104:107]
  ds_read_b128 v[168:171], v238 offset:5120
  v_mfma_f32_16x16x32_bf16 v[108:111], v[200:203], v[228:231], v[108:111]
  ds_read_b128 v[172:175], v238 offset:6144
  v_mfma_f32_16x16x32_bf16 v[112:115], v[200:203], v[232:235], v[112:115]
  ds_read_b128 v[176:179], v238 offset:7168
  v_mfma_f32_16x16x32_bf16 v[116:119], v[204:207], v[228:231], v[116:119]
  ds_read_b128 v[180:183], v238 offset:8192
  v_mfma_f32_16x16x32_bf16 v[120:123], v[204:207], v[232:235], v[120:123]
  v_mfma_f32_16x16x32_bf16 v[124:127], v[208:211], v[228:231], v[124:127]
  v_mfma_f32_16x16x32_bf16 v[128:131], v[208:211], v[232:235], v[128:131]
  v_mfma_f32_16x16x32_bf16 v[132:135], v[212:215], v[228:231], v[132:135]
  v_mfma_f32_16x16x32_bf16 v[136:139], v[212:215], v[232:235], v[136:139]
  v_mfma_f32_16x16x32_bf16 v[140:143], v[216:219], v[228:231], v[140:143]
  v_mfma_f32_16x16x32_bf16 v[144:147], v[216:219], v[232:235], v[144:147]
  s_waitcnt lgkmcnt(0)
  v_mfma_f32_16x16x32_bf16 v[76:79], v[148:151], v[220:223], v[76:79]
  ds_read_b128 v[228:231], v237 offset:0
  v_mfma_f32_16x16x32_bf16 v[80:83], v[148:151], v[224:227], v[80:83]
  ds_read_b128 v[232:235], v237 offset:2048
  v_mfma_f32_16x16x32_bf16 v[84:87], v[152:155], v[220:223], v[84:87]
  ds_read_b128 v[184:187], v238 offset:9216
  v_mfma_f32_16x16x32_bf16 v[88:91], v[152:155], v[224:227], v[88:91]
  ds_read_b128 v[188:191], v238 offset:10240
  v_mfma_f32_16x16x32_bf16 v[92:95], v[156:159], v[220:223], v[92:95]
  ds_read_b128 v[192:195], v238 offset:11264
  v_mfma_f32_16x16x32_bf16 v[96:99], v[156:159], v[224:227], v[96:99]
  ds_read_b128 v[196:199], v238 offset:12288
  v_mfma_f32_16x16x32_bf16 v[100:103], v[160:163], v[220:223], v[100:103]
  ds_read_b128 v[200:203], v238 offset:13312
  v_mfma_f32_16x16x32_bf16 v[104:107], v[160:163], v[224:227], v[104:107]
  ds_read_b128 v[204:207], v238 offset:14336
  v_mfma_f32_16x16x32_bf16 v[108:111], v[164:167], v[220:223], v[108:111]
  ds_read_b128 v[208:211], v238 offset:15360
  v_mfma_f32_16x16x32_bf16 v[112:115], v[164:167], v[224:227], v[112:115]
  ds_read_b128 v[212:215], v238 offset:16384
  v_mfma_f32_16x16x32_bf16 v[116:119], v[168:171], v[220:223], v[116:119]
  ds_read_b128 v[216:219], v238 offset:17408
  v_mfma_f32_16x16x32_bf16 v[120:123], v[168:171], v[224:227], v[120:123]
  v_mfma_f32_16x16x32_bf16 v[124:127], v[172:175], v[220:223], v[124:127]
  v_mfma_f32_16x16x32_bf16 v[128:131], v[172:175], v[224:227], v[128:131]
  v_mfma_f32_16x16x32_bf16 v[132:135], v[176:179], v[220:223], v[132:135]
  v_mfma_f32_16x16x32_bf16 v[136:139], v[176:179], v[224:227], v[136:139]
  v_mfma_f32_16x16x32_bf16 v[140:143], v[180:183], v[220:223], v[140:143]
  v_mfma_f32_16x16x32_bf16 v[144:147], v[180:183], v[224:227], v[144:147]
  s_waitcnt lgkmcnt(0)
  s_barrier
  v_mfma_f32_16x16x32_bf16 v[76:79], v[184:187], v[228:231], v[76:79]
  ds_read_b128 v[220:223], v236 offset:16384
  v_mfma_f32_16x16x32_bf16 v[80:83], v[184:187], v[232:235], v[80:83]
  ds_read_b128 v[224:227], v236 offset:18432
  v_mfma_f32_16x16x32_bf16 v[84:87], v[188:191], v[228:231], v[84:87]
  ds_read_b128 v[148:151], v238 offset:18432
  v_mfma_f32_16x16x32_bf16 v[88:91], v[188:191], v[232:235], v[88:91]
  ds_read_b128 v[152:155], v238 offset:19456
  v_mfma_f32_16x16x32_bf16 v[92:95], v[192:195], v[228:231], v[92:95]
  ds_read_b128 v[156:159], v238 offset:20480
  v_mfma_f32_16x16x32_bf16 v[96:99], v[192:195], v[232:235], v[96:99]
  ds_read_b128 v[160:163], v238 offset:21504
  v_mfma_f32_16x16x32_bf16 v[100:103], v[196:199], v[228:231], v[100:103]
  ds_read_b128 v[164:167], v238 offset:22528
  v_mfma_f32_16x16x32_bf16 v[104:107], v[196:199], v[232:235], v[104:107]
  ds_read_b128 v[168:171], v238 offset:23552
  v_mfma_f32_16x16x32_bf16 v[108:111], v[200:203], v[228:231], v[108:111]
  ds_read_b128 v[172:175], v238 offset:24576
  v_mfma_f32_16x16x32_bf16 v[112:115], v[200:203], v[232:235], v[112:115]
  ds_read_b128 v[176:179], v238 offset:25600
  v_mfma_f32_16x16x32_bf16 v[116:119], v[204:207], v[228:231], v[116:119]
  ds_read_b128 v[180:183], v238 offset:26624
  v_mfma_f32_16x16x32_bf16 v[120:123], v[204:207], v[232:235], v[120:123]
  v_mfma_f32_16x16x32_bf16 v[124:127], v[208:211], v[228:231], v[124:127]
  v_mfma_f32_16x16x32_bf16 v[128:131], v[208:211], v[232:235], v[128:131]
  v_mfma_f32_16x16x32_bf16 v[132:135], v[212:215], v[228:231], v[132:135]
  v_mfma_f32_16x16x32_bf16 v[136:139], v[212:215], v[232:235], v[136:139]
  v_mfma_f32_16x16x32_bf16 v[140:143], v[216:219], v[228:231], v[140:143]
  v_mfma_f32_16x16x32_bf16 v[144:147], v[216:219], v[232:235], v[144:147]
  s_waitcnt lgkmcnt(0)
  v_mfma_f32_16x16x32_bf16 v[76:79], v[148:151], v[220:223], v[76:79]
  ds_read_b128 v[228:231], v237 offset:16384
  v_mfma_f32_16x16x32_bf16 v[80:83], v[148:151], v[224:227], v[80:83]
  ds_read_b128 v[232:235], v237 offset:18432
  v_mfma_f32_16x16x32_bf16 v[84:87], v[152:155], v[220:223], v[84:87]
  ds_read_b128 v[184:187], v238 offset:27648
  v_mfma_f32_16x16x32_bf16 v[88:91], v[152:155], v[224:227], v[88:91]
  ds_read_b128 v[188:191], v238 offset:28672
  v_mfma_f32_16x16x32_bf16 v[92:95], v[156:159], v[220:223], v[92:95]
  ds_read_b128 v[192:195], v238 offset:29696
  v_mfma_f32_16x16x32_bf16 v[96:99], v[156:159], v[224:227], v[96:99]
  ds_read_b128 v[196:199], v238 offset:30720
  v_mfma_f32_16x16x32_bf16 v[100:103], v[160:163], v[220:223], v[100:103]
  ds_read_b128 v[200:203], v238 offset:31744
  v_mfma_f32_16x16x32_bf16 v[104:107], v[160:163], v[224:227], v[104:107]
  ds_read_b128 v[204:207], v238 offset:32768
  v_mfma_f32_16x16x32_bf16 v[108:111], v[164:167], v[220:223], v[108:111]
  ds_read_b128 v[208:211], v238 offset:33792
  v_mfma_f32_16x16x32_bf16 v[112:115], v[164:167], v[224:227], v[112:115]
  ds_read_b128 v[212:215], v238 offset:34816
  v_mfma_f32_16x16x32_bf16 v[116:119], v[168:171], v[220:223], v[116:119]
  ds_read_b128 v[216:219], v238 offset:35840
  v_mfma_f32_16x16x32_bf16 v[120:123], v[168:171], v[224:227], v[120:123]
  v_mfma_f32_16x16x32_bf16 v[124:127], v[172:175], v[220:223], v[124:127]
  v_mfma_f32_16x16x32_bf16 v[128:131], v[172:175], v[224:227], v[128:131]
  v_mfma_f32_16x16x32_bf16 v[132:135], v[176:179], v[220:223], v[132:135]
  v_mfma_f32_16x16x32_bf16 v[136:139], v[176:179], v[224:227], v[136:139]
  v_mfma_f32_16x16x32_bf16 v[140:143], v[180:183], v[220:223], v[140:143]
  v_mfma_f32_16x16x32_bf16 v[144:147], v[180:183], v[224:227], v[144:147]
  s_waitcnt lgkmcnt(0)
  s_barrier
  v_mfma_f32_16x16x32_bf16 v[76:79], v[184:187], v[228:231], v[76:79]
  ds_read_b128 v[220:223], v236 offset:32768
  v_mfma_f32_16x16x32_bf16 v[80:83], v[184:187], v[232:235], v[80:83]
  ds_read_b128 v[224:227], v236 offset:34816
  v_mfma_f32_16x16x32_bf16 v[84:87], v[188:191], v[228:231], v[84:87]
  ds_read_b128 v[148:151], v239 offset:0
  v_mfma_f32_16x16x32_bf16 v[88:91], v[188:191], v[232:235], v[88:91]
  ds_read_b128 v[152:155], v239 offset:1024
  v_mfma_f32_16x16x32_bf16 v[92:95], v[192:195], v[228:231], v[92:95]
  ds_read_b128 v[156:159], v239 offset:2048
  v_mfma_f32_16x16x32_bf16 v[96:99], v[192:195], v[232:235], v[96:99]
  ds_read_b128 v[160:163], v239 offset:3072
  v_mfma_f32_16x16x32_bf16 v[100:103], v[196:199], v[228:231], v[100:103]
  ds_read_b128 v[164:167], v239 offset:4096
  v_mfma_f32_16x16x32_bf16 v[104:107], v[196:199], v[232:235], v[104:107]
  ds_read_b128 v[168:171], v239 offset:5120
  v_mfma_f32_16x16x32_bf16 v[108:111], v[200:203], v[228:231], v[108:111]
  ds_read_b128 v[172:175], v239 offset:6144
  v_mfma_f32_16x16x32_bf16 v[112:115], v[200:203], v[232:235], v[112:115]
  ds_read_b128 v[176:179], v239 offset:7168
  v_mfma_f32_16x16x32_bf16 v[116:119], v[204:207], v[228:231], v[116:119]
  ds_read_b128 v[180:183], v239 offset:8192
  v_mfma_f32_16x16x32_bf16 v[120:123], v[204:207], v[232:235], v[120:123]
  v_mfma_f32_16x16x32_bf16 v[124:127], v[208:211], v[228:231], v[124:127]
  v_mfma_f32_16x16x32_bf16 v[128:131], v[208:211], v[232:235], v[128:131]
  v_mfma_f32_16x16x32_bf16 v[132:135], v[212:215], v[228:231], v[132:135]
  v_mfma_f32_16x16x32_bf16 v[136:139], v[212:215], v[232:235], v[136:139]
  v_mfma_f32_16x16x32_bf16 v[140:143], v[216:219], v[228:231], v[140:143]
  v_mfma_f32_16x16x32_bf16 v[144:147], v[216:219], v[232:235], v[144:147]
  s_waitcnt lgkmcnt(0)
  v_mfma_f32_16x16x32_bf16 v[76:79], v[148:151], v[220:223], v[76:79]
  ds_read_b128 v[228:231], v237 offset:32768
  v_mfma_f32_16x16x32_bf16 v[80:83], v[148:151], v[224:227], v[80:83]
  ds_read_b128 v[232:235], v237 offset:34816
  v_mfma_f32_16x16x32_bf16 v[84:87], v[152:155], v[220:223], v[84:87]
  ds_read_b128 v[184:187], v239 offset:9216
  v_mfma_f32_16x16x32_bf16 v[88:91], v[152:155], v[224:227], v[88:91]
  ds_read_b128 v[188:191], v239 offset:10240
  v_mfma_f32_16x16x32_bf16 v[92:95], v[156:159], v[220:223], v[92:95]
  ds_read_b128 v[192:195], v239 offset:11264
  v_mfma_f32_16x16x32_bf16 v[96:99], v[156:159], v[224:227], v[96:99]
  ds_read_b128 v[196:199], v239 offset:12288
  v_mfma_f32_16x16x32_bf16 v[100:103], v[160:163], v[220:223], v[100:103]
  ds_read_b128 v[200:203], v239 offset:13312
  v_mfma_f32_16x16x32_bf16 v[104:107], v[160:163], v[224:227], v[104:107]
  ds_read_b128 v[204:207], v239 offset:14336
  v_mfma_f32_16x16x32_bf16 v[108:111], v[164:167], v[220:223], v[108:111]
  ds_read_b128 v[208:211], v239 offset:15360
  v_mfma_f32_16x16x32_bf16 v[112:115], v[164:167], v[224:227], v[112:115]
  ds_read_b128 v[212:215], v239 offset:16384
  v_mfma_f32_16x16x32_bf16 v[116:119], v[168:171], v[220:223], v[116:119]
  ds_read_b128 v[216:219], v239 offset:17408
  v_mfma_f32_16x16x32_bf16 v[120:123], v[168:171], v[224:227], v[120:123]
  v_mfma_f32_16x16x32_bf16 v[124:127], v[172:175], v[220:223], v[124:127]
  v_mfma_f32_16x16x32_bf16 v[128:131], v[172:175], v[224:227], v[128:131]
  v_mfma_f32_16x16x32_bf16 v[132:135], v[176:179], v[220:223], v[132:135]
  v_mfma_f32_16x16x32_bf16 v[136:139], v[176:179], v[224:227], v[136:139]
  v_mfma_f32_16x16x32_bf16 v[140:143], v[180:183], v[220:223], v[140:143]
  v_mfma_f32_16x16x32_bf16 v[144:147], v[180:183], v[224:227], v[144:147]
  s_waitcnt lgkmcnt(0)
  s_barrier
  v_mfma_f32_16x16x32_bf16 v[76:79], v[184:187], v[228:231], v[76:79]
  ds_read_b128 v[220:223], v236 offset:49152
  v_mfma_f32_16x16x32_bf16 v[80:83], v[184:187], v[232:235], v[80:83]
  ds_read_b128 v[224:227], v236 offset:51200
  v_mfma_f32_16x16x32_bf16 v[84:87], v[188:191], v[228:231], v[84:87]
  ds_read_b128 v[148:151], v239 offset:18432
  v_mfma_f32_16x16x32_bf16 v[88:91], v[188:191], v[232:235], v[88:91]
  ds_read_b128 v[152:155], v239 offset:19456
  v_mfma_f32_16x16x32_bf16 v[92:95], v[192:195], v[228:231], v[92:95]
  ds_read_b128 v[156:159], v239 offset:20480
  v_mfma_f32_16x16x32_bf16 v[96:99], v[192:195], v[232:235], v[96:99]
  ds_read_b128 v[160:163], v239 offset:21504
  v_mfma_f32_16x16x32_bf16 v[100:103], v[196:199], v[228:231], v[100:103]
  ds_read_b128 v[164:167], v239 offset:22528
  v_mfma_f32_16x16x32_bf16 v[104:107], v[196:199], v[232:235], v[104:107]
  ds_read_b128 v[168:171], v239 offset:23552
  v_mfma_f32_16x16x32_bf16 v[108:111], v[200:203], v[228:231], v[108:111]
  ds_read_b128 v[172:175], v239 offset:24576
  v_mfma_f32_16x16x32_bf16 v[112:115], v[200:203], v[232:235], v[112:115]
  ds_read_b128 v[176:179], v239 offset:25600
  v_mfma_f32_16x16x32_bf16 v[116:119], v[204:207], v[228:231], v[116:119]
  ds_read_b128 v[180:183], v239 offset:26624
  v_mfma_f32_16x16x32_bf16 v[120:123], v[204:207], v[232:235], v[120:123]
  v_mfma_f32_16x16x32_bf16 v[124:127], v[208:211], v[228:231], v[124:127]
  v_mfma_f32_16x16x32_bf16 v[128:131], v[208:211], v[232:235], v[128:131]
  v_mfma_f32_16x16x32_bf16 v[132:135], v[212:215], v[228:231], v[132:135]
  v_mfma_f32_16x16x32_bf16 v[136:139], v[212:215], v[232:235], v[136:139]
  v_mfma_f32_16x16x32_bf16 v[140:143], v[216:219], v[228:231], v[140:143]
  v_mfma_f32_16x16x32_bf16 v[144:147], v[216:219], v[232:235], v[144:147]
  s_waitcnt lgkmcnt(0)
  v_mfma_f32_16x16x32_bf16 v[76:79], v[148:151], v[220:223], v[76:79]
  ds_read_b128 v[228:231], v237 offset:49152
  v_mfma_f32_16x16x32_bf16 v[80:83], v[148:151], v[224:227], v[80:83]
  ds_read_b128 v[232:235], v237 offset:51200
  v_mfma_f32_16x16x32_bf16 v[84:87], v[152:155], v[220:223], v[84:87]
  ds_read_b128 v[184:187], v239 offset:27648
  v_mfma_f32_16x16x32_bf16 v[88:91], v[152:155], v[224:227], v[88:91]
  ds_read_b128 v[188:191], v239 offset:28672
  v_mfma_f32_16x16x32_bf16 v[92:95], v[156:159], v[220:223], v[92:95]
  ds_read_b128 v[192:195], v239 offset:29696
  v_mfma_f32_16x16x32_bf16 v[96:99], v[156:159], v[224:227], v[96:99]
  ds_read_b128 v[196:199], v239 offset:30720
  v_mfma_f32_16x16x32_bf16 v[100:103], v[160:163], v[220:223], v[100:103]
  ds_read_b128 v[200:203], v239 offset:31744
  v_mfma_f32_16x16x32_bf16 v[104:107], v[160:163], v[224:227], v[104:107]
  ds_read_b128 v[204:207], v239 offset:32768
  v_mfma_f32_16x16x32_bf16 v[108:111], v[164:167], v[220:223], v[108:111]
  ds_read_b128 v[208:211], v239 offset:33792
  v_mfma_f32_16x16x32_bf16 v[112:115], v[164:167], v[224:227], v[112:115]
  ds_read_b128 v[212:215], v239 offset:34816
  v_mfma_f32_16x16x32_bf16 v[116:119], v[168:171], v[220:223], v[116:119]
  ds_read_b128 v[216:219], v239 offset:35840
  v_mfma_f32_16x16x32_bf16 v[120:123], v[168:171], v[224:227], v[120:123]
  v_mfma_f32_16x16x32_bf16 v[124:127], v[172:175], v[220:223], v[124:127]
  v_mfma_f32_16x16x32_bf16 v[128:131], v[172:175], v[224:227], v[128:131]
  v_mfma_f32_16x16x32_bf16 v[132:135], v[176:179], v[220:223], v[132:135]
  v_mfma_f32_16x16x32_bf16 v[136:139], v[176:179], v[224:227], v[136:139]
  v_mfma_f32_16x16x32_bf16 v[140:143], v[180:183], v[220:223], v[140:143]
  v_mfma_f32_16x16x32_bf16 v[144:147], v[180:183], v[224:227], v[144:147]
  s_waitcnt lgkmcnt(0)
  s_barrier
  v_mfma_f32_16x16x32_bf16 v[76:79], v[184:187], v[228:231], v[76:79]
  ds_read_b128 v[220:223], v236 offset:0
  v_mfma_f32_16x16x32_bf16 v[80:83], v[184:187], v[232:235], v[80:83]
  ds_read_b128 v[224:227], v236 offset:2048
  v_mfma_f32_16x16x32_bf16 v[84:87], v[188:191], v[228:231], v[84:87]
  ds_read_b128 v[148:151], v238 offset:0
  v_mfma_f32_16x16x32_bf16 v[88:91], v[188:191], v[232:235], v[88:91]
  ds_read_b128 v[152:155], v238 offset:1024
  v_mfma_f32_16x16x32_bf16 v[92:95], v[192:195], v[228:231], v[92:95]
  ds_read_b128 v[156:159], v238 offset:2048
  v_mfma_f32_16x16x32_bf16 v[96:99], v[192:195], v[232:235], v[96:99]
  ds_read_b128 v[160:163], v238 offset:3072
  v_mfma_f32_16x16x32_bf16 v[100:103], v[196:199], v[228:231], v[100:103]
  ds_read_b128 v[164:167], v238 offset:4096
  v_mfma_f32_16x16x32_bf16 v[104:107], v[196:199], v[232:235], v[104:107]
  ds_read_b128 v[168:171], v238 offset:5120
  v_mfma_f32_16x16x32_bf16 v[108:111], v[200:203], v[228:231], v[108:111]
  ds_read_b128 v[172:175], v238 offset:6144
  v_mfma_f32_16x16x32_bf16 v[112:115], v[200:203], v[232:235], v[112:115]
  ds_read_b128 v[176:179], v238 offset:7168
  v_mfma_f32_16x16x32_bf16 v[116:119], v[204:207], v[228:231], v[116:119]
  ds_read_b128 v[180:183], v238 offset:8192
  v_mfma_f32_16x16x32_bf16 v[120:123], v[204:207], v[232:235], v[120:123]
  v_mfma_f32_16x16x32_bf16 v[124:127], v[208:211], v[228:231], v[124:127]
  v_mfma_f32_16x16x32_bf16 v[128:131], v[208:211], v[232:235], v[128:131]
  v_mfma_f32_16x16x32_bf16 v[132:135], v[212:215], v[228:231], v[132:135]
  v_mfma_f32_16x16x32_bf16 v[136:139], v[212:215], v[232:235], v[136:139]
  v_mfma_f32_16x16x32_bf16 v[140:143], v[216:219], v[228:231], v[140:143]
  v_mfma_f32_16x16x32_bf16 v[144:147], v[216:219], v[232:235], v[144:147]
  s_waitcnt lgkmcnt(0)
  v_mfma_f32_16x16x32_bf16 v[76:79], v[148:151], v[220:223], v[76:79]
  ds_read_b128 v[228:231], v237 offset:0
  v_mfma_f32_16x16x32_bf16 v[80:83], v[148:151], v[224:227], v[80:83]
  ds_read_b128 v[232:235], v237 offset:2048
  v_mfma_f32_16x16x32_bf16 v[84:87], v[152:155], v[220:223], v[84:87]
  ds_read_b128 v[184:187], v238 offset:9216
  v_mfma_f32_16x16x32_bf16 v[88:91], v[152:155], v[224:227], v[88:91]
  ds_read_b128 v[188:191], v238 offset:10240
  v_mfma_f32_16x16x32_bf16 v[92:95], v[156:159], v[220:223], v[92:95]
  ds_read_b128 v[192:195], v238 offset:11264
  v_mfma_f32_16x16x32_bf16 v[96:99], v[156:159], v[224:227], v[96:99]
  ds_read_b128 v[196:199], v238 offset:12288
  v_mfma_f32_16x16x32_bf16 v[100:103], v[160:163], v[220:223], v[100:103]
  ds_read_b128 v[200:203], v238 offset:13312
  v_mfma_f32_16x16x32_bf16 v[104:107], v[160:163], v[224:227], v[104:107]
  ds_read_b128 v[204:207], v238 offset:14336
  v_mfma_f32_16x16x32_bf16 v[108:111], v[164:167], v[220:223], v[108:111]
  ds_read_b128 v[208:211], v238 offset:15360
  v_mfma_f32_16x16x32_bf16 v[112:115], v[164:167], v[224:227], v[112:115]
  ds_read_b128 v[212:215], v238 offset:16384
  v_mfma_f32_16x16x32_bf16 v[116:119], v[168:171], v[220:223], v[116:119]
  ds_read_b128 v[216:219], v238 offset:17408
  v_mfma_f32_16x16x32_bf16 v[120:123], v[168:171], v[224:227], v[120:123]
  v_mfma_f32_16x16x32_bf16 v[124:127], v[172:175], v[220:223], v[124:127]
  v_mfma_f32_16x16x32_bf16 v[128:131], v[172:175], v[224:227], v[128:131]
  v_mfma_f32_16x16x32_bf16 v[132:135], v[176:179], v[220:223], v[132:135]
  v_mfma_f32_16x16x32_bf16 v[136:139], v[176:179], v[224:227], v[136:139]
  v_mfma_f32_16x16x32_bf16 v[140:143], v[180:183], v[220:223], v[140:143]
  v_mfma_f32_16x16x32_bf16 v[144:147], v[180:183], v[224:227], v[144:147]
  s_waitcnt lgkmcnt(0)
  s_barrier
  v_mfma_f32_16x16x32_bf16 v[76:79], v[184:187], v[228:231], v[76:79]
  ds_read_b128 v[220:223], v236 offset:16384
  v_mfma_f32_16x16x32_bf16 v[80:83], v[184:187], v[232:235], v[80:83]
  ds_read_b128 v[224:227], v236 offset:18432
  v_mfma_f32_16x16x32_bf16 v[84:87], v[188:191], v[228:231], v[84:87]
  ds_read_b128 v[148:151], v238 offset:18432
  v_mfma_f32_16x16x32_bf16 v[88:91], v[188:191], v[232:235], v[88:91]
  ds_read_b128 v[152:155], v238 offset:19456
  v_mfma_f32_16x16x32_bf16 v[92:95], v[192:195], v[228:231], v[92:95]
  ds_read_b128 v[156:159], v238 offset:20480
  v_mfma_f32_16x16x32_bf16 v[96:99], v[192:195], v[232:235], v[96:99]
  ds_read_b128 v[160:163], v238 offset:21504
  v_mfma_f32_16x16x32_bf16 v[100:103], v[196:199], v[228:231], v[100:103]
  ds_read_b128 v[164:167], v238 offset:22528
  v_mfma_f32_16x16x32_bf16 v[104:107], v[196:199], v[232:235], v[104:107]
  ds_read_b128 v[168:171], v238 offset:23552
  v_mfma_f32_16x16x32_bf16 v[108:111], v[200:203], v[228:231], v[108:111]
  ds_read_b128 v[172:175], v238 offset:24576
  v_mfma_f32_16x16x32_bf16 v[112:115], v[200:203], v[232:235], v[112:115]
  ds_read_b128 v[176:179], v238 offset:25600
  v_mfma_f32_16x16x32_bf16 v[116:119], v[204:207], v[228:231], v[116:119]
  ds_read_b128 v[180:183], v238 offset:26624
  v_mfma_f32_16x16x32_bf16 v[120:123], v[204:207], v[232:235], v[120:123]
  v_mfma_f32_16x16x32_bf16 v[124:127], v[208:211], v[228:231], v[124:127]
  v_mfma_f32_16x16x32_bf16 v[128:131], v[208:211], v[232:235], v[128:131]
  v_mfma_f32_16x16x32_bf16 v[132:135], v[212:215], v[228:231], v[132:135]
  v_mfma_f32_16x16x32_bf16 v[136:139], v[212:215], v[232:235], v[136:139]
  v_mfma_f32_16x16x32_bf16 v[140:143], v[216:219], v[228:231], v[140:143]
  v_mfma_f32_16x16x32_bf16 v[144:147], v[216:219], v[232:235], v[144:147]
  s_waitcnt lgkmcnt(0)
  v_mfma_f32_16x16x32_bf16 v[76:79], v[148:151], v[220:223], v[76:79]
  ds_read_b128 v[228:231], v237 offset:16384
  v_mfma_f32_16x16x32_bf16 v[80:83], v[148:151], v[224:227], v[80:83]
  ds_read_b128 v[232:235], v237 offset:18432
  v_mfma_f32_16x16x32_bf16 v[84:87], v[152:155], v[220:223], v[84:87]
  ds_read_b128 v[184:187], v238 offset:27648
  v_mfma_f32_16x16x32_bf16 v[88:91], v[152:155], v[224:227], v[88:91]
  ds_read_b128 v[188:191], v238 offset:28672
  v_mfma_f32_16x16x32_bf16 v[92:95], v[156:159], v[220:223], v[92:95]
  ds_read_b128 v[192:195], v238 offset:29696
  v_mfma_f32_16x16x32_bf16 v[96:99], v[156:159], v[224:227], v[96:99]
  ds_read_b128 v[196:199], v238 offset:30720
  v_mfma_f32_16x16x32_bf16 v[100:103], v[160:163], v[220:223], v[100:103]
  ds_read_b128 v[200:203], v238 offset:31744
  v_mfma_f32_16x16x32_bf16 v[104:107], v[160:163], v[224:227], v[104:107]
  ds_read_b128 v[204:207], v238 offset:32768
  v_mfma_f32_16x16x32_bf16 v[108:111], v[164:167], v[220:223], v[108:111]
  ds_read_b128 v[208:211], v238 offset:33792
  v_mfma_f32_16x16x32_bf16 v[112:115], v[164:167], v[224:227], v[112:115]
  ds_read_b128 v[212:215], v238 offset:34816
  v_mfma_f32_16x16x32_bf16 v[116:119], v[168:171], v[220:223], v[116:119]
  ds_read_b128 v[216:219], v238 offset:35840
  v_mfma_f32_16x16x32_bf16 v[120:123], v[168:171], v[224:227], v[120:123]
  v_mfma_f32_16x16x32_bf16 v[124:127], v[172:175], v[220:223], v[124:127]
  v_mfma_f32_16x16x32_bf16 v[128:131], v[172:175], v[224:227], v[128:131]
  v_mfma_f32_16x16x32_bf16 v[132:135], v[176:179], v[220:223], v[132:135]
  v_mfma_f32_16x16x32_bf16 v[136:139], v[176:179], v[224:227], v[136:139]
  v_mfma_f32_16x16x32_bf16 v[140:143], v[180:183], v[220:223], v[140:143]
  v_mfma_f32_16x16x32_bf16 v[144:147], v[180:183], v[224:227], v[144:147]
  s_waitcnt lgkmcnt(0)
  v_mfma_f32_16x16x32_bf16 v[76:79], v[184:187], v[228:231], v[76:79]
  v_mfma_f32_16x16x32_bf16 v[80:83], v[184:187], v[232:235], v[80:83]
  v_mfma_f32_16x16x32_bf16 v[84:87], v[188:191], v[228:231], v[84:87]
  v_mfma_f32_16x16x32_bf16 v[88:91], v[188:191], v[232:235], v[88:91]
  v_mfma_f32_16x16x32_bf16 v[92:95], v[192:195], v[228:231], v[92:95]
  v_mfma_f32_16x16x32_bf16 v[96:99], v[192:195], v[232:235], v[96:99]
  v_mfma_f32_16x16x32_bf16 v[100:103], v[196:199], v[228:231], v[100:103]
  v_mfma_f32_16x16x32_bf16 v[104:107], v[196:199], v[232:235], v[104:107]
  v_mfma_f32_16x16x32_bf16 v[108:111], v[200:203], v[228:231], v[108:111]
  v_mfma_f32_16x16x32_bf16 v[112:115], v[200:203], v[232:235], v[112:115]
  v_mfma_f32_16x16x32_bf16 v[116:119], v[204:207], v[228:231], v[116:119]
  v_mfma_f32_16x16x32_bf16 v[120:123], v[204:207], v[232:235], v[120:123]
  v_mfma_f32_16x16x32_bf16 v[124:127], v[208:211], v[228:231], v[124:127]
  v_mfma_f32_16x16x32_bf16 v[128:131], v[208:211], v[232:235], v[128:131]
  v_mfma_f32_16x16x32_bf16 v[132:135], v[212:215], v[228:231], v[132:135]
  v_mfma_f32_16x16x32_bf16 v[136:139], v[212:215], v[232:235], v[136:139]
  v_mfma_f32_16x16x32_bf16 v[140:143], v[216:219], v[228:231], v[140:143]
  v_mfma_f32_16x16x32_bf16 v[144:147], v[216:219], v[232:235], v[144:147]
L_c_yepi:
  v_pk_add_f32 v[76:77], v[76:77], v[242:243] op_sel:[0,0] op_sel_hi:[1,0]
  v_pk_add_f32 v[78:79], v[78:79], v[242:243] op_sel:[0,0] op_sel_hi:[1,0]
  v_pk_mul_f32 v[76:77], v[76:77], v[4:5]
  v_pk_mul_f32 v[78:79], v[78:79], v[6:7]
  v_cvt_pk_bf16_f32 v148, v76, v77
  v_cvt_pk_bf16_f32 v149, v78, v79
  v_pk_add_f32 v[84:85], v[84:85], v[242:243] op_sel:[0,0] op_sel_hi:[1,0]
  v_pk_add_f32 v[86:87], v[86:87], v[242:243] op_sel:[0,0] op_sel_hi:[1,0]
  v_pk_mul_f32 v[84:85], v[84:85], v[12:13]
  v_pk_mul_f32 v[86:87], v[86:87], v[14:15]
  v_cvt_pk_bf16_f32 v150, v84, v85
  v_cvt_pk_bf16_f32 v151, v86, v87
  buffer_store_dwordx4 v[148:151], v240, s[40:43], s36 offen offset:0 sc1
  v_pk_add_f32 v[80:81], v[80:81], v[242:243] op_sel:[0,1] op_sel_hi:[1,1]
  v_pk_add_f32 v[82:83], v[82:83], v[242:243] op_sel:[0,1] op_sel_hi:[1,1]
  v_pk_mul_f32 v[80:81], v[80:81], v[8:9]
  v_pk_mul_f32 v[82:83], v[82:83], v[10:11]
  v_cvt_pk_bf16_f32 v152, v80, v81
  v_cvt_pk_bf16_f32 v153, v82, v83
  v_pk_add_f32 v[88:89], v[88:89], v[242:243] op_sel:[0,1] op_sel_hi:[1,1]
  v_pk_add_f32 v[90:91], v[90:91], v[242:243] op_sel:[0,1] op_sel_hi:[1,1]
  v_pk_mul_f32 v[88:89], v[88:89], v[16:17]
  v_pk_mul_f32 v[90:91], v[90:91], v[18:19]
  v_cvt_pk_bf16_f32 v154, v88, v89
  v_cvt_pk_bf16_f32 v155, v90, v91
  buffer_store_dwordx4 v[152:155], v240, s[40:43], s37 offen offset:0 sc1
  v_pk_add_f32 v[92:93], v[92:93], v[242:243] op_sel:[0,0] op_sel_hi:[1,0]
  v_pk_add_f32 v[94:95], v[94:95], v[242:243] op_sel:[0,0] op_sel_hi:[1,0]
  v_pk_mul_f32 v[92:93], v[92:93], v[20:21]
  v_pk_mul_f32 v[94:95], v[94:95], v[22:23]
  v_cvt_pk_bf16_f32 v156, v92, v93
  v_cvt_pk_bf16_f32 v157, v94, v95
  v_pk_add_f32 v[100:101], v[100:101], v[242:243] op_sel:[0,0] op_sel_hi:[1,0]
  v_pk_add_f32 v[102:103], v[102:103], v[242:243] op_sel:[0,0] op_sel_hi:[1,0]
  v_pk_mul_f32 v[100:101], v[100:101], v[28:29]
  v_pk_mul_f32 v[102:103], v[102:103], v[30:31]
  v_cvt_pk_bf16_f32 v158, v100, v101
  v_cvt_pk_bf16_f32 v159, v102, v103
  buffer_store_dwordx4 v[156:159], v240, s[40:43], s36 offen offset:1024 sc1
  v_pk_add_f32 v[96:97], v[96:97], v[242:243] op_sel:[0,1] op_sel_hi:[1,1]
  v_pk_add_f32 v[98:99], v[98:99], v[242:243] op_sel:[0,1] op_sel_hi:[1,1]
  v_pk_mul_f32 v[96:97], v[96:97], v[24:25]
  v_pk_mul_f32 v[98:99], v[98:99], v[26:27]
  v_cvt_pk_bf16_f32 v160, v96, v97
  v_cvt_pk_bf16_f32 v161, v98, v99
  v_pk_add_f32 v[104:105], v[104:105], v[242:243] op_sel:[0,1] op_sel_hi:[1,1]
  v_pk_add_f32 v[106:107], v[106:107], v[242:243] op_sel:[0,1] op_sel_hi:[1,1]
  v_pk_mul_f32 v[104:105], v[104:105], v[32:33]
  v_pk_mul_f32 v[106:107], v[106:107], v[34:35]
  v_cvt_pk_bf16_f32 v162, v104, v105
  v_cvt_pk_bf16_f32 v163, v106, v107
  buffer_store_dwordx4 v[160:163], v240, s[40:43], s37 offen offset:1024 sc1
  v_pk_add_f32 v[108:109], v[108:109], v[242:243] op_sel:[0,0] op_sel_hi:[1,0]
  v_pk_add_f32 v[110:111], v[110:111], v[242:243] op_sel:[0,0] op_sel_hi:[1,0]
  v_pk_mul_f32 v[108:109], v[108:109], v[36:37]
  v_pk_mul_f32 v[110:111], v[110:111], v[38:39]
  v_cvt_pk_bf16_f32 v164, v108, v109
  v_cvt_pk_bf16_f32 v165, v110, v111
  v_pk_add_f32 v[116:117], v[116:117], v[242:243] op_sel:[0,0] op_sel_hi:[1,0]
  v_pk_add_f32 v[118:119], v[118:119], v[242:243] op_sel:[0,0] op_sel_hi:[1,0]
  v_pk_mul_f32 v[116:117], v[116:117], v[44:45]
  v_pk_mul_f32 v[118:119], v[118:119], v[46:47]
  v_cvt_pk_bf16_f32 v166, v116, v117
  v_cvt_pk_bf16_f32 v167, v118, v119
  buffer_store_dwordx4 v[164:167], v240, s[40:43], s36 offen offset:2048 sc1
  v_pk_add_f32 v[112:113], v[112:113], v[242:243] op_sel:[0,1] op_sel_hi:[1,1]
  v_pk_add_f32 v[114:115], v[114:115], v[242:243] op_sel:[0,1] op_sel_hi:[1,1]
  v_pk_mul_f32 v[112:113], v[112:113], v[40:41]
  v_pk_mul_f32 v[114:115], v[114:115], v[42:43]
  v_cvt_pk_bf16_f32 v168, v112, v113
  v_cvt_pk_bf16_f32 v169, v114, v115
  v_pk_add_f32 v[120:121], v[120:121], v[242:243] op_sel:[0,1] op_sel_hi:[1,1]
  v_pk_add_f32 v[122:123], v[122:123], v[242:243] op_sel:[0,1] op_sel_hi:[1,1]
  v_pk_mul_f32 v[120:121], v[120:121], v[48:49]
  v_pk_mul_f32 v[122:123], v[122:123], v[50:51]
  v_cvt_pk_bf16_f32 v170, v120, v121
  v_cvt_pk_bf16_f32 v171, v122, v123
  buffer_store_dwordx4 v[168:171], v240, s[40:43], s37 offen offset:2048 sc1
  v_pk_add_f32 v[124:125], v[124:125], v[242:243] op_sel:[0,0] op_sel_hi:[1,0]
  v_pk_add_f32 v[126:127], v[126:127], v[242:243] op_sel:[0,0] op_sel_hi:[1,0]
  v_pk_mul_f32 v[124:125], v[124:125], v[52:53]
  v_pk_mul_f32 v[126:127], v[126:127], v[54:55]
  v_cvt_pk_bf16_f32 v172, v124, v125
  v_cvt_pk_bf16_f32 v173, v126, v127
  v_pk_add_f32 v[132:133], v[132:133], v[242:243] op_sel:[0,0] op_sel_hi:[1,0]
  v_pk_add_f32 v[134:135], v[134:135], v[242:243] op_sel:[0,0] op_sel_hi:[1,0]
  v_pk_mul_f32 v[132:133], v[132:133], v[60:61]
  v_pk_mul_f32 v[134:135], v[134:135], v[62:63]
  v_cvt_pk_bf16_f32 v174, v132, v133
  v_cvt_pk_bf16_f32 v175, v134, v135
  buffer_store_dwordx4 v[172:175], v240, s[40:43], s36 offen offset:3072 sc1
  v_pk_add_f32 v[128:129], v[128:129], v[242:243] op_sel:[0,1] op_sel_hi:[1,1]
  v_pk_add_f32 v[130:131], v[130:131], v[242:243] op_sel:[0,1] op_sel_hi:[1,1]
  v_pk_mul_f32 v[128:129], v[128:129], v[56:57]
  v_pk_mul_f32 v[130:131], v[130:131], v[58:59]
  v_cvt_pk_bf16_f32 v176, v128, v129
  v_cvt_pk_bf16_f32 v177, v130, v131
  v_pk_add_f32 v[136:137], v[136:137], v[242:243] op_sel:[0,1] op_sel_hi:[1,1]
  v_pk_add_f32 v[138:139], v[138:139], v[242:243] op_sel:[0,1] op_sel_hi:[1,1]
  v_pk_mul_f32 v[136:137], v[136:137], v[64:65]
  v_pk_mul_f32 v[138:139], v[138:139], v[66:67]
  v_cvt_pk_bf16_f32 v178, v136, v137
  v_cvt_pk_bf16_f32 v179, v138, v139
  buffer_store_dwordx4 v[176:179], v240, s[40:43], s37 offen offset:3072 sc1
  v_pk_add_f32 v[140:141], v[140:141], v[242:243] op_sel:[0,0] op_sel_hi:[1,0]
  v_pk_add_f32 v[142:143], v[142:143], v[242:243] op_sel:[0,0] op_sel_hi:[1,0]
  v_pk_mul_f32 v[140:141], v[140:141], v[68:69]
  v_pk_mul_f32 v[142:143], v[142:143], v[70:71]
  v_cvt_pk_bf16_f32 v180, v140, v141
  v_cvt_pk_bf16_f32 v181, v142, v143
  buffer_store_dwordx2 v[180:181], v240, s[40:43], s38 offen sc1
  v_pk_add_f32 v[144:145], v[144:145], v[242:243] op_sel:[0,1] op_sel_hi:[1,1]
  v_pk_add_f32 v[146:147], v[146:147], v[242:243] op_sel:[0,1] op_sel_hi:[1,1]
  v_pk_mul_f32 v[144:145], v[144:145], v[72:73]
  v_pk_mul_f32 v[146:147], v[146:147], v[74:75]
  v_cvt_pk_bf16_f32 v184, v144, v145
  v_cvt_pk_bf16_f32 v185, v146, v147
  buffer_store_dwordx2 v[184:185], v240, s[40:43], s39 offen sc1
  s_add_u32 s64, s6, 0x2148000
  s_addc_u32 s65, s7, 0
  s_mov_b32 s66, 0x10000
  s_mov_b32 s67, 0x20000
  s_lshl_b32 s68, s11, 2
  s_add_u32 s68, s68, s10
  s_lshl_b32 s68, s68, 7
  s_add_u32 s68, s68, 8192
  s_and_b32 s11, s2, 1
  s_lshl_b32 s11, s11, 4
  s_bfe_u32 s13, s2, 0x20001
  s_lshl_b32 s13, s13, 2
  s_add_u32 s11, s11, s13
  s_bfe_u32 s13, s2, 0x20003
  s_add_u32 s11, s11, s13
  s_lshr_b32 s12, s2, 5
  v_and_b32 v57, 15, v1
  v_lshrrev_b32 v58, 4, v1
  v_lshrrev_b32 v60, 2, v57
  v_and_b32 v59, 3, v57
  v_lshl_add_u32 v59, v60, 3, v59
  s_lshl_b32 s14, s11, 6
  s_lshr_b32 s15, s10, 1
  s_lshl_b32 s15, s15, 5
  s_add_u32 s14, s14, s15
  s_and_b32 s25, s10, 1
  s_lshl_b32 s15, s25, 2
  s_add_u32 s14, s14, s15
  v_add_u32 v59, s14, v59
  v_xor_b32 v60, 4, v59
  s_mul_i32 s14, s12, 144
  s_lshl_b32 s15, s25, 6
  s_add_u32 s15, s15, s14
  v_mul_u32_u24 v59, 1152, v59
  v_mul_u32_u24 v60, 1152, v60
  v_lshl_add_u32 v56, v58, 3, v59
  v_add_u32 v56, s14, v56
  v_lshl_add_u32 v48, v58, 4, s15
  v_add_u32 v63, v48, v59
  v_add_u32 v64, v48, v60
  v_lshrrev_b32 v59, 1, v58
  v_lshl_or_b32 v56, v59, 30, v56
  v_lshlrev_b32 v59, 1, v48
  s_lshl_b32 s14, s14, 1
  v_lshl_add_u32 v60, v58, 4, s14
  s_lshl_b32 s15, s10, 11
  v_add_u32 v61, s15, v240
  v_xor_b32 v62, 2048, v61
  v_and_b32 v57, 3, v1
  v_lshlrev_b32 v57, 6, v57
  v_bfe_u32 v48, v1, 2, 1
  v_lshl_add_u32 v57, v48, 4, v57
  v_bfe_u32 v48, v1, 4, 1
  v_lshl_add_u32 v57, v48, 5, v57
  v_lshrrev_b32 v48, 5, v1
  v_lshl_add_u32 v57, v48, 8, v57
  s_lshl_b32 s15, s25, 11
  v_add_u32 v48, s15, v240
  v_add_u32 v65, 32768, v48
  v_add_u32 v67, 36864, v57
  v_add_u32 v66, 94208, v48
  v_add_u32 v68, 98304, v57
  s_add_u32 s16, s6, 0x1365000
  s_addc_u32 s17, s7, 0
  s_mov_b32 s18, 0x240000
  s_mov_b32 s19, 0x20000
  s_add_u32 s20, s6, 0x920000
  s_addc_u32 s21, s7, 0
  s_mov_b32 s22, 0x3600
  s_mov_b32 s23, 0x20000
  s_mov_b32 s24, 11520
  s_waitcnt vmcnt(0)
  s_mov_b64 exec, 1
  v_mov_b32 v48, 0
  v_mov_b32 v49, 1
  buffer_atomic_add v49, v48, s[64:67], s68 offen sc1
  s_mov_b64 exec, -1
  s_barrier
  buffer_load_dwordx4 v[24:27], v63, s[16:19], 0 offen sc1
  buffer_load_dwordx4 v[28:31], v64, s[16:19], 0 offen sc1
  buffer_load_dwordx2 v[32:33], v56, s[16:19], 0 offen offset:128 sc1
  buffer_load_dwordx4 v[36:39], v59, s[20:23], s24 offen offset:0 sc1
  buffer_load_dwordx4 v[40:43], v59, s[20:23], s24 offen offset:16 sc1
  buffer_load_dwordx4 v[44:47], v60, s[20:23], s24 offen offset:256 sc1
  s_waitcnt lgkmcnt(0)
  s_barrier
  ds_read_b128 v[120:123], v61 offset:0
  ds_read_b128 v[124:127], v62 offset:0
  ds_read_b128 v[72:75], v66 offset:8192
  ds_read_b128 v[76:79], v66 offset:9216
  ds_read_b128 v[80:83], v68 offset:8192
  ds_read_b128 v[128:131], v61 offset:1024
  ds_read_b128 v[132:135], v62 offset:1024
  ds_read_b128 v[84:87], v66 offset:12800
  ds_read_b128 v[88:91], v66 offset:13824
  ds_read_b128 v[92:95], v68 offset:12800
  s_waitcnt lgkmcnt(0)
  s_barrier
  v_mfma_f32_16x16x32_bf16 v[4:7], v[72:75], v[120:123], 0
  ds_read_b128 v[136:139], v61 offset:8192
  v_mfma_f32_16x16x32_bf16 v[8:11], v[76:79], v[120:123], 0
  ds_read_b128 v[140:143], v62 offset:8192
  v_mfma_f32_16x16x32_bf16 v[20:23], v[80:83], v[120:123], 0
  ds_read_b128 v[96:99], v66 offset:17408
  v_mfma_f32_16x16x32_bf16 v[12:15], v[72:75], v[124:127], 0
  ds_read_b128 v[100:103], v66 offset:18432
  v_mfma_f32_16x16x32_bf16 v[16:19], v[76:79], v[124:127], 0
  ds_read_b128 v[104:107], v68 offset:17408
  v_mfma_f32_16x16x32_bf16 v[4:7], v[84:87], v[128:131], v[4:7]
  ds_read_b128 v[144:147], v61 offset:9216
  v_mfma_f32_16x16x32_bf16 v[8:11], v[88:91], v[128:131], v[8:11]
  ds_read_b128 v[148:151], v62 offset:9216
  v_mfma_f32_16x16x32_bf16 v[20:23], v[92:95], v[128:131], v[20:23]
  ds_read_b128 v[108:111], v66 offset:22016
  v_mfma_f32_16x16x32_bf16 v[12:15], v[84:87], v[132:135], v[12:15]
  ds_read_b128 v[112:115], v66 offset:23040
  v_mfma_f32_16x16x32_bf16 v[16:19], v[88:91], v[132:135], v[16:19]
  ds_read_b128 v[116:119], v68 offset:22016
  s_waitcnt lgkmcnt(0)
  s_barrier
  v_mfma_f32_16x16x32_bf16 v[4:7], v[96:99], v[136:139], v[4:7]
  ds_read_b128 v[120:123], v61 offset:16384
  v_mfma_f32_16x16x32_bf16 v[8:11], v[100:103], v[136:139], v[8:11]
  ds_read_b128 v[124:127], v62 offset:16384
  v_mfma_f32_16x16x32_bf16 v[20:23], v[104:107], v[136:139], v[20:23]
  ds_read_b128 v[72:75], v66 offset:26624
  v_mfma_f32_16x16x32_bf16 v[12:15], v[96:99], v[140:143], v[12:15]
  ds_read_b128 v[76:79], v66 offset:27648
  v_mfma_f32_16x16x32_bf16 v[16:19], v[100:103], v[140:143], v[16:19]
  ds_read_b128 v[80:83], v68 offset:26624
  v_mfma_f32_16x16x32_bf16 v[4:7], v[108:111], v[144:147], v[4:7]
  ds_read_b128 v[128:131], v61 offset:17408
  v_mfma_f32_16x16x32_bf16 v[8:11], v[112:115], v[144:147], v[8:11]
  ds_read_b128 v[132:135], v62 offset:17408
  v_mfma_f32_16x16x32_bf16 v[20:23], v[116:119], v[144:147], v[20:23]
  ds_read_b128 v[84:87], v66 offset:31232
  v_mfma_f32_16x16x32_bf16 v[12:15], v[108:111], v[148:151], v[12:15]
  ds_read_b128 v[88:91], v66 offset:32256
  v_mfma_f32_16x16x32_bf16 v[16:19], v[112:115], v[148:151], v[16:19]
  ds_read_b128 v[92:95], v68 offset:31232
  s_waitcnt lgkmcnt(0)
  s_barrier
  v_mfma_f32_16x16x32_bf16 v[4:7], v[72:75], v[120:123], v[4:7]
  ds_read_b128 v[136:139], v61 offset:24576
  v_mfma_f32_16x16x32_bf16 v[8:11], v[76:79], v[120:123], v[8:11]
  ds_read_b128 v[140:143], v62 offset:24576
  v_mfma_f32_16x16x32_bf16 v[20:23], v[80:83], v[120:123], v[20:23]
  ds_read_b128 v[96:99], v66 offset:35840
  v_mfma_f32_16x16x32_bf16 v[12:15], v[72:75], v[124:127], v[12:15]
  ds_read_b128 v[100:103], v66 offset:36864
  v_mfma_f32_16x16x32_bf16 v[16:19], v[76:79], v[124:127], v[16:19]
  ds_read_b128 v[104:107], v68 offset:35840
  v_mfma_f32_16x16x32_bf16 v[4:7], v[84:87], v[128:131], v[4:7]
  ds_read_b128 v[144:147], v61 offset:25600
  v_mfma_f32_16x16x32_bf16 v[8:11], v[88:91], v[128:131], v[8:11]
  ds_read_b128 v[148:151], v62 offset:25600
  v_mfma_f32_16x16x32_bf16 v[20:23], v[92:95], v[128:131], v[20:23]
  ds_read_b128 v[108:111], v66 offset:40448
  v_mfma_f32_16x16x32_bf16 v[12:15], v[84:87], v[132:135], v[12:15]
  ds_read_b128 v[112:115], v66 offset:41472
  v_mfma_f32_16x16x32_bf16 v[16:19], v[88:91], v[132:135], v[16:19]
  ds_read_b128 v[116:119], v68 offset:40448
  s_waitcnt lgkmcnt(0)
  s_barrier
  v_mfma_f32_16x16x32_bf16 v[4:7], v[96:99], v[136:139], v[4:7]
  ds_read_b128 v[120:123], v61 offset:32768
  v_mfma_f32_16x16x32_bf16 v[8:11], v[100:103], v[136:139], v[8:11]
  ds_read_b128 v[124:127], v62 offset:32768
  v_mfma_f32_16x16x32_bf16 v[20:23], v[104:107], v[136:139], v[20:23]
  ds_read_b128 v[72:75], v65 offset:32768
  v_mfma_f32_16x16x32_bf16 v[12:15], v[96:99], v[140:143], v[12:15]
  ds_read_b128 v[76:79], v65 offset:33792
  v_mfma_f32_16x16x32_bf16 v[16:19], v[100:103], v[140:143], v[16:19]
  ds_read_b128 v[80:83], v67 offset:32768
  v_mfma_f32_16x16x32_bf16 v[4:7], v[108:111], v[144:147], v[4:7]
  ds_read_b128 v[128:131], v61 offset:33792
  v_mfma_f32_16x16x32_bf16 v[8:11], v[112:115], v[144:147], v[8:11]
  ds_read_b128 v[132:135], v62 offset:33792
  v_mfma_f32_16x16x32_bf16 v[20:23], v[116:119], v[144:147], v[20:23]
  ds_read_b128 v[84:87], v65 offset:37376
  v_mfma_f32_16x16x32_bf16 v[12:15], v[108:111], v[148:151], v[12:15]
  ds_read_b128 v[88:91], v65 offset:38400
  v_mfma_f32_16x16x32_bf16 v[16:19], v[112:115], v[148:151], v[16:19]
  ds_read_b128 v[92:95], v67 offset:37376
  s_waitcnt lgkmcnt(0)
  s_barrier
  v_mfma_f32_16x16x32_bf16 v[4:7], v[72:75], v[120:123], v[4:7]
  ds_read_b128 v[136:139], v61 offset:40960
  v_mfma_f32_16x16x32_bf16 v[8:11], v[76:79], v[120:123], v[8:11]
  ds_read_b128 v[140:143], v62 offset:40960
  v_mfma_f32_16x16x32_bf16 v[20:23], v[80:83], v[120:123], v[20:23]
  ds_read_b128 v[96:99], v65 offset:41984
  v_mfma_f32_16x16x32_bf16 v[12:15], v[72:75], v[124:127], v[12:15]
  ds_read_b128 v[100:103], v65 offset:43008
  v_mfma_f32_16x16x32_bf16 v[16:19], v[76:79], v[124:127], v[16:19]
  ds_read_b128 v[104:107], v67 offset:41984
  v_mfma_f32_16x16x32_bf16 v[4:7], v[84:87], v[128:131], v[4:7]
  ds_read_b128 v[144:147], v61 offset:41984
  v_mfma_f32_16x16x32_bf16 v[8:11], v[88:91], v[128:131], v[8:11]
  ds_read_b128 v[148:151], v62 offset:41984
  v_mfma_f32_16x16x32_bf16 v[20:23], v[92:95], v[128:131], v[20:23]
  ds_read_b128 v[108:111], v65 offset:46592
  v_mfma_f32_16x16x32_bf16 v[12:15], v[84:87], v[132:135], v[12:15]
  ds_read_b128 v[112:115], v65 offset:47616
  v_mfma_f32_16x16x32_bf16 v[16:19], v[88:91], v[132:135], v[16:19]
  ds_read_b128 v[116:119], v67 offset:46592
  s_waitcnt lgkmcnt(0)
  s_barrier
  v_mfma_f32_16x16x32_bf16 v[4:7], v[96:99], v[136:139], v[4:7]
  ds_read_b128 v[120:123], v61 offset:0
  v_mfma_f32_16x16x32_bf16 v[8:11], v[100:103], v[136:139], v[8:11]
  ds_read_b128 v[124:127], v62 offset:0
  v_mfma_f32_16x16x32_bf16 v[20:23], v[104:107], v[136:139], v[20:23]
  ds_read_b128 v[72:75], v65 offset:51200
  v_mfma_f32_16x16x32_bf16 v[12:15], v[96:99], v[140:143], v[12:15]
  ds_read_b128 v[76:79], v65 offset:52224
  v_mfma_f32_16x16x32_bf16 v[16:19], v[100:103], v[140:143], v[16:19]
  ds_read_b128 v[80:83], v67 offset:51200
  v_mfma_f32_16x16x32_bf16 v[4:7], v[108:111], v[144:147], v[4:7]
  ds_read_b128 v[128:131], v61 offset:1024
  v_mfma_f32_16x16x32_bf16 v[8:11], v[112:115], v[144:147], v[8:11]
  ds_read_b128 v[132:135], v62 offset:1024
  v_mfma_f32_16x16x32_bf16 v[20:23], v[116:119], v[144:147], v[20:23]
  ds_read_b128 v[84:87], v65 offset:55808
  v_mfma_f32_16x16x32_bf16 v[12:15], v[108:111], v[148:151], v[12:15]
  ds_read_b128 v[88:91], v65 offset:56832
  v_mfma_f32_16x16x32_bf16 v[16:19], v[112:115], v[148:151], v[16:19]
  ds_read_b128 v[92:95], v67 offset:55808
  s_waitcnt lgkmcnt(0)
  s_barrier
  v_mfma_f32_16x16x32_bf16 v[4:7], v[72:75], v[120:123], v[4:7]
  ds_read_b128 v[136:139], v61 offset:8192
  v_mfma_f32_16x16x32_bf16 v[8:11], v[76:79], v[120:123], v[8:11]
  ds_read_b128 v[140:143], v62 offset:8192
  v_mfma_f32_16x16x32_bf16 v[20:23], v[80:83], v[120:123], v[20:23]
  ds_read_b128 v[96:99], v65 offset:60416
  v_mfma_f32_16x16x32_bf16 v[12:15], v[72:75], v[124:127], v[12:15]
  ds_read_b128 v[100:103], v65 offset:61440
  v_mfma_f32_16x16x32_bf16 v[16:19], v[76:79], v[124:127], v[16:19]
  ds_read_b128 v[104:107], v67 offset:60416
  v_mfma_f32_16x16x32_bf16 v[4:7], v[84:87], v[128:131], v[4:7]
  ds_read_b128 v[144:147], v61 offset:9216
  v_mfma_f32_16x16x32_bf16 v[8:11], v[88:91], v[128:131], v[8:11]
  ds_read_b128 v[148:151], v62 offset:9216
  v_mfma_f32_16x16x32_bf16 v[20:23], v[92:95], v[128:131], v[20:23]
  ds_read_b128 v[108:111], v66 offset:3584
  v_mfma_f32_16x16x32_bf16 v[12:15], v[84:87], v[132:135], v[12:15]
  ds_read_b128 v[112:115], v66 offset:4608
  v_mfma_f32_16x16x32_bf16 v[16:19], v[88:91], v[132:135], v[16:19]
  ds_read_b128 v[116:119], v68 offset:3584
  s_waitcnt lgkmcnt(0)
  s_barrier
  v_mfma_f32_16x16x32_bf16 v[4:7], v[96:99], v[136:139], v[4:7]
  ds_read_b128 v[120:123], v61 offset:16384
  v_mfma_f32_16x16x32_bf16 v[8:11], v[100:103], v[136:139], v[8:11]
  ds_read_b128 v[124:127], v62 offset:16384
  v_mfma_f32_16x16x32_bf16 v[20:23], v[104:107], v[136:139], v[20:23]
  ds_read_b128 v[72:75], v65 offset:16384
  v_mfma_f32_16x16x32_bf16 v[12:15], v[96:99], v[140:143], v[12:15]
  ds_read_b128 v[76:79], v65 offset:17408
  v_mfma_f32_16x16x32_bf16 v[16:19], v[100:103], v[140:143], v[16:19]
  ds_read_b128 v[80:83], v67 offset:16384
  v_mfma_f32_16x16x32_bf16 v[4:7], v[108:111], v[144:147], v[4:7]
  ds_read_b128 v[128:131], v61 offset:17408
  v_mfma_f32_16x16x32_bf16 v[8:11], v[112:115], v[144:147], v[8:11]
  ds_read_b128 v[132:135], v62 offset:17408
  v_mfma_f32_16x16x32_bf16 v[20:23], v[116:119], v[144:147], v[20:23]
  ds_read_b128 v[84:87], v65 offset:20992
  v_mfma_f32_16x16x32_bf16 v[12:15], v[108:111], v[148:151], v[12:15]
  ds_read_b128 v[88:91], v65 offset:22016
  v_mfma_f32_16x16x32_bf16 v[16:19], v[112:115], v[148:151], v[16:19]
  ds_read_b128 v[92:95], v67 offset:20992
  s_waitcnt lgkmcnt(0)
  s_barrier
  v_mfma_f32_16x16x32_bf16 v[4:7], v[72:75], v[120:123], v[4:7]
  ds_read_b128 v[136:139], v61 offset:24576
  v_mfma_f32_16x16x32_bf16 v[8:11], v[76:79], v[120:123], v[8:11]
  ds_read_b128 v[140:143], v62 offset:24576
  v_mfma_f32_16x16x32_bf16 v[20:23], v[80:83], v[120:123], v[20:23]
  ds_read_b128 v[96:99], v66 offset:45056
  v_mfma_f32_16x16x32_bf16 v[12:15], v[72:75], v[124:127], v[12:15]
  ds_read_b128 v[100:103], v66 offset:46080
  v_mfma_f32_16x16x32_bf16 v[16:19], v[76:79], v[124:127], v[16:19]
  ds_read_b128 v[104:107], v68 offset:45056
  v_mfma_f32_16x16x32_bf16 v[4:7], v[84:87], v[128:131], v[4:7]
  ds_read_b128 v[144:147], v61 offset:25600
  v_mfma_f32_16x16x32_bf16 v[8:11], v[88:91], v[128:131], v[8:11]
  ds_read_b128 v[148:151], v62 offset:25600
  v_mfma_f32_16x16x32_bf16 v[20:23], v[92:95], v[128:131], v[20:23]
  ds_read_b128 v[108:111], v66 offset:49664
  v_mfma_f32_16x16x32_bf16 v[12:15], v[84:87], v[132:135], v[12:15]
  ds_read_b128 v[112:115], v66 offset:50688
  v_mfma_f32_16x16x32_bf16 v[16:19], v[88:91], v[132:135], v[16:19]
  ds_read_b128 v[116:119], v68 offset:49664
  s_waitcnt lgkmcnt(0)
  s_barrier
  v_mfma_f32_16x16x32_bf16 v[4:7], v[96:99], v[136:139], v[4:7]
  ds_read_b128 v[120:123], v61 offset:32768
  v_mfma_f32_16x16x32_bf16 v[8:11], v[100:103], v[136:139], v[8:11]
  ds_read_b128 v[124:127], v62 offset:32768
  v_mfma_f32_16x16x32_bf16 v[20:23], v[104:107], v[136:139], v[20:23]
  ds_read_b128 v[72:75], v66 offset:54272
  v_mfma_f32_16x16x32_bf16 v[12:15], v[96:99], v[140:143], v[12:15]
  ds_read_b128 v[76:79], v66 offset:55296
  v_mfma_f32_16x16x32_bf16 v[16:19], v[100:103], v[140:143], v[16:19]
  ds_read_b128 v[80:83], v68 offset:54272
  v_mfma_f32_16x16x32_bf16 v[4:7], v[108:111], v[144:147], v[4:7]
  ds_read_b128 v[128:131], v61 offset:33792
  v_mfma_f32_16x16x32_bf16 v[8:11], v[112:115], v[144:147], v[8:11]
  ds_read_b128 v[132:135], v62 offset:33792
  v_mfma_f32_16x16x32_bf16 v[20:23], v[116:119], v[144:147], v[20:23]
  ds_read_b128 v[84:87], v66 offset:58880
  v_mfma_f32_16x16x32_bf16 v[12:15], v[108:111], v[148:151], v[12:15]
  ds_read_b128 v[88:91], v66 offset:59904
  v_mfma_f32_16x16x32_bf16 v[16:19], v[112:115], v[148:151], v[16:19]
  ds_read_b128 v[92:95], v68 offset:58880
  s_waitcnt lgkmcnt(0)
  s_barrier
  v_mfma_f32_16x16x32_bf16 v[4:7], v[72:75], v[120:123], v[4:7]
  ds_read_b128 v[136:139], v61 offset:40960
  v_mfma_f32_16x16x32_bf16 v[8:11], v[76:79], v[120:123], v[8:11]
  ds_read_b128 v[140:143], v62 offset:40960
  v_mfma_f32_16x16x32_bf16 v[20:23], v[80:83], v[120:123], v[20:23]
  ds_read_b128 v[96:99], v66 offset:8192
  v_mfma_f32_16x16x32_bf16 v[12:15], v[72:75], v[124:127], v[12:15]
  ds_read_b128 v[100:103], v66 offset:9216
  v_mfma_f32_16x16x32_bf16 v[16:19], v[76:79], v[124:127], v[16:19]
  ds_read_b128 v[104:107], v68 offset:8192
  v_mfma_f32_16x16x32_bf16 v[4:7], v[84:87], v[128:131], v[4:7]
  ds_read_b128 v[144:147], v61 offset:41984
  v_mfma_f32_16x16x32_bf16 v[8:11], v[88:91], v[128:131], v[8:11]
  ds_read_b128 v[148:151], v62 offset:41984
  v_mfma_f32_16x16x32_bf16 v[20:23], v[92:95], v[128:131], v[20:23]
  ds_read_b128 v[108:111], v66 offset:12800
  v_mfma_f32_16x16x32_bf16 v[12:15], v[84:87], v[132:135], v[12:15]
  ds_read_b128 v[112:115], v66 offset:13824
  v_mfma_f32_16x16x32_bf16 v[16:19], v[88:91], v[132:135], v[16:19]
  ds_read_b128 v[116:119], v68 offset:12800
  s_waitcnt lgkmcnt(0)
  s_barrier
  v_mfma_f32_16x16x32_bf16 v[4:7], v[96:99], v[136:139], v[4:7]
  ds_read_b128 v[120:123], v61 offset:0
  v_mfma_f32_16x16x32_bf16 v[8:11], v[100:103], v[136:139], v[8:11]
  ds_read_b128 v[124:127], v62 offset:0
  v_mfma_f32_16x16x32_bf16 v[20:23], v[104:107], v[136:139], v[20:23]
  ds_read_b128 v[72:75], v66 offset:17408
  v_mfma_f32_16x16x32_bf16 v[12:15], v[96:99], v[140:143], v[12:15]
  ds_read_b128 v[76:79], v66 offset:18432
  v_mfma_f32_16x16x32_bf16 v[16:19], v[100:103], v[140:143], v[16:19]
  ds_read_b128 v[80:83], v68 offset:17408
  v_mfma_f32_16x16x32_bf16 v[4:7], v[108:111], v[144:147], v[4:7]
  ds_read_b128 v[128:131], v61 offset:1024
  v_mfma_f32_16x16x32_bf16 v[8:11], v[112:115], v[144:147], v[8:11]
  ds_read_b128 v[132:135], v62 offset:1024
  v_mfma_f32_16x16x32_bf16 v[20:23], v[116:119], v[144:147], v[20:23]
  ds_read_b128 v[84:87], v66 offset:22016
  v_mfma_f32_16x16x32_bf16 v[12:15], v[108:111], v[148:151], v[12:15]
  ds_read_b128 v[88:91], v66 offset:23040
  v_mfma_f32_16x16x32_bf16 v[16:19], v[112:115], v[148:151], v[16:19]
  ds_read_b128 v[92:95], v68 offset:22016
  s_waitcnt lgkmcnt(0)
  s_barrier
  v_mfma_f32_16x16x32_bf16 v[4:7], v[72:75], v[120:123], v[4:7]
  ds_read_b128 v[136:139], v61 offset:8192
  v_mfma_f32_16x16x32_bf16 v[8:11], v[76:79], v[120:123], v[8:11]
  ds_read_b128 v[140:143], v62 offset:8192
  v_mfma_f32_16x16x32_bf16 v[20:23], v[80:83], v[120:123], v[20:23]
  ds_read_b128 v[96:99], v66 offset:26624
  v_mfma_f32_16x16x32_bf16 v[12:15], v[72:75], v[124:127], v[12:15]
  ds_read_b128 v[100:103], v66 offset:27648
  v_mfma_f32_16x16x32_bf16 v[16:19], v[76:79], v[124:127], v[16:19]
  ds_read_b128 v[104:107], v68 offset:26624
  v_mfma_f32_16x16x32_bf16 v[4:7], v[84:87], v[128:131], v[4:7]
  ds_read_b128 v[144:147], v61 offset:9216
  v_mfma_f32_16x16x32_bf16 v[8:11], v[88:91], v[128:131], v[8:11]
  ds_read_b128 v[148:151], v62 offset:9216
  v_mfma_f32_16x16x32_bf16 v[20:23], v[92:95], v[128:131], v[20:23]
  ds_read_b128 v[108:111], v66 offset:31232
  v_mfma_f32_16x16x32_bf16 v[12:15], v[84:87], v[132:135], v[12:15]
  ds_read_b128 v[112:115], v66 offset:32256
  v_mfma_f32_16x16x32_bf16 v[16:19], v[88:91], v[132:135], v[16:19]
  ds_read_b128 v[116:119], v68 offset:31232
  s_waitcnt lgkmcnt(0)
  s_barrier
  v_mfma_f32_16x16x32_bf16 v[4:7], v[96:99], v[136:139], v[4:7]
  ds_read_b128 v[120:123], v61 offset:16384
  v_mfma_f32_16x16x32_bf16 v[8:11], v[100:103], v[136:139], v[8:11]
  ds_read_b128 v[124:127], v62 offset:16384
  v_mfma_f32_16x16x32_bf16 v[20:23], v[104:107], v[136:139], v[20:23]
  ds_read_b128 v[72:75], v66 offset:35840
  v_mfma_f32_16x16x32_bf16 v[12:15], v[96:99], v[140:143], v[12:15]
  ds_read_b128 v[76:79], v66 offset:36864
  v_mfma_f32_16x16x32_bf16 v[16:19], v[100:103], v[140:143], v[16:19]
  ds_read_b128 v[80:83], v68 offset:35840
  v_mfma_f32_16x16x32_bf16 v[4:7], v[108:111], v[144:147], v[4:7]
  ds_read_b128 v[128:131], v61 offset:17408
  v_mfma_f32_16x16x32_bf16 v[8:11], v[112:115], v[144:147], v[8:11]
  ds_read_b128 v[132:135], v62 offset:17408
  v_mfma_f32_16x16x32_bf16 v[20:23], v[116:119], v[144:147], v[20:23]
  ds_read_b128 v[84:87], v66 offset:40448
  v_mfma_f32_16x16x32_bf16 v[12:15], v[108:111], v[148:151], v[12:15]
  ds_read_b128 v[88:91], v66 offset:41472
  v_mfma_f32_16x16x32_bf16 v[16:19], v[112:115], v[148:151], v[16:19]
  ds_read_b128 v[92:95], v68 offset:40448
  s_waitcnt lgkmcnt(0)
  s_barrier
  v_mfma_f32_16x16x32_bf16 v[4:7], v[72:75], v[120:123], v[4:7]
  ds_read_b128 v[136:139], v61 offset:24576
  v_mfma_f32_16x16x32_bf16 v[8:11], v[76:79], v[120:123], v[8:11]
  ds_read_b128 v[140:143], v62 offset:24576
  v_mfma_f32_16x16x32_bf16 v[20:23], v[80:83], v[120:123], v[20:23]
  ds_read_b128 v[96:99], v65 offset:32768
  v_mfma_f32_16x16x32_bf16 v[12:15], v[72:75], v[124:127], v[12:15]
  ds_read_b128 v[100:103], v65 offset:33792
  v_mfma_f32_16x16x32_bf16 v[16:19], v[76:79], v[124:127], v[16:19]
  ds_read_b128 v[104:107], v67 offset:32768
  v_mfma_f32_16x16x32_bf16 v[4:7], v[84:87], v[128:131], v[4:7]
  ds_read_b128 v[144:147], v61 offset:25600
  v_mfma_f32_16x16x32_bf16 v[8:11], v[88:91], v[128:131], v[8:11]
  ds_read_b128 v[148:151], v62 offset:25600
  v_mfma_f32_16x16x32_bf16 v[20:23], v[92:95], v[128:131], v[20:23]
  ds_read_b128 v[108:111], v65 offset:37376
  v_mfma_f32_16x16x32_bf16 v[12:15], v[84:87], v[132:135], v[12:15]
  ds_read_b128 v[112:115], v65 offset:38400
  v_mfma_f32_16x16x32_bf16 v[16:19], v[88:91], v[132:135], v[16:19]
  ds_read_b128 v[116:119], v67 offset:37376
  s_waitcnt lgkmcnt(0)
  s_barrier
  v_mfma_f32_16x16x32_bf16 v[4:7], v[96:99], v[136:139], v[4:7]
  ds_read_b128 v[120:123], v61 offset:32768
  v_mfma_f32_16x16x32_bf16 v[8:11], v[100:103], v[136:139], v[8:11]
  ds_read_b128 v[124:127], v62 offset:32768
  v_mfma_f32_16x16x32_bf16 v[20:23], v[104:107], v[136:139], v[20:23]
  ds_read_b128 v[72:75], v65 offset:41984
  v_mfma_f32_16x16x32_bf16 v[12:15], v[96:99], v[140:143], v[12:15]
  ds_read_b128 v[76:79], v65 offset:43008
  v_mfma_f32_16x16x32_bf16 v[16:19], v[100:103], v[140:143], v[16:19]
  ds_read_b128 v[80:83], v67 offset:41984
  v_mfma_f32_16x16x32_bf16 v[4:7], v[108:111], v[144:147], v[4:7]
  ds_read_b128 v[128:131], v61 offset:33792
  v_mfma_f32_16x16x32_bf16 v[8:11], v[112:115], v[144:147], v[8:11]
  ds_read_b128 v[132:135], v62 offset:33792
  v_mfma_f32_16x16x32_bf16 v[20:23], v[116:119], v[144:147], v[20:23]
  ds_read_b128 v[84:87], v65 offset:46592
  v_mfma_f32_16x16x32_bf16 v[12:15], v[108:111], v[148:151], v[12:15]
  ds_read_b128 v[88:91], v65 offset:47616
  v_mfma_f32_16x16x32_bf16 v[16:19], v[112:115], v[148:151], v[16:19]
  ds_read_b128 v[92:95], v67 offset:46592
  s_waitcnt lgkmcnt(0)
  s_barrier
  v_mfma_f32_16x16x32_bf16 v[4:7], v[72:75], v[120:123], v[4:7]
  ds_read_b128 v[136:139], v61 offset:40960
  v_mfma_f32_16x16x32_bf16 v[8:11], v[76:79], v[120:123], v[8:11]
  ds_read_b128 v[140:143], v62 offset:40960
  v_mfma_f32_16x16x32_bf16 v[20:23], v[80:83], v[120:123], v[20:23]
  ds_read_b128 v[96:99], v65 offset:51200
  v_mfma_f32_16x16x32_bf16 v[12:15], v[72:75], v[124:127], v[12:15]
  ds_read_b128 v[100:103], v65 offset:52224
  v_mfma_f32_16x16x32_bf16 v[16:19], v[76:79], v[124:127], v[16:19]
  ds_read_b128 v[104:107], v67 offset:51200
  v_mfma_f32_16x16x32_bf16 v[4:7], v[84:87], v[128:131], v[4:7]
  ds_read_b128 v[144:147], v61 offset:41984
  v_mfma_f32_16x16x32_bf16 v[8:11], v[88:91], v[128:131], v[8:11]
  ds_read_b128 v[148:151], v62 offset:41984
  v_mfma_f32_16x16x32_bf16 v[20:23], v[92:95], v[128:131], v[20:23]
  ds_read_b128 v[108:111], v65 offset:55808
  v_mfma_f32_16x16x32_bf16 v[12:15], v[84:87], v[132:135], v[12:15]
  ds_read_b128 v[112:115], v65 offset:56832
  v_mfma_f32_16x16x32_bf16 v[16:19], v[88:91], v[132:135], v[16:19]
  ds_read_b128 v[116:119], v67 offset:55808
  s_waitcnt lgkmcnt(0)
  s_barrier
  v_mfma_f32_16x16x32_bf16 v[4:7], v[96:99], v[136:139], v[4:7]
  ds_read_b128 v[120:123], v61 offset:0
  v_mfma_f32_16x16x32_bf16 v[8:11], v[100:103], v[136:139], v[8:11]
  ds_read_b128 v[124:127], v62 offset:0
  v_mfma_f32_16x16x32_bf16 v[20:23], v[104:107], v[136:139], v[20:23]
  ds_read_b128 v[72:75], v65 offset:60416
  v_mfma_f32_16x16x32_bf16 v[12:15], v[96:99], v[140:143], v[12:15]
  ds_read_b128 v[76:79], v65 offset:61440
  v_mfma_f32_16x16x32_bf16 v[16:19], v[100:103], v[140:143], v[16:19]
  ds_read_b128 v[80:83], v67 offset:60416
  v_mfma_f32_16x16x32_bf16 v[4:7], v[108:111], v[144:147], v[4:7]
  ds_read_b128 v[128:131], v61 offset:1024
  v_mfma_f32_16x16x32_bf16 v[8:11], v[112:115], v[144:147], v[8:11]
  ds_read_b128 v[132:135], v62 offset:1024
  v_mfma_f32_16x16x32_bf16 v[20:23], v[116:119], v[144:147], v[20:23]
  ds_read_b128 v[84:87], v66 offset:3584
  v_mfma_f32_16x16x32_bf16 v[12:15], v[108:111], v[148:151], v[12:15]
  ds_read_b128 v[88:91], v66 offset:4608
  v_mfma_f32_16x16x32_bf16 v[16:19], v[112:115], v[148:151], v[16:19]
  ds_read_b128 v[92:95], v68 offset:3584
  s_waitcnt lgkmcnt(0)
  s_barrier
  v_mfma_f32_16x16x32_bf16 v[4:7], v[72:75], v[120:123], v[4:7]
  ds_read_b128 v[136:139], v61 offset:8192
  v_mfma_f32_16x16x32_bf16 v[8:11], v[76:79], v[120:123], v[8:11]
  ds_read_b128 v[140:143], v62 offset:8192
  v_mfma_f32_16x16x32_bf16 v[20:23], v[80:83], v[120:123], v[20:23]
  ds_read_b128 v[96:99], v65 offset:16384
  v_mfma_f32_16x16x32_bf16 v[12:15], v[72:75], v[124:127], v[12:15]
  ds_read_b128 v[100:103], v65 offset:17408
  v_mfma_f32_16x16x32_bf16 v[16:19], v[76:79], v[124:127], v[16:19]
  ds_read_b128 v[104:107], v67 offset:16384
  v_mfma_f32_16x16x32_bf16 v[4:7], v[84:87], v[128:131], v[4:7]
  ds_read_b128 v[144:147], v61 offset:9216
  v_mfma_f32_16x16x32_bf16 v[8:11], v[88:91], v[128:131], v[8:11]
  ds_read_b128 v[148:151], v62 offset:9216
  v_mfma_f32_16x16x32_bf16 v[20:23], v[92:95], v[128:131], v[20:23]
  ds_read_b128 v[108:111], v65 offset:20992
  v_mfma_f32_16x16x32_bf16 v[12:15], v[84:87], v[132:135], v[12:15]
  ds_read_b128 v[112:115], v65 offset:22016
  v_mfma_f32_16x16x32_bf16 v[16:19], v[88:91], v[132:135], v[16:19]
  ds_read_b128 v[116:119], v67 offset:20992
  s_waitcnt lgkmcnt(0)
  s_barrier
  v_mfma_f32_16x16x32_bf16 v[4:7], v[96:99], v[136:139], v[4:7]
  ds_read_b128 v[120:123], v61 offset:16384
  v_mfma_f32_16x16x32_bf16 v[8:11], v[100:103], v[136:139], v[8:11]
  ds_read_b128 v[124:127], v62 offset:16384
  v_mfma_f32_16x16x32_bf16 v[20:23], v[104:107], v[136:139], v[20:23]
  ds_read_b128 v[72:75], v66 offset:45056
  v_mfma_f32_16x16x32_bf16 v[12:15], v[96:99], v[140:143], v[12:15]
  ds_read_b128 v[76:79], v66 offset:46080
  v_mfma_f32_16x16x32_bf16 v[16:19], v[100:103], v[140:143], v[16:19]
  ds_read_b128 v[80:83], v68 offset:45056
  v_mfma_f32_16x16x32_bf16 v[4:7], v[108:111], v[144:147], v[4:7]
  ds_read_b128 v[128:131], v61 offset:17408
  v_mfma_f32_16x16x32_bf16 v[8:11], v[112:115], v[144:147], v[8:11]
  ds_read_b128 v[132:135], v62 offset:17408
  v_mfma_f32_16x16x32_bf16 v[20:23], v[116:119], v[144:147], v[20:23]
  ds_read_b128 v[84:87], v66 offset:49664
  v_mfma_f32_16x16x32_bf16 v[12:15], v[108:111], v[148:151], v[12:15]
  ds_read_b128 v[88:91], v66 offset:50688
  v_mfma_f32_16x16x32_bf16 v[16:19], v[112:115], v[148:151], v[16:19]
  ds_read_b128 v[92:95], v68 offset:49664
  s_waitcnt lgkmcnt(0)
  s_barrier
  v_mfma_f32_16x16x32_bf16 v[4:7], v[72:75], v[120:123], v[4:7]
  ds_read_b128 v[136:139], v61 offset:24576
  v_mfma_f32_16x16x32_bf16 v[8:11], v[76:79], v[120:123], v[8:11]
  ds_read_b128 v[140:143], v62 offset:24576
  v_mfma_f32_16x16x32_bf16 v[20:23], v[80:83], v[120:123], v[20:23]
  ds_read_b128 v[96:99], v66 offset:54272
  v_mfma_f32_16x16x32_bf16 v[12:15], v[72:75], v[124:127], v[12:15]
  ds_read_b128 v[100:103], v66 offset:55296
  v_mfma_f32_16x16x32_bf16 v[16:19], v[76:79], v[124:127], v[16:19]
  ds_read_b128 v[104:107], v68 offset:54272
  v_mfma_f32_16x16x32_bf16 v[4:7], v[84:87], v[128:131], v[4:7]
  ds_read_b128 v[144:147], v61 offset:25600
  v_mfma_f32_16x16x32_bf16 v[8:11], v[88:91], v[128:131], v[8:11]
  ds_read_b128 v[148:151], v62 offset:25600
  v_mfma_f32_16x16x32_bf16 v[20:23], v[92:95], v[128:131], v[20:23]
  ds_read_b128 v[108:111], v66 offset:58880
  v_mfma_f32_16x16x32_bf16 v[12:15], v[84:87], v[132:135], v[12:15]
  ds_read_b128 v[112:115], v66 offset:59904
  v_mfma_f32_16x16x32_bf16 v[16:19], v[88:91], v[132:135], v[16:19]
  ds_read_b128 v[116:119], v68 offset:58880
  s_waitcnt lgkmcnt(0)
  s_barrier
  v_mfma_f32_16x16x32_bf16 v[4:7], v[96:99], v[136:139], v[4:7]
  ds_read_b128 v[120:123], v61 offset:32768
  v_mfma_f32_16x16x32_bf16 v[8:11], v[100:103], v[136:139], v[8:11]
  ds_read_b128 v[124:127], v62 offset:32768
  v_mfma_f32_16x16x32_bf16 v[20:23], v[104:107], v[136:139], v[20:23]
  ds_read_b128 v[72:75], v66 offset:8192
  v_mfma_f32_16x16x32_bf16 v[12:15], v[96:99], v[140:143], v[12:15]
  ds_read_b128 v[76:79], v66 offset:9216
  v_mfma_f32_16x16x32_bf16 v[16:19], v[100:103], v[140:143], v[16:19]
  ds_read_b128 v[80:83], v68 offset:8192
  v_mfma_f32_16x16x32_bf16 v[4:7], v[108:111], v[144:147], v[4:7]
  ds_read_b128 v[128:131], v61 offset:33792
  v_mfma_f32_16x16x32_bf16 v[8:11], v[112:115], v[144:147], v[8:11]
  ds_read_b128 v[132:135], v62 offset:33792
  v_mfma_f32_16x16x32_bf16 v[20:23], v[116:119], v[144:147], v[20:23]
  ds_read_b128 v[84:87], v66 offset:12800
  v_mfma_f32_16x16x32_bf16 v[12:15], v[108:111], v[148:151], v[12:15]
  ds_read_b128 v[88:91], v66 offset:13824
  v_mfma_f32_16x16x32_bf16 v[16:19], v[112:115], v[148:151], v[16:19]
  ds_read_b128 v[92:95], v68 offset:12800
  s_waitcnt lgkmcnt(0)
  s_barrier
  v_mfma_f32_16x16x32_bf16 v[4:7], v[72:75], v[120:123], v[4:7]
  ds_read_b128 v[136:139], v61 offset:40960
  v_mfma_f32_16x16x32_bf16 v[8:11], v[76:79], v[120:123], v[8:11]
  ds_read_b128 v[140:143], v62 offset:40960
  v_mfma_f32_16x16x32_bf16 v[20:23], v[80:83], v[120:123], v[20:23]
  ds_read_b128 v[96:99], v66 offset:17408
  v_mfma_f32_16x16x32_bf16 v[12:15], v[72:75], v[124:127], v[12:15]
  ds_read_b128 v[100:103], v66 offset:18432
  v_mfma_f32_16x16x32_bf16 v[16:19], v[76:79], v[124:127], v[16:19]
  ds_read_b128 v[104:107], v68 offset:17408
  v_mfma_f32_16x16x32_bf16 v[4:7], v[84:87], v[128:131], v[4:7]
  ds_read_b128 v[144:147], v61 offset:41984
  v_mfma_f32_16x16x32_bf16 v[8:11], v[88:91], v[128:131], v[8:11]
  ds_read_b128 v[148:151], v62 offset:41984
  v_mfma_f32_16x16x32_bf16 v[20:23], v[92:95], v[128:131], v[20:23]
  ds_read_b128 v[108:111], v66 offset:22016
  v_mfma_f32_16x16x32_bf16 v[12:15], v[84:87], v[132:135], v[12:15]
  ds_read_b128 v[112:115], v66 offset:23040
  v_mfma_f32_16x16x32_bf16 v[16:19], v[88:91], v[132:135], v[16:19]
  ds_read_b128 v[116:119], v68 offset:22016
  s_waitcnt lgkmcnt(0)
  s_barrier
  v_mfma_f32_16x16x32_bf16 v[4:7], v[96:99], v[136:139], v[4:7]
  ds_read_b128 v[120:123], v61 offset:0
  v_mfma_f32_16x16x32_bf16 v[8:11], v[100:103], v[136:139], v[8:11]
  ds_read_b128 v[124:127], v62 offset:0
  v_mfma_f32_16x16x32_bf16 v[20:23], v[104:107], v[136:139], v[20:23]
  ds_read_b128 v[72:75], v66 offset:26624
  v_mfma_f32_16x16x32_bf16 v[12:15], v[96:99], v[140:143], v[12:15]
  ds_read_b128 v[76:79], v66 offset:27648
  v_mfma_f32_16x16x32_bf16 v[16:19], v[100:103], v[140:143], v[16:19]
  ds_read_b128 v[80:83], v68 offset:26624
  v_mfma_f32_16x16x32_bf16 v[4:7], v[108:111], v[144:147], v[4:7]
  ds_read_b128 v[128:131], v61 offset:1024
  v_mfma_f32_16x16x32_bf16 v[8:11], v[112:115], v[144:147], v[8:11]
  ds_read_b128 v[132:135], v62 offset:1024
  v_mfma_f32_16x16x32_bf16 v[20:23], v[116:119], v[144:147], v[20:23]
  ds_read_b128 v[84:87], v66 offset:31232
  v_mfma_f32_16x16x32_bf16 v[12:15], v[108:111], v[148:151], v[12:15]
  ds_read_b128 v[88:91], v66 offset:32256
  v_mfma_f32_16x16x32_bf16 v[16:19], v[112:115], v[148:151], v[16:19]
  ds_read_b128 v[92:95], v68 offset:31232
  s_waitcnt lgkmcnt(0)
  s_barrier
  v_mfma_f32_16x16x32_bf16 v[4:7], v[72:75], v[120:123], v[4:7]
  ds_read_b128 v[136:139], v61 offset:8192
  v_mfma_f32_16x16x32_bf16 v[8:11], v[76:79], v[120:123], v[8:11]
  ds_read_b128 v[140:143], v62 offset:8192
  v_mfma_f32_16x16x32_bf16 v[20:23], v[80:83], v[120:123], v[20:23]
  ds_read_b128 v[96:99], v66 offset:35840
  v_mfma_f32_16x16x32_bf16 v[12:15], v[72:75], v[124:127], v[12:15]
  ds_read_b128 v[100:103], v66 offset:36864
  v_mfma_f32_16x16x32_bf16 v[16:19], v[76:79], v[124:127], v[16:19]
  ds_read_b128 v[104:107], v68 offset:35840
  v_mfma_f32_16x16x32_bf16 v[4:7], v[84:87], v[128:131], v[4:7]
  ds_read_b128 v[144:147], v61 offset:9216
  v_mfma_f32_16x16x32_bf16 v[8:11], v[88:91], v[128:131], v[8:11]
  ds_read_b128 v[148:151], v62 offset:9216
  v_mfma_f32_16x16x32_bf16 v[20:23], v[92:95], v[128:131], v[20:23]
  ds_read_b128 v[108:111], v66 offset:40448
  v_mfma_f32_16x16x32_bf16 v[12:15], v[84:87], v[132:135], v[12:15]
  ds_read_b128 v[112:115], v66 offset:41472
  v_mfma_f32_16x16x32_bf16 v[16:19], v[88:91], v[132:135], v[16:19]
  ds_read_b128 v[116:119], v68 offset:40448
  s_waitcnt lgkmcnt(0)
  s_barrier
  v_mfma_f32_16x16x32_bf16 v[4:7], v[96:99], v[136:139], v[4:7]
  ds_read_b128 v[120:123], v61 offset:16384
  v_mfma_f32_16x16x32_bf16 v[8:11], v[100:103], v[136:139], v[8:11]
  ds_read_b128 v[124:127], v62 offset:16384
  v_mfma_f32_16x16x32_bf16 v[20:23], v[104:107], v[136:139], v[20:23]
  ds_read_b128 v[72:75], v65 offset:32768
  v_mfma_f32_16x16x32_bf16 v[12:15], v[96:99], v[140:143], v[12:15]
  ds_read_b128 v[76:79], v65 offset:33792
  v_mfma_f32_16x16x32_bf16 v[16:19], v[100:103], v[140:143], v[16:19]
  ds_read_b128 v[80:83], v67 offset:32768
  v_mfma_f32_16x16x32_bf16 v[4:7], v[108:111], v[144:147], v[4:7]
  ds_read_b128 v[128:131], v61 offset:17408
  v_mfma_f32_16x16x32_bf16 v[8:11], v[112:115], v[144:147], v[8:11]
  ds_read_b128 v[132:135], v62 offset:17408
  v_mfma_f32_16x16x32_bf16 v[20:23], v[116:119], v[144:147], v[20:23]
  ds_read_b128 v[84:87], v65 offset:37376
  v_mfma_f32_16x16x32_bf16 v[12:15], v[108:111], v[148:151], v[12:15]
  ds_read_b128 v[88:91], v65 offset:38400
  v_mfma_f32_16x16x32_bf16 v[16:19], v[112:115], v[148:151], v[16:19]
  ds_read_b128 v[92:95], v67 offset:37376
  s_waitcnt lgkmcnt(0)
  s_barrier
  v_mfma_f32_16x16x32_bf16 v[4:7], v[72:75], v[120:123], v[4:7]
  ds_read_b128 v[136:139], v61 offset:24576
  v_mfma_f32_16x16x32_bf16 v[8:11], v[76:79], v[120:123], v[8:11]
  ds_read_b128 v[140:143], v62 offset:24576
  v_mfma_f32_16x16x32_bf16 v[20:23], v[80:83], v[120:123], v[20:23]
  ds_read_b128 v[96:99], v65 offset:41984
  v_mfma_f32_16x16x32_bf16 v[12:15], v[72:75], v[124:127], v[12:15]
  ds_read_b128 v[100:103], v65 offset:43008
  v_mfma_f32_16x16x32_bf16 v[16:19], v[76:79], v[124:127], v[16:19]
  ds_read_b128 v[104:107], v67 offset:41984
  v_mfma_f32_16x16x32_bf16 v[4:7], v[84:87], v[128:131], v[4:7]
  ds_read_b128 v[144:147], v61 offset:25600
  v_mfma_f32_16x16x32_bf16 v[8:11], v[88:91], v[128:131], v[8:11]
  ds_read_b128 v[148:151], v62 offset:25600
  v_mfma_f32_16x16x32_bf16 v[20:23], v[92:95], v[128:131], v[20:23]
  ds_read_b128 v[108:111], v65 offset:46592
  v_mfma_f32_16x16x32_bf16 v[12:15], v[84:87], v[132:135], v[12:15]
  ds_read_b128 v[112:115], v65 offset:47616
  v_mfma_f32_16x16x32_bf16 v[16:19], v[88:91], v[132:135], v[16:19]
  ds_read_b128 v[116:119], v67 offset:46592
  s_waitcnt lgkmcnt(0)
  s_barrier
  v_mfma_f32_16x16x32_bf16 v[4:7], v[96:99], v[136:139], v[4:7]
  ds_read_b128 v[120:123], v61 offset:32768
  v_mfma_f32_16x16x32_bf16 v[8:11], v[100:103], v[136:139], v[8:11]
  ds_read_b128 v[124:127], v62 offset:32768
  v_mfma_f32_16x16x32_bf16 v[20:23], v[104:107], v[136:139], v[20:23]
  ds_read_b128 v[72:75], v65 offset:51200
  v_mfma_f32_16x16x32_bf16 v[12:15], v[96:99], v[140:143], v[12:15]
  ds_read_b128 v[76:79], v65 offset:52224
  v_mfma_f32_16x16x32_bf16 v[16:19], v[100:103], v[140:143], v[16:19]
  ds_read_b128 v[80:83], v67 offset:51200
  v_mfma_f32_16x16x32_bf16 v[4:7], v[108:111], v[144:147], v[4:7]
  ds_read_b128 v[128:131], v61 offset:33792
  v_mfma_f32_16x16x32_bf16 v[8:11], v[112:115], v[144:147], v[8:11]
  ds_read_b128 v[132:135], v62 offset:33792
  v_mfma_f32_16x16x32_bf16 v[20:23], v[116:119], v[144:147], v[20:23]
  ds_read_b128 v[84:87], v65 offset:55808
  v_mfma_f32_16x16x32_bf16 v[12:15], v[108:111], v[148:151], v[12:15]
  ds_read_b128 v[88:91], v65 offset:56832
  v_mfma_f32_16x16x32_bf16 v[16:19], v[112:115], v[148:151], v[16:19]
  ds_read_b128 v[92:95], v67 offset:55808
  s_waitcnt lgkmcnt(0)
  s_barrier
  v_mfma_f32_16x16x32_bf16 v[4:7], v[72:75], v[120:123], v[4:7]
  ds_read_b128 v[136:139], v61 offset:40960
  v_mfma_f32_16x16x32_bf16 v[8:11], v[76:79], v[120:123], v[8:11]
  ds_read_b128 v[140:143], v62 offset:40960
  v_mfma_f32_16x16x32_bf16 v[20:23], v[80:83], v[120:123], v[20:23]
  ds_read_b128 v[96:99], v65 offset:60416
  v_mfma_f32_16x16x32_bf16 v[12:15], v[72:75], v[124:127], v[12:15]
  ds_read_b128 v[100:103], v65 offset:61440
  v_mfma_f32_16x16x32_bf16 v[16:19], v[76:79], v[124:127], v[16:19]
  ds_read_b128 v[104:107], v67 offset:60416
  v_mfma_f32_16x16x32_bf16 v[4:7], v[84:87], v[128:131], v[4:7]
  ds_read_b128 v[144:147], v61 offset:41984
  v_mfma_f32_16x16x32_bf16 v[8:11], v[88:91], v[128:131], v[8:11]
  ds_read_b128 v[148:151], v62 offset:41984
  v_mfma_f32_16x16x32_bf16 v[20:23], v[92:95], v[128:131], v[20:23]
  ds_read_b128 v[108:111], v66 offset:3584
  v_mfma_f32_16x16x32_bf16 v[12:15], v[84:87], v[132:135], v[12:15]
  ds_read_b128 v[112:115], v66 offset:4608
  v_mfma_f32_16x16x32_bf16 v[16:19], v[88:91], v[132:135], v[16:19]
  ds_read_b128 v[116:119], v68 offset:3584
  s_waitcnt lgkmcnt(0)
  s_barrier
  v_mfma_f32_16x16x32_bf16 v[4:7], v[96:99], v[136:139], v[4:7]
  ds_read_b128 v[120:123], v61 offset:0
  v_mfma_f32_16x16x32_bf16 v[8:11], v[100:103], v[136:139], v[8:11]
  ds_read_b128 v[124:127], v62 offset:0
  v_mfma_f32_16x16x32_bf16 v[20:23], v[104:107], v[136:139], v[20:23]
  ds_read_b128 v[72:75], v65 offset:16384
  v_mfma_f32_16x16x32_bf16 v[12:15], v[96:99], v[140:143], v[12:15]
  ds_read_b128 v[76:79], v65 offset:17408
  v_mfma_f32_16x16x32_bf16 v[16:19], v[100:103], v[140:143], v[16:19]
  ds_read_b128 v[80:83], v67 offset:16384
  v_mfma_f32_16x16x32_bf16 v[4:7], v[108:111], v[144:147], v[4:7]
  ds_read_b128 v[128:131], v61 offset:1024
  v_mfma_f32_16x16x32_bf16 v[8:11], v[112:115], v[144:147], v[8:11]
  ds_read_b128 v[132:135], v62 offset:1024
  v_mfma_f32_16x16x32_bf16 v[20:23], v[116:119], v[144:147], v[20:23]
  ds_read_b128 v[84:87], v65 offset:20992
  v_mfma_f32_16x16x32_bf16 v[12:15], v[108:111], v[148:151], v[12:15]
  ds_read_b128 v[88:91], v65 offset:22016
  v_mfma_f32_16x16x32_bf16 v[16:19], v[112:115], v[148:151], v[16:19]
  ds_read_b128 v[92:95], v67 offset:20992
  s_waitcnt lgkmcnt(0)
  s_barrier
  v_mfma_f32_16x16x32_bf16 v[4:7], v[72:75], v[120:123], v[4:7]
  ds_read_b128 v[136:139], v61 offset:8192
  v_mfma_f32_16x16x32_bf16 v[8:11], v[76:79], v[120:123], v[8:11]
  ds_read_b128 v[140:143], v62 offset:8192
  v_mfma_f32_16x16x32_bf16 v[20:23], v[80:83], v[120:123], v[20:23]
  ds_read_b128 v[96:99], v66 offset:45056
  v_mfma_f32_16x16x32_bf16 v[12:15], v[72:75], v[124:127], v[12:15]
  ds_read_b128 v[100:103], v66 offset:46080
  v_mfma_f32_16x16x32_bf16 v[16:19], v[76:79], v[124:127], v[16:19]
  ds_read_b128 v[104:107], v68 offset:45056
  v_mfma_f32_16x16x32_bf16 v[4:7], v[84:87], v[128:131], v[4:7]
  ds_read_b128 v[144:147], v61 offset:9216
  v_mfma_f32_16x16x32_bf16 v[8:11], v[88:91], v[128:131], v[8:11]
  ds_read_b128 v[148:151], v62 offset:9216
  v_mfma_f32_16x16x32_bf16 v[20:23], v[92:95], v[128:131], v[20:23]
  ds_read_b128 v[108:111], v66 offset:49664
  v_mfma_f32_16x16x32_bf16 v[12:15], v[84:87], v[132:135], v[12:15]
  ds_read_b128 v[112:115], v66 offset:50688
  v_mfma_f32_16x16x32_bf16 v[16:19], v[88:91], v[132:135], v[16:19]
  ds_read_b128 v[116:119], v68 offset:49664
  s_waitcnt lgkmcnt(0)
  s_barrier
  v_mfma_f32_16x16x32_bf16 v[4:7], v[96:99], v[136:139], v[4:7]
  ds_read_b128 v[120:123], v61 offset:16384
  v_mfma_f32_16x16x32_bf16 v[8:11], v[100:103], v[136:139], v[8:11]
  ds_read_b128 v[124:127], v62 offset:16384
  v_mfma_f32_16x16x32_bf16 v[20:23], v[104:107], v[136:139], v[20:23]
  ds_read_b128 v[72:75], v66 offset:54272
  v_mfma_f32_16x16x32_bf16 v[12:15], v[96:99], v[140:143], v[12:15]
  ds_read_b128 v[76:79], v66 offset:55296
  v_mfma_f32_16x16x32_bf16 v[16:19], v[100:103], v[140:143], v[16:19]
  ds_read_b128 v[80:83], v68 offset:54272
  v_mfma_f32_16x16x32_bf16 v[4:7], v[108:111], v[144:147], v[4:7]
  ds_read_b128 v[128:131], v61 offset:17408
  v_mfma_f32_16x16x32_bf16 v[8:11], v[112:115], v[144:147], v[8:11]
  ds_read_b128 v[132:135], v62 offset:17408
  v_mfma_f32_16x16x32_bf16 v[20:23], v[116:119], v[144:147], v[20:23]
  ds_read_b128 v[84:87], v66 offset:58880
  v_mfma_f32_16x16x32_bf16 v[12:15], v[108:111], v[148:151], v[12:15]
  ds_read_b128 v[88:91], v66 offset:59904
  v_mfma_f32_16x16x32_bf16 v[16:19], v[112:115], v[148:151], v[16:19]
  ds_read_b128 v[92:95], v68 offset:58880
  s_waitcnt lgkmcnt(0)
  s_barrier
  v_mfma_f32_16x16x32_bf16 v[4:7], v[72:75], v[120:123], v[4:7]
  ds_read_b128 v[136:139], v61 offset:24576
  v_mfma_f32_16x16x32_bf16 v[8:11], v[76:79], v[120:123], v[8:11]
  ds_read_b128 v[140:143], v62 offset:24576
  v_mfma_f32_16x16x32_bf16 v[20:23], v[80:83], v[120:123], v[20:23]
  ds_read_b128 v[96:99], v66 offset:8192
  v_mfma_f32_16x16x32_bf16 v[12:15], v[72:75], v[124:127], v[12:15]
  ds_read_b128 v[100:103], v66 offset:9216
  v_mfma_f32_16x16x32_bf16 v[16:19], v[76:79], v[124:127], v[16:19]
  ds_read_b128 v[104:107], v68 offset:8192
  v_mfma_f32_16x16x32_bf16 v[4:7], v[84:87], v[128:131], v[4:7]
  ds_read_b128 v[144:147], v61 offset:25600
  v_mfma_f32_16x16x32_bf16 v[8:11], v[88:91], v[128:131], v[8:11]
  ds_read_b128 v[148:151], v62 offset:25600
  v_mfma_f32_16x16x32_bf16 v[20:23], v[92:95], v[128:131], v[20:23]
  ds_read_b128 v[108:111], v66 offset:12800
  v_mfma_f32_16x16x32_bf16 v[12:15], v[84:87], v[132:135], v[12:15]
  ds_read_b128 v[112:115], v66 offset:13824
  v_mfma_f32_16x16x32_bf16 v[16:19], v[88:91], v[132:135], v[16:19]
  ds_read_b128 v[116:119], v68 offset:12800
  s_waitcnt lgkmcnt(0)
  s_barrier
  v_mfma_f32_16x16x32_bf16 v[4:7], v[96:99], v[136:139], v[4:7]
  ds_read_b128 v[120:123], v61 offset:32768
  v_mfma_f32_16x16x32_bf16 v[8:11], v[100:103], v[136:139], v[8:11]
  ds_read_b128 v[124:127], v62 offset:32768
  v_mfma_f32_16x16x32_bf16 v[20:23], v[104:107], v[136:139], v[20:23]
  ds_read_b128 v[72:75], v66 offset:17408
  v_mfma_f32_16x16x32_bf16 v[12:15], v[96:99], v[140:143], v[12:15]
  ds_read_b128 v[76:79], v66 offset:18432
  v_mfma_f32_16x16x32_bf16 v[16:19], v[100:103], v[140:143], v[16:19]
  ds_read_b128 v[80:83], v68 offset:17408
  v_mfma_f32_16x16x32_bf16 v[4:7], v[108:111], v[144:147], v[4:7]
  ds_read_b128 v[128:131], v61 offset:33792
  v_mfma_f32_16x16x32_bf16 v[8:11], v[112:115], v[144:147], v[8:11]
  ds_read_b128 v[132:135], v62 offset:33792
  v_mfma_f32_16x16x32_bf16 v[20:23], v[116:119], v[144:147], v[20:23]
  ds_read_b128 v[84:87], v66 offset:22016
  v_mfma_f32_16x16x32_bf16 v[12:15], v[108:111], v[148:151], v[12:15]
  ds_read_b128 v[88:91], v66 offset:23040
  v_mfma_f32_16x16x32_bf16 v[16:19], v[112:115], v[148:151], v[16:19]
  ds_read_b128 v[92:95], v68 offset:22016
  s_waitcnt lgkmcnt(0)
  s_barrier
  v_mfma_f32_16x16x32_bf16 v[4:7], v[72:75], v[120:123], v[4:7]
  ds_read_b128 v[136:139], v61 offset:40960
  v_mfma_f32_16x16x32_bf16 v[8:11], v[76:79], v[120:123], v[8:11]
  ds_read_b128 v[140:143], v62 offset:40960
  v_mfma_f32_16x16x32_bf16 v[20:23], v[80:83], v[120:123], v[20:23]
  ds_read_b128 v[96:99], v66 offset:26624
  v_mfma_f32_16x16x32_bf16 v[12:15], v[72:75], v[124:127], v[12:15]
  ds_read_b128 v[100:103], v66 offset:27648
  v_mfma_f32_16x16x32_bf16 v[16:19], v[76:79], v[124:127], v[16:19]
  ds_read_b128 v[104:107], v68 offset:26624
  v_mfma_f32_16x16x32_bf16 v[4:7], v[84:87], v[128:131], v[4:7]
  ds_read_b128 v[144:147], v61 offset:41984
  v_mfma_f32_16x16x32_bf16 v[8:11], v[88:91], v[128:131], v[8:11]
  ds_read_b128 v[148:151], v62 offset:41984
  v_mfma_f32_16x16x32_bf16 v[20:23], v[92:95], v[128:131], v[20:23]
  ds_read_b128 v[108:111], v66 offset:31232
  v_mfma_f32_16x16x32_bf16 v[12:15], v[84:87], v[132:135], v[12:15]
  ds_read_b128 v[112:115], v66 offset:32256
  v_mfma_f32_16x16x32_bf16 v[16:19], v[88:91], v[132:135], v[16:19]
  ds_read_b128 v[116:119], v68 offset:31232
  s_waitcnt lgkmcnt(0)
  v_mfma_f32_16x16x32_bf16 v[4:7], v[96:99], v[136:139], v[4:7]
  v_mfma_f32_16x16x32_bf16 v[8:11], v[100:103], v[136:139], v[8:11]
  v_mfma_f32_16x16x32_bf16 v[20:23], v[104:107], v[136:139], v[20:23]
  v_mfma_f32_16x16x32_bf16 v[12:15], v[96:99], v[140:143], v[12:15]
  v_mfma_f32_16x16x32_bf16 v[16:19], v[100:103], v[140:143], v[16:19]
  v_mfma_f32_16x16x32_bf16 v[4:7], v[108:111], v[144:147], v[4:7]
  v_mfma_f32_16x16x32_bf16 v[8:11], v[112:115], v[144:147], v[8:11]
  v_mfma_f32_16x16x32_bf16 v[20:23], v[116:119], v[144:147], v[20:23]
  v_mfma_f32_16x16x32_bf16 v[12:15], v[108:111], v[148:151], v[12:15]
  v_mfma_f32_16x16x32_bf16 v[16:19], v[112:115], v[148:151], v[16:19]
  s_mov_b32 s16, s8
  s_mov_b32 s17, s9
  s_mov_b32 s18, 0x240000
  s_mov_b32 s19, 0x20000
  v_permlane32_swap_b32 v4, v6
  v_permlane32_swap_b32 v5, v7
  v_permlane32_swap_b32 v8, v10
  v_permlane32_swap_b32 v9, v11
  v_permlane32_swap_b32 v12, v14
  v_permlane32_swap_b32 v13, v15
  v_permlane32_swap_b32 v16, v18
  v_permlane32_swap_b32 v17, v19
  v_permlane16_swap_b32 v4, v5
  v_permlane16_swap_b32 v6, v7
  v_permlane16_swap_b32 v8, v9
  v_permlane16_swap_b32 v10, v11
  v_permlane16_swap_b32 v12, v13
  v_permlane16_swap_b32 v14, v15
  v_permlane16_swap_b32 v16, v17
  v_permlane16_swap_b32 v18, v19
  s_waitcnt vmcnt(0)
  v_lshlrev_b32 v48, 16, v24
  v_and_b32 v49, 0xffff0000, v24
  v_lshlrev_b32 v50, 16, v25
  v_and_b32 v51, 0xffff0000, v25
  v_lshlrev_b32 v52, 16, v26
  v_and_b32 v53, 0xffff0000, v26
  v_lshlrev_b32 v54, 16, v27
  v_and_b32 v55, 0xffff0000, v27
  v_pk_fma_f32 v[48:49], v[36:37], v[4:5], v[48:49]
  v_pk_fma_f32 v[50:51], v[38:39], v[6:7], v[50:51]
  v_pk_fma_f32 v[52:53], v[40:41], v[8:9], v[52:53]
  v_pk_fma_f32 v[54:55], v[42:43], v[10:11], v[54:55]
  v_cvt_pk_bf16_f32 v24, v48, v49
  v_cvt_pk_bf16_f32 v25, v50, v51
  v_cvt_pk_bf16_f32 v26, v52, v53
  v_cvt_pk_bf16_f32 v27, v54, v55
  buffer_store_dwordx4 v[24:27], v63, s[16:19], 0 offen
  v_lshlrev_b32 v48, 16, v28
  v_and_b32 v49, 0xffff0000, v28
  v_lshlrev_b32 v50, 16, v29
  v_and_b32 v51, 0xffff0000, v29
  v_lshlrev_b32 v52, 16, v30
  v_and_b32 v53, 0xffff0000, v30
  v_lshlrev_b32 v54, 16, v31
  v_and_b32 v55, 0xffff0000, v31
  v_pk_fma_f32 v[48:49], v[36:37], v[12:13], v[48:49]
  v_pk_fma_f32 v[50:51], v[38:39], v[14:15], v[50:51]
  v_pk_fma_f32 v[52:53], v[40:41], v[16:17], v[52:53]
  v_pk_fma_f32 v[54:55], v[42:43], v[18:19], v[54:55]
  v_cvt_pk_bf16_f32 v28, v48, v49
  v_cvt_pk_bf16_f32 v29, v50, v51
  v_cvt_pk_bf16_f32 v30, v52, v53
  v_cvt_pk_bf16_f32 v31, v54, v55
  buffer_store_dwordx4 v[28:31], v64, s[16:19], 0 offen
  v_lshlrev_b32 v48, 16, v32
  v_and_b32 v49, 0xffff0000, v32
  v_lshlrev_b32 v50, 16, v33
  v_and_b32 v51, 0xffff0000, v33
  v_pk_fma_f32 v[48:49], v[44:45], v[20:21], v[48:49]
  v_pk_fma_f32 v[50:51], v[46:47], v[22:23], v[50:51]
  v_cvt_pk_bf16_f32 v32, v48, v49
  v_cvt_pk_bf16_f32 v33, v50, v51
  buffer_store_dwordx2 v[32:33], v56, s[16:19], 0 offen offset:128
  s_endpgm
L_c_end:
L_k57_prod:
  s_sub_u32 s14, s10, 4
  s_lshl_b32 s15, s11, 3
  s_lshl_b32 s24, s14, 1
  s_add_u32 s15, s15, s24
  s_mul_i32 s25, s15, 18432
  v_lshl_add_u32 v6, v1, 4, s25
  v_add_u32 v7, 18432, v6
  s_mul_i32 s24, s14, 4608
  s_mul_i32 s25, s12, 165888
  s_add_u32 s25, s25, s24
  v_lshl_add_u32 v8, v1, 4, s25
  s_add_u32 s24, s24, 65536
  s_lshl_b32 s23, s14, 12
  s_waitcnt lgkmcnt(0)
  s_add_u32 s28, s6, 0xbcd000
  s_addc_u32 s29, s7, 0
  s_mov_b32 s30, 0x510000
  s_mov_b32 s31, 0x20000
  s_add_u32 s32, s6, 0x15a5000
  s_addc_u32 s33, s7, 0
  s_mov_b32 s34, 0x240000
  s_mov_b32 s35, 0x20000
  s_add_u32 s64, s6, 0x2148000
  s_addc_u32 s65, s7, 0
  s_mov_b32 s66, 0x10000
  s_mov_b32 s67, 0x20000
  v_mov_b32 v32, 0
  s_lshr_b32 s13, s15, 1
  s_lshl_b32 s13, s13, 7
  s_add_u32 s13, s13, 24576
  s_cmp_eq_u32 s69, 0
  s_cbranch_scc1 L_k57_nok
  s_barrier
L_k57_nok:
  s_mov_b32 s26, 2654208
  s_add_u32 m0, s24, 0
  s_bfm_b64 exec, 32, 0
  buffer_load_dwordx4 v8, s[28:31], s26 offen sc1 lds
  s_mov_b64 exec, -1
  buffer_load_dwordx4 v8, s[28:31], s26 offen offset:512 sc1 lds
  buffer_load_dwordx4 v8, s[28:31], s26 offen offset:1536 sc1 lds
  buffer_load_dwordx4 v8, s[28:31], s26 offen offset:2560 sc1 lds
  buffer_load_dwordx4 v8, s[28:31], s26 offen offset:3584 sc1 lds
  s_mov_b32 s26, 2672640
  s_add_u32 m0, s24, 18432
  s_bfm_b64 exec, 32, 0
  buffer_load_dwordx4 v8, s[28:31], s26 offen sc1 lds
  s_mov_b64 exec, -1
  buffer_load_dwordx4 v8, s[28:31], s26 offen offset:512 sc1 lds
  buffer_load_dwordx4 v8, s[28:31], s26 offen offset:1536 sc1 lds
  buffer_load_dwordx4 v8, s[28:31], s26 offen offset:2560 sc1 lds
  buffer_load_dwordx4 v8, s[28:31], s26 offen offset:3584 sc1 lds
  s_mov_b32 s26, 2691072
  s_add_u32 m0, s24, 36864
  s_bfm_b64 exec, 32, 0
  buffer_load_dwordx4 v8, s[28:31], s26 offen sc1 lds
  s_mov_b64 exec, -1
  buffer_load_dwordx4 v8, s[28:31], s26 offen offset:512 sc1 lds
  buffer_load_dwordx4 v8, s[28:31], s26 offen offset:1536 sc1 lds
  buffer_load_dwordx4 v8, s[28:31], s26 offen offset:2560 sc1 lds
  buffer_load_dwordx4 v8, s[28:31], s26 offen offset:3584 sc1 lds
  s_mov_b32 s26, 2709504
  s_add_u32 m0, s24, 55296
  s_bfm_b64 exec, 32, 0
  buffer_load_dwordx4 v8, s[28:31], s26 offen sc1 lds
  s_mov_b64 exec, -1
  buffer_load_dwordx4 v8, s[28:31], s26 offen offset:512 sc1 lds
  buffer_load_dwordx4 v8, s[28:31], s26 offen offset:1536 sc1 lds
  buffer_load_dwordx4 v8, s[28:31], s26 offen offset:2560 sc1 lds
  buffer_load_dwordx4 v8, s[28:31], s26 offen offset:3584 sc1 lds
  v_mov_b32 v33, 0x7fffffff
  s_bfm_b64 exec, 1, 0
  v_mov_b32 v33, 0
  buffer_atomic_add v33, v32, s[64:67], s13 offen sc0 sc1
  s_mov_b64 exec, -1
  s_waitcnt vmcnt(0)
  s_mov_b32 s26, 0x40000
L_k57_poll4_chk:
  v_readfirstlane_b32 s25, v33
  s_nop 0
  s_cmp_ge_u32 s25, 12
  s_cbranch_scc1 L_k57_poll4_ok
  s_sub_u32 s26, s26, 1
  s_cbranch_scc1 L_k57_poll4_ok
  s_sleep 4
  v_mov_b32 v33, 0x7fffffff
  s_bfm_b64 exec, 1, 0
  v_mov_b32 v33, 0
  buffer_atomic_add v33, v32, s[64:67], s13 offen sc0 sc1
  s_mov_b64 exec, -1
  s_waitcnt vmcnt(0)
  s_branch L_k57_poll4_chk
L_k57_poll4_ok:
  s_mov_b32 s25, 0
  s_add_u32 m0, s23, 0
  s_nop 0
  buffer_load_dwordx4 v6, s[32:35], s25 offen sc1 lds
  buffer_load_dwordx4 v6, s[32:35], s25 offen offset:1024 sc1 lds
  s_add_u32 m0, s23, 2048
  s_nop 0
  buffer_load_dwordx4 v7, s[32:35], s25 offen sc1 lds
  buffer_load_dwordx4 v7, s[32:35], s25 offen offset:1024 sc1 lds
  s_mov_b32 s25, 2048
  s_add_u32 m0, s23, 16384
  s_nop 0
  buffer_load_dwordx4 v6, s[32:35], s25 offen sc1 lds
  buffer_load_dwordx4 v6, s[32:35], s25 offen offset:1024 sc1 lds
  s_add_u32 m0, s23, 18432
  s_nop 0
  buffer_load_dwordx4 v7, s[32:35], s25 offen sc1 lds
  buffer_load_dwordx4 v7, s[32:35], s25 offen offset:1024 sc1 lds
  s_mov_b32 s25, 4096
  s_add_u32 m0, s23, 32768
  s_nop 0
  buffer_load_dwordx4 v6, s[32:35], s25 offen sc1 lds
  buffer_load_dwordx4 v6, s[32:35], s25 offen offset:1024 sc1 lds
  s_add_u32 m0, s23, 34816
  s_nop 0
  buffer_load_dwordx4 v7, s[32:35], s25 offen sc1 lds
  buffer_load_dwordx4 v7, s[32:35], s25 offen offset:1024 sc1 lds
  s_waitcnt vmcnt(8)
  s_barrier
  s_mov_b32 s25, 6144
  s_add_u32 m0, s23, 49152
  s_nop 0
  buffer_load_dwordx4 v6, s[32:35], s25 offen sc1 lds
  buffer_load_dwordx4 v6, s[32:35], s25 offen offset:1024 sc1 lds
  s_add_u32 m0, s23, 51200
  s_nop 0
  buffer_load_dwordx4 v7, s[32:35], s25 offen sc1 lds
  buffer_load_dwordx4 v7, s[32:35], s25 offen offset:1024 sc1 lds
  s_add_u32 s36, s6, 0x1806000
  s_addc_u32 s37, s7, 0
  s_mov_b32 s38, 0x900000
  s_mov_b32 s39, 0x20000
  s_mov_b32 s40, s62
  s_mov_b32 s41, s63
  s_mov_b32 s42, 0x800000
  s_mov_b32 s43, 0x20000
  s_add_u32 s44, s6, 0x17fd000
  s_addc_u32 s45, s7, 0
  s_mov_b32 s46, 0x9000
  s_mov_b32 s47, 0x20000
  s_add_u32 s48, s6, 0x17e5000
  s_addc_u32 s49, s7, 0
  s_mov_b32 s50, 0x18000
  s_mov_b32 s51, 0x20000
  s_mov_b32 s56, s4
  s_mov_b32 s57, s5
  s_mov_b32 s58, 0x1000
  s_mov_b32 s59, 0x20000
  s_lshl_b32 s13, s12, 7
  s_mul_i32 s25, s12, 589824
  s_mul_i32 s26, s14, 4608
  s_add_u32 s25, s25, s26
  v_lshl_add_u32 v11, v1, 4, s25
  v_lshrrev_b32 v4, 3, v1
  v_lshrrev_b32 v5, 5, v1
  v_and_b32 v28, 3, v4
  v_lshl_add_u32 v5, v5, 3, v28
  s_lshl_b32 s25, s15, 4
  v_add_lshl_u32 v5, v5, s25, 12
  v_lshrrev_b32 v4, 1, v4
  v_and_b32 v28, 7, v1
  v_xor_b32 v4, v4, v28
  v_lshl_add_u32 v9, v4, 4, v5
  v_xor_b32 v10, 64, v9
  v_add_u32 v10, 65536, v10
  s_mul_i32 s22, s14, 576
  s_add_u32 s22, s22, 139264
  s_and_b32 s25, s14, 1
  s_mul_i32 s25, s25, 18432
  s_lshr_b32 s26, s14, 1
  s_xor_b32 s26, s26, 1
  s_lshl_b32 s26, s26, 4
  s_add_u32 s26, s26, s12
  s_lshl_b32 s21, s26, 7
  s_add_u32 s21, s21, 2048
  s_mul_i32 s26, s26, 576
  s_add_u32 s25, s25, s26
  v_lshl_add_u32 v12, v1, 4, s25
  v_and_b32 v2, 31, v1
  s_lshl_b32 s25, s15, 4
  v_add_u32 v13, s25, v2
  v_lshlrev_b32 v4, 3, v13
  s_add_u32 s52, s6, 0x2106000
  s_addc_u32 s53, s7, 0
  s_mov_b32 s54, 0x40000
  s_mov_b32 s55, 0x20000
  v_lshrrev_b32 v5, 5, v1
  v_lshl_add_u32 v54, v5, 17, v4
  s_mov_b32 s25, 0
  buffer_load_dwordx2 v[16:17], v4, s[48:51], s25 offen sc1
  s_mov_b32 s25, 16384
  buffer_load_dwordx2 v[18:19], v4, s[48:51], s25 offen sc1
  s_mov_b32 s25, 32768
  buffer_load_dwordx2 v[20:21], v4, s[48:51], s25 offen sc1
  s_mov_b32 s25, 49152
  buffer_load_dwordx2 v[22:23], v4, s[48:51], s25 offen sc1
  s_mov_b32 s25, 65536
  buffer_load_dwordx2 v[24:25], v4, s[48:51], s25 offen sc1
  s_mov_b32 s25, 81920
  buffer_load_dwordx2 v[26:27], v4, s[48:51], s25 offen sc1
  v_lshlrev_b32 v4, 1, v13
  buffer_load_ushort v28, v4, s[56:59], 0 offen
  s_waitcnt vmcnt(15)
  s_barrier
  s_mov_b32 s25, 8192
  s_add_u32 m0, s23, 144384
  s_nop 0
  buffer_load_dwordx4 v6, s[32:35], s25 offen sc1 lds
  buffer_load_dwordx4 v6, s[32:35], s25 offen offset:1024 sc1 lds
  s_add_u32 m0, s23, 146432
  s_nop 0
  buffer_load_dwordx4 v7, s[32:35], s25 offen sc1 lds
  buffer_load_dwordx4 v7, s[32:35], s25 offen offset:1024 sc1 lds
  s_mov_b32 s26, 2727936
  s_add_u32 m0, s24, 0
  s_bfm_b64 exec, 32, 0
  buffer_load_dwordx4 v8, s[28:31], s26 offen sc1 lds
  s_mov_b64 exec, -1
  buffer_load_dwordx4 v8, s[28:31], s26 offen offset:512 sc1 lds
  buffer_load_dwordx4 v8, s[28:31], s26 offen offset:1536 sc1 lds
  buffer_load_dwordx4 v8, s[28:31], s26 offen offset:2560 sc1 lds
  buffer_load_dwordx4 v8, s[28:31], s26 offen offset:3584 sc1 lds
  s_waitcnt vmcnt(20)
  s_barrier
  s_mov_b32 s25, 10240
  s_add_u32 m0, s23, 16384
  s_nop 0
  buffer_load_dwordx4 v6, s[32:35], s25 offen sc1 lds
  buffer_load_dwordx4 v6, s[32:35], s25 offen offset:1024 sc1 lds
  s_add_u32 m0, s23, 18432
  s_nop 0
  buffer_load_dwordx4 v7, s[32:35], s25 offen sc1 lds
  buffer_load_dwordx4 v7, s[32:35], s25 offen offset:1024 sc1 lds
  s_mov_b32 s26, 2746368
  s_add_u32 m0, s24, 18432
  s_bfm_b64 exec, 32, 0
  buffer_load_dwordx4 v8, s[28:31], s26 offen sc1 lds
  s_mov_b64 exec, -1
  buffer_load_dwordx4 v8, s[28:31], s26 offen offset:512 sc1 lds
  buffer_load_dwordx4 v8, s[28:31], s26 offen offset:1536 sc1 lds
  buffer_load_dwordx4 v8, s[28:31], s26 offen offset:2560 sc1 lds
  buffer_load_dwordx4 v8, s[28:31], s26 offen offset:3584 sc1 lds
  s_lshr_b32 s86, s2, 3
  s_lshl_b32 s86, s86, 2
  s_add_u32 s86, s86, s14
  v_lshlrev_b32 v56, 2, v1
  s_getpc_b64 s[88:89]
L_pcc2:
  s_sub_u32 s88, s88, L_pcc2 - L_c_geluz
  s_subb_u32 s89, s89, 0
  s_mov_b32 s90, L_c_gelua - L_c_geluz
  s_mov_b32 s91, 0x20000
  s_lshl_b32 s92, s86, 8
  buffer_load_dword v55, v56, s[88:91], s92 offen
  s_waitcnt vmcnt(26)
  s_barrier
  s_mov_b32 s25, 12288
  s_add_u32 m0, s23, 32768
  s_nop 0
  buffer_load_dwordx4 v6, s[32:35], s25 offen sc1 lds
  buffer_load_dwordx4 v6, s[32:35], s25 offen offset:1024 sc1 lds
  s_add_u32 m0, s23, 34816
  s_nop 0
  buffer_load_dwordx4 v7, s[32:35], s25 offen sc1 lds
  buffer_load_dwordx4 v7, s[32:35], s25 offen offset:1024 sc1 lds
  s_mov_b32 s26, 2764800
  s_add_u32 m0, s24, 36864
  s_bfm_b64 exec, 32, 0
  buffer_load_dwordx4 v8, s[28:31], s26 offen sc1 lds
  s_mov_b64 exec, -1
  buffer_load_dwordx4 v8, s[28:31], s26 offen offset:512 sc1 lds
  buffer_load_dwordx4 v8, s[28:31], s26 offen offset:1536 sc1 lds
  buffer_load_dwordx4 v8, s[28:31], s26 offen offset:2560 sc1 lds
  buffer_load_dwordx4 v8, s[28:31], s26 offen offset:3584 sc1 lds
  s_waitcnt vmcnt(28)
  v_add_f32 v16, v16, v18
  v_add_f32 v17, v17, v19
  v_add_f32 v16, v16, v20
  v_add_f32 v17, v17, v21
  v_add_f32 v16, v16, v22
  v_add_f32 v17, v17, v23
  v_add_f32 v16, v16, v24
  v_add_f32 v17, v17, v25
  v_add_f32 v16, v16, v26
  v_add_f32 v17, v17, v27
  v_mul_f32 v16, 0x3ae38e39, v16
  v_mul_f32 v20, v16, v16
  v_mov_b32 v18, 0x3ae38e39
  v_fma_f32 v20, v17, v18, -v20
  v_max_f32 v20, 0, v20
  v_add_f32 v20, 0x3727c5ac, v20
  v_rsq_f32 v18, v20
  s_nop 0
  v_mul_f32 v19, v16, v18
  v_sub_f32 v19, 0, v19
  v_lshlrev_b32 v28, 16, v28
  s_lshl_b32 s25, s14, 7
  s_add_u32 s25, s25, 141568
  v_lshl_add_u32 v5, v2, 2, s25
  ds_write_b32 v5, v18
  ds_write_b32 v5, v19 offset:512
  ds_write_b32 v5, v28 offset:1024
  s_waitcnt lgkmcnt(0)
  s_waitcnt vmcnt(19)
  s_barrier
  v_mov_b32 v33, 0x7fffffff
  s_bfm_b64 exec, 1, 0
  v_mov_b32 v33, 0
  buffer_atomic_add v33, v32, s[64:67], s21 offen sc0 sc1
  s_mov_b64 exec, -1
  s_mov_b32 s25, 14336
  s_add_u32 m0, s23, 49152
  s_nop 0
  buffer_load_dwordx4 v6, s[32:35], s25 offen sc1 lds
  buffer_load_dwordx4 v6, s[32:35], s25 offen offset:1024 sc1 lds
  s_add_u32 m0, s23, 51200
  s_nop 0
  buffer_load_dwordx4 v7, s[32:35], s25 offen sc1 lds
  buffer_load_dwordx4 v7, s[32:35], s25 offen offset:1024 sc1 lds
  s_mov_b32 s26, 2783232
  s_add_u32 m0, s24, 55296
  s_bfm_b64 exec, 32, 0
  buffer_load_dwordx4 v8, s[28:31], s26 offen sc1 lds
  s_mov_b64 exec, -1
  buffer_load_dwordx4 v8, s[28:31], s26 offen offset:512 sc1 lds
  buffer_load_dwordx4 v8, s[28:31], s26 offen offset:1536 sc1 lds
  buffer_load_dwordx4 v8, s[28:31], s26 offen offset:2560 sc1 lds
  buffer_load_dwordx4 v8, s[28:31], s26 offen offset:3584 sc1 lds
  s_waitcnt vmcnt(20)
  s_barrier
  s_waitcnt vmcnt(9)
  s_mov_b32 s26, 0x40000
L_k57_pollu_chk:
  v_readfirstlane_b32 s25, v33
  s_nop 0
  s_cmp_ge_u32 s25, 9
  s_cbranch_scc1 L_k57_pollu_ok
  s_sub_u32 s26, s26, 1
  s_cbranch_scc1 L_k57_pollu_ok
  s_sleep 4
  v_mov_b32 v33, 0x7fffffff
  s_bfm_b64 exec, 1, 0
  v_mov_b32 v33, 0
  buffer_atomic_add v33, v32, s[64:67], s21 offen sc0 sc1
  s_mov_b64 exec, -1
  s_waitcnt vmcnt(0)
  s_branch L_k57_pollu_chk
L_k57_pollu_ok:
  s_add_u32 m0, s22, 0
  s_bfm_b64 exec, 36, 0
  buffer_load_dwordx4 v12, s[44:47], 0 offen sc1 lds
  s_mov_b64 exec, -1
  s_mov_b32 s25, 16384
  s_add_u32 m0, s23, 0
  s_nop 0
  buffer_load_dwordx4 v6, s[32:35], s25 offen sc1 lds
  buffer_load_dwordx4 v6, s[32:35], s25 offen offset:1024 sc1 lds
  s_add_u32 m0, s23, 2048
  s_nop 0
  buffer_load_dwordx4 v7, s[32:35], s25 offen sc1 lds
  buffer_load_dwordx4 v7, s[32:35], s25 offen offset:1024 sc1 lds
  s_mov_b32 s26, 2801664
  s_add_u32 m0, s24, 0
  s_bfm_b64 exec, 32, 0
  buffer_load_dwordx4 v8, s[28:31], s26 offen sc1 lds
  s_mov_b64 exec, -1
  buffer_load_dwordx4 v8, s[28:31], s26 offen offset:512 sc1 lds
  buffer_load_dwordx4 v8, s[28:31], s26 offen offset:1536 sc1 lds
  buffer_load_dwordx4 v8, s[28:31], s26 offen offset:2560 sc1 lds
  buffer_load_dwordx4 v8, s[28:31], s26 offen offset:3584 sc1 lds
  s_barrier
  s_mov_b32 s26, 92160
  s_add_u32 m0, s24, 18432
  s_bfm_b64 exec, 32, 0
  buffer_load_dwordx4 v8, s[28:31], s26 offen sc1 lds
  s_mov_b64 exec, -1
  buffer_load_dwordx4 v8, s[28:31], s26 offen offset:512 sc1 lds
  buffer_load_dwordx4 v8, s[28:31], s26 offen offset:1536 sc1 lds
  buffer_load_dwordx4 v8, s[28:31], s26 offen offset:2560 sc1 lds
  buffer_load_dwordx4 v8, s[28:31], s26 offen offset:3584 sc1 lds
  s_waitcnt vmcnt(15)
  s_barrier
  s_mov_b32 s26, 110592
  s_add_u32 m0, s24, 36864
  s_bfm_b64 exec, 32, 0
  buffer_load_dwordx4 v8, s[28:31], s26 offen sc1 lds
  s_mov_b64 exec, -1
  buffer_load_dwordx4 v8, s[28:31], s26 offen offset:512 sc1 lds
  buffer_load_dwordx4 v8, s[28:31], s26 offen offset:1536 sc1 lds
  buffer_load_dwordx4 v8, s[28:31], s26 offen offset:2560 sc1 lds
  buffer_load_dwordx4 v8, s[28:31], s26 offen offset:3584 sc1 lds
  s_waitcnt vmcnt(10)
  s_barrier
  s_mov_b32 s26, 129024
  s_add_u32 m0, s24, 55296
  s_bfm_b64 exec, 32, 0
  buffer_load_dwordx4 v8, s[28:31], s26 offen sc1 lds
  s_mov_b64 exec, -1
  buffer_load_dwordx4 v8, s[28:31], s26 offen offset:512 sc1 lds
  buffer_load_dwordx4 v8, s[28:31], s26 offen offset:1536 sc1 lds
  buffer_load_dwordx4 v8, s[28:31], s26 offen offset:2560 sc1 lds
  buffer_load_dwordx4 v8, s[28:31], s26 offen offset:3584 sc1 lds
  s_waitcnt vmcnt(10)
  s_barrier
  s_mov_b32 s26, 147456
  s_add_u32 m0, s24, 0
  s_bfm_b64 exec, 32, 0
  buffer_load_dwordx4 v8, s[28:31], s26 offen sc1 lds
  s_mov_b64 exec, -1
  buffer_load_dwordx4 v8, s[28:31], s26 offen offset:512 sc1 lds
  buffer_load_dwordx4 v8, s[28:31], s26 offen offset:1536 sc1 lds
  buffer_load_dwordx4 v8, s[28:31], s26 offen offset:2560 sc1 lds
  buffer_load_dwordx4 v8, s[28:31], s26 offen offset:3584 sc1 lds
  s_add_u32 s16, s6, 0x10dd000
  s_addc_u32 s17, s7, 0
  s_mov_b32 s18, 0x288000
  s_mov_b32 s19, 0x20000
  s_lshr_b32 s25, s2, 5
  s_mul_i32 s25, s25, 331776
  s_mul_i32 s26, s14, 9216
  s_add_u32 s25, s25, s26
  v_lshlrev_b32 v57, 4, v1
  s_add_u32 s26, s25, 55296
  buffer_load_dwordx4 v[60:63], v57, s[16:19], s26 offen offset:0 sc1
  buffer_load_dwordx4 v[64:67], v57, s[16:19], s26 offen offset:1024 sc1
  buffer_load_dwordx4 v[68:71], v57, s[16:19], s26 offen offset:2048 sc1
  buffer_load_dwordx4 v[72:75], v57, s[16:19], s26 offen offset:3072 sc1
  s_add_u32 s26, s25, 59392
  buffer_load_dwordx4 v[76:79], v57, s[16:19], s26 offen offset:0 sc1
  buffer_load_dwordx4 v[80:83], v57, s[16:19], s26 offen offset:1024 sc1
  buffer_load_dwordx4 v[84:87], v57, s[16:19], s26 offen offset:2048 sc1
  buffer_load_dwordx4 v[88:91], v57, s[16:19], s26 offen offset:3072 sc1
  s_add_u32 s26, s25, 63488
  buffer_load_dwordx4 v[92:95], v57, s[16:19], s26 offen offset:0 sc1
  s_add_u32 s26, s25, 92160
  buffer_load_dwordx4 v[96:99], v57, s[16:19], s26 offen offset:0 sc1
  buffer_load_dwordx4 v[100:103], v57, s[16:19], s26 offen offset:1024 sc1
  buffer_load_dwordx4 v[104:107], v57, s[16:19], s26 offen offset:2048 sc1
  buffer_load_dwordx4 v[108:111], v57, s[16:19], s26 offen offset:3072 sc1
  s_add_u32 s26, s25, 96256
  buffer_load_dwordx4 v[112:115], v57, s[16:19], s26 offen offset:0 sc1
  buffer_load_dwordx4 v[116:119], v57, s[16:19], s26 offen offset:1024 sc1
  buffer_load_dwordx4 v[120:123], v57, s[16:19], s26 offen offset:2048 sc1
  buffer_load_dwordx4 v[124:127], v57, s[16:19], s26 offen offset:3072 sc1
  s_add_u32 s26, s25, 100352
  buffer_load_dwordx4 v[128:131], v57, s[16:19], s26 offen offset:0 sc1
  s_add_u32 s26, s25, 129024
  buffer_load_dwordx4 v[132:135], v57, s[16:19], s26 offen offset:0 sc1
  buffer_load_dwordx4 v[136:139], v57, s[16:19], s26 offen offset:1024 sc1
  buffer_load_dwordx4 v[140:143], v57, s[16:19], s26 offen offset:2048 sc1
  buffer_load_dwordx4 v[144:147], v57, s[16:19], s26 offen offset:3072 sc1
  s_add_u32 s26, s25, 133120
  buffer_load_dwordx4 v[148:151], v57, s[16:19], s26 offen offset:0 sc1
  buffer_load_dwordx4 v[152:155], v57, s[16:19], s26 offen offset:1024 sc1
  buffer_load_dwordx4 v[156:159], v57, s[16:19], s26 offen offset:2048 sc1
  buffer_load_dwordx4 v[160:163], v57, s[16:19], s26 offen offset:3072 sc1
  s_add_u32 s26, s25, 137216
  buffer_load_dwordx4 v[164:167], v57, s[16:19], s26 offen offset:0 sc1
  s_waitcnt vmcnt(37)
  s_barrier
  s_mov_b32 s26, 73728
  s_add_u32 m0, s24, 18432
  s_bfm_b64 exec, 32, 0
  buffer_load_dwordx4 v8, s[28:31], s26 offen sc1 lds
  s_mov_b64 exec, -1
  buffer_load_dwordx4 v8, s[28:31], s26 offen offset:512 sc1 lds
  buffer_load_dwordx4 v8, s[28:31], s26 offen offset:1536 sc1 lds
  buffer_load_dwordx4 v8, s[28:31], s26 offen offset:2560 sc1 lds
  buffer_load_dwordx4 v8, s[28:31], s26 offen offset:3584 sc1 lds
  s_lshr_b32 s86, s2, 3
  s_lshl_b32 s86, s86, 2
  s_add_u32 s86, s86, s14
  v_lshlrev_b32 v56, 2, v1
  s_getpc_b64 s[88:89]
L_pcc10:
  s_sub_u32 s88, s88, L_pcc10 - L_c_gelua
  s_subb_u32 s89, s89, 0
  s_mov_b32 s90, L_c_yepi - L_c_gelua
  s_mov_b32 s91, 0x20000
  s_lshl_b32 s92, s86, 8
  buffer_load_dword v55, v56, s[88:91], s92 offen
  s_getpc_b64 s[88:89]
L_pcp10:
  s_add_u32 s88, s88, L_p_m - L_pcp10
  s_addc_u32 s89, s89, 0
  s_mov_b32 s90, L_p_o - L_p_m
  s_mov_b32 s91, 0x20000
  s_lshl_b32 s92, s86, 8
  buffer_load_dword v55, v56, s[88:91], s92 offen
  s_waitcnt vmcnt(39)
  s_barrier
  s_mov_b32 s26, 0
  buffer_load_dwordx2 v[36:37], v54, s[52:55], s26 offen sc1
  s_mov_b32 s26, 16384
  buffer_load_dwordx2 v[38:39], v54, s[52:55], s26 offen sc1
  s_mov_b32 s26, 32768
  buffer_load_dwordx2 v[40:41], v54, s[52:55], s26 offen sc1
  s_mov_b32 s26, 49152
  buffer_load_dwordx2 v[42:43], v54, s[52:55], s26 offen sc1
  s_mov_b32 s26, 65536
  buffer_load_dwordx2 v[44:45], v54, s[52:55], s26 offen sc1
  s_mov_b32 s26, 81920
  buffer_load_dwordx2 v[46:47], v54, s[52:55], s26 offen sc1
  s_mov_b32 s26, 98304
  buffer_load_dwordx2 v[48:49], v54, s[52:55], s26 offen sc1
  s_mov_b32 s26, 114688
  buffer_load_dwordx2 v[50:51], v54, s[52:55], s26 offen sc1
  s_mov_b32 s25, 0
  s_add_u32 m0, s23, 32768
  s_nop 0
  buffer_load_dwordx4 v6, s[32:35], s25 offen sc1 lds
  buffer_load_dwordx4 v6, s[32:35], s25 offen offset:1024 sc1 lds
  s_add_u32 m0, s23, 34816
  s_nop 0
  buffer_load_dwordx4 v7, s[32:35], s25 offen sc1 lds
  buffer_load_dwordx4 v7, s[32:35], s25 offen offset:1024 sc1 lds
  s_mov_b32 s26, 0
  s_add_u32 m0, s24, 36864
  s_bfm_b64 exec, 32, 0
  buffer_load_dwordx4 v8, s[28:31], s26 offen sc1 lds
  s_mov_b64 exec, -1
  buffer_load_dwordx4 v8, s[28:31], s26 offen offset:512 sc1 lds
  buffer_load_dwordx4 v8, s[28:31], s26 offen offset:1536 sc1 lds
  buffer_load_dwordx4 v8, s[28:31], s26 offen offset:2560 sc1 lds
  buffer_load_dwordx4 v8, s[28:31], s26 offen offset:3584 sc1 lds
  s_mov_b32 s25, 0x20000
  s_waitcnt vmcnt(9)
L_k57_st:
  v_max3_u32 v52, v36, v37, v38
  v_max3_u32 v52, v52, v39, v40
  v_max3_u32 v52, v52, v41, v42
  v_max3_u32 v52, v52, v43, v44
  v_max3_u32 v52, v52, v45, v46
  v_max3_u32 v52, v52, v47, v48
  v_max3_u32 v52, v52, v49, v50
  v_max_u32 v52, v52, v51
  v_cmp_eq_u32 vcc, -1, v52
  s_nop 1
  s_cbranch_vccz L_k57_stok
  s_sub_u32 s25, s25, 1
  s_cbranch_scc1 L_k57_stok
  s_sleep 1
  s_mov_b32 s26, 0
  buffer_load_dwordx2 v[36:37], v54, s[52:55], s26 offen sc1
  s_mov_b32 s26, 16384
  buffer_load_dwordx2 v[38:39], v54, s[52:55], s26 offen sc1
  s_mov_b32 s26, 32768
  buffer_load_dwordx2 v[40:41], v54, s[52:55], s26 offen sc1
  s_mov_b32 s26, 49152
  buffer_load_dwordx2 v[42:43], v54, s[52:55], s26 offen sc1
  s_mov_b32 s26, 65536
  buffer_load_dwordx2 v[44:45], v54, s[52:55], s26 offen sc1
  s_mov_b32 s26, 81920
  buffer_load_dwordx2 v[46:47], v54, s[52:55], s26 offen sc1
  s_mov_b32 s26, 98304
  buffer_load_dwordx2 v[48:49], v54, s[52:55], s26 offen sc1
  s_mov_b32 s26, 114688
  buffer_load_dwordx2 v[50:51], v54, s[52:55], s26 offen sc1
  s_waitcnt vmcnt(0)
  s_branch L_k57_st
L_k57_stok:
  v_add_f32 v36, v36, v38
  v_add_f32 v37, v37, v39
  v_add_f32 v36, v36, v40
  v_add_f32 v37, v37, v41
  v_add_f32 v36, v36, v42
  v_add_f32 v37, v37, v43
  v_add_f32 v36, v36, v44
  v_add_f32 v37, v37, v45
  v_add_f32 v36, v36, v46
  v_add_f32 v37, v37, v47
  v_add_f32 v36, v36, v48
  v_add_f32 v37, v37, v49
  v_add_f32 v36, v36, v50
  v_add_f32 v37, v37, v51
  v_mov_b32 v52, v36
  s_nop 1
  v_permlane32_swap_b32 v36, v52
  v_add_f32 v36, v36, v52
  v_mov_b32 v53, v37
  s_nop 1
  v_permlane32_swap_b32 v37, v53
  v_add_f32 v37, v37, v53
  v_mul_f32 v36, 0x39e38e39, v36
  v_mul_f32 v40, v36, v36
  v_mov_b32 v38, 0x39e38e39
  v_fma_f32 v40, v37, v38, -v40
  v_max_f32 v40, 0, v40
  v_add_f32 v40, 0x3727c5ac, v40
  v_rsq_f32 v38, v40
  s_nop 0
  v_mul_f32 v39, v36, v38
  v_sub_f32 v39, 0, v39
  s_lshl_b32 s25, s14, 8
  s_add_u32 s25, s25, 143104
  v_and_b32 v52, 31, v1
  v_lshl_add_u32 v52, v52, 2, s25
  ds_write_b32 v52, v38
  ds_write_b32 v52, v39 offset:128
  s_waitcnt lgkmcnt(0)
  s_barrier
  s_mov_b32 s25, 2048
  s_add_u32 m0, s23, 49152
  s_nop 0
  buffer_load_dwordx4 v6, s[32:35], s25 offen sc1 lds
  buffer_load_dwordx4 v6, s[32:35], s25 offen offset:1024 sc1 lds
  s_add_u32 m0, s23, 51200
  s_nop 0
  buffer_load_dwordx4 v7, s[32:35], s25 offen sc1 lds
  buffer_load_dwordx4 v7, s[32:35], s25 offen offset:1024 sc1 lds
  s_mov_b32 s26, 18432
  s_add_u32 m0, s24, 55296
  s_bfm_b64 exec, 32, 0
  buffer_load_dwordx4 v8, s[28:31], s26 offen sc1 lds
  s_mov_b64 exec, -1
  buffer_load_dwordx4 v8, s[28:31], s26 offen offset:512 sc1 lds
  buffer_load_dwordx4 v8, s[28:31], s26 offen offset:1536 sc1 lds
  buffer_load_dwordx4 v8, s[28:31], s26 offen offset:2560 sc1 lds
  buffer_load_dwordx4 v8, s[28:31], s26 offen offset:3584 sc1 lds
  s_barrier
  s_mov_b32 s25, 4096
  s_add_u32 m0, s23, 0
  s_nop 0
  buffer_load_dwordx4 v6, s[32:35], s25 offen sc1 lds
  buffer_load_dwordx4 v6, s[32:35], s25 offen offset:1024 sc1 lds
  s_add_u32 m0, s23, 2048
  s_nop 0
  buffer_load_dwordx4 v7, s[32:35], s25 offen sc1 lds
  buffer_load_dwordx4 v7, s[32:35], s25 offen offset:1024 sc1 lds
  s_mov_b32 s26, 36864
  s_add_u32 m0, s24, 0
  s_bfm_b64 exec, 32, 0
  buffer_load_dwordx4 v8, s[28:31], s26 offen sc1 lds
  s_mov_b64 exec, -1
  buffer_load_dwordx4 v8, s[28:31], s26 offen offset:512 sc1 lds
  buffer_load_dwordx4 v8, s[28:31], s26 offen offset:1536 sc1 lds
  buffer_load_dwordx4 v8, s[28:31], s26 offen offset:2560 sc1 lds
  buffer_load_dwordx4 v8, s[28:31], s26 offen offset:3584 sc1 lds
  s_waitcnt vmcnt(18)
  s_barrier
  s_mov_b32 s25, 6144
  s_add_u32 m0, s23, 16384
  s_nop 0
  buffer_load_dwordx4 v6, s[32:35], s25 offen sc1 lds
  buffer_load_dwordx4 v6, s[32:35], s25 offen offset:1024 sc1 lds
  s_add_u32 m0, s23, 18432
  s_nop 0
  buffer_load_dwordx4 v7, s[32:35], s25 offen sc1 lds
  buffer_load_dwordx4 v7, s[32:35], s25 offen offset:1024 sc1 lds
  s_mov_b32 s26, 55296
  s_add_u32 m0, s24, 18432
  s_bfm_b64 exec, 32, 0
  buffer_load_dwordx4 v8, s[28:31], s26 offen sc1 lds
  s_mov_b64 exec, -1
  buffer_load_dwordx4 v8, s[28:31], s26 offen offset:512 sc1 lds
  buffer_load_dwordx4 v8, s[28:31], s26 offen offset:1536 sc1 lds
  buffer_load_dwordx4 v8, s[28:31], s26 offen offset:2560 sc1 lds
  buffer_load_dwordx4 v8, s[28:31], s26 offen offset:3584 sc1 lds
  s_waitcnt vmcnt(18)
  s_barrier
  s_mov_b32 s27, 0
  s_add_u32 s27, s27, 0
  s_and_b32 s27, s27, 31
  s_lshl_b32 s25, s27, 7
  s_add_u32 s26, s25, 16384
  s_add_u32 m0, s23, 32768
  s_nop 0
  buffer_load_dwordx4 v9, s[40:43], s25 offen lds
  s_add_u32 m0, s23, 33792
  s_nop 0
  buffer_load_dwordx4 v10, s[40:43], s25 offen lds
  s_add_u32 m0, s23, 34816
  s_nop 0
  buffer_load_dwordx4 v9, s[40:43], s26 offen lds
  s_add_u32 m0, s23, 35840
  s_nop 0
  buffer_load_dwordx4 v10, s[40:43], s26 offen lds
  s_waitcnt vmcnt(13)
  s_barrier
  s_cmp_eq_u32 s14, 0
  s_cbranch_scc0 L_k57_nosig
  s_mov_b64 exec, 1
  v_mov_b32 v30, 0
  v_mov_b32 v31, 1
  buffer_atomic_add v31, v30, s[64:67], s13 offen sc1
  s_mov_b64 exec, -1
L_k57_nosig:
  s_mov_b32 s27, 0
  s_add_u32 s27, s27, 1
  s_and_b32 s27, s27, 31
  s_lshl_b32 s25, s27, 7
  s_add_u32 s26, s25, 16384
  s_add_u32 m0, s23, 49152
  s_nop 0
  buffer_load_dwordx4 v9, s[40:43], s25 offen lds
  s_add_u32 m0, s23, 50176
  s_nop 0
  buffer_load_dwordx4 v10, s[40:43], s25 offen lds
  s_add_u32 m0, s23, 51200
  s_nop 0
  buffer_load_dwordx4 v9, s[40:43], s26 offen lds
  s_add_u32 m0, s23, 52224
  s_nop 0
  buffer_load_dwordx4 v10, s[40:43], s26 offen lds
  s_waitcnt vmcnt(8)
  s_barrier
  s_mov_b32 s27, 0
  s_add_u32 s27, s27, 2
  s_and_b32 s27, s27, 31
  s_lshl_b32 s25, s27, 7
  s_add_u32 s26, s25, 16384
  s_add_u32 m0, s23, 0
  s_nop 0
  buffer_load_dwordx4 v9, s[40:43], s25 offen lds
  s_add_u32 m0, s23, 1024
  s_nop 0
  buffer_load_dwordx4 v10, s[40:43], s25 offen lds
  s_add_u32 m0, s23, 2048
  s_nop 0
  buffer_load_dwordx4 v9, s[40:43], s26 offen lds
  s_add_u32 m0, s23, 3072
  s_nop 0
  buffer_load_dwordx4 v10, s[40:43], s26 offen lds
  v_mov_b32 v33, 0x7fffffff
  s_bfm_b64 exec, 1, 0
  v_mov_b32 v33, 0
  buffer_atomic_add v33, v32, s[64:67], s13 offen sc0 sc1
  s_mov_b64 exec, -1
  s_waitcnt vmcnt(0)
  s_mov_b32 s26, 0x40000
L_k57_poll_chk:
  v_readfirstlane_b32 s25, v33
  s_nop 0
  s_cmp_ge_u32 s25, 16
  s_cbranch_scc1 L_k57_poll_ok
  s_sub_u32 s26, s26, 1
  s_cbranch_scc1 L_k57_poll_ok
  s_sleep 1
  v_mov_b32 v33, 0x7fffffff
  s_bfm_b64 exec, 1, 0
  v_mov_b32 v33, 0
  buffer_atomic_add v33, v32, s[64:67], s13 offen sc0 sc1
  s_mov_b64 exec, -1
  s_waitcnt vmcnt(0)
  s_branch L_k57_poll_chk
L_k57_poll_ok:
  s_mov_b32 s27, 0
  s_add_u32 s27, s27, 0
  s_and_b32 s27, s27, 31
  s_mul_i32 s26, s27, 18432
  s_add_u32 m0, s24, 36864
  s_bfm_b64 exec, 32, 0
  buffer_load_dwordx4 v11, s[36:39], s26 offen sc1 lds
  s_mov_b64 exec, -1
  buffer_load_dwordx4 v11, s[36:39], s26 offen offset:512 sc1 lds
  buffer_load_dwordx4 v11, s[36:39], s26 offen offset:1536 sc1 lds
  buffer_load_dwordx4 v11, s[36:39], s26 offen offset:2560 sc1 lds
  buffer_load_dwordx4 v11, s[36:39], s26 offen offset:3584 sc1 lds
  s_mov_b32 s27, 0
  s_add_u32 s27, s27, 1
  s_and_b32 s27, s27, 31
  s_mul_i32 s26, s27, 18432
  s_add_u32 m0, s24, 55296
  s_bfm_b64 exec, 32, 0
  buffer_load_dwordx4 v11, s[36:39], s26 offen sc1 lds
  s_mov_b64 exec, -1
  buffer_load_dwordx4 v11, s[36:39], s26 offen offset:512 sc1 lds
  buffer_load_dwordx4 v11, s[36:39], s26 offen offset:1536 sc1 lds
  buffer_load_dwordx4 v11, s[36:39], s26 offen offset:2560 sc1 lds
  buffer_load_dwordx4 v11, s[36:39], s26 offen offset:3584 sc1 lds
  s_mov_b32 s27, 0
  s_add_u32 s27, s27, 2
  s_and_b32 s27, s27, 31
  s_mul_i32 s26, s27, 18432
  s_add_u32 m0, s24, 0
  s_bfm_b64 exec, 32, 0
  buffer_load_dwordx4 v11, s[36:39], s26 offen sc1 lds
  s_mov_b64 exec, -1
  buffer_load_dwordx4 v11, s[36:39], s26 offen offset:512 sc1 lds
  buffer_load_dwordx4 v11, s[36:39], s26 offen offset:1536 sc1 lds
  buffer_load_dwordx4 v11, s[36:39], s26 offen offset:2560 sc1 lds
  buffer_load_dwordx4 v11, s[36:39], s26 offen offset:3584 sc1 lds
  s_waitcnt vmcnt(10)
  s_barrier
  s_mov_b32 s27, 0
  s_add_u32 s27, s27, 3
  s_and_b32 s27, s27, 31
  s_lshl_b32 s25, s27, 7
  s_add_u32 s26, s25, 16384
  s_add_u32 m0, s23, 16384
  s_nop 0
  buffer_load_dwordx4 v9, s[40:43], s25 offen lds
  s_add_u32 m0, s23, 17408
  s_nop 0
  buffer_load_dwordx4 v10, s[40:43], s25 offen lds
  s_add_u32 m0, s23, 18432
  s_nop 0
  buffer_load_dwordx4 v9, s[40:43], s26 offen lds
  s_add_u32 m0, s23, 19456
  s_nop 0
  buffer_load_dwordx4 v10, s[40:43], s26 offen lds
  s_mov_b32 s27, 0
  s_add_u32 s27, s27, 3
  s_and_b32 s27, s27, 31
  s_mul_i32 s26, s27, 18432
  s_add_u32 m0, s24, 18432
  s_bfm_b64 exec, 32, 0
  buffer_load_dwordx4 v11, s[36:39], s26 offen sc1 lds
  s_mov_b64 exec, -1
  buffer_load_dwordx4 v11, s[36:39], s26 offen offset:512 sc1 lds
  buffer_load_dwordx4 v11, s[36:39], s26 offen offset:1536 sc1 lds
  buffer_load_dwordx4 v11, s[36:39], s26 offen offset:2560 sc1 lds
  buffer_load_dwordx4 v11, s[36:39], s26 offen offset:3584 sc1 lds
L_p_m:
  s_waitcnt vmcnt(14)
  s_barrier
  s_mov_b32 s27, 0
  s_add_u32 s27, s27, 4
  s_and_b32 s27, s27, 31
  s_lshl_b32 s25, s27, 7
  s_add_u32 s26, s25, 16384
  s_add_u32 m0, s23, 32768
  s_nop 0
  buffer_load_dwordx4 v9, s[40:43], s25 offen lds
  s_add_u32 m0, s23, 33792
  s_nop 0
  buffer_load_dwordx4 v10, s[40:43], s25 offen lds
  s_add_u32 m0, s23, 34816
  s_nop 0
  buffer_load_dwordx4 v9, s[40:43], s26 offen lds
  s_add_u32 m0, s23, 35840
  s_nop 0
  buffer_load_dwordx4 v10, s[40:43], s26 offen lds
  s_mov_b32 s27, 0
  s_add_u32 s27, s27, 4
  s_and_b32 s27, s27, 31
  s_mul_i32 s26, s27, 18432
  s_add_u32 m0, s24, 36864
  s_bfm_b64 exec, 32, 0
  buffer_load_dwordx4 v11, s[36:39], s26 offen sc1 lds
  s_mov_b64 exec, -1
  buffer_load_dwordx4 v11, s[36:39], s26 offen offset:512 sc1 lds
  buffer_load_dwordx4 v11, s[36:39], s26 offen offset:1536 sc1 lds
  buffer_load_dwordx4 v11, s[36:39], s26 offen offset:2560 sc1 lds
  buffer_load_dwordx4 v11, s[36:39], s26 offen offset:3584 sc1 lds
  s_waitcnt vmcnt(18)
  s_barrier
  s_mov_b32 s27, 0
  s_add_u32 s27, s27, 5
  s_and_b32 s27, s27, 31
  s_lshl_b32 s25, s27, 7
  s_add_u32 s26, s25, 16384
  s_add_u32 m0, s23, 49152
  s_nop 0
  buffer_load_dwordx4 v9, s[40:43], s25 offen lds
  s_add_u32 m0, s23, 50176
  s_nop 0
  buffer_load_dwordx4 v10, s[40:43], s25 offen lds
  s_add_u32 m0, s23, 51200
  s_nop 0
  buffer_load_dwordx4 v9, s[40:43], s26 offen lds
  s_add_u32 m0, s23, 52224
  s_nop 0
  buffer_load_dwordx4 v10, s[40:43], s26 offen lds
  s_mov_b32 s27, 0
  s_add_u32 s27, s27, 5
  s_and_b32 s27, s27, 31
  s_mul_i32 s26, s27, 18432
  s_add_u32 m0, s24, 55296
  s_bfm_b64 exec, 32, 0
  buffer_load_dwordx4 v11, s[36:39], s26 offen sc1 lds
  s_mov_b64 exec, -1
  buffer_load_dwordx4 v11, s[36:39], s26 offen offset:512 sc1 lds
  buffer_load_dwordx4 v11, s[36:39], s26 offen offset:1536 sc1 lds
  buffer_load_dwordx4 v11, s[36:39], s26 offen offset:2560 sc1 lds
  buffer_load_dwordx4 v11, s[36:39], s26 offen offset:3584 sc1 lds
  s_waitcnt vmcnt(18)
  s_barrier
  s_mov_b32 s27, 0
  s_add_u32 s27, s27, 6
  s_and_b32 s27, s27, 31
  s_lshl_b32 s25, s27, 7
  s_add_u32 s26, s25, 16384
  s_add_u32 m0, s23, 0
  s_nop 0
  buffer_load_dwordx4 v9, s[40:43], s25 offen lds
  s_add_u32 m0, s23, 1024
  s_nop 0
  buffer_load_dwordx4 v10, s[40:43], s25 offen lds
  s_add_u32 m0, s23, 2048
  s_nop 0
  buffer_load_dwordx4 v9, s[40:43], s26 offen lds
  s_add_u32 m0, s23, 3072
  s_nop 0
  buffer_load_dwordx4 v10, s[40:43], s26 offen lds
  s_mov_b32 s27, 0
  s_add_u32 s27, s27, 6
  s_and_b32 s27, s27, 31
  s_mul_i32 s26, s27, 18432
  s_add_u32 m0, s24, 0
  s_bfm_b64 exec, 32, 0
  buffer_load_dwordx4 v11, s[36:39], s26 offen sc1 lds
  s_mov_b64 exec, -1
  buffer_load_dwordx4 v11, s[36:39], s26 offen offset:512 sc1 lds
  buffer_load_dwordx4 v11, s[36:39], s26 offen offset:1536 sc1 lds
  buffer_load_dwordx4 v11, s[36:39], s26 offen offset:2560 sc1 lds
  buffer_load_dwordx4 v11, s[36:39], s26 offen offset:3584 sc1 lds
  s_waitcnt vmcnt(18)
  s_barrier
  s_mov_b32 s27, 0
  s_add_u32 s27, s27, 7
  s_and_b32 s27, s27, 31
  s_lshl_b32 s25, s27, 7
  s_add_u32 s26, s25, 16384
  s_add_u32 m0, s23, 16384
  s_nop 0
  buffer_load_dwordx4 v9, s[40:43], s25 offen lds
  s_add_u32 m0, s23, 17408
  s_nop 0
  buffer_load_dwordx4 v10, s[40:43], s25 offen lds
  s_add_u32 m0, s23, 18432
  s_nop 0
  buffer_load_dwordx4 v9, s[40:43], s26 offen lds
  s_add_u32 m0, s23, 19456
  s_nop 0
  buffer_load_dwordx4 v10, s[40:43], s26 offen lds
  s_mov_b32 s27, 0
  s_add_u32 s27, s27, 7
  s_and_b32 s27, s27, 31
  s_mul_i32 s26, s27, 18432
  s_add_u32 m0, s24, 18432
  s_bfm_b64 exec, 32, 0
  buffer_load_dwordx4 v11, s[36:39], s26 offen sc1 lds
  s_mov_b64 exec, -1
  buffer_load_dwordx4 v11, s[36:39], s26 offen offset:512 sc1 lds
  buffer_load_dwordx4 v11, s[36:39], s26 offen offset:1536 sc1 lds
  buffer_load_dwordx4 v11, s[36:39], s26 offen offset:2560 sc1 lds
  buffer_load_dwordx4 v11, s[36:39], s26 offen offset:3584 sc1 lds
  s_waitcnt vmcnt(18)
  s_barrier
  s_mov_b32 s27, 0
  s_add_u32 s27, s27, 8
  s_and_b32 s27, s27, 31
  s_lshl_b32 s25, s27, 7
  s_add_u32 s26, s25, 16384
  s_add_u32 m0, s23, 32768
  s_nop 0
  buffer_load_dwordx4 v9, s[40:43], s25 offen lds
  s_add_u32 m0, s23, 33792
  s_nop 0
  buffer_load_dwordx4 v10, s[40:43], s25 offen lds
  s_add_u32 m0, s23, 34816
  s_nop 0
  buffer_load_dwordx4 v9, s[40:43], s26 offen lds
  s_add_u32 m0, s23, 35840
  s_nop 0
  buffer_load_dwordx4 v10, s[40:43], s26 offen lds
  s_mov_b32 s27, 0
  s_add_u32 s27, s27, 8
  s_and_b32 s27, s27, 31
  s_mul_i32 s26, s27, 18432
  s_add_u32 m0, s24, 36864
  s_bfm_b64 exec, 32, 0
  buffer_load_dwordx4 v11, s[36:39], s26 offen sc1 lds
  s_mov_b64 exec, -1
  buffer_load_dwordx4 v11, s[36:39], s26 offen offset:512 sc1 lds
  buffer_load_dwordx4 v11, s[36:39], s26 offen offset:1536 sc1 lds
  buffer_load_dwordx4 v11, s[36:39], s26 offen offset:2560 sc1 lds
  buffer_load_dwordx4 v11, s[36:39], s26 offen offset:3584 sc1 lds
  s_waitcnt vmcnt(18)
  s_barrier
  s_mov_b32 s27, 0
  s_add_u32 s27, s27, 9
  s_and_b32 s27, s27, 31
  s_lshl_b32 s25, s27, 7
  s_add_u32 s26, s25, 16384
  s_add_u32 m0, s23, 49152
  s_nop 0
  buffer_load_dwordx4 v9, s[40:43], s25 offen lds
  s_add_u32 m0, s23, 50176
  s_nop 0
  buffer_load_dwordx4 v10, s[40:43], s25 offen lds
  s_add_u32 m0, s23, 51200
  s_nop 0
  buffer_load_dwordx4 v9, s[40:43], s26 offen lds
  s_add_u32 m0, s23, 52224
  s_nop 0
  buffer_load_dwordx4 v10, s[40:43], s26 offen lds
  s_mov_b32 s27, 0
  s_add_u32 s27, s27, 9
  s_and_b32 s27, s27, 31
  s_mul_i32 s26, s27, 18432
  s_add_u32 m0, s24, 55296
  s_bfm_b64 exec, 32, 0
  buffer_load_dwordx4 v11, s[36:39], s26 offen sc1 lds
  s_mov_b64 exec, -1
  buffer_load_dwordx4 v11, s[36:39], s26 offen offset:512 sc1 lds
  buffer_load_dwordx4 v11, s[36:39], s26 offen offset:1536 sc1 lds
  buffer_load_dwordx4 v11, s[36:39], s26 offen offset:2560 sc1 lds
  buffer_load_dwordx4 v11, s[36:39], s26 offen offset:3584 sc1 lds
  s_waitcnt vmcnt(18)
  s_barrier
  s_mov_b32 s27, 0
  s_add_u32 s27, s27, 10
  s_and_b32 s27, s27, 31
  s_lshl_b32 s25, s27, 7
  s_add_u32 s26, s25, 16384
  s_add_u32 m0, s23, 0
  s_nop 0
  buffer_load_dwordx4 v9, s[40:43], s25 offen lds
  s_add_u32 m0, s23, 1024
  s_nop 0
  buffer_load_dwordx4 v10, s[40:43], s25 offen lds
  s_add_u32 m0, s23, 2048
  s_nop 0
  buffer_load_dwordx4 v9, s[40:43], s26 offen lds
  s_add_u32 m0, s23, 3072
  s_nop 0
  buffer_load_dwordx4 v10, s[40:43], s26 offen lds
  s_mov_b32 s27, 0
  s_add_u32 s27, s27, 10
  s_and_b32 s27, s27, 31
  s_mul_i32 s26, s27, 18432
  s_add_u32 m0, s24, 0
  s_bfm_b64 exec, 32, 0
  buffer_load_dwordx4 v11, s[36:39], s26 offen sc1 lds
  s_mov_b64 exec, -1
  buffer_load_dwordx4 v11, s[36:39], s26 offen offset:512 sc1 lds
  buffer_load_dwordx4 v11, s[36:39], s26 offen offset:1536 sc1 lds
  buffer_load_dwordx4 v11, s[36:39], s26 offen offset:2560 sc1 lds
  buffer_load_dwordx4 v11, s[36:39], s26 offen offset:3584 sc1 lds
  s_waitcnt vmcnt(18)
  s_barrier
  s_mov_b32 s27, 0
  s_add_u32 s27, s27, 11
  s_and_b32 s27, s27, 31
  s_lshl_b32 s25, s27, 7
  s_add_u32 s26, s25, 16384
  s_add_u32 m0, s23, 16384
  s_nop 0
  buffer_load_dwordx4 v9, s[40:43], s25 offen lds
  s_add_u32 m0, s23, 17408
  s_nop 0
  buffer_load_dwordx4 v10, s[40:43], s25 offen lds
  s_add_u32 m0, s23, 18432
  s_nop 0
  buffer_load_dwordx4 v9, s[40:43], s26 offen lds
  s_add_u32 m0, s23, 19456
  s_nop 0
  buffer_load_dwordx4 v10, s[40:43], s26 offen lds
  s_mov_b32 s27, 0
  s_add_u32 s27, s27, 11
  s_and_b32 s27, s27, 31
  s_mul_i32 s26, s27, 18432
  s_add_u32 m0, s24, 18432
  s_bfm_b64 exec, 32, 0
  buffer_load_dwordx4 v11, s[36:39], s26 offen sc1 lds
  s_mov_b64 exec, -1
  buffer_load_dwordx4 v11, s[36:39], s26 offen offset:512 sc1 lds
  buffer_load_dwordx4 v11, s[36:39], s26 offen offset:1536 sc1 lds
  buffer_load_dwordx4 v11, s[36:39], s26 offen offset:2560 sc1 lds
  buffer_load_dwordx4 v11, s[36:39], s26 offen offset:3584 sc1 lds
  s_waitcnt vmcnt(18)
  s_barrier
  s_mov_b32 s27, 0
  s_add_u32 s27, s27, 12
  s_and_b32 s27, s27, 31
  s_lshl_b32 s25, s27, 7
  s_add_u32 s26, s25, 16384
  s_add_u32 m0, s23, 32768
  s_nop 0
  buffer_load_dwordx4 v9, s[40:43], s25 offen lds
  s_add_u32 m0, s23, 33792
  s_nop 0
  buffer_load_dwordx4 v10, s[40:43], s25 offen lds
  s_add_u32 m0, s23, 34816
  s_nop 0
  buffer_load_dwordx4 v9, s[40:43], s26 offen lds
  s_add_u32 m0, s23, 35840
  s_nop 0
  buffer_load_dwordx4 v10, s[40:43], s26 offen lds
  s_mov_b32 s27, 0
  s_add_u32 s27, s27, 12
  s_and_b32 s27, s27, 31
  s_mul_i32 s26, s27, 18432
  s_add_u32 m0, s24, 36864
  s_bfm_b64 exec, 32, 0
  buffer_load_dwordx4 v11, s[36:39], s26 offen sc1 lds
  s_mov_b64 exec, -1
  buffer_load_dwordx4 v11, s[36:39], s26 offen offset:512 sc1 lds
  buffer_load_dwordx4 v11, s[36:39], s26 offen offset:1536 sc1 lds
  buffer_load_dwordx4 v11, s[36:39], s26 offen offset:2560 sc1 lds
  buffer_load_dwordx4 v11, s[36:39], s26 offen offset:3584 sc1 lds
  s_waitcnt vmcnt(18)
  s_barrier
  s_mov_b32 s27, 0
  s_add_u32 s27, s27, 13
  s_and_b32 s27, s27, 31
  s_lshl_b32 s25, s27, 7
  s_add_u32 s26, s25, 16384
  s_add_u32 m0, s23, 49152
  s_nop 0
  buffer_load_dwordx4 v9, s[40:43], s25 offen lds
  s_add_u32 m0, s23, 50176
  s_nop 0
  buffer_load_dwordx4 v10, s[40:43], s25 offen lds
  s_add_u32 m0, s23, 51200
  s_nop 0
  buffer_load_dwordx4 v9, s[40:43], s26 offen lds
  s_add_u32 m0, s23, 52224
  s_nop 0
  buffer_load_dwordx4 v10, s[40:43], s26 offen lds
  s_mov_b32 s27, 0
  s_add_u32 s27, s27, 13
  s_and_b32 s27, s27, 31
  s_mul_i32 s26, s27, 18432
  s_add_u32 m0, s24, 55296
  s_bfm_b64 exec, 32, 0
  buffer_load_dwordx4 v11, s[36:39], s26 offen sc1 lds
  s_mov_b64 exec, -1
  buffer_load_dwordx4 v11, s[36:39], s26 offen offset:512 sc1 lds
  buffer_load_dwordx4 v11, s[36:39], s26 offen offset:1536 sc1 lds
  buffer_load_dwordx4 v11, s[36:39], s26 offen offset:2560 sc1 lds
  buffer_load_dwordx4 v11, s[36:39], s26 offen offset:3584 sc1 lds
  s_waitcnt vmcnt(18)
  s_barrier
  s_mov_b32 s27, 0
  s_add_u32 s27, s27, 14
  s_and_b32 s27, s27, 31
  s_lshl_b32 s25, s27, 7
  s_add_u32 s26, s25, 16384
  s_add_u32 m0, s23, 0
  s_nop 0
  buffer_load_dwordx4 v9, s[40:43], s25 offen lds
  s_add_u32 m0, s23, 1024
  s_nop 0
  buffer_load_dwordx4 v10, s[40:43], s25 offen lds
  s_add_u32 m0, s23, 2048
  s_nop 0
  buffer_load_dwordx4 v9, s[40:43], s26 offen lds
  s_add_u32 m0, s23, 3072
  s_nop 0
  buffer_load_dwordx4 v10, s[40:43], s26 offen lds
  s_mov_b32 s27, 0
  s_add_u32 s27, s27, 14
  s_and_b32 s27, s27, 31
  s_mul_i32 s26, s27, 18432
  s_add_u32 m0, s24, 0
  s_bfm_b64 exec, 32, 0
  buffer_load_dwordx4 v11, s[36:39], s26 offen sc1 lds
  s_mov_b64 exec, -1
  buffer_load_dwordx4 v11, s[36:39], s26 offen offset:512 sc1 lds
  buffer_load_dwordx4 v11, s[36:39], s26 offen offset:1536 sc1 lds
  buffer_load_dwordx4 v11, s[36:39], s26 offen offset:2560 sc1 lds
  buffer_load_dwordx4 v11, s[36:39], s26 offen offset:3584 sc1 lds
  s_waitcnt vmcnt(18)
  s_barrier
  s_mov_b32 s27, 0
  s_add_u32 s27, s27, 15
  s_and_b32 s27, s27, 31
  s_lshl_b32 s25, s27, 7
  s_add_u32 s26, s25, 16384
  s_add_u32 m0, s23, 16384
  s_nop 0
  buffer_load_dwordx4 v9, s[40:43], s25 offen lds
  s_add_u32 m0, s23, 17408
  s_nop 0
  buffer_load_dwordx4 v10, s[40:43], s25 offen lds
  s_add_u32 m0, s23, 18432
  s_nop 0
  buffer_load_dwordx4 v9, s[40:43], s26 offen lds
  s_add_u32 m0, s23, 19456
  s_nop 0
  buffer_load_dwordx4 v10, s[40:43], s26 offen lds
  s_mov_b32 s27, 0
  s_add_u32 s27, s27, 15
  s_and_b32 s27, s27, 31
  s_mul_i32 s26, s27, 18432
  s_add_u32 m0, s24, 18432
  s_bfm_b64 exec, 32, 0
  buffer_load_dwordx4 v11, s[36:39], s26 offen sc1 lds
  s_mov_b64 exec, -1
  buffer_load_dwordx4 v11, s[36:39], s26 offen offset:512 sc1 lds
  buffer_load_dwordx4 v11, s[36:39], s26 offen offset:1536 sc1 lds
  buffer_load_dwordx4 v11, s[36:39], s26 offen offset:2560 sc1 lds
  buffer_load_dwordx4 v11, s[36:39], s26 offen offset:3584 sc1 lds
  s_waitcnt vmcnt(18)
  s_barrier
  s_mov_b32 s27, 0
  s_add_u32 s27, s27, 16
  s_and_b32 s27, s27, 31
  s_lshl_b32 s25, s27, 7
  s_add_u32 s26, s25, 16384
  s_add_u32 m0, s23, 32768
  s_nop 0
  buffer_load_dwordx4 v9, s[40:43], s25 offen lds
  s_add_u32 m0, s23, 33792
  s_nop 0
  buffer_load_dwordx4 v10, s[40:43], s25 offen lds
  s_add_u32 m0, s23, 34816
  s_nop 0
  buffer_load_dwordx4 v9, s[40:43], s26 offen lds
  s_add_u32 m0, s23, 35840
  s_nop 0
  buffer_load_dwordx4 v10, s[40:43], s26 offen lds
  s_mov_b32 s27, 0
  s_add_u32 s27, s27, 16
  s_and_b32 s27, s27, 31
  s_mul_i32 s26, s27, 18432
  s_add_u32 m0, s24, 36864
  s_bfm_b64 exec, 32, 0
  buffer_load_dwordx4 v11, s[36:39], s26 offen sc1 lds
  s_mov_b64 exec, -1
  buffer_load_dwordx4 v11, s[36:39], s26 offen offset:512 sc1 lds
  buffer_load_dwordx4 v11, s[36:39], s26 offen offset:1536 sc1 lds
  buffer_load_dwordx4 v11, s[36:39], s26 offen offset:2560 sc1 lds
  buffer_load_dwordx4 v11, s[36:39], s26 offen offset:3584 sc1 lds
  s_waitcnt vmcnt(18)
  s_barrier
  s_mov_b32 s27, 0
  s_add_u32 s27, s27, 17
  s_and_b32 s27, s27, 31
  s_lshl_b32 s25, s27, 7
  s_add_u32 s26, s25, 16384
  s_add_u32 m0, s23, 49152
  s_nop 0
  buffer_load_dwordx4 v9, s[40:43], s25 offen lds
  s_add_u32 m0, s23, 50176
  s_nop 0
  buffer_load_dwordx4 v10, s[40:43], s25 offen lds
  s_add_u32 m0, s23, 51200
  s_nop 0
  buffer_load_dwordx4 v9, s[40:43], s26 offen lds
  s_add_u32 m0, s23, 52224
  s_nop 0
  buffer_load_dwordx4 v10, s[40:43], s26 offen lds
  s_mov_b32 s27, 0
  s_add_u32 s27, s27, 17
  s_and_b32 s27, s27, 31
  s_mul_i32 s26, s27, 18432
  s_add_u32 m0, s24, 55296
  s_bfm_b64 exec, 32, 0
  buffer_load_dwordx4 v11, s[36:39], s26 offen sc1 lds
  s_mov_b64 exec, -1
  buffer_load_dwordx4 v11, s[36:39], s26 offen offset:512 sc1 lds
  buffer_load_dwordx4 v11, s[36:39], s26 offen offset:1536 sc1 lds
  buffer_load_dwordx4 v11, s[36:39], s26 offen offset:2560 sc1 lds
  buffer_load_dwordx4 v11, s[36:39], s26 offen offset:3584 sc1 lds
  s_waitcnt vmcnt(18)
  s_barrier
  s_mov_b32 s27, 0
  s_add_u32 s27, s27, 18
  s_and_b32 s27, s27, 31
  s_lshl_b32 s25, s27, 7
  s_add_u32 s26, s25, 16384
  s_add_u32 m0, s23, 0
  s_nop 0
  buffer_load_dwordx4 v9, s[40:43], s25 offen lds
  s_add_u32 m0, s23, 1024
  s_nop 0
  buffer_load_dwordx4 v10, s[40:43], s25 offen lds
  s_add_u32 m0, s23, 2048
  s_nop 0
  buffer_load_dwordx4 v9, s[40:43], s26 offen lds
  s_add_u32 m0, s23, 3072
  s_nop 0
  buffer_load_dwordx4 v10, s[40:43], s26 offen lds
  s_mov_b32 s27, 0
  s_add_u32 s27, s27, 18
  s_and_b32 s27, s27, 31
  s_mul_i32 s26, s27, 18432
  s_add_u32 m0, s24, 0
  s_bfm_b64 exec, 32, 0
  buffer_load_dwordx4 v11, s[36:39], s26 offen sc1 lds
  s_mov_b64 exec, -1
  buffer_load_dwordx4 v11, s[36:39], s26 offen offset:512 sc1 lds
  buffer_load_dwordx4 v11, s[36:39], s26 offen offset:1536 sc1 lds
  buffer_load_dwordx4 v11, s[36:39], s26 offen offset:2560 sc1 lds
  buffer_load_dwordx4 v11, s[36:39], s26 offen offset:3584 sc1 lds
  s_waitcnt vmcnt(18)
  s_barrier
  s_mov_b32 s27, 0
  s_add_u32 s27, s27, 19
  s_and_b32 s27, s27, 31
  s_lshl_b32 s25, s27, 7
  s_add_u32 s26, s25, 16384
  s_add_u32 m0, s23, 16384
  s_nop 0
  buffer_load_dwordx4 v9, s[40:43], s25 offen lds
  s_add_u32 m0, s23, 17408
  s_nop 0
  buffer_load_dwordx4 v10, s[40:43], s25 offen lds
  s_add_u32 m0, s23, 18432
  s_nop 0
  buffer_load_dwordx4 v9, s[40:43], s26 offen lds
  s_add_u32 m0, s23, 19456
  s_nop 0
  buffer_load_dwordx4 v10, s[40:43], s26 offen lds
  s_mov_b32 s27, 0
  s_add_u32 s27, s27, 19
  s_and_b32 s27, s27, 31
  s_mul_i32 s26, s27, 18432
  s_add_u32 m0, s24, 18432
  s_bfm_b64 exec, 32, 0
  buffer_load_dwordx4 v11, s[36:39], s26 offen sc1 lds
  s_mov_b64 exec, -1
  buffer_load_dwordx4 v11, s[36:39], s26 offen offset:512 sc1 lds
  buffer_load_dwordx4 v11, s[36:39], s26 offen offset:1536 sc1 lds
  buffer_load_dwordx4 v11, s[36:39], s26 offen offset:2560 sc1 lds
  buffer_load_dwordx4 v11, s[36:39], s26 offen offset:3584 sc1 lds
  s_waitcnt vmcnt(18)
  s_barrier
  s_mov_b32 s27, 0
  s_add_u32 s27, s27, 20
  s_and_b32 s27, s27, 31
  s_lshl_b32 s25, s27, 7
  s_add_u32 s26, s25, 16384
  s_add_u32 m0, s23, 32768
  s_nop 0
  buffer_load_dwordx4 v9, s[40:43], s25 offen lds
  s_add_u32 m0, s23, 33792
  s_nop 0
  buffer_load_dwordx4 v10, s[40:43], s25 offen lds
  s_add_u32 m0, s23, 34816
  s_nop 0
  buffer_load_dwordx4 v9, s[40:43], s26 offen lds
  s_add_u32 m0, s23, 35840
  s_nop 0
  buffer_load_dwordx4 v10, s[40:43], s26 offen lds
  s_mov_b32 s27, 0
  s_add_u32 s27, s27, 20
  s_and_b32 s27, s27, 31
  s_mul_i32 s26, s27, 18432
  s_add_u32 m0, s24, 36864
  s_bfm_b64 exec, 32, 0
  buffer_load_dwordx4 v11, s[36:39], s26 offen sc1 lds
  s_mov_b64 exec, -1
  buffer_load_dwordx4 v11, s[36:39], s26 offen offset:512 sc1 lds
  buffer_load_dwordx4 v11, s[36:39], s26 offen offset:1536 sc1 lds
  buffer_load_dwordx4 v11, s[36:39], s26 offen offset:2560 sc1 lds
  buffer_load_dwordx4 v11, s[36:39], s26 offen offset:3584 sc1 lds
  s_waitcnt vmcnt(18)
  s_barrier
  s_mov_b32 s27, 0
  s_add_u32 s27, s27, 21
  s_and_b32 s27, s27, 31
  s_lshl_b32 s25, s27, 7
  s_add_u32 s26, s25, 16384
  s_add_u32 m0, s23, 49152
  s_nop 0
  buffer_load_dwordx4 v9, s[40:43], s25 offen lds
  s_add_u32 m0, s23, 50176
  s_nop 0
  buffer_load_dwordx4 v10, s[40:43], s25 offen lds
  s_add_u32 m0, s23, 51200
  s_nop 0
  buffer_load_dwordx4 v9, s[40:43], s26 offen lds
  s_add_u32 m0, s23, 52224
  s_nop 0
  buffer_load_dwordx4 v10, s[40:43], s26 offen lds
  s_mov_b32 s27, 0
  s_add_u32 s27, s27, 21
  s_and_b32 s27, s27, 31
  s_mul_i32 s26, s27, 18432
  s_add_u32 m0, s24, 55296
  s_bfm_b64 exec, 32, 0
  buffer_load_dwordx4 v11, s[36:39], s26 offen sc1 lds
  s_mov_b64 exec, -1
  buffer_load_dwordx4 v11, s[36:39], s26 offen offset:512 sc1 lds
  buffer_load_dwordx4 v11, s[36:39], s26 offen offset:1536 sc1 lds
  buffer_load_dwordx4 v11, s[36:39], s26 offen offset:2560 sc1 lds
  buffer_load_dwordx4 v11, s[36:39], s26 offen offset:3584 sc1 lds
  s_waitcnt vmcnt(18)
  s_barrier
  s_mov_b32 s27, 0
  s_add_u32 s27, s27, 22
  s_and_b32 s27, s27, 31
  s_lshl_b32 s25, s27, 7
  s_add_u32 s26, s25, 16384
  s_add_u32 m0, s23, 0
  s_nop 0
  buffer_load_dwordx4 v9, s[40:43], s25 offen lds
  s_add_u32 m0, s23, 1024
  s_nop 0
  buffer_load_dwordx4 v10, s[40:43], s25 offen lds
  s_add_u32 m0, s23, 2048
  s_nop 0
  buffer_load_dwordx4 v9, s[40:43], s26 offen lds
  s_add_u32 m0, s23, 3072
  s_nop 0
  buffer_load_dwordx4 v10, s[40:43], s26 offen lds
  s_mov_b32 s27, 0
  s_add_u32 s27, s27, 22
  s_and_b32 s27, s27, 31
  s_mul_i32 s26, s27, 18432
  s_add_u32 m0, s24, 0
  s_bfm_b64 exec, 32, 0
  buffer_load_dwordx4 v11, s[36:39], s26 offen sc1 lds
  s_mov_b64 exec, -1
  buffer_load_dwordx4 v11, s[36:39], s26 offen offset:512 sc1 lds
  buffer_load_dwordx4 v11, s[36:39], s26 offen offset:1536 sc1 lds
  buffer_load_dwordx4 v11, s[36:39], s26 offen offset:2560 sc1 lds
  buffer_load_dwordx4 v11, s[36:39], s26 offen offset:3584 sc1 lds
  s_waitcnt vmcnt(18)
  s_barrier
  s_mov_b32 s27, 0
  s_add_u32 s27, s27, 23
  s_and_b32 s27, s27, 31
  s_lshl_b32 s25, s27, 7
  s_add_u32 s26, s25, 16384
  s_add_u32 m0, s23, 16384
  s_nop 0
  buffer_load_dwordx4 v9, s[40:43], s25 offen lds
  s_add_u32 m0, s23, 17408
  s_nop 0
  buffer_load_dwordx4 v10, s[40:43], s25 offen lds
  s_add_u32 m0, s23, 18432
  s_nop 0
  buffer_load_dwordx4 v9, s[40:43], s26 offen lds
  s_add_u32 m0, s23, 19456
  s_nop 0
  buffer_load_dwordx4 v10, s[40:43], s26 offen lds
  s_mov_b32 s27, 0
  s_add_u32 s27, s27, 23
  s_and_b32 s27, s27, 31
  s_mul_i32 s26, s27, 18432
  s_add_u32 m0, s24, 18432
  s_bfm_b64 exec, 32, 0
  buffer_load_dwordx4 v11, s[36:39], s26 offen sc1 lds
  s_mov_b64 exec, -1
  buffer_load_dwordx4 v11, s[36:39], s26 offen offset:512 sc1 lds
  buffer_load_dwordx4 v11, s[36:39], s26 offen offset:1536 sc1 lds
  buffer_load_dwordx4 v11, s[36:39], s26 offen offset:2560 sc1 lds
  buffer_load_dwordx4 v11, s[36:39], s26 offen offset:3584 sc1 lds
  s_waitcnt vmcnt(18)
  s_barrier
  s_mov_b32 s27, 0
  s_add_u32 s27, s27, 24
  s_and_b32 s27, s27, 31
  s_lshl_b32 s25, s27, 7
  s_add_u32 s26, s25, 16384
  s_add_u32 m0, s23, 32768
  s_nop 0
  buffer_load_dwordx4 v9, s[40:43], s25 offen lds
  s_add_u32 m0, s23, 33792
  s_nop 0
  buffer_load_dwordx4 v10, s[40:43], s25 offen lds
  s_add_u32 m0, s23, 34816
  s_nop 0
  buffer_load_dwordx4 v9, s[40:43], s26 offen lds
  s_add_u32 m0, s23, 35840
  s_nop 0
  buffer_load_dwordx4 v10, s[40:43], s26 offen lds
  s_mov_b32 s27, 0
  s_add_u32 s27, s27, 24
  s_and_b32 s27, s27, 31
  s_mul_i32 s26, s27, 18432
  s_add_u32 m0, s24, 36864
  s_bfm_b64 exec, 32, 0
  buffer_load_dwordx4 v11, s[36:39], s26 offen sc1 lds
  s_mov_b64 exec, -1
  buffer_load_dwordx4 v11, s[36:39], s26 offen offset:512 sc1 lds
  buffer_load_dwordx4 v11, s[36:39], s26 offen offset:1536 sc1 lds
  buffer_load_dwordx4 v11, s[36:39], s26 offen offset:2560 sc1 lds
  buffer_load_dwordx4 v11, s[36:39], s26 offen offset:3584 sc1 lds
  s_waitcnt vmcnt(18)
  s_barrier
  s_mov_b32 s27, 0
  s_add_u32 s27, s27, 25
  s_and_b32 s27, s27, 31
  s_lshl_b32 s25, s27, 7
  s_add_u32 s26, s25, 16384
  s_add_u32 m0, s23, 49152
  s_nop 0
  buffer_load_dwordx4 v9, s[40:43], s25 offen lds
  s_add_u32 m0, s23, 50176
  s_nop 0
  buffer_load_dwordx4 v10, s[40:43], s25 offen lds
  s_add_u32 m0, s23, 51200
  s_nop 0
  buffer_load_dwordx4 v9, s[40:43], s26 offen lds
  s_add_u32 m0, s23, 52224
  s_nop 0
  buffer_load_dwordx4 v10, s[40:43], s26 offen lds
  s_mov_b32 s27, 0
  s_add_u32 s27, s27, 25
  s_and_b32 s27, s27, 31
  s_mul_i32 s26, s27, 18432
  s_add_u32 m0, s24, 55296
  s_bfm_b64 exec, 32, 0
  buffer_load_dwordx4 v11, s[36:39], s26 offen sc1 lds
  s_mov_b64 exec, -1
  buffer_load_dwordx4 v11, s[36:39], s26 offen offset:512 sc1 lds
  buffer_load_dwordx4 v11, s[36:39], s26 offen offset:1536 sc1 lds
  buffer_load_dwordx4 v11, s[36:39], s26 offen offset:2560 sc1 lds
  buffer_load_dwordx4 v11, s[36:39], s26 offen offset:3584 sc1 lds
  s_waitcnt vmcnt(18)
  s_barrier
  s_mov_b32 s27, 0
  s_add_u32 s27, s27, 26
  s_and_b32 s27, s27, 31
  s_lshl_b32 s25, s27, 7
  s_add_u32 s26, s25, 16384
  s_add_u32 m0, s23, 0
  s_nop 0
  buffer_load_dwordx4 v9, s[40:43], s25 offen lds
  s_add_u32 m0, s23, 1024
  s_nop 0
  buffer_load_dwordx4 v10, s[40:43], s25 offen lds
  s_add_u32 m0, s23, 2048
  s_nop 0
  buffer_load_dwordx4 v9, s[40:43], s26 offen lds
  s_add_u32 m0, s23, 3072
  s_nop 0
  buffer_load_dwordx4 v10, s[40:43], s26 offen lds
  s_mov_b32 s27, 0
  s_add_u32 s27, s27, 26
  s_and_b32 s27, s27, 31
  s_mul_i32 s26, s27, 18432
  s_add_u32 m0, s24, 0
  s_bfm_b64 exec, 32, 0
  buffer_load_dwordx4 v11, s[36:39], s26 offen sc1 lds
  s_mov_b64 exec, -1
  buffer_load_dwordx4 v11, s[36:39], s26 offen offset:512 sc1 lds
  buffer_load_dwordx4 v11, s[36:39], s26 offen offset:1536 sc1 lds
  buffer_load_dwordx4 v11, s[36:39], s26 offen offset:2560 sc1 lds
  buffer_load_dwordx4 v11, s[36:39], s26 offen offset:3584 sc1 lds
  s_waitcnt vmcnt(18)
  s_barrier
  s_mov_b32 s27, 0
  s_add_u32 s27, s27, 27
  s_and_b32 s27, s27, 31
  s_lshl_b32 s25, s27, 7
  s_add_u32 s26, s25, 16384
  s_add_u32 m0, s23, 16384
  s_nop 0
  buffer_load_dwordx4 v9, s[40:43], s25 offen lds
  s_add_u32 m0, s23, 17408
  s_nop 0
  buffer_load_dwordx4 v10, s[40:43], s25 offen lds
  s_add_u32 m0, s23, 18432
  s_nop 0
  buffer_load_dwordx4 v9, s[40:43], s26 offen lds
  s_add_u32 m0, s23, 19456
  s_nop 0
  buffer_load_dwordx4 v10, s[40:43], s26 offen lds
  s_mov_b32 s27, 0
  s_add_u32 s27, s27, 27
  s_and_b32 s27, s27, 31
  s_mul_i32 s26, s27, 18432
  s_add_u32 m0, s24, 18432
  s_bfm_b64 exec, 32, 0
  buffer_load_dwordx4 v11, s[36:39], s26 offen sc1 lds
  s_mov_b64 exec, -1
  buffer_load_dwordx4 v11, s[36:39], s26 offen offset:512 sc1 lds
  buffer_load_dwordx4 v11, s[36:39], s26 offen offset:1536 sc1 lds
  buffer_load_dwordx4 v11, s[36:39], s26 offen offset:2560 sc1 lds
  buffer_load_dwordx4 v11, s[36:39], s26 offen offset:3584 sc1 lds
  s_lshr_b32 s86, s2, 3
  s_lshl_b32 s86, s86, 2
  s_add_u32 s86, s86, s14
  v_lshlrev_b32 v56, 2, v1
  s_getpc_b64 s[88:89]
L_pcc42:
  s_sub_u32 s88, s88, L_pcc42 - L_c_yepi
  s_subb_u32 s89, s89, 0
  s_mov_b32 s90, L_c_end - L_c_yepi
  s_mov_b32 s91, 0x20000
  s_lshl_b32 s92, s86, 8
  buffer_load_dword v55, v56, s[88:91], s92 offen
  s_getpc_b64 s[88:89]
L_pcp42:
  s_add_u32 s88, s88, L_p_o - L_pcp42
  s_addc_u32 s89, s89, 0
  s_mov_b32 s90, L_k57_exit - L_p_o
  s_mov_b32 s91, 0x20000
  s_lshl_b32 s92, s86, 8
  buffer_load_dword v55, v56, s[88:91], s92 offen
  s_waitcnt vmcnt(20)
  s_barrier
  s_mov_b32 s27, 0
  s_add_u32 s27, s27, 28
  s_and_b32 s27, s27, 31
  s_lshl_b32 s25, s27, 7
  s_add_u32 s26, s25, 16384
  s_add_u32 m0, s23, 32768
  s_nop 0
  buffer_load_dwordx4 v9, s[40:43], s25 offen lds
  s_add_u32 m0, s23, 33792
  s_nop 0
  buffer_load_dwordx4 v10, s[40:43], s25 offen lds
  s_add_u32 m0, s23, 34816
  s_nop 0
  buffer_load_dwordx4 v9, s[40:43], s26 offen lds
  s_add_u32 m0, s23, 35840
  s_nop 0
  buffer_load_dwordx4 v10, s[40:43], s26 offen lds
  s_mov_b32 s27, 0
  s_add_u32 s27, s27, 28
  s_and_b32 s27, s27, 31
  s_mul_i32 s26, s27, 18432
  s_add_u32 m0, s24, 36864
  s_bfm_b64 exec, 32, 0
  buffer_load_dwordx4 v11, s[36:39], s26 offen sc1 lds
  s_mov_b64 exec, -1
  buffer_load_dwordx4 v11, s[36:39], s26 offen offset:512 sc1 lds
  buffer_load_dwordx4 v11, s[36:39], s26 offen offset:1536 sc1 lds
  buffer_load_dwordx4 v11, s[36:39], s26 offen offset:2560 sc1 lds
  buffer_load_dwordx4 v11, s[36:39], s26 offen offset:3584 sc1 lds
  s_waitcnt vmcnt(20)
  s_barrier
  s_mov_b32 s27, 0
  s_add_u32 s27, s27, 29
  s_and_b32 s27, s27, 31
  s_lshl_b32 s25, s27, 7
  s_add_u32 s26, s25, 16384
  s_add_u32 m0, s23, 49152
  s_nop 0
  buffer_load_dwordx4 v9, s[40:43], s25 offen lds
  s_add_u32 m0, s23, 50176
  s_nop 0
  buffer_load_dwordx4 v10, s[40:43], s25 offen lds
  s_add_u32 m0, s23, 51200
  s_nop 0
  buffer_load_dwordx4 v9, s[40:43], s26 offen lds
  s_add_u32 m0, s23, 52224
  s_nop 0
  buffer_load_dwordx4 v10, s[40:43], s26 offen lds
  s_mov_b32 s27, 0
  s_add_u32 s27, s27, 29
  s_and_b32 s27, s27, 31
  s_mul_i32 s26, s27, 18432
  s_add_u32 m0, s24, 55296
  s_bfm_b64 exec, 32, 0
  buffer_load_dwordx4 v11, s[36:39], s26 offen sc1 lds
  s_mov_b64 exec, -1
  buffer_load_dwordx4 v11, s[36:39], s26 offen offset:512 sc1 lds
  buffer_load_dwordx4 v11, s[36:39], s26 offen offset:1536 sc1 lds
  buffer_load_dwordx4 v11, s[36:39], s26 offen offset:2560 sc1 lds
  buffer_load_dwordx4 v11, s[36:39], s26 offen offset:3584 sc1 lds
  s_waitcnt vmcnt(20)
  s_barrier
  s_mov_b32 s27, 0
  s_add_u32 s27, s27, 30
  s_and_b32 s27, s27, 31
  s_lshl_b32 s25, s27, 7
  s_add_u32 s26, s25, 16384
  s_add_u32 m0, s23, 0
  s_nop 0
  buffer_load_dwordx4 v9, s[40:43], s25 offen lds
  s_add_u32 m0, s23, 1024
  s_nop 0
  buffer_load_dwordx4 v10, s[40:43], s25 offen lds
  s_add_u32 m0, s23, 2048
  s_nop 0
  buffer_load_dwordx4 v9, s[40:43], s26 offen lds
  s_add_u32 m0, s23, 3072
  s_nop 0
  buffer_load_dwordx4 v10, s[40:43], s26 offen lds
  s_mov_b32 s27, 0
  s_add_u32 s27, s27, 30
  s_and_b32 s27, s27, 31
  s_mul_i32 s26, s27, 18432
  s_add_u32 m0, s24, 0
  s_bfm_b64 exec, 32, 0
  buffer_load_dwordx4 v11, s[36:39], s26 offen sc1 lds
  s_mov_b64 exec, -1
  buffer_load_dwordx4 v11, s[36:39], s26 offen offset:512 sc1 lds
  buffer_load_dwordx4 v11, s[36:39], s26 offen offset:1536 sc1 lds
  buffer_load_dwordx4 v11, s[36:39], s26 offen offset:2560 sc1 lds
  buffer_load_dwordx4 v11, s[36:39], s26 offen offset:3584 sc1 lds
  s_waitcnt vmcnt(18)
  s_barrier
  s_mov_b32 s27, 0
  s_add_u32 s27, s27, 31
  s_and_b32 s27, s27, 31
  s_lshl_b32 s25, s27, 7
  s_add_u32 s26, s25, 16384
  s_add_u32 m0, s23, 16384
  s_nop 0
  buffer_load_dwordx4 v9, s[40:43], s25 offen lds
  s_add_u32 m0, s23, 17408
  s_nop 0
  buffer_load_dwordx4 v10, s[40:43], s25 offen lds
  s_add_u32 m0, s23, 18432
  s_nop 0
  buffer_load_dwordx4 v9, s[40:43], s26 offen lds
  s_add_u32 m0, s23, 19456
  s_nop 0
  buffer_load_dwordx4 v10, s[40:43], s26 offen lds
  s_mov_b32 s27, 0
  s_add_u32 s27, s27, 31
  s_and_b32 s27, s27, 31
  s_mul_i32 s26, s27, 18432
  s_add_u32 m0, s24, 18432
  s_bfm_b64 exec, 32, 0
  buffer_load_dwordx4 v11, s[36:39], s26 offen sc1 lds
  s_mov_b64 exec, -1
  buffer_load_dwordx4 v11, s[36:39], s26 offen offset:512 sc1 lds
  buffer_load_dwordx4 v11, s[36:39], s26 offen offset:1536 sc1 lds
  buffer_load_dwordx4 v11, s[36:39], s26 offen offset:2560 sc1 lds
  buffer_load_dwordx4 v11, s[36:39], s26 offen offset:3584 sc1 lds
L_p_o:
  s_lshl_b32 s13, s11, 7
  s_add_u32 s68, s13, 2048
  s_and_b32 s11, s2, 1
  s_lshl_b32 s11, s11, 4
  s_bfe_u32 s13, s2, 0x20001
  s_lshl_b32 s13, s13, 2
  s_add_u32 s11, s11, s13
  s_bfe_u32 s13, s2, 0x20003
  s_add_u32 s11, s11, s13
  s_lshr_b32 s12, s2, 5
  s_lshr_b32 s13, s11, 1
  s_lshl_b32 s13, s13, 7
  s_add_u32 s13, s13, 2048
  s_lshl_b32 s13, s11, 1
  s_lshr_b32 s15, s14, 1
  s_add_u32 s13, s13, s15
  s_lshl_b32 s13, s13, 7
  s_add_u32 s13, s13, 8192
  s_add_u32 s28, s6, 0x10dd000
  s_addc_u32 s29, s7, 0
  s_mov_b32 s30, 0x288000
  s_mov_b32 s31, 0x20000
  s_mov_b32 s32, s6
  s_mov_b32 s33, s7
  s_mov_b32 s34, 0x900000
  s_mov_b32 s35, 0x20000
  s_lshl_b32 s15, s11, 2
  s_add_u32 s15, s15, s14
  s_mul_i32 s15, s15, 73728
  v_lshl_add_u32 v6, v1, 4, s15
  s_mul_i32 s15, s12, 331776
  s_mul_i32 s24, s14, 2304
  s_add_u32 s15, s15, s24
  v_lshl_add_u32 v8, v1, 4, s15
  s_lshl_b32 s23, s14, 11
  s_waitcnt vmcnt(18)
  s_barrier
  s_mov_b32 s26, 0
  s_add_u32 m0, s24, 102400
  s_bfm_b64 exec, 16, 0
  buffer_load_dwordx4 v8, s[28:31], s26 offen sc1 lds
  s_mov_b64 exec, -1
  buffer_load_dwordx4 v8, s[28:31], s26 offen offset:256 sc1 lds
  buffer_load_dwordx4 v8, s[28:31], s26 offen offset:1280 sc1 lds
  s_mov_b32 s26, 9216
  s_add_u32 m0, s24, 111616
  s_bfm_b64 exec, 16, 0
  buffer_load_dwordx4 v8, s[28:31], s26 offen sc1 lds
  s_mov_b64 exec, -1
  buffer_load_dwordx4 v8, s[28:31], s26 offen offset:256 sc1 lds
  buffer_load_dwordx4 v8, s[28:31], s26 offen offset:1280 sc1 lds
  s_waitcnt vmcnt(15)
  s_barrier
  s_mov_b32 s26, 18432
  s_add_u32 m0, s24, 120832
  s_bfm_b64 exec, 16, 0
  buffer_load_dwordx4 v8, s[28:31], s26 offen sc1 lds
  s_mov_b64 exec, -1
  buffer_load_dwordx4 v8, s[28:31], s26 offen offset:256 sc1 lds
  buffer_load_dwordx4 v8, s[28:31], s26 offen offset:1280 sc1 lds
  s_mov_b32 s26, 27648
  s_add_u32 m0, s24, 130048
  s_bfm_b64 exec, 16, 0
  buffer_load_dwordx4 v8, s[28:31], s26 offen sc1 lds
  s_mov_b64 exec, -1
  buffer_load_dwordx4 v8, s[28:31], s26 offen offset:256 sc1 lds
  buffer_load_dwordx4 v8, s[28:31], s26 offen offset:1280 sc1 lds
  s_waitcnt vmcnt(12)
  s_barrier
  s_mov_b32 s26, 36864
  s_add_u32 m0, s24, 65536
  s_bfm_b64 exec, 16, 0
  buffer_load_dwordx4 v8, s[28:31], s26 offen sc1 lds
  s_mov_b64 exec, -1
  buffer_load_dwordx4 v8, s[28:31], s26 offen offset:256 sc1 lds
  buffer_load_dwordx4 v8, s[28:31], s26 offen offset:1280 sc1 lds
  s_mov_b32 s26, 46080
  s_add_u32 m0, s24, 74752
  s_bfm_b64 exec, 16, 0
  buffer_load_dwordx4 v8, s[28:31], s26 offen sc1 lds
  s_mov_b64 exec, -1
  buffer_load_dwordx4 v8, s[28:31], s26 offen offset:256 sc1 lds
  buffer_load_dwordx4 v8, s[28:31], s26 offen offset:1280 sc1 lds
  s_barrier
  v_mov_b32 v33, 0x7fffffff
  s_bfm_b64 exec, 1, 0
  v_mov_b32 v33, 0
  buffer_atomic_add v33, v32, s[64:67], s13 offen sc0 sc1
  s_mov_b64 exec, -1
  s_mov_b32 s25, 83968
  s_cmp_eq_u32 s14, 1
  s_cselect_b32 s25, 93184, s25
  s_cmp_eq_u32 s14, 2
  s_cselect_b32 s25, 49152, s25
  s_cmp_eq_u32 s14, 3
  s_cselect_b32 s25, 139264, s25
  v_add_u32 v58, s25, v57
  ds_write_b128 v58, v[60:63] offset:0
  ds_write_b128 v58, v[64:67] offset:1024
  ds_write_b128 v58, v[68:71] offset:2048
  ds_write_b128 v58, v[72:75] offset:3072
  ds_write_b128 v58, v[76:79] offset:4096
  ds_write_b128 v58, v[80:83] offset:5120
  ds_write_b128 v58, v[84:87] offset:6144
  ds_write_b128 v58, v[88:91] offset:7168
  ds_write_b128 v58, v[92:95] offset:8192
  s_waitcnt vmcnt(0) lgkmcnt(0)
  s_mov_b32 s26, 0x40000
L_k57_poll8_chk:
  v_readfirstlane_b32 s25, v33
  s_nop 0
  s_cmp_ge_u32 s25, 16
  s_cbranch_scc1 L_k57_poll8_ok
  s_sub_u32 s26, s26, 1
  s_cbranch_scc1 L_k57_poll8_ok
  s_sleep 4
  v_mov_b32 v33, 0x7fffffff
  s_bfm_b64 exec, 1, 0
  v_mov_b32 v33, 0
  buffer_atomic_add v33, v32, s[64:67], s13 offen sc0 sc1
  s_mov_b64 exec, -1
  s_waitcnt vmcnt(0)
  s_branch L_k57_poll8_chk
L_k57_poll8_ok:
  s_mov_b32 s25, 0
  s_add_u32 m0, s23, 0
  s_nop 0
  buffer_load_dwordx4 v6, s[32:35], s25 offen sc1 lds
  buffer_load_dwordx4 v6, s[32:35], s25 offen offset:1024 sc1 lds
  s_mov_b32 s25, 2048
  s_add_u32 m0, s23, 8192
  s_nop 0
  buffer_load_dwordx4 v6, s[32:35], s25 offen sc1 lds
  buffer_load_dwordx4 v6, s[32:35], s25 offen offset:1024 sc1 lds
  s_mov_b32 s25, 4096
  s_add_u32 m0, s23, 16384
  s_nop 0
  buffer_load_dwordx4 v6, s[32:35], s25 offen sc1 lds
  buffer_load_dwordx4 v6, s[32:35], s25 offen offset:1024 sc1 lds
  s_mov_b32 s25, 6144
  s_add_u32 m0, s23, 24576
  s_nop 0
  buffer_load_dwordx4 v6, s[32:35], s25 offen sc1 lds
  buffer_load_dwordx4 v6, s[32:35], s25 offen offset:1024 sc1 lds
  s_waitcnt vmcnt(6)
  s_barrier
  s_mov_b32 s25, 8192
  s_add_u32 m0, s23, 32768
  s_nop 0
  buffer_load_dwordx4 v6, s[32:35], s25 offen sc1 lds
  buffer_load_dwordx4 v6, s[32:35], s25 offen offset:1024 sc1 lds
  s_mov_b32 s25, 10240
  s_add_u32 m0, s23, 40960
  s_nop 0
  buffer_load_dwordx4 v6, s[32:35], s25 offen sc1 lds
  buffer_load_dwordx4 v6, s[32:35], s25 offen offset:1024 sc1 lds
  s_waitcnt vmcnt(8)
  s_barrier
  s_mov_b32 s25, 12288
  s_add_u32 m0, s23, 0
  s_nop 0
  buffer_load_dwordx4 v6, s[32:35], s25 offen sc1 lds
  buffer_load_dwordx4 v6, s[32:35], s25 offen offset:1024 sc1 lds
  s_waitcnt vmcnt(8)
  s_barrier
  s_mov_b32 s25, 14336
  s_add_u32 m0, s23, 8192
  s_nop 0
  buffer_load_dwordx4 v6, s[32:35], s25 offen sc1 lds
  buffer_load_dwordx4 v6, s[32:35], s25 offen offset:1024 sc1 lds
  s_waitcnt vmcnt(8)
  s_barrier
  s_mov_b32 s25, 16384
  s_add_u32 m0, s23, 16384
  s_nop 0
  buffer_load_dwordx4 v6, s[32:35], s25 offen sc1 lds
  buffer_load_dwordx4 v6, s[32:35], s25 offen offset:1024 sc1 lds
  s_mov_b32 s25, 148480
  s_cmp_eq_u32 s14, 1
  s_cselect_b32 s25, 102400, s25
  s_cmp_eq_u32 s14, 2
  s_cselect_b32 s25, 111616, s25
  s_cmp_eq_u32 s14, 3
  s_cselect_b32 s25, 120832, s25
  v_add_u32 v58, s25, v57
  ds_write_b128 v58, v[96:99] offset:0
  ds_write_b128 v58, v[100:103] offset:1024
  ds_write_b128 v58, v[104:107] offset:2048
  ds_write_b128 v58, v[108:111] offset:3072
  ds_write_b128 v58, v[112:115] offset:4096
  ds_write_b128 v58, v[116:119] offset:5120
  ds_write_b128 v58, v[120:123] offset:6144
  ds_write_b128 v58, v[124:127] offset:7168
  ds_write_b128 v58, v[128:131] offset:8192
  s_waitcnt lgkmcnt(0)
  s_waitcnt vmcnt(8)
  s_barrier
  s_mov_b32 s25, 18432
  s_add_u32 m0, s23, 24576
  s_nop 0
  buffer_load_dwordx4 v6, s[32:35], s25 offen sc1 lds
  buffer_load_dwordx4 v6, s[32:35], s25 offen offset:1024 sc1 lds
  s_waitcnt vmcnt(8)
  s_barrier
  s_mov_b32 s25, 20480
  s_add_u32 m0, s23, 32768
  s_nop 0
  buffer_load_dwordx4 v6, s[32:35], s25 offen sc1 lds
  buffer_load_dwordx4 v6, s[32:35], s25 offen offset:1024 sc1 lds
  s_waitcnt vmcnt(8)
  s_barrier
  s_mov_b32 s25, 22528
  s_add_u32 m0, s23, 40960
  s_nop 0
  buffer_load_dwordx4 v6, s[32:35], s25 offen sc1 lds
  buffer_load_dwordx4 v6, s[32:35], s25 offen offset:1024 sc1 lds
  s_waitcnt vmcnt(8)
  s_barrier
  s_mov_b32 s25, 24576
  s_add_u32 m0, s23, 0
  s_nop 0
  buffer_load_dwordx4 v6, s[32:35], s25 offen sc1 lds
  buffer_load_dwordx4 v6, s[32:35], s25 offen offset:1024 sc1 lds
  s_mov_b32 s25, 130048
  s_cmp_eq_u32 s14, 1
  s_cselect_b32 s25, 65536, s25
  s_cmp_eq_u32 s14, 2
  s_cselect_b32 s25, 74752, s25
  s_cmp_eq_u32 s14, 3
  s_cselect_b32 s25, 83968, s25
  v_add_u32 v58, s25, v57
  ds_write_b128 v58, v[132:135] offset:0
  ds_write_b128 v58, v[136:139] offset:1024
  ds_write_b128 v58, v[140:143] offset:2048
  ds_write_b128 v58, v[144:147] offset:3072
  ds_write_b128 v58, v[148:151] offset:4096
  ds_write_b128 v58, v[152:155] offset:5120
  ds_write_b128 v58, v[156:159] offset:6144
  ds_write_b128 v58, v[160:163] offset:7168
  ds_write_b128 v58, v[164:167] offset:8192
  s_waitcnt lgkmcnt(0)
  s_waitcnt vmcnt(8)
  s_barrier
  s_mov_b32 s25, 26624
  s_add_u32 m0, s23, 8192
  s_nop 0
  buffer_load_dwordx4 v6, s[32:35], s25 offen sc1 lds
  buffer_load_dwordx4 v6, s[32:35], s25 offen offset:1024 sc1 lds
  s_mov_b32 s26, 165888
  s_add_u32 m0, s24, 93184
  s_bfm_b64 exec, 16, 0
  buffer_load_dwordx4 v8, s[28:31], s26 offen sc1 lds
  s_mov_b64 exec, -1
  buffer_load_dwordx4 v8, s[28:31], s26 offen offset:256 sc1 lds
  buffer_load_dwordx4 v8, s[28:31], s26 offen offset:1280 sc1 lds
  s_waitcnt vmcnt(11)
  s_barrier
  s_mov_b32 s25, 28672
  s_add_u32 m0, s23, 16384
  s_nop 0
  buffer_load_dwordx4 v6, s[32:35], s25 offen sc1 lds
  buffer_load_dwordx4 v6, s[32:35], s25 offen offset:1024 sc1 lds
  s_mov_b32 s26, 175104
  s_add_u32 m0, s24, 49152
  s_bfm_b64 exec, 16, 0
  buffer_load_dwordx4 v8, s[28:31], s26 offen sc1 lds
  s_mov_b64 exec, -1
  buffer_load_dwordx4 v8, s[28:31], s26 offen offset:256 sc1 lds
  buffer_load_dwordx4 v8, s[28:31], s26 offen offset:1280 sc1 lds
  s_waitcnt vmcnt(14)
  s_barrier
  s_mov_b32 s25, 30720
  s_add_u32 m0, s23, 24576
  s_nop 0
  buffer_load_dwordx4 v6, s[32:35], s25 offen sc1 lds
  buffer_load_dwordx4 v6, s[32:35], s25 offen offset:1024 sc1 lds
  s_mov_b32 s26, 184320
  s_add_u32 m0, s24, 139264
  s_bfm_b64 exec, 16, 0
  buffer_load_dwordx4 v8, s[28:31], s26 offen sc1 lds
  s_mov_b64 exec, -1
  buffer_load_dwordx4 v8, s[28:31], s26 offen offset:256 sc1 lds
  buffer_load_dwordx4 v8, s[28:31], s26 offen offset:1280 sc1 lds
  s_waitcnt vmcnt(17)
  s_barrier
  s_mov_b32 s25, 32768
  s_add_u32 m0, s23, 32768
  s_nop 0
  buffer_load_dwordx4 v6, s[32:35], s25 offen sc1 lds
  buffer_load_dwordx4 v6, s[32:35], s25 offen offset:1024 sc1 lds
  s_mov_b32 s26, 193536
  s_add_u32 m0, s24, 148480
  s_bfm_b64 exec, 16, 0
  buffer_load_dwordx4 v8, s[28:31], s26 offen sc1 lds
  s_mov_b64 exec, -1
  buffer_load_dwordx4 v8, s[28:31], s26 offen offset:256 sc1 lds
  buffer_load_dwordx4 v8, s[28:31], s26 offen offset:1280 sc1 lds
  s_waitcnt vmcnt(20)
  s_barrier
  s_mov_b32 s25, 34816
  s_add_u32 m0, s23, 40960
  s_nop 0
  buffer_load_dwordx4 v6, s[32:35], s25 offen sc1 lds
  buffer_load_dwordx4 v6, s[32:35], s25 offen offset:1024 sc1 lds
  s_mov_b32 s26, 202752
  s_add_u32 m0, s24, 102400
  s_bfm_b64 exec, 16, 0
  buffer_load_dwordx4 v8, s[28:31], s26 offen sc1 lds
  s_mov_b64 exec, -1
  buffer_load_dwordx4 v8, s[28:31], s26 offen offset:256 sc1 lds
  buffer_load_dwordx4 v8, s[28:31], s26 offen offset:1280 sc1 lds
  s_waitcnt vmcnt(23)
  s_barrier
  s_mov_b32 s25, 36864
  s_add_u32 m0, s23, 0
  s_nop 0
  buffer_load_dwordx4 v6, s[32:35], s25 offen sc1 lds
  buffer_load_dwordx4 v6, s[32:35], s25 offen offset:1024 sc1 lds
  s_mov_b32 s26, 211968
  s_add_u32 m0, s24, 111616
  s_bfm_b64 exec, 16, 0
  buffer_load_dwordx4 v8, s[28:31], s26 offen sc1 lds
  s_mov_b64 exec, -1
  buffer_load_dwordx4 v8, s[28:31], s26 offen offset:256 sc1 lds
  buffer_load_dwordx4 v8, s[28:31], s26 offen offset:1280 sc1 lds
  s_waitcnt vmcnt(23)
  s_barrier
  s_mov_b32 s25, 38912
  s_add_u32 m0, s23, 8192
  s_nop 0
  buffer_load_dwordx4 v6, s[32:35], s25 offen sc1 lds
  buffer_load_dwordx4 v6, s[32:35], s25 offen offset:1024 sc1 lds
  s_mov_b32 s26, 221184
  s_add_u32 m0, s24, 120832
  s_bfm_b64 exec, 16, 0
  buffer_load_dwordx4 v8, s[28:31], s26 offen sc1 lds
  s_mov_b64 exec, -1
  buffer_load_dwordx4 v8, s[28:31], s26 offen offset:256 sc1 lds
  buffer_load_dwordx4 v8, s[28:31], s26 offen offset:1280 sc1 lds
  s_waitcnt vmcnt(23)
  s_barrier
  s_mov_b32 s25, 40960
  s_add_u32 m0, s23, 16384
  s_nop 0
  buffer_load_dwordx4 v6, s[32:35], s25 offen sc1 lds
  buffer_load_dwordx4 v6, s[32:35], s25 offen offset:1024 sc1 lds
  s_mov_b32 s26, 230400
  s_add_u32 m0, s24, 130048
  s_bfm_b64 exec, 16, 0
  buffer_load_dwordx4 v8, s[28:31], s26 offen sc1 lds
  s_mov_b64 exec, -1
  buffer_load_dwordx4 v8, s[28:31], s26 offen offset:256 sc1 lds
  buffer_load_dwordx4 v8, s[28:31], s26 offen offset:1280 sc1 lds
  s_waitcnt vmcnt(23)
  s_barrier
  s_mov_b32 s25, 43008
  s_add_u32 m0, s23, 24576
  s_nop 0
  buffer_load_dwordx4 v6, s[32:35], s25 offen sc1 lds
  buffer_load_dwordx4 v6, s[32:35], s25 offen offset:1024 sc1 lds
  s_mov_b32 s26, 239616
  s_add_u32 m0, s24, 65536
  s_bfm_b64 exec, 16, 0
  buffer_load_dwordx4 v8, s[28:31], s26 offen sc1 lds
  s_mov_b64 exec, -1
  buffer_load_dwordx4 v8, s[28:31], s26 offen offset:256 sc1 lds
  buffer_load_dwordx4 v8, s[28:31], s26 offen offset:1280 sc1 lds
  s_waitcnt vmcnt(23)
  s_barrier
  s_mov_b32 s25, 45056
  s_add_u32 m0, s23, 32768
  s_nop 0
  buffer_load_dwordx4 v6, s[32:35], s25 offen sc1 lds
  buffer_load_dwordx4 v6, s[32:35], s25 offen offset:1024 sc1 lds
  s_mov_b32 s26, 248832
  s_add_u32 m0, s24, 74752
  s_bfm_b64 exec, 16, 0
  buffer_load_dwordx4 v8, s[28:31], s26 offen sc1 lds
  s_mov_b64 exec, -1
  buffer_load_dwordx4 v8, s[28:31], s26 offen offset:256 sc1 lds
  buffer_load_dwordx4 v8, s[28:31], s26 offen offset:1280 sc1 lds
  s_waitcnt vmcnt(23)
  s_barrier
  s_mov_b32 s25, 47104
  s_add_u32 m0, s23, 40960
  s_nop 0
  buffer_load_dwordx4 v6, s[32:35], s25 offen sc1 lds
  buffer_load_dwordx4 v6, s[32:35], s25 offen offset:1024 sc1 lds
  s_mov_b32 s26, 258048
  s_add_u32 m0, s24, 83968
  s_bfm_b64 exec, 16, 0
  buffer_load_dwordx4 v8, s[28:31], s26 offen sc1 lds
  s_mov_b64 exec, -1
  buffer_load_dwordx4 v8, s[28:31], s26 offen offset:256 sc1 lds
  buffer_load_dwordx4 v8, s[28:31], s26 offen offset:1280 sc1 lds
  s_waitcnt vmcnt(23)
  s_barrier
  s_mov_b32 s25, 49152
  s_add_u32 m0, s23, 0
  s_nop 0
  buffer_load_dwordx4 v6, s[32:35], s25 offen sc1 lds
  buffer_load_dwordx4 v6, s[32:35], s25 offen offset:1024 sc1 lds
  s_mov_b32 s26, 267264
  s_add_u32 m0, s24, 93184
  s_bfm_b64 exec, 16, 0
  buffer_load_dwordx4 v8, s[28:31], s26 offen sc1 lds
  s_mov_b64 exec, -1
  buffer_load_dwordx4 v8, s[28:31], s26 offen offset:256 sc1 lds
  buffer_load_dwordx4 v8, s[28:31], s26 offen offset:1280 sc1 lds
  s_waitcnt vmcnt(23)
  s_barrier
  s_mov_b32 s25, 51200
  s_add_u32 m0, s23, 8192
  s_nop 0
  buffer_load_dwordx4 v6, s[32:35], s25 offen sc1 lds
  buffer_load_dwordx4 v6, s[32:35], s25 offen offset:1024 sc1 lds
  s_mov_b32 s26, 276480
  s_add_u32 m0, s24, 49152
  s_bfm_b64 exec, 16, 0
  buffer_load_dwordx4 v8, s[28:31], s26 offen sc1 lds
  s_mov_b64 exec, -1
  buffer_load_dwordx4 v8, s[28:31], s26 offen offset:256 sc1 lds
  buffer_load_dwordx4 v8, s[28:31], s26 offen offset:1280 sc1 lds
  s_waitcnt vmcnt(23)
  s_barrier
  s_mov_b32 s25, 53248
  s_add_u32 m0, s23, 16384
  s_nop 0
  buffer_load_dwordx4 v6, s[32:35], s25 offen sc1 lds
  buffer_load_dwordx4 v6, s[32:35], s25 offen offset:1024 sc1 lds
  s_mov_b32 s26, 285696
  s_add_u32 m0, s24, 139264
  s_bfm_b64 exec, 16, 0
  buffer_load_dwordx4 v8, s[28:31], s26 offen sc1 lds
  s_mov_b64 exec, -1
  buffer_load_dwordx4 v8, s[28:31], s26 offen offset:256 sc1 lds
  buffer_load_dwordx4 v8, s[28:31], s26 offen offset:1280 sc1 lds
  s_waitcnt vmcnt(23)
  s_barrier
  s_mov_b32 s25, 55296
  s_add_u32 m0, s23, 24576
  s_nop 0
  buffer_load_dwordx4 v6, s[32:35], s25 offen sc1 lds
  buffer_load_dwordx4 v6, s[32:35], s25 offen offset:1024 sc1 lds
  s_mov_b32 s26, 294912
  s_add_u32 m0, s24, 148480
  s_bfm_b64 exec, 16, 0
  buffer_load_dwordx4 v8, s[28:31], s26 offen sc1 lds
  s_mov_b64 exec, -1
  buffer_load_dwordx4 v8, s[28:31], s26 offen offset:256 sc1 lds
  buffer_load_dwordx4 v8, s[28:31], s26 offen offset:1280 sc1 lds
  s_waitcnt vmcnt(23)
  s_barrier
  s_mov_b32 s25, 57344
  s_add_u32 m0, s23, 32768
  s_nop 0
  buffer_load_dwordx4 v6, s[32:35], s25 offen sc1 lds
  buffer_load_dwordx4 v6, s[32:35], s25 offen offset:1024 sc1 lds
  s_mov_b32 s26, 304128
  s_add_u32 m0, s24, 102400
  s_bfm_b64 exec, 16, 0
  buffer_load_dwordx4 v8, s[28:31], s26 offen sc1 lds
  s_mov_b64 exec, -1
  buffer_load_dwordx4 v8, s[28:31], s26 offen offset:256 sc1 lds
  buffer_load_dwordx4 v8, s[28:31], s26 offen offset:1280 sc1 lds
  s_waitcnt vmcnt(23)
  s_barrier
  s_mov_b32 s25, 59392
  s_add_u32 m0, s23, 40960
  s_nop 0
  buffer_load_dwordx4 v6, s[32:35], s25 offen sc1 lds
  buffer_load_dwordx4 v6, s[32:35], s25 offen offset:1024 sc1 lds
  s_mov_b32 s26, 313344
  s_add_u32 m0, s24, 111616
  s_bfm_b64 exec, 16, 0
  buffer_load_dwordx4 v8, s[28:31], s26 offen sc1 lds
  s_mov_b64 exec, -1
  buffer_load_dwordx4 v8, s[28:31], s26 offen offset:256 sc1 lds
  buffer_load_dwordx4 v8, s[28:31], s26 offen offset:1280 sc1 lds
  s_waitcnt vmcnt(23)
  s_barrier
  s_mov_b32 s25, 61440
  s_add_u32 m0, s23, 0
  s_nop 0
  buffer_load_dwordx4 v6, s[32:35], s25 offen sc1 lds
  buffer_load_dwordx4 v6, s[32:35], s25 offen offset:1024 sc1 lds
  s_mov_b32 s26, 322560
  s_add_u32 m0, s24, 120832
  s_bfm_b64 exec, 16, 0
  buffer_load_dwordx4 v8, s[28:31], s26 offen sc1 lds
  s_mov_b64 exec, -1
  buffer_load_dwordx4 v8, s[28:31], s26 offen offset:256 sc1 lds
  buffer_load_dwordx4 v8, s[28:31], s26 offen offset:1280 sc1 lds
  s_waitcnt vmcnt(23)
  s_barrier
  s_mov_b32 s25, 63488
  s_add_u32 m0, s23, 8192
  s_nop 0
  buffer_load_dwordx4 v6, s[32:35], s25 offen sc1 lds
  buffer_load_dwordx4 v6, s[32:35], s25 offen offset:1024 sc1 lds
  s_waitcnt vmcnt(20)
  s_barrier
  s_mov_b32 s25, 65536
  s_add_u32 m0, s23, 16384
  s_nop 0
  buffer_load_dwordx4 v6, s[32:35], s25 offen sc1 lds
  buffer_load_dwordx4 v6, s[32:35], s25 offen offset:1024 sc1 lds
  s_waitcnt vmcnt(17)
  s_barrier
  s_mov_b32 s25, 67584
  s_add_u32 m0, s23, 24576
  s_nop 0
  buffer_load_dwordx4 v6, s[32:35], s25 offen sc1 lds
  buffer_load_dwordx4 v6, s[32:35], s25 offen offset:1024 sc1 lds
  s_waitcnt vmcnt(14)
  s_barrier
  s_mov_b32 s25, 69632
  s_add_u32 m0, s23, 32768
  s_nop 0
  buffer_load_dwordx4 v6, s[32:35], s25 offen sc1 lds
  buffer_load_dwordx4 v6, s[32:35], s25 offen offset:1024 sc1 lds
  s_waitcnt vmcnt(11)
  s_barrier
  s_mov_b32 s25, 71680
  s_add_u32 m0, s23, 40960
  s_nop 0
  buffer_load_dwordx4 v6, s[32:35], s25 offen sc1 lds
  buffer_load_dwordx4 v6, s[32:35], s25 offen offset:1024 sc1 lds
  s_waitcnt vmcnt(8)
  s_barrier
  s_waitcnt vmcnt(6)
  s_barrier
  s_waitcnt vmcnt(4)
  s_barrier
  s_waitcnt vmcnt(2)
  s_barrier
  s_waitcnt vmcnt(0)
  s_barrier
L_k57_exit:
  s_endpgm
.section .rodata,"a"
.p2align 6
.amdhsa_kernel adaLN_cond__softmax_full_mha__mixer_gmlp__prompt_kernel
  .amdhsa_next_free_vgpr 256
  .amdhsa_next_free_sgpr 96
  .amdhsa_accum_offset 256
  .amdhsa_group_segment_fixed_size 0
  .amdhsa_kernarg_size 104
  .amdhsa_user_sgpr_count 2
  .amdhsa_user_sgpr_kernarg_segment_ptr 1
  .amdhsa_system_sgpr_workgroup_id_x 1
  .amdhsa_float_denorm_mode_32 3
.end_amdhsa_kernel
.text
L_code_end:
  s_endpgm
```
